```python
import torch

def _softmax(x, axis=-1):
    return torch.softmax(x, dim=axis)
def _gelu(x):
    return torch.nn.functional.gelu(x, approximate="tanh")
def _silu(x):
    return torch.nn.functional.silu(x)
def _sigmoid(x):
    return torch.sigmoid(x)
def _layernorm(x, axis=-1, eps=1e-5):
    m = x.mean(dim=axis, keepdim=True)
    v = x.var(dim=axis, keepdim=True, unbiased=False)
    return (x - m) / torch.sqrt(v + eps)
def _scatter_add(tgt, idx, src, axis=0):
    return tgt.clone().index_add_(axis, idx, src)
def _segment_sum(src, seg, n):
    out = torch.zeros((n,) + src.shape[1:], dtype=src.dtype)
    return out.index_add_(0, seg, src)
def _pad(x, pw):
    flat = tuple(v for pair in reversed(pw) for v in pair)
    return torch.nn.functional.pad(x, flat)

kernel_name = 'interleave_layers__linear_attn_block__glu_gated_bilinear__prompt'

def setup_inputs():

    _w = (lambda a: (lambda t: t.to(torch.bfloat16) if t.is_floating_point() else t)(torch.as_tensor(a)))
    def _A_setup():
        B, S, D = 1, 2048, 1024
        return {
            "x": _w((lambda *s: torch.randn(*s, dtype=torch.bfloat16) * 0.05)(B, S, D)),
            "wqkv": _w((lambda *s: torch.randn(*s, dtype=torch.bfloat16) * 0.05)(D, 3 * D)),
            "wo": _w((lambda *s: torch.randn(*s, dtype=torch.bfloat16) * 0.05)(D, D)),
        }
    _A_in = _A_setup()

    def _B_setup():
        B, S, D, F = 1, 2048, 1024, 3584
        return {
            "x": _w((lambda *s: torch.randn(*s, dtype=torch.bfloat16) * 0.05)(B, S, D)),
            "w_gate": _w((lambda *s: torch.randn(*s, dtype=torch.bfloat16) * 0.8)(D, F) * (D ** -0.5)),
            "w_up": _w((lambda *s: torch.randn(*s, dtype=torch.bfloat16) * 0.8)(D, F) * (D ** -0.5)),
            "w_down": _w((lambda *s: torch.randn(*s, dtype=torch.bfloat16) * 0.8)(F, D) * (F ** -0.5)),
        }
    _B_in = _B_setup()

    return {
        "A_x": _A_in["x"],
        "A_wqkv": _A_in["wqkv"],
        "A_wo": _A_in["wo"],
        "B_x": _B_in["x"],
        "B_w_gate": _B_in["w_gate"],
        "B_w_up": _B_in["w_up"],
        "B_w_down": _B_in["w_down"],
    }

def reference(A_x, A_wqkv, A_wo, B_x, B_w_gate, B_w_up, B_w_down):
    def _A_ref(x, wqkv, wo):
        B, S, D = x.shape
        H = 32; Dh = D // H
        qkv = (lambda x, *d: x.permute(*d))((x @ wqkv).reshape(B, S, 3, H, Dh), 2, 0, 3, 1, 4)
        q, k, v = qkv[0], qkv[1], qkv[2]
        phi = lambda t: torch.where(t > 0, t + 1, torch.exp(t)) + 1e-6
        pq, pk = phi(q), phi(k)
        kv = torch.einsum("bhsd,bhse->bhde", pk, v)
        z = torch.einsum("bhsd->bhd", pk)
        num = torch.einsum("bhqd,bhde->bhqe", pq, kv)
        den = torch.einsum("bhqd,bhd->bhq", pq, z)[..., None] + 1e-6
        o = num / den
        return (lambda x, *d: x.permute(*d))(o, 0, 2, 1, 3).reshape(B, S, D) @ wo

    def _B_ref(x, w_gate, w_up, w_down):
        g = torch.einsum("bsd,df->bsf", x, w_gate)
        u = torch.einsum("bsd,df->bsf", x, w_up)
        h = g * u
        return torch.einsum("bsf,fd->bsd", h, w_down)

    x = A_x
    x = x + _A_ref(_layernorm(x, axis=-1), A_wqkv, A_wo)
    x = x + _B_ref(_layernorm(x, axis=-1), B_w_gate, B_w_up, B_w_down)
    x = x + _A_ref(_layernorm(x, axis=-1), A_wqkv, A_wo)
    x = x + _B_ref(_layernorm(x, axis=-1), B_w_gate, B_w_up, B_w_down)
    return x
```

```asm
; @launch grid=(256,1,1) block=(256,1,1) lds=159744
.amdgcn_target "amdgcn-amd-amdhsa--gfx950"
.text
.globl interleave_layers__linear_attn_block__glu_gated_bilinear__prompt_kernel
.p2align 8
.type interleave_layers__linear_attn_block__glu_gated_bilinear__prompt_kernel,@function
interleave_layers__linear_attn_block__glu_gated_bilinear__prompt_kernel:
    s_cmp_ge_u32 s2, 256
    s_cbranch_scc0 S_interleave_layers__linear_attn_block__glu_gated_bilinear__prompt_kernel
    s_endpgm
S_interleave_layers__linear_attn_block__glu_gated_bilinear__prompt_kernel:
    s_load_dwordx2 s[32:33], s[0:1], 72
    s_load_dwordx4 s[28:31], s[0:1], 48
    s_load_dwordx4 s[4:7], s[0:1], 0
    s_load_dwordx2 s[8:9], s[0:1], 16
    s_load_dwordx4 s[12:15], s[0:1], 32
    s_load_dwordx2 s[20:21], s[0:1], 64
    v_lshrrev_b32 v1, 6, v0
    s_nop 0
    v_readfirstlane_b32 s34, v1
    v_mbcnt_lo_u32_b32 v1, -1, 0
    v_mbcnt_hi_u32_b32 v1, -1, v1
    s_cmp_lt_u32 s2, 192
    s_cselect_b32 s25, 6144, 0
    s_cselect_b32 s26, 0, 2048
    s_add_u32 s25, s25, s26
    v_lshrrev_b32 v5, 3, v1
    v_bfe_u32 v6, v1, 4, 2
    v_lshlrev_b32 v6, 1, v6
    v_and_b32 v9, 7, v1
    v_xor_b32 v6, v6, v9
    v_lshlrev_b32 v6, 4, v6
    v_mul_u32_u24 v5, s25, v5
    v_add_u32 v3, v5, v6
    v_lshrrev_b32 v5, 3, v1
    v_bfe_u32 v6, v1, 4, 2
    v_lshlrev_b32 v6, 1, v6
    v_and_b32 v9, 7, v1
    v_xor_b32 v6, v6, v9
    v_lshlrev_b32 v6, 4, v6
    v_mul_u32_u24 v5, 7168, v5
    v_add_u32 v4, v5, v6
    s_mul_i32 s36, s2, 1366
    s_lshr_b32 s36, s36, 16
    s_mul_i32 s22, s36, 48
    s_sub_u32 s22, s2, s22
    s_sub_u32 s26, s2, 192
    s_lshr_b32 s26, s26, 4
    s_and_b32 s27, s2, 15
    s_cmp_lt_u32 s2, 192
    s_cselect_b32 s36, s36, s26
    s_cselect_b32 s22, s22, s27
    s_lshl_b32 s36, s36, 2
    s_add_u32 s36, s36, s34
    s_lshl_b32 s23, s22, 7
    s_lshl_b32 s24, s25, 6
    s_mul_i32 s24, s24, s36
    s_add_u32 s23, s23, s24
    s_lshl_b32 s24, s25, 3
    s_mul_i32 s35, s34, 24576
    s_waitcnt lgkmcnt(0)
    s_mov_b32 s44, s32
    s_mov_b32 s45, s33
    s_mov_b32 s46, 63963136
    s_mov_b32 s47, 0x20000
    s_cmp_lt_u32 s2, 192
    s_cselect_b32 s48, s6, s8
    s_cselect_b32 s49, s7, s9
    s_lshl_b32 s50, s25, 10
    s_mov_b32 s51, 0x20000
    s_add_u32 m0, s35, 0
    s_nop 0
    buffer_load_dwordx4 v3, s[48:51], s23 offen nt lds
    s_add_u32 m0, s35, 1024
    s_add_u32 s23, s23, s24
    buffer_load_dwordx4 v3, s[48:51], s23 offen nt lds
    s_add_u32 m0, s35, 2048
    s_add_u32 s23, s23, s24
    buffer_load_dwordx4 v3, s[48:51], s23 offen nt lds
    s_add_u32 m0, s35, 3072
    s_add_u32 s23, s23, s24
    buffer_load_dwordx4 v3, s[48:51], s23 offen nt lds
    s_add_u32 m0, s35, 4096
    s_add_u32 s23, s23, s24
    buffer_load_dwordx4 v3, s[48:51], s23 offen nt lds
    s_add_u32 m0, s35, 5120
    s_add_u32 s23, s23, s24
    buffer_load_dwordx4 v3, s[48:51], s23 offen nt lds
    s_add_u32 m0, s35, 6144
    s_add_u32 s23, s23, s24
    buffer_load_dwordx4 v3, s[48:51], s23 offen nt lds
    s_add_u32 m0, s35, 7168
    s_add_u32 s23, s23, s24
    buffer_load_dwordx4 v3, s[48:51], s23 offen nt lds
    s_lshl_b32 s37, s2, 2
    s_add_u32 s37, s37, s34
    s_lshr_b32 s38, s37, 3
    s_and_b32 s39, s37, 7
    v_and_b32 v5, 15, v1
    v_lshrrev_b32 v6, 4, v1
    v_lshlrev_b32 v9, 11, v5
    v_and_b32 v10, 1, v6
    v_lshl_add_u32 v9, v10, 5, v9
    v_lshrrev_b32 v10, 1, v6
    v_lshl_add_u32 v9, v10, 4, v9
    s_lshl_b32 s40, s38, 15
    s_lshl_b32 s41, s39, 8
    s_add_u32 s41, s41, s40
    s_mov_b32 s52, s4
    s_mov_b32 s53, s5
    s_mov_b32 s54, 4194304
    s_mov_b32 s55, 0x20000
    buffer_load_dwordx4 v[64:67], v9, s[52:55], s41 offen offset:0 nt
    buffer_load_dwordx4 v[68:71], v9, s[52:55], s41 offen offset:64 nt
    buffer_load_dwordx4 v[72:75], v9, s[52:55], s41 offen offset:128 nt
    buffer_load_dwordx4 v[76:79], v9, s[52:55], s41 offen offset:192 nt
    v_and_b32 v10, 1, v6
    v_lshlrev_b32 v11, 4, v5
    v_lshl_add_u32 v11, v10, 8, v11
    v_cmp_eq_u32 s[62:63], 0, v10
    s_lshr_b32 s42, s2, 4
    s_mov_b32 s58, 0
    s_mov_b32 s59, 0x20000
    s_and_b32 s16, s22, 15
    s_mul_i32 s17, s16, 393216
    s_lshr_b32 s18, s22, 4
    s_lshl_b32 s19, s36, 14
    s_sub_u32 s26, s18, 1
    s_lshl_b32 s26, s26, 13
    s_add_u32 s19, s19, s26
    s_lshl_b32 s26, s36, 11
    s_add_u32 s26, s26, 262144
    s_cmp_eq_u32 s18, 0
    s_cselect_b32 s19, s26, s19
    s_cselect_b32 s27, 16, 1
    s_add_u32 s17, s17, s19
    s_add_u32 s17, s17, 23068672
    s_lshl_b32 s19, s16, 17
    s_lshl_b32 s26, s36, 13
    s_add_u32 s19, s19, s26
    s_add_u32 s19, s19, 29360128
    s_cmp_lt_u32 s2, 192
    s_cselect_b32 s84, s17, s19
    s_cselect_b32 s27, s27, 1
    s_lshl_b32 s27, s27, 11
    s_add_u32 s85, s84, s27
    s_add_u32 s86, s85, s27
    s_add_u32 s87, s86, s27
    s_lshr_b32 s18, s2, 3
    s_and_b32 s18, s18, 31
    s_lshl_b32 s18, s18, 10
    v_and_b32 v24, 7, v1
    v_lshlrev_b32 v24, 7, v24
    v_add_u32 v24, s18, v24
    s_getpc_b64 s[16:17]
    s_add_u32 s16, s16, PH_a0@rel32@lo+4
    s_addc_u32 s17, s17, PH_a0@rel32@hi+12
    v_min_u32 v25, END_PH_a0-PH_a0-4, v24
    global_load_dword v25, v25, s[16:17]
    s_and_b32 s43, s2, 15
    s_mul_i32 s43, s43, 7
    s_add_u32 s43, s43, s34
    s_cmp_ge_u32 s43, 56
    s_cselect_b32 s56, s14, s12
    s_cselect_b32 s57, s15, s13
    s_cselect_b32 s26, 56, 0
    s_cselect_b32 s27, 2048, 0
    s_sub_u32 s26, s43, s26
    s_lshl_b32 s23, s26, 7
    s_mul_i32 s24, s42, 458752
    s_add_u32 s23, s23, s24
    s_mul_i32 s24, s42, 28672
    s_add_u32 s27, s27, s24
    s_add_u32 s27, s27, 31457280
    s_mov_b32 s58, 7340032
    s_add_u32 m0, s35, 8192
    s_nop 0
    buffer_load_dwordx4 v4, s[56:59], s23 offen nt lds
    s_add_u32 m0, s35, 9216
    s_add_u32 s23, s23, 57344
    buffer_load_dwordx4 v4, s[56:59], s23 offen nt lds
    s_add_u32 m0, s35, 10240
    s_add_u32 s23, s23, 57344
    buffer_load_dwordx4 v4, s[56:59], s23 offen nt lds
    s_add_u32 m0, s35, 11264
    s_add_u32 s23, s23, 57344
    buffer_load_dwordx4 v4, s[56:59], s23 offen nt lds
    s_add_u32 m0, s35, 12288
    s_add_u32 s23, s23, 57344
    buffer_load_dwordx4 v4, s[56:59], s23 offen nt lds
    s_add_u32 m0, s35, 13312
    s_add_u32 s23, s23, 57344
    buffer_load_dwordx4 v4, s[56:59], s23 offen nt lds
    s_add_u32 m0, s35, 14336
    s_add_u32 s23, s23, 57344
    buffer_load_dwordx4 v4, s[56:59], s23 offen nt lds
    s_add_u32 m0, s35, 15360
    s_add_u32 s23, s23, 57344
    buffer_load_dwordx4 v4, s[56:59], s23 offen nt lds
    s_lshl_b32 s16, s26, 2
    s_add_u32 s16, s16, 0
    s_mul_i32 s17, s16, 9363
    s_lshr_b32 s17, s17, 16
    s_mul_i32 s18, s17, 7
    s_sub_u32 s18, s16, s18
    s_and_b32 s19, s17, 1
    s_mul_i32 s19, s19, 6
    s_add_u32 s18, s18, s19
    s_sub_u32 s19, s18, 7
    s_min_u32 s18, s18, s19
    s_lshl_b32 s18, s18, 12
    s_mul_i32 s17, s17, 458752
    s_add_u32 s89, s17, s18
    s_add_u32 s89, s89, s27
    s_lshl_b32 s16, s26, 2
    s_add_u32 s16, s16, 1
    s_mul_i32 s17, s16, 9363
    s_lshr_b32 s17, s17, 16
    s_mul_i32 s18, s17, 7
    s_sub_u32 s18, s16, s18
    s_and_b32 s19, s17, 1
    s_mul_i32 s19, s19, 6
    s_add_u32 s18, s18, s19
    s_sub_u32 s19, s18, 7
    s_min_u32 s18, s18, s19
    s_lshl_b32 s18, s18, 12
    s_mul_i32 s17, s17, 458752
    s_add_u32 s90, s17, s18
    s_add_u32 s90, s90, s27
    s_lshl_b32 s16, s26, 2
    s_add_u32 s16, s16, 2
    s_mul_i32 s17, s16, 9363
    s_lshr_b32 s17, s17, 16
    s_mul_i32 s18, s17, 7
    s_sub_u32 s18, s16, s18
    s_and_b32 s19, s17, 1
    s_mul_i32 s19, s19, 6
    s_add_u32 s18, s18, s19
    s_sub_u32 s19, s18, 7
    s_min_u32 s18, s18, s19
    s_lshl_b32 s18, s18, 12
    s_mul_i32 s17, s17, 458752
    s_add_u32 s91, s17, s18
    s_add_u32 s91, s91, s27
    s_lshl_b32 s16, s26, 2
    s_add_u32 s16, s16, 3
    s_mul_i32 s17, s16, 9363
    s_lshr_b32 s17, s17, 16
    s_mul_i32 s18, s17, 7
    s_sub_u32 s18, s16, s18
    s_and_b32 s19, s17, 1
    s_mul_i32 s19, s19, 6
    s_add_u32 s18, s18, s19
    s_sub_u32 s19, s18, 7
    s_min_u32 s18, s18, s19
    s_lshl_b32 s18, s18, 12
    s_mul_i32 s17, s17, 458752
    s_add_u32 s92, s17, s18
    s_add_u32 s92, s92, s27
    s_mul_i32 s93, s42, 28672
    s_lshl_b32 s16, s43, 8
    s_add_u32 s93, s93, s16
    s_add_u32 s93, s93, 54394880
    v_lshrrev_b32 v5, 2, v1
    v_lshlrev_b32 v5, 7, v5
    v_and_b32 v6, 3, v1
    v_lshl_add_u32 v5, v6, 3, v5
    v_bfe_u32 v6, v1, 3, 2
    v_xor_b32 v9, 0, v6
    v_lshl_add_u32 v16, v9, 5, v5
    v_xor_b32 v9, 1, v6
    v_lshl_add_u32 v17, v9, 5, v5
    v_xor_b32 v9, 2, v6
    v_lshl_add_u32 v18, v9, 5, v5
    v_xor_b32 v9, 3, v6
    v_lshl_add_u32 v19, v9, 5, v5
    v_add_u32 v16, s35, v16
    v_add_u32 v17, s35, v17
    v_add_u32 v18, s35, v18
    v_add_u32 v19, s35, v19
    v_lshlrev_b32 v7, 4, v1
    v_lshlrev_b32 v2, 2, v1
    v_mov_b32 v12, 0x3f803f80
    v_mov_b32 v13, 0x3f803f80
    v_mov_b32 v14, 0x3f803f80
    v_mov_b32 v15, 0x3f803f80
    v_cmp_gt_u32 s[10:11], 16, v1
    v_cmp_gt_u32 s[60:61], 32, v1
    v_cmp_gt_u32 vcc, 48, v1
    v_mov_b32 v20, 0
    v_mov_b32 v21, 0
    v_mov_b32 v22, 0
    v_mov_b32 v23, 0
    s_mul_i32 s16, s37, 288
    s_add_u32 s16, s16, 54067200
    s_mov_b32 exec_lo, 262143
    s_mov_b32 exec_hi, 0
    buffer_store_dwordx4 v[20:23], v7, s[44:47], s16 offen sc1
    s_mov_b64 exec, -1
    s_waitcnt vmcnt(14)
    ds_read_b64_tr_b16 v[96:97], v16 offset:0
    ds_read_b64_tr_b16 v[98:99], v16 offset:2048
    ds_read_b64_tr_b16 v[100:101], v16 offset:4096
    ds_read_b64_tr_b16 v[102:103], v16 offset:6144
    ds_read_b64_tr_b16 v[104:105], v17 offset:0
    ds_read_b64_tr_b16 v[106:107], v17 offset:2048
    ds_read_b64_tr_b16 v[108:109], v17 offset:4096
    ds_read_b64_tr_b16 v[110:111], v17 offset:6144
    ds_read_b64_tr_b16 v[112:113], v18 offset:0
    ds_read_b64_tr_b16 v[114:115], v18 offset:2048
    ds_read_b64_tr_b16 v[116:117], v18 offset:4096
    ds_read_b64_tr_b16 v[118:119], v18 offset:6144
    ds_read_b64_tr_b16 v[120:121], v19 offset:0
    ds_read_b64_tr_b16 v[122:123], v19 offset:2048
    ds_read_b64_tr_b16 v[124:125], v19 offset:4096
    ds_read_b64_tr_b16 v[126:127], v19 offset:6144
    s_waitcnt lgkmcnt(14)
    buffer_store_dwordx4 v[96:99], v7, s[44:47], s84 offen offset:0 sc1
    v_mfma_f32_16x16x32_bf16 v[128:131], v[12:15], v[96:99], 0
    s_waitcnt lgkmcnt(12)
    buffer_store_dwordx4 v[100:103], v7, s[44:47], s84 offen offset:1024 sc1
    v_mfma_f32_16x16x32_bf16 v[128:131], v[12:15], v[100:103], v[128:131]
    s_waitcnt lgkmcnt(10)
    buffer_store_dwordx4 v[104:107], v7, s[44:47], s85 offen offset:0 sc1
    v_mfma_f32_16x16x32_bf16 v[132:135], v[12:15], v[104:107], 0
    s_waitcnt lgkmcnt(8)
    buffer_store_dwordx4 v[108:111], v7, s[44:47], s85 offen offset:1024 sc1
    v_mfma_f32_16x16x32_bf16 v[132:135], v[12:15], v[108:111], v[132:135]
    s_waitcnt lgkmcnt(6)
    buffer_store_dwordx4 v[112:115], v7, s[44:47], s86 offen offset:0 sc1
    v_mfma_f32_16x16x32_bf16 v[136:139], v[12:15], v[112:115], 0
    s_waitcnt lgkmcnt(4)
    buffer_store_dwordx4 v[116:119], v7, s[44:47], s86 offen offset:1024 sc1
    v_mfma_f32_16x16x32_bf16 v[136:139], v[12:15], v[116:119], v[136:139]
    s_waitcnt lgkmcnt(2)
    buffer_store_dwordx4 v[120:123], v7, s[44:47], s87 offen offset:0 sc1
    v_mfma_f32_16x16x32_bf16 v[140:143], v[12:15], v[120:123], 0
    s_waitcnt lgkmcnt(0)
    buffer_store_dwordx4 v[124:127], v7, s[44:47], s87 offen offset:1024 sc1
    v_mfma_f32_16x16x32_bf16 v[140:143], v[12:15], v[124:127], v[140:143]
    s_nop 7
    v_cndmask_b32 v136, v140, v136, vcc
    v_cndmask_b32 v132, v136, v132, s[60:61]
    v_cndmask_b32 v128, v132, v128, s[10:11]
    s_lshl_b32 s16, s34, 8
    s_add_u32 s16, s16, 98304
    v_add_u32 v24, s16, v2
    ds_write_b32 v24, v128
    v_mov_b32 v80, 0
    v_mov_b32 v81, 0
    v_mov_b32 v82, 0
    v_mov_b32 v83, 0
    s_lshl_b32 s41, s39, 12
    s_add_u32 s41, s41, s40
    s_waitcnt vmcnt(18)
    v_permlane16_swap_b32 v64, v66
    v_permlane16_swap_b32 v65, v67
    buffer_store_dwordx4 v[64:67], v7, s[44:47], s41 offen offset:0 sc1
    v_dot2_f32_bf16 v80, v64, v12, v80
    v_dot2_f32_bf16 v81, v64, v64, v81
    v_dot2_f32_bf16 v80, v65, v12, v80
    v_dot2_f32_bf16 v81, v65, v65, v81
    v_dot2_f32_bf16 v80, v66, v12, v80
    v_dot2_f32_bf16 v81, v66, v66, v81
    v_dot2_f32_bf16 v80, v67, v12, v80
    v_dot2_f32_bf16 v81, v67, v67, v81
    v_permlane16_swap_b32 v68, v70
    v_permlane16_swap_b32 v69, v71
    buffer_store_dwordx4 v[68:71], v7, s[44:47], s41 offen offset:1024 sc1
    v_dot2_f32_bf16 v80, v68, v12, v80
    v_dot2_f32_bf16 v81, v68, v68, v81
    v_dot2_f32_bf16 v80, v69, v12, v80
    v_dot2_f32_bf16 v81, v69, v69, v81
    v_dot2_f32_bf16 v80, v70, v12, v80
    v_dot2_f32_bf16 v81, v70, v70, v81
    v_dot2_f32_bf16 v80, v71, v12, v80
    v_dot2_f32_bf16 v81, v71, v71, v81
    v_permlane16_swap_b32 v72, v74
    v_permlane16_swap_b32 v73, v75
    buffer_store_dwordx4 v[72:75], v7, s[44:47], s41 offen offset:2048 sc1
    v_dot2_f32_bf16 v82, v72, v12, v82
    v_dot2_f32_bf16 v83, v72, v72, v83
    v_dot2_f32_bf16 v82, v73, v12, v82
    v_dot2_f32_bf16 v83, v73, v73, v83
    v_dot2_f32_bf16 v82, v74, v12, v82
    v_dot2_f32_bf16 v83, v74, v74, v83
    v_dot2_f32_bf16 v82, v75, v12, v82
    v_dot2_f32_bf16 v83, v75, v75, v83
    v_permlane16_swap_b32 v76, v78
    v_permlane16_swap_b32 v77, v79
    buffer_store_dwordx4 v[76:79], v7, s[44:47], s41 offen offset:3072 sc1
    v_dot2_f32_bf16 v82, v76, v12, v82
    v_dot2_f32_bf16 v83, v76, v76, v83
    v_dot2_f32_bf16 v82, v77, v12, v82
    v_dot2_f32_bf16 v83, v77, v77, v83
    v_dot2_f32_bf16 v82, v78, v12, v82
    v_dot2_f32_bf16 v83, v78, v78, v83
    v_dot2_f32_bf16 v82, v79, v12, v82
    v_dot2_f32_bf16 v83, v79, v79, v83
    s_nop 2
    v_mov_b32 v84, v80
    v_mov_b32 v85, v81
    v_mov_b32 v86, v82
    v_mov_b32 v87, v83
    v_permlane32_swap_b32 v80, v84
    v_permlane32_swap_b32 v81, v85
    v_permlane32_swap_b32 v82, v86
    v_permlane32_swap_b32 v83, v87
    v_add_f32 v80, v80, v84
    v_add_f32 v81, v81, v85
    v_add_f32 v82, v82, v86
    v_add_f32 v83, v83, v87
    v_mov_b32 v84, v80
    v_mov_b32 v85, v81
    v_mov_b32 v86, v82
    v_mov_b32 v87, v83
    v_permlane16_swap_b32 v80, v84
    v_permlane16_swap_b32 v81, v85
    v_permlane16_swap_b32 v82, v86
    v_permlane16_swap_b32 v83, v87
    v_add_f32 v80, v80, v84
    v_add_f32 v81, v81, v85
    v_add_f32 v82, v82, v86
    v_add_f32 v83, v83, v87
    v_cndmask_b32 v80, v82, v80, s[62:63]
    v_cndmask_b32 v81, v83, v81, s[62:63]
    s_lshr_b32 s16, s38, 1
    s_lshl_b32 s16, s16, 12
    s_lshl_b32 s17, s39, 9
    s_add_u32 s16, s16, s17
    s_and_b32 s17, s38, 1
    s_lshl_b32 s17, s17, 3
    s_add_u32 s16, s16, s17
    s_add_u32 s16, s16, 53477376
    buffer_store_dwordx2 v[80:81], v11, s[44:47], s16 offen sc1
    s_waitcnt lgkmcnt(0)
    s_barrier
    v_add_u32 v24, 98304, v2
    ds_read_b32 v26, v24 offset:0
    ds_read_b32 v27, v24 offset:256
    ds_read_b32 v28, v24 offset:512
    ds_read_b32 v29, v24 offset:768
    s_lshl_b32 s16, s2, 8
    s_add_u32 s16, s16, 54853632
    s_cmp_lt_u32 s2, 192
    s_cselect_b32 s16, s16, 0x7ff00000
    s_waitcnt lgkmcnt(0)
    v_add_f32 v26, v26, v27
    v_add_f32 v28, v28, v29
    v_add_f32 v26, v26, v28
    buffer_store_dword v26, v2, s[44:47], s16 offen sc1
    s_waitcnt vmcnt(15)
    ds_read_b64_tr_b16 v[144:145], v16 offset:8192
    ds_read_b64_tr_b16 v[146:147], v16 offset:10240
    ds_read_b64_tr_b16 v[148:149], v16 offset:12288
    ds_read_b64_tr_b16 v[150:151], v16 offset:14336
    ds_read_b64_tr_b16 v[152:153], v17 offset:8192
    ds_read_b64_tr_b16 v[154:155], v17 offset:10240
    ds_read_b64_tr_b16 v[156:157], v17 offset:12288
    ds_read_b64_tr_b16 v[158:159], v17 offset:14336
    ds_read_b64_tr_b16 v[160:161], v18 offset:8192
    ds_read_b64_tr_b16 v[162:163], v18 offset:10240
    ds_read_b64_tr_b16 v[164:165], v18 offset:12288
    ds_read_b64_tr_b16 v[166:167], v18 offset:14336
    ds_read_b64_tr_b16 v[168:169], v19 offset:8192
    ds_read_b64_tr_b16 v[170:171], v19 offset:10240
    ds_read_b64_tr_b16 v[172:173], v19 offset:12288
    ds_read_b64_tr_b16 v[174:175], v19 offset:14336
    s_waitcnt lgkmcnt(14)
    buffer_store_dwordx4 v[144:147], v7, s[44:47], s89 offen offset:0 sc1
    v_mfma_f32_16x16x32_bf16 v[176:179], v[12:15], v[144:147], 0
    s_waitcnt lgkmcnt(12)
    buffer_store_dwordx4 v[148:151], v7, s[44:47], s89 offen offset:1024 sc1
    v_mfma_f32_16x16x32_bf16 v[176:179], v[12:15], v[148:151], v[176:179]
    s_waitcnt lgkmcnt(10)
    buffer_store_dwordx4 v[152:155], v7, s[44:47], s90 offen offset:0 sc1
    v_mfma_f32_16x16x32_bf16 v[180:183], v[12:15], v[152:155], 0
    s_waitcnt lgkmcnt(8)
    buffer_store_dwordx4 v[156:159], v7, s[44:47], s90 offen offset:1024 sc1
    v_mfma_f32_16x16x32_bf16 v[180:183], v[12:15], v[156:159], v[180:183]
    s_waitcnt lgkmcnt(6)
    buffer_store_dwordx4 v[160:163], v7, s[44:47], s91 offen offset:0 sc1
    v_mfma_f32_16x16x32_bf16 v[184:187], v[12:15], v[160:163], 0
    s_waitcnt lgkmcnt(4)
    buffer_store_dwordx4 v[164:167], v7, s[44:47], s91 offen offset:1024 sc1
    v_mfma_f32_16x16x32_bf16 v[184:187], v[12:15], v[164:167], v[184:187]
    s_waitcnt lgkmcnt(2)
    buffer_store_dwordx4 v[168:171], v7, s[44:47], s92 offen offset:0 sc1
    v_mfma_f32_16x16x32_bf16 v[188:191], v[12:15], v[168:171], 0
    s_waitcnt lgkmcnt(0)
    buffer_store_dwordx4 v[172:175], v7, s[44:47], s92 offen offset:1024 sc1
    v_mfma_f32_16x16x32_bf16 v[188:191], v[12:15], v[172:175], v[188:191]
    s_nop 7
    v_cndmask_b32 v184, v188, v184, vcc
    v_cndmask_b32 v180, v184, v180, s[60:61]
    v_cndmask_b32 v176, v180, v176, s[10:11]
    buffer_store_dword v176, v2, s[44:47], s93 offen sc1
    s_mov_b32 s52, s20
    s_mov_b32 s53, s21
    s_mov_b32 s54, 256
    s_mov_b32 s55, 0x20000
    v_min_u32 v24, 1, v1
    v_lshlrev_b32 v24, 26, v24
    v_mov_b32 v25, 1
    s_and_b32 s16, s2, 3
    s_lshl_b32 s16, s16, 6
    s_cmp_eq_u32 s34, 0
    s_cselect_b32 s16, s16, 0x7ff00000
    s_waitcnt vmcnt(0)
    s_barrier
    buffer_atomic_add v25, v24, s[52:55], s16 offen sc1
    s_and_b32 s43, s2, 15
    s_mul_i32 s43, s43, 7
    s_add_u32 s43, s43, s34
    s_add_u32 s43, s43, 4
    s_cmp_ge_u32 s43, 56
    s_cselect_b32 s56, s14, s12
    s_cselect_b32 s57, s15, s13
    s_cselect_b32 s26, 56, 0
    s_cselect_b32 s27, 2048, 0
    s_sub_u32 s26, s43, s26
    s_lshl_b32 s23, s26, 7
    s_mul_i32 s24, s42, 458752
    s_add_u32 s23, s23, s24
    s_mul_i32 s24, s42, 28672
    s_add_u32 s27, s27, s24
    s_add_u32 s27, s27, 31457280
    s_mov_b32 s58, 7340032
    s_cmp_eq_u32 s34, 3
    s_cselect_b32 s58, 0, s58
    s_cselect_b32 s27, 0x7ff00000, s27
    s_add_u32 m0, s35, 16384
    s_nop 0
    buffer_load_dwordx4 v4, s[56:59], s23 offen nt lds
    s_add_u32 m0, s35, 17408
    s_add_u32 s23, s23, 57344
    buffer_load_dwordx4 v4, s[56:59], s23 offen nt lds
    s_add_u32 m0, s35, 18432
    s_add_u32 s23, s23, 57344
    buffer_load_dwordx4 v4, s[56:59], s23 offen nt lds
    s_add_u32 m0, s35, 19456
    s_add_u32 s23, s23, 57344
    buffer_load_dwordx4 v4, s[56:59], s23 offen nt lds
    s_add_u32 m0, s35, 20480
    s_add_u32 s23, s23, 57344
    buffer_load_dwordx4 v4, s[56:59], s23 offen nt lds
    s_add_u32 m0, s35, 21504
    s_add_u32 s23, s23, 57344
    buffer_load_dwordx4 v4, s[56:59], s23 offen nt lds
    s_add_u32 m0, s35, 22528
    s_add_u32 s23, s23, 57344
    buffer_load_dwordx4 v4, s[56:59], s23 offen nt lds
    s_add_u32 m0, s35, 23552
    s_add_u32 s23, s23, 57344
    buffer_load_dwordx4 v4, s[56:59], s23 offen nt lds
    s_lshl_b32 s16, s26, 2
    s_add_u32 s16, s16, 0
    s_mul_i32 s17, s16, 9363
    s_lshr_b32 s17, s17, 16
    s_mul_i32 s18, s17, 7
    s_sub_u32 s18, s16, s18
    s_and_b32 s19, s17, 1
    s_mul_i32 s19, s19, 6
    s_add_u32 s18, s18, s19
    s_sub_u32 s19, s18, 7
    s_min_u32 s18, s18, s19
    s_lshl_b32 s18, s18, 12
    s_mul_i32 s17, s17, 458752
    s_add_u32 s94, s17, s18
    s_add_u32 s94, s94, s27
    s_lshl_b32 s16, s26, 2
    s_add_u32 s16, s16, 1
    s_mul_i32 s17, s16, 9363
    s_lshr_b32 s17, s17, 16
    s_mul_i32 s18, s17, 7
    s_sub_u32 s18, s16, s18
    s_and_b32 s19, s17, 1
    s_mul_i32 s19, s19, 6
    s_add_u32 s18, s18, s19
    s_sub_u32 s19, s18, 7
    s_min_u32 s18, s18, s19
    s_lshl_b32 s18, s18, 12
    s_mul_i32 s17, s17, 458752
    s_add_u32 s95, s17, s18
    s_add_u32 s95, s95, s27
    s_lshl_b32 s16, s26, 2
    s_add_u32 s16, s16, 2
    s_mul_i32 s17, s16, 9363
    s_lshr_b32 s17, s17, 16
    s_mul_i32 s18, s17, 7
    s_sub_u32 s18, s16, s18
    s_and_b32 s19, s17, 1
    s_mul_i32 s19, s19, 6
    s_add_u32 s18, s18, s19
    s_sub_u32 s19, s18, 7
    s_min_u32 s18, s18, s19
    s_lshl_b32 s18, s18, 12
    s_mul_i32 s17, s17, 458752
    s_add_u32 s96, s17, s18
    s_add_u32 s96, s96, s27
    s_lshl_b32 s16, s26, 2
    s_add_u32 s16, s16, 3
    s_mul_i32 s17, s16, 9363
    s_lshr_b32 s17, s17, 16
    s_mul_i32 s18, s17, 7
    s_sub_u32 s18, s16, s18
    s_and_b32 s19, s17, 1
    s_mul_i32 s19, s19, 6
    s_add_u32 s18, s18, s19
    s_sub_u32 s19, s18, 7
    s_min_u32 s18, s18, s19
    s_lshl_b32 s18, s18, 12
    s_mul_i32 s17, s17, 458752
    s_add_u32 s97, s17, s18
    s_add_u32 s97, s97, s27
    s_mul_i32 s98, s42, 28672
    s_lshl_b32 s16, s43, 8
    s_add_u32 s98, s98, s16
    s_add_u32 s98, s98, 54394880
    s_cmp_eq_u32 s34, 3
    s_cselect_b32 s98, 0x7ff00000, s98
    s_waitcnt vmcnt(0)
    ds_read_b64_tr_b16 v[96:97], v16 offset:16384
    ds_read_b64_tr_b16 v[98:99], v16 offset:18432
    ds_read_b64_tr_b16 v[100:101], v16 offset:20480
    ds_read_b64_tr_b16 v[102:103], v16 offset:22528
    ds_read_b64_tr_b16 v[104:105], v17 offset:16384
    ds_read_b64_tr_b16 v[106:107], v17 offset:18432
    ds_read_b64_tr_b16 v[108:109], v17 offset:20480
    ds_read_b64_tr_b16 v[110:111], v17 offset:22528
    ds_read_b64_tr_b16 v[112:113], v18 offset:16384
    ds_read_b64_tr_b16 v[114:115], v18 offset:18432
    ds_read_b64_tr_b16 v[116:117], v18 offset:20480
    ds_read_b64_tr_b16 v[118:119], v18 offset:22528
    ds_read_b64_tr_b16 v[120:121], v19 offset:16384
    ds_read_b64_tr_b16 v[122:123], v19 offset:18432
    ds_read_b64_tr_b16 v[124:125], v19 offset:20480
    ds_read_b64_tr_b16 v[126:127], v19 offset:22528
    s_waitcnt lgkmcnt(14)
    buffer_store_dwordx4 v[96:99], v7, s[44:47], s94 offen offset:0 sc1
    v_mfma_f32_16x16x32_bf16 v[128:131], v[12:15], v[96:99], 0
    s_waitcnt lgkmcnt(12)
    buffer_store_dwordx4 v[100:103], v7, s[44:47], s94 offen offset:1024 sc1
    v_mfma_f32_16x16x32_bf16 v[128:131], v[12:15], v[100:103], v[128:131]
    s_waitcnt lgkmcnt(10)
    buffer_store_dwordx4 v[104:107], v7, s[44:47], s95 offen offset:0 sc1
    v_mfma_f32_16x16x32_bf16 v[132:135], v[12:15], v[104:107], 0
    s_waitcnt lgkmcnt(8)
    buffer_store_dwordx4 v[108:111], v7, s[44:47], s95 offen offset:1024 sc1
    v_mfma_f32_16x16x32_bf16 v[132:135], v[12:15], v[108:111], v[132:135]
    s_waitcnt lgkmcnt(6)
    buffer_store_dwordx4 v[112:115], v7, s[44:47], s96 offen offset:0 sc1
    v_mfma_f32_16x16x32_bf16 v[136:139], v[12:15], v[112:115], 0
    s_waitcnt lgkmcnt(4)
    buffer_store_dwordx4 v[116:119], v7, s[44:47], s96 offen offset:1024 sc1
    v_mfma_f32_16x16x32_bf16 v[136:139], v[12:15], v[116:119], v[136:139]
    s_waitcnt lgkmcnt(2)
    buffer_store_dwordx4 v[120:123], v7, s[44:47], s97 offen offset:0 sc1
    v_mfma_f32_16x16x32_bf16 v[140:143], v[12:15], v[120:123], 0
    s_waitcnt lgkmcnt(0)
    buffer_store_dwordx4 v[124:127], v7, s[44:47], s97 offen offset:1024 sc1
    v_mfma_f32_16x16x32_bf16 v[140:143], v[12:15], v[124:127], v[140:143]
    s_nop 7
    v_cndmask_b32 v136, v140, v136, vcc
    v_cndmask_b32 v132, v136, v132, s[60:61]
    v_cndmask_b32 v128, v132, v128, s[10:11]
    buffer_store_dword v128, v2, s[44:47], s98 offen sc1
    s_cmp_lg_u32 s34, 0
    s_cbranch_scc1 PEp0
    v_and_b32 v24, 3, v1
    v_lshlrev_b32 v24, 6, v24
    s_mov_b32 s17, 0
Pp0:
    buffer_load_dword v25, v24, s[52:55], 0 offen sc1
    s_waitcnt vmcnt(0)
    v_cmp_gt_u32 vcc, 64, v25
    s_cbranch_vccz PEp0
    s_sleep 4
    s_add_u32 s17, s17, 1
    s_cmp_lt_u32 s17, 0x40000
    s_cbranch_scc1 Pp0
PEp0:
    s_barrier
PH_a0:
    v_mbcnt_lo_u32_b32 v133, -1, 0
    v_mbcnt_hi_u32_b32 v133, -1, v133
    s_and_b32 s35, s2, 7
    s_lshr_b32 s36, s2, 3
    s_lshr_b32 s37, s35, 2
    s_lshl_b32 s37, s37, 3
    s_lshr_b32 s38, s36, 2
    s_add_u32 s37, s37, s38
    s_and_b32 s38, s35, 3
    s_lshl_b32 s38, s38, 2
    s_and_b32 s39, s36, 3
    s_add_u32 s38, s38, s39
    v_lshlrev_b32 v128, 4, v133
    v_add_u32 v129, 32768, v128
    s_mul_i32 s26, s34, 4096
    v_add_u32 v130, s26, v128
    s_lshl_b32 s42, s37, 3
    s_lshl_b32 s43, s34, 1
    s_add_u32 s42, s42, s43
    s_lshl_b32 s25, s42, 15
    s_mul_i32 s24, s38, 393216
    s_add_u32 s24, s24, 23068672
    v_lshlrev_b32 v184, 2, v133
    s_lshl_b32 s50, s38, 8
    s_lshl_b32 s51, s34, 12
    s_add_u32 s50, s50, s51
    s_add_u32 s50, s50, 54853632
    buffer_load_dword v174, v184, s[44:47], s50 offen sc1
    s_add_u32 s50, s50, 12288
    buffer_load_dword v175, v184, s[44:47], s50 offen sc1
    s_add_u32 s50, s50, 12288
    buffer_load_dword v176, v184, s[44:47], s50 offen sc1
    s_add_u32 s50, s50, 12288
    buffer_load_dword v177, v184, s[44:47], s50 offen sc1
    v_and_b32 v134, 15, v133
    v_lshrrev_b32 v135, 4, v133
    s_lshl_b32 s48, s42, 11
    s_add_u32 s48, s48, 53477376
    buffer_load_dwordx4 v[142:145], v128, s[44:47], s48 offen offset:0 sc1
    buffer_load_dwordx4 v[146:149], v128, s[44:47], s48 offen offset:1024 sc1
    buffer_load_dwordx4 v[150:153], v128, s[44:47], s48 offen offset:2048 sc1
    buffer_load_dwordx4 v[154:157], v128, s[44:47], s48 offen offset:3072 sc1
    s_add_u32 m0, s26, 0
    s_nop 0
    buffer_load_dwordx4 v130, s[44:47], s24 offen offset:0 sc1 lds
    buffer_load_dwordx4 v130, s[44:47], s24 offen offset:1024 sc1 lds
    buffer_load_dwordx4 v130, s[44:47], s24 offen offset:2048 sc1 lds
    buffer_load_dwordx4 v130, s[44:47], s24 offen offset:3072 sc1 lds
    buffer_load_dwordx4 a[0:3], v128, s[44:47], s25 offen offset:0 sc1
    buffer_load_dwordx4 a[4:7], v128, s[44:47], s25 offen offset:1024 sc1
    buffer_load_dwordx4 a[8:11], v129, s[44:47], s25 offen offset:0 sc1
    buffer_load_dwordx4 a[12:15], v129, s[44:47], s25 offen offset:1024 sc1
    s_add_u32 m0, s26, 16384
    s_add_u32 s24, s24, 16384
    buffer_load_dwordx4 v130, s[44:47], s24 offen offset:0 sc1 lds
    buffer_load_dwordx4 v130, s[44:47], s24 offen offset:1024 sc1 lds
    buffer_load_dwordx4 v130, s[44:47], s24 offen offset:2048 sc1 lds
    buffer_load_dwordx4 v130, s[44:47], s24 offen offset:3072 sc1 lds
    s_lshl_b32 s51, s34, 8
    v_add_u32 v137, s51, v184
    s_add_u32 s51, s51, 99328
    v_lshl_add_u32 v185, v134, 2, s51
    v_lshl_add_u32 v186, v135, 4, s51
    v_add_u32 v187, 98304, v137
    v_lshlrev_b32 v188, 2, v134
    v_add_u32 v188, 98304, v188
    v_lshlrev_b32 v189, 4, v135
    v_add_u32 v189, 98304, v189
    v_mov_b32 v131, v128
    v_add_u32 v132, 65536, v128
    s_waitcnt vmcnt(16)
    v_add_f32 v174, v174, v175
    v_add_f32 v176, v176, v177
    v_add_f32 v174, v174, v176
    ds_write_b32 v187, v174
    s_waitcnt vmcnt(12)
    v_add_f32 v142, v142, v146
    v_add_f32 v143, v143, v147
    v_add_f32 v144, v144, v148
    v_add_f32 v145, v145, v149
    v_add_f32 v150, v150, v154
    v_add_f32 v151, v151, v155
    v_add_f32 v152, v152, v156
    v_add_f32 v153, v153, v157
    v_add_f32 v146, v143, v151
    v_add_f32 v154, v145, v153
    v_add_f32 v142, v142, v150
    v_add_f32 v150, v144, v152
    v_mov_b32 v143, v142
    v_mov_b32 v151, v150
    s_nop 1
    s_nop 1
    v_permlane32_swap_b32 v142, v143
    v_permlane32_swap_b32 v150, v151
    v_add_f32 v142, v142, v143
    v_add_f32 v150, v150, v151
    v_mov_b32 v143, v142
    v_mov_b32 v151, v150
    s_nop 1
    s_nop 1
    v_permlane16_swap_b32 v142, v143
    v_permlane16_swap_b32 v150, v151
    v_add_f32 v142, v142, v143
    v_add_f32 v150, v150, v151
    v_mul_f32 v142, 0xba800000, v142
    v_mul_f32 v150, 0xba800000, v150
    v_mov_b32 v147, v146
    v_mov_b32 v155, v154
    s_nop 1
    s_nop 1
    v_permlane32_swap_b32 v146, v147
    v_permlane32_swap_b32 v154, v155
    v_add_f32 v146, v146, v147
    v_add_f32 v154, v154, v155
    v_mov_b32 v147, v146
    v_mov_b32 v155, v154
    s_nop 1
    s_nop 1
    v_permlane16_swap_b32 v146, v147
    v_permlane16_swap_b32 v154, v155
    v_add_f32 v146, v146, v147
    v_add_f32 v154, v154, v155
    v_mul_f32 v146, 0x3a800000, v146
    v_mul_f32 v154, 0x3a800000, v154
    v_fma_f32 v146, -v142, v142, v146
    v_fma_f32 v154, -v150, v150, v154
    v_max_f32 v146, 0, v146
    v_max_f32 v154, 0, v154
    v_cvt_pk_bf16_f32 v146, v146, v146
    v_cvt_pk_bf16_f32 v154, v154, v154
    v_and_b32 v146, 0xffff0000, v146
    v_and_b32 v154, 0xffff0000, v154
    v_add_f32 v146, 0x3727c5ac, v146
    v_add_f32 v154, 0x3727c5ac, v154
    v_cvt_pk_bf16_f32 v146, v146, v146
    v_cvt_pk_bf16_f32 v154, v154, v154
    v_and_b32 v146, 0xffff0000, v146
    v_and_b32 v154, 0xffff0000, v154
    v_sqrt_f32 v146, v146
    v_sqrt_f32 v154, v154
    s_nop 0
    s_nop 0
    v_cvt_pk_bf16_f32 v146, v146, v146
    v_cvt_pk_bf16_f32 v154, v154, v154
    v_and_b32 v146, 0xffff0000, v146
    v_and_b32 v154, 0xffff0000, v154
    v_rcp_f32 v146, v146
    v_rcp_f32 v154, v154
    s_nop 0
    s_nop 0
    v_cvt_pk_bf16_f32 v142, v142, v142
    v_cvt_pk_bf16_f32 v150, v150, v150
    v_and_b32 v142, 0xffff0000, v142
    v_and_b32 v150, 0xffff0000, v150
    ds_write_b32 v185, v142 offset:0
    ds_write_b32 v185, v150 offset:128
    ds_write_b32 v185, v146 offset:64
    ds_write_b32 v185, v154 offset:192
    ds_read_b128 v[158:161], v186 offset:0
    ds_read_b128 v[166:169], v186 offset:128
    ds_read_b128 v[162:165], v186 offset:64
    ds_read_b128 v[170:173], v186 offset:192
    s_waitcnt lgkmcnt(0)
    s_barrier
    ds_read_b32 v174, v188 offset:256
    ds_read_b32 v175, v188 offset:320
    ds_read_b32 v176, v188 offset:384
    ds_read_b32 v177, v188 offset:448
    ds_read_b32 v178, v188 offset:512
    ds_read_b32 v179, v188 offset:576
    ds_read_b32 v180, v188 offset:640
    ds_read_b32 v181, v188 offset:704
    ds_read_b128 v[64:67], v189 offset:0
    ds_read_b128 v[72:75], v189 offset:64
    ds_read_b128 v[80:83], v189 offset:128
    ds_read_b128 v[88:91], v189 offset:192
    s_waitcnt lgkmcnt(0)
    v_pk_mul_f32 v[0:1], v[158:159], v[174:175] op_sel_hi:[1,0]
    v_pk_mul_f32 v[2:3], v[160:161], v[174:175] op_sel_hi:[1,0]
    v_pk_mul_f32 v[4:5], v[166:167], v[174:175] op_sel_hi:[1,0]
    v_pk_mul_f32 v[6:7], v[168:169], v[174:175] op_sel_hi:[1,0]
    v_pk_mul_f32 v[8:9], v[158:159], v[174:175] op_sel:[0,1] op_sel_hi:[1,1]
    v_pk_mul_f32 v[10:11], v[160:161], v[174:175] op_sel:[0,1] op_sel_hi:[1,1]
    v_pk_mul_f32 v[12:13], v[166:167], v[174:175] op_sel:[0,1] op_sel_hi:[1,1]
    v_pk_mul_f32 v[14:15], v[168:169], v[174:175] op_sel:[0,1] op_sel_hi:[1,1]
    v_pk_mul_f32 v[16:17], v[158:159], v[176:177] op_sel_hi:[1,0]
    v_pk_mul_f32 v[18:19], v[160:161], v[176:177] op_sel_hi:[1,0]
    v_pk_mul_f32 v[20:21], v[166:167], v[176:177] op_sel_hi:[1,0]
    v_pk_mul_f32 v[22:23], v[168:169], v[176:177] op_sel_hi:[1,0]
    v_pk_mul_f32 v[24:25], v[158:159], v[176:177] op_sel:[0,1] op_sel_hi:[1,1]
    v_pk_mul_f32 v[26:27], v[160:161], v[176:177] op_sel:[0,1] op_sel_hi:[1,1]
    v_pk_mul_f32 v[28:29], v[166:167], v[176:177] op_sel:[0,1] op_sel_hi:[1,1]
    v_pk_mul_f32 v[30:31], v[168:169], v[176:177] op_sel:[0,1] op_sel_hi:[1,1]
    v_pk_mul_f32 v[32:33], v[158:159], v[178:179] op_sel_hi:[1,0]
    v_pk_mul_f32 v[34:35], v[160:161], v[178:179] op_sel_hi:[1,0]
    v_pk_mul_f32 v[36:37], v[166:167], v[178:179] op_sel_hi:[1,0]
    v_pk_mul_f32 v[38:39], v[168:169], v[178:179] op_sel_hi:[1,0]
    v_pk_mul_f32 v[40:41], v[158:159], v[178:179] op_sel:[0,1] op_sel_hi:[1,1]
    v_pk_mul_f32 v[42:43], v[160:161], v[178:179] op_sel:[0,1] op_sel_hi:[1,1]
    v_pk_mul_f32 v[44:45], v[166:167], v[178:179] op_sel:[0,1] op_sel_hi:[1,1]
    v_pk_mul_f32 v[46:47], v[168:169], v[178:179] op_sel:[0,1] op_sel_hi:[1,1]
    v_pk_mul_f32 v[48:49], v[158:159], v[180:181] op_sel_hi:[1,0]
    v_pk_mul_f32 v[50:51], v[160:161], v[180:181] op_sel_hi:[1,0]
    v_pk_mul_f32 v[52:53], v[166:167], v[180:181] op_sel_hi:[1,0]
    v_pk_mul_f32 v[54:55], v[168:169], v[180:181] op_sel_hi:[1,0]
    v_pk_mul_f32 v[56:57], v[158:159], v[180:181] op_sel:[0,1] op_sel_hi:[1,1]
    v_pk_mul_f32 v[58:59], v[160:161], v[180:181] op_sel:[0,1] op_sel_hi:[1,1]
    v_pk_mul_f32 v[60:61], v[166:167], v[180:181] op_sel:[0,1] op_sel_hi:[1,1]
    v_pk_mul_f32 v[62:63], v[168:169], v[180:181] op_sel:[0,1] op_sel_hi:[1,1]
    s_waitcnt vmcnt(8)
    s_barrier
    ds_read_b128 v[96:99], v131 offset:0
    ds_read_b128 v[100:103], v131 offset:1024
    ds_read_b128 v[104:107], v131 offset:2048
    ds_read_b128 v[108:111], v131 offset:3072
    ds_read_b128 v[112:115], v131 offset:4096
    ds_read_b128 v[116:119], v131 offset:5120
    ds_read_b128 v[120:123], v131 offset:6144
    ds_read_b128 v[124:127], v131 offset:7168
    s_waitcnt vmcnt(6) lgkmcnt(6)
    v_mfma_f32_16x16x32_bf16 v[0:3], a[0:3], v[96:99], v[0:3]
    s_add_u32 s25, s25, 2048
    buffer_load_dwordx4 a[16:19], v128, s[44:47], s25 offen offset:0 sc1
    v_mfma_f32_16x16x32_bf16 v[0:3], a[4:7], v[100:103], v[0:3]
    s_waitcnt vmcnt(5)
    v_mfma_f32_16x16x32_bf16 v[4:7], a[12:15], v[100:103], v[4:7]
    v_mfma_f32_16x16x32_bf16 v[4:7], a[8:11], v[96:99], v[4:7]
    ds_read_b128 v[96:99], v131 offset:8192
    s_waitcnt lgkmcnt(5)
    v_mfma_f32_16x16x32_bf16 v[12:15], a[8:11], v[104:107], v[12:15]
    buffer_load_dwordx4 a[20:23], v128, s[44:47], s25 offen offset:1024 sc1
    ds_read_b128 v[100:103], v131 offset:9216
    v_mfma_f32_16x16x32_bf16 v[12:15], a[12:15], v[108:111], v[12:15]
    v_mfma_f32_16x16x32_bf16 v[8:11], a[4:7], v[108:111], v[8:11]
    v_mfma_f32_16x16x32_bf16 v[8:11], a[0:3], v[104:107], v[8:11]
    ds_read_b128 v[104:107], v131 offset:10240
    s_waitcnt lgkmcnt(5)
    v_mfma_f32_16x16x32_bf16 v[16:19], a[0:3], v[112:115], v[16:19]
    buffer_load_dwordx4 a[24:27], v129, s[44:47], s25 offen offset:0 sc1
    ds_read_b128 v[108:111], v131 offset:11264
    v_mfma_f32_16x16x32_bf16 v[16:19], a[4:7], v[116:119], v[16:19]
    v_mfma_f32_16x16x32_bf16 v[20:23], a[12:15], v[116:119], v[20:23]
    v_mfma_f32_16x16x32_bf16 v[20:23], a[8:11], v[112:115], v[20:23]
    ds_read_b128 v[112:115], v131 offset:12288
    s_waitcnt lgkmcnt(5)
    v_mfma_f32_16x16x32_bf16 v[28:31], a[8:11], v[120:123], v[28:31]
    buffer_load_dwordx4 a[28:31], v129, s[44:47], s25 offen offset:1024 sc1
    ds_read_b128 v[116:119], v131 offset:13312
    v_mfma_f32_16x16x32_bf16 v[28:31], a[12:15], v[124:127], v[28:31]
    v_mfma_f32_16x16x32_bf16 v[24:27], a[4:7], v[124:127], v[24:27]
    v_mfma_f32_16x16x32_bf16 v[24:27], a[0:3], v[120:123], v[24:27]
    ds_read_b128 v[120:123], v131 offset:14336
    s_waitcnt lgkmcnt(5)
    v_mfma_f32_16x16x32_bf16 v[32:35], a[0:3], v[96:99], v[32:35]
    s_add_u32 m0, s26, 32768
    s_add_u32 s24, s24, 16384
    buffer_load_dwordx4 v130, s[44:47], s24 offen offset:0 sc1 lds
    ds_read_b128 v[124:127], v131 offset:15360
    v_mfma_f32_16x16x32_bf16 v[32:35], a[4:7], v[100:103], v[32:35]
    v_mfma_f32_16x16x32_bf16 v[36:39], a[12:15], v[100:103], v[36:39]
    s_waitcnt vmcnt(5)
    s_barrier
    v_mfma_f32_16x16x32_bf16 v[36:39], a[8:11], v[96:99], v[36:39]
    ds_read_b128 v[96:99], v131 offset:16384
    s_waitcnt lgkmcnt(5)
    v_mfma_f32_16x16x32_bf16 v[44:47], a[8:11], v[104:107], v[44:47]
    buffer_load_dwordx4 v130, s[44:47], s24 offen offset:1024 sc1 lds
    ds_read_b128 v[100:103], v131 offset:17408
    v_mfma_f32_16x16x32_bf16 v[44:47], a[12:15], v[108:111], v[44:47]
    v_mfma_f32_16x16x32_bf16 v[40:43], a[4:7], v[108:111], v[40:43]
    v_mfma_f32_16x16x32_bf16 v[40:43], a[0:3], v[104:107], v[40:43]
    ds_read_b128 v[104:107], v131 offset:18432
    s_waitcnt lgkmcnt(5)
    v_mfma_f32_16x16x32_bf16 v[48:51], a[0:3], v[112:115], v[48:51]
    buffer_load_dwordx4 v130, s[44:47], s24 offen offset:2048 sc1 lds
    ds_read_b128 v[108:111], v131 offset:19456
    v_mfma_f32_16x16x32_bf16 v[48:51], a[4:7], v[116:119], v[48:51]
    v_mfma_f32_16x16x32_bf16 v[52:55], a[12:15], v[116:119], v[52:55]
    v_mfma_f32_16x16x32_bf16 v[52:55], a[8:11], v[112:115], v[52:55]
    ds_read_b128 v[112:115], v131 offset:20480
    s_waitcnt lgkmcnt(5)
    v_mfma_f32_16x16x32_bf16 v[60:63], a[8:11], v[120:123], v[60:63]
    buffer_load_dwordx4 v130, s[44:47], s24 offen offset:3072 sc1 lds
    ds_read_b128 v[116:119], v131 offset:21504
    v_mfma_f32_16x16x32_bf16 v[60:63], a[12:15], v[124:127], v[60:63]
    v_mfma_f32_16x16x32_bf16 v[56:59], a[4:7], v[124:127], v[56:59]
    v_mfma_f32_16x16x32_bf16 v[56:59], a[0:3], v[120:123], v[56:59]
    s_add_u32 s25, s25, 2048
    buffer_load_dwordx4 a[32:35], v128, s[44:47], s25 offen offset:0 sc1
    ds_read_b128 v[120:123], v131 offset:22528
    ds_read_b128 v[124:127], v131 offset:23552
    s_waitcnt vmcnt(7) lgkmcnt(6)
    v_mfma_f32_16x16x32_bf16 v[0:3], a[16:19], v[96:99], v[0:3]
    v_mfma_f32_16x16x32_bf16 v[0:3], a[20:23], v[100:103], v[0:3]
    s_waitcnt vmcnt(5)
    v_mfma_f32_16x16x32_bf16 v[4:7], a[28:31], v[100:103], v[4:7]
    buffer_load_dwordx4 a[36:39], v128, s[44:47], s25 offen offset:1024 sc1
    v_mfma_f32_16x16x32_bf16 v[4:7], a[24:27], v[96:99], v[4:7]
    ds_read_b128 v[96:99], v131 offset:24576
    s_waitcnt lgkmcnt(5)
    v_mfma_f32_16x16x32_bf16 v[12:15], a[24:27], v[104:107], v[12:15]
    ds_read_b128 v[100:103], v131 offset:25600
    v_mfma_f32_16x16x32_bf16 v[12:15], a[28:31], v[108:111], v[12:15]
    buffer_load_dwordx4 a[40:43], v129, s[44:47], s25 offen offset:0 sc1
    v_mfma_f32_16x16x32_bf16 v[8:11], a[20:23], v[108:111], v[8:11]
    v_mfma_f32_16x16x32_bf16 v[8:11], a[16:19], v[104:107], v[8:11]
    ds_read_b128 v[104:107], v131 offset:26624
    s_waitcnt lgkmcnt(5)
    v_mfma_f32_16x16x32_bf16 v[16:19], a[16:19], v[112:115], v[16:19]
    buffer_load_dwordx4 a[44:47], v129, s[44:47], s25 offen offset:1024 sc1
    ds_read_b128 v[108:111], v131 offset:27648
    v_mfma_f32_16x16x32_bf16 v[16:19], a[20:23], v[116:119], v[16:19]
    v_mfma_f32_16x16x32_bf16 v[20:23], a[28:31], v[116:119], v[20:23]
    v_mfma_f32_16x16x32_bf16 v[20:23], a[24:27], v[112:115], v[20:23]
    ds_read_b128 v[112:115], v131 offset:28672
    s_waitcnt lgkmcnt(5)
    v_mfma_f32_16x16x32_bf16 v[28:31], a[24:27], v[120:123], v[28:31]
    s_add_u32 m0, s26, 49152
    s_add_u32 s24, s24, 16384
    buffer_load_dwordx4 v130, s[44:47], s24 offen offset:0 sc1 lds
    ds_read_b128 v[116:119], v131 offset:29696
    v_mfma_f32_16x16x32_bf16 v[28:31], a[28:31], v[124:127], v[28:31]
    v_mfma_f32_16x16x32_bf16 v[24:27], a[20:23], v[124:127], v[24:27]
    v_mfma_f32_16x16x32_bf16 v[24:27], a[16:19], v[120:123], v[24:27]
    ds_read_b128 v[120:123], v131 offset:30720
    s_waitcnt lgkmcnt(5)
    v_mfma_f32_16x16x32_bf16 v[32:35], a[16:19], v[96:99], v[32:35]
    buffer_load_dwordx4 v130, s[44:47], s24 offen offset:1024 sc1 lds
    ds_read_b128 v[124:127], v131 offset:31744
    v_mfma_f32_16x16x32_bf16 v[32:35], a[20:23], v[100:103], v[32:35]
    v_mfma_f32_16x16x32_bf16 v[36:39], a[28:31], v[100:103], v[36:39]
    s_waitcnt vmcnt(6)
    s_barrier
    v_mfma_f32_16x16x32_bf16 v[36:39], a[24:27], v[96:99], v[36:39]
    ds_read_b128 v[96:99], v131 offset:32768
    s_waitcnt lgkmcnt(5)
    v_mfma_f32_16x16x32_bf16 v[44:47], a[24:27], v[104:107], v[44:47]
    buffer_load_dwordx4 v130, s[44:47], s24 offen offset:2048 sc1 lds
    ds_read_b128 v[100:103], v131 offset:33792
    v_mfma_f32_16x16x32_bf16 v[44:47], a[28:31], v[108:111], v[44:47]
    v_mfma_f32_16x16x32_bf16 v[40:43], a[20:23], v[108:111], v[40:43]
    v_mfma_f32_16x16x32_bf16 v[40:43], a[16:19], v[104:107], v[40:43]
    ds_read_b128 v[104:107], v131 offset:34816
    s_waitcnt lgkmcnt(5)
    v_mfma_f32_16x16x32_bf16 v[48:51], a[16:19], v[112:115], v[48:51]
    buffer_load_dwordx4 v130, s[44:47], s24 offen offset:3072 sc1 lds
    ds_read_b128 v[108:111], v131 offset:35840
    v_mfma_f32_16x16x32_bf16 v[48:51], a[20:23], v[116:119], v[48:51]
    v_mfma_f32_16x16x32_bf16 v[52:55], a[28:31], v[116:119], v[52:55]
    v_mfma_f32_16x16x32_bf16 v[52:55], a[24:27], v[112:115], v[52:55]
    ds_read_b128 v[112:115], v131 offset:36864
    s_waitcnt lgkmcnt(5)
    v_mfma_f32_16x16x32_bf16 v[60:63], a[24:27], v[120:123], v[60:63]
    s_add_u32 s25, s25, 2048
    buffer_load_dwordx4 a[48:51], v128, s[44:47], s25 offen offset:0 sc1
    ds_read_b128 v[116:119], v131 offset:37888
    v_mfma_f32_16x16x32_bf16 v[60:63], a[28:31], v[124:127], v[60:63]
    v_mfma_f32_16x16x32_bf16 v[56:59], a[20:23], v[124:127], v[56:59]
    v_mfma_f32_16x16x32_bf16 v[56:59], a[16:19], v[120:123], v[56:59]
    buffer_load_dwordx4 a[52:55], v128, s[44:47], s25 offen offset:1024 sc1
    ds_read_b128 v[120:123], v131 offset:38912
    ds_read_b128 v[124:127], v131 offset:39936
    s_waitcnt vmcnt(6) lgkmcnt(6)
    v_mfma_f32_16x16x32_bf16 v[0:3], a[32:35], v[96:99], v[0:3]
    v_mfma_f32_16x16x32_bf16 v[0:3], a[36:39], v[100:103], v[0:3]
    v_mfma_f32_16x16x32_bf16 v[4:7], a[44:47], v[100:103], v[4:7]
    buffer_load_dwordx4 a[56:59], v129, s[44:47], s25 offen offset:0 sc1
    v_mfma_f32_16x16x32_bf16 v[4:7], a[40:43], v[96:99], v[4:7]
    ds_read_b128 v[96:99], v131 offset:40960
    s_waitcnt lgkmcnt(5)
    v_mfma_f32_16x16x32_bf16 v[12:15], a[40:43], v[104:107], v[12:15]
    ds_read_b128 v[100:103], v131 offset:41984
    v_mfma_f32_16x16x32_bf16 v[12:15], a[44:47], v[108:111], v[12:15]
    buffer_load_dwordx4 a[60:63], v129, s[44:47], s25 offen offset:1024 sc1
    v_mfma_f32_16x16x32_bf16 v[8:11], a[36:39], v[108:111], v[8:11]
    v_mfma_f32_16x16x32_bf16 v[8:11], a[32:35], v[104:107], v[8:11]
    ds_read_b128 v[104:107], v131 offset:43008
    s_waitcnt lgkmcnt(5)
    v_mfma_f32_16x16x32_bf16 v[16:19], a[32:35], v[112:115], v[16:19]
    s_add_u32 m0, s26, 65536
    s_add_u32 s24, s24, 16384
    buffer_load_dwordx4 v130, s[44:47], s24 offen offset:0 sc1 lds
    ds_read_b128 v[108:111], v131 offset:44032
    v_mfma_f32_16x16x32_bf16 v[16:19], a[36:39], v[116:119], v[16:19]
    v_mfma_f32_16x16x32_bf16 v[20:23], a[44:47], v[116:119], v[20:23]
    v_mfma_f32_16x16x32_bf16 v[20:23], a[40:43], v[112:115], v[20:23]
    ds_read_b128 v[112:115], v131 offset:45056
    s_waitcnt lgkmcnt(5)
    v_mfma_f32_16x16x32_bf16 v[28:31], a[40:43], v[120:123], v[28:31]
    buffer_load_dwordx4 v130, s[44:47], s24 offen offset:1024 sc1 lds
    ds_read_b128 v[116:119], v131 offset:46080
    v_mfma_f32_16x16x32_bf16 v[28:31], a[44:47], v[124:127], v[28:31]
    v_mfma_f32_16x16x32_bf16 v[24:27], a[36:39], v[124:127], v[24:27]
    v_mfma_f32_16x16x32_bf16 v[24:27], a[32:35], v[120:123], v[24:27]
    ds_read_b128 v[120:123], v131 offset:47104
    s_waitcnt lgkmcnt(5)
    v_mfma_f32_16x16x32_bf16 v[32:35], a[32:35], v[96:99], v[32:35]
    buffer_load_dwordx4 v130, s[44:47], s24 offen offset:2048 sc1 lds
    ds_read_b128 v[124:127], v131 offset:48128
    v_mfma_f32_16x16x32_bf16 v[32:35], a[36:39], v[100:103], v[32:35]
    v_mfma_f32_16x16x32_bf16 v[36:39], a[44:47], v[100:103], v[36:39]
    s_waitcnt vmcnt(7)
    s_barrier
    v_mfma_f32_16x16x32_bf16 v[36:39], a[40:43], v[96:99], v[36:39]
    ds_read_b128 v[96:99], v131 offset:49152
    s_waitcnt lgkmcnt(5)
    v_mfma_f32_16x16x32_bf16 v[44:47], a[40:43], v[104:107], v[44:47]
    buffer_load_dwordx4 v130, s[44:47], s24 offen offset:3072 sc1 lds
    ds_read_b128 v[100:103], v131 offset:50176
    v_mfma_f32_16x16x32_bf16 v[44:47], a[44:47], v[108:111], v[44:47]
    v_mfma_f32_16x16x32_bf16 v[40:43], a[36:39], v[108:111], v[40:43]
    v_mfma_f32_16x16x32_bf16 v[40:43], a[32:35], v[104:107], v[40:43]
    ds_read_b128 v[104:107], v131 offset:51200
    s_waitcnt lgkmcnt(5)
    v_mfma_f32_16x16x32_bf16 v[48:51], a[32:35], v[112:115], v[48:51]
    s_add_u32 s25, s25, 2048
    buffer_load_dwordx4 a[64:67], v128, s[44:47], s25 offen offset:0 sc1
    ds_read_b128 v[108:111], v131 offset:52224
    v_mfma_f32_16x16x32_bf16 v[48:51], a[36:39], v[116:119], v[48:51]
    v_mfma_f32_16x16x32_bf16 v[52:55], a[44:47], v[116:119], v[52:55]
    v_mfma_f32_16x16x32_bf16 v[52:55], a[40:43], v[112:115], v[52:55]
    ds_read_b128 v[112:115], v131 offset:53248
    s_waitcnt lgkmcnt(5)
    v_mfma_f32_16x16x32_bf16 v[60:63], a[40:43], v[120:123], v[60:63]
    buffer_load_dwordx4 a[68:71], v128, s[44:47], s25 offen offset:1024 sc1
    ds_read_b128 v[116:119], v131 offset:54272
    v_mfma_f32_16x16x32_bf16 v[60:63], a[44:47], v[124:127], v[60:63]
    v_mfma_f32_16x16x32_bf16 v[56:59], a[36:39], v[124:127], v[56:59]
    v_mfma_f32_16x16x32_bf16 v[56:59], a[32:35], v[120:123], v[56:59]
    buffer_load_dwordx4 a[72:75], v129, s[44:47], s25 offen offset:0 sc1
    ds_read_b128 v[120:123], v131 offset:55296
    ds_read_b128 v[124:127], v131 offset:56320
    s_waitcnt vmcnt(7) lgkmcnt(6)
    v_mfma_f32_16x16x32_bf16 v[0:3], a[48:51], v[96:99], v[0:3]
    v_mfma_f32_16x16x32_bf16 v[0:3], a[52:55], v[100:103], v[0:3]
    v_mfma_f32_16x16x32_bf16 v[4:7], a[60:63], v[100:103], v[4:7]
    buffer_load_dwordx4 a[76:79], v129, s[44:47], s25 offen offset:1024 sc1
    v_mfma_f32_16x16x32_bf16 v[4:7], a[56:59], v[96:99], v[4:7]
    ds_read_b128 v[96:99], v131 offset:57344
    s_waitcnt lgkmcnt(5)
    v_mfma_f32_16x16x32_bf16 v[12:15], a[56:59], v[104:107], v[12:15]
    ds_read_b128 v[100:103], v131 offset:58368
    v_mfma_f32_16x16x32_bf16 v[12:15], a[60:63], v[108:111], v[12:15]
    s_add_u32 m0, s26, 81920
    s_add_u32 s24, s24, 16384
    buffer_load_dwordx4 v130, s[44:47], s24 offen offset:0 sc1 lds
    v_mfma_f32_16x16x32_bf16 v[8:11], a[52:55], v[108:111], v[8:11]
    v_mfma_f32_16x16x32_bf16 v[8:11], a[48:51], v[104:107], v[8:11]
    ds_read_b128 v[104:107], v131 offset:59392
    s_waitcnt lgkmcnt(5)
    v_mfma_f32_16x16x32_bf16 v[16:19], a[48:51], v[112:115], v[16:19]
    buffer_load_dwordx4 v130, s[44:47], s24 offen offset:1024 sc1 lds
    ds_read_b128 v[108:111], v131 offset:60416
    v_mfma_f32_16x16x32_bf16 v[16:19], a[52:55], v[116:119], v[16:19]
    v_mfma_f32_16x16x32_bf16 v[20:23], a[60:63], v[116:119], v[20:23]
    v_mfma_f32_16x16x32_bf16 v[20:23], a[56:59], v[112:115], v[20:23]
    ds_read_b128 v[112:115], v131 offset:61440
    s_waitcnt lgkmcnt(5)
    v_mfma_f32_16x16x32_bf16 v[28:31], a[56:59], v[120:123], v[28:31]
    buffer_load_dwordx4 v130, s[44:47], s24 offen offset:2048 sc1 lds
    ds_read_b128 v[116:119], v131 offset:62464
    v_mfma_f32_16x16x32_bf16 v[28:31], a[60:63], v[124:127], v[28:31]
    v_mfma_f32_16x16x32_bf16 v[24:27], a[52:55], v[124:127], v[24:27]
    v_mfma_f32_16x16x32_bf16 v[24:27], a[48:51], v[120:123], v[24:27]
    ds_read_b128 v[120:123], v131 offset:63488
    s_waitcnt lgkmcnt(5)
    v_mfma_f32_16x16x32_bf16 v[32:35], a[48:51], v[96:99], v[32:35]
    buffer_load_dwordx4 v130, s[44:47], s24 offen offset:3072 sc1 lds
    ds_read_b128 v[124:127], v131 offset:64512
    v_mfma_f32_16x16x32_bf16 v[32:35], a[52:55], v[100:103], v[32:35]
    v_mfma_f32_16x16x32_bf16 v[36:39], a[60:63], v[100:103], v[36:39]
    s_waitcnt vmcnt(8)
    s_barrier
    v_mfma_f32_16x16x32_bf16 v[36:39], a[56:59], v[96:99], v[36:39]
    ds_read_b128 v[96:99], v132 offset:0
    s_waitcnt lgkmcnt(5)
    v_mfma_f32_16x16x32_bf16 v[44:47], a[56:59], v[104:107], v[44:47]
    s_add_u32 s25, s25, 2048
    buffer_load_dwordx4 a[80:83], v128, s[44:47], s25 offen offset:0 sc1
    ds_read_b128 v[100:103], v132 offset:1024
    v_mfma_f32_16x16x32_bf16 v[44:47], a[60:63], v[108:111], v[44:47]
    v_mfma_f32_16x16x32_bf16 v[40:43], a[52:55], v[108:111], v[40:43]
    v_mfma_f32_16x16x32_bf16 v[40:43], a[48:51], v[104:107], v[40:43]
    ds_read_b128 v[104:107], v132 offset:2048
    s_waitcnt lgkmcnt(5)
    v_mfma_f32_16x16x32_bf16 v[48:51], a[48:51], v[112:115], v[48:51]
    buffer_load_dwordx4 a[84:87], v128, s[44:47], s25 offen offset:1024 sc1
    ds_read_b128 v[108:111], v132 offset:3072
    v_mfma_f32_16x16x32_bf16 v[48:51], a[52:55], v[116:119], v[48:51]
    v_mfma_f32_16x16x32_bf16 v[52:55], a[60:63], v[116:119], v[52:55]
    v_mfma_f32_16x16x32_bf16 v[52:55], a[56:59], v[112:115], v[52:55]
    ds_read_b128 v[112:115], v132 offset:4096
    s_waitcnt lgkmcnt(5)
    v_mfma_f32_16x16x32_bf16 v[60:63], a[56:59], v[120:123], v[60:63]
    buffer_load_dwordx4 a[88:91], v129, s[44:47], s25 offen offset:0 sc1
    ds_read_b128 v[116:119], v132 offset:5120
    v_mfma_f32_16x16x32_bf16 v[60:63], a[60:63], v[124:127], v[60:63]
    v_mfma_f32_16x16x32_bf16 v[56:59], a[52:55], v[124:127], v[56:59]
    v_mfma_f32_16x16x32_bf16 v[56:59], a[48:51], v[120:123], v[56:59]
    buffer_load_dwordx4 a[92:95], v129, s[44:47], s25 offen offset:1024 sc1
    ds_read_b128 v[120:123], v132 offset:6144
    ds_read_b128 v[124:127], v132 offset:7168
    s_waitcnt vmcnt(8) lgkmcnt(6)
    v_mfma_f32_16x16x32_bf16 v[0:3], a[64:67], v[96:99], v[0:3]
    v_mfma_f32_16x16x32_bf16 v[0:3], a[68:71], v[100:103], v[0:3]
    v_mfma_f32_16x16x32_bf16 v[4:7], a[76:79], v[100:103], v[4:7]
    s_add_u32 m0, s26, 0
    s_add_u32 s24, s24, 16384
    buffer_load_dwordx4 v130, s[44:47], s24 offen offset:0 sc1 lds
    v_mfma_f32_16x16x32_bf16 v[4:7], a[72:75], v[96:99], v[4:7]
    ds_read_b128 v[96:99], v132 offset:8192
    s_waitcnt lgkmcnt(5)
    v_mfma_f32_16x16x32_bf16 v[12:15], a[72:75], v[104:107], v[12:15]
    ds_read_b128 v[100:103], v132 offset:9216
    v_mfma_f32_16x16x32_bf16 v[12:15], a[76:79], v[108:111], v[12:15]
    buffer_load_dwordx4 v130, s[44:47], s24 offen offset:1024 sc1 lds
    v_mfma_f32_16x16x32_bf16 v[8:11], a[68:71], v[108:111], v[8:11]
    v_mfma_f32_16x16x32_bf16 v[8:11], a[64:67], v[104:107], v[8:11]
    ds_read_b128 v[104:107], v132 offset:10240
    s_waitcnt lgkmcnt(5)
    v_mfma_f32_16x16x32_bf16 v[16:19], a[64:67], v[112:115], v[16:19]
    buffer_load_dwordx4 v130, s[44:47], s24 offen offset:2048 sc1 lds
    ds_read_b128 v[108:111], v132 offset:11264
    v_mfma_f32_16x16x32_bf16 v[16:19], a[68:71], v[116:119], v[16:19]
    v_mfma_f32_16x16x32_bf16 v[20:23], a[76:79], v[116:119], v[20:23]
    v_mfma_f32_16x16x32_bf16 v[20:23], a[72:75], v[112:115], v[20:23]
    ds_read_b128 v[112:115], v132 offset:12288
    s_waitcnt lgkmcnt(5)
    v_mfma_f32_16x16x32_bf16 v[28:31], a[72:75], v[120:123], v[28:31]
    buffer_load_dwordx4 v130, s[44:47], s24 offen offset:3072 sc1 lds
    ds_read_b128 v[116:119], v132 offset:13312
    v_mfma_f32_16x16x32_bf16 v[28:31], a[76:79], v[124:127], v[28:31]
    v_mfma_f32_16x16x32_bf16 v[24:27], a[68:71], v[124:127], v[24:27]
    v_mfma_f32_16x16x32_bf16 v[24:27], a[64:67], v[120:123], v[24:27]
    ds_read_b128 v[120:123], v132 offset:14336
    s_waitcnt lgkmcnt(5)
    v_mfma_f32_16x16x32_bf16 v[32:35], a[64:67], v[96:99], v[32:35]
    s_add_u32 s25, s25, 2048
    buffer_load_dwordx4 a[96:99], v128, s[44:47], s25 offen offset:0 sc1
    ds_read_b128 v[124:127], v132 offset:15360
    v_mfma_f32_16x16x32_bf16 v[32:35], a[68:71], v[100:103], v[32:35]
    v_mfma_f32_16x16x32_bf16 v[36:39], a[76:79], v[100:103], v[36:39]
    s_waitcnt vmcnt(9)
    s_barrier
    v_mfma_f32_16x16x32_bf16 v[36:39], a[72:75], v[96:99], v[36:39]
    ds_read_b128 v[96:99], v132 offset:16384
    s_waitcnt lgkmcnt(5)
    v_mfma_f32_16x16x32_bf16 v[44:47], a[72:75], v[104:107], v[44:47]
    buffer_load_dwordx4 a[100:103], v128, s[44:47], s25 offen offset:1024 sc1
    ds_read_b128 v[100:103], v132 offset:17408
    v_mfma_f32_16x16x32_bf16 v[44:47], a[76:79], v[108:111], v[44:47]
    v_mfma_f32_16x16x32_bf16 v[40:43], a[68:71], v[108:111], v[40:43]
    v_mfma_f32_16x16x32_bf16 v[40:43], a[64:67], v[104:107], v[40:43]
    ds_read_b128 v[104:107], v132 offset:18432
    s_waitcnt lgkmcnt(5)
    v_mfma_f32_16x16x32_bf16 v[48:51], a[64:67], v[112:115], v[48:51]
    buffer_load_dwordx4 a[104:107], v129, s[44:47], s25 offen offset:0 sc1
    ds_read_b128 v[108:111], v132 offset:19456
    v_mfma_f32_16x16x32_bf16 v[48:51], a[68:71], v[116:119], v[48:51]
    v_mfma_f32_16x16x32_bf16 v[52:55], a[76:79], v[116:119], v[52:55]
    v_mfma_f32_16x16x32_bf16 v[52:55], a[72:75], v[112:115], v[52:55]
    ds_read_b128 v[112:115], v132 offset:20480
    s_waitcnt lgkmcnt(5)
    v_mfma_f32_16x16x32_bf16 v[60:63], a[72:75], v[120:123], v[60:63]
    buffer_load_dwordx4 a[108:111], v129, s[44:47], s25 offen offset:1024 sc1
    ds_read_b128 v[116:119], v132 offset:21504
    v_mfma_f32_16x16x32_bf16 v[60:63], a[76:79], v[124:127], v[60:63]
    v_mfma_f32_16x16x32_bf16 v[56:59], a[68:71], v[124:127], v[56:59]
    v_mfma_f32_16x16x32_bf16 v[56:59], a[64:67], v[120:123], v[56:59]
    s_add_u32 m0, s26, 16384
    s_add_u32 s24, s24, 16384
    buffer_load_dwordx4 v130, s[44:47], s24 offen offset:0 sc1 lds
    ds_read_b128 v[120:123], v132 offset:22528
    ds_read_b128 v[124:127], v132 offset:23552
    s_waitcnt vmcnt(9) lgkmcnt(6)
    v_mfma_f32_16x16x32_bf16 v[0:3], a[80:83], v[96:99], v[0:3]
    v_mfma_f32_16x16x32_bf16 v[0:3], a[84:87], v[100:103], v[0:3]
    v_mul_f32 v68, v64, v150
    v_mfma_f32_16x16x32_bf16 v[4:7], a[92:95], v[100:103], v[4:7]
    v_mul_f32 v69, v65, v150
    v_mfma_f32_16x16x32_bf16 v[4:7], a[88:91], v[96:99], v[4:7]
    v_mul_f32 v70, v66, v150
    s_waitcnt lgkmcnt(4)
    v_mfma_f32_16x16x32_bf16 v[12:15], a[88:91], v[104:107], v[12:15]
    v_mul_f32 v71, v67, v150
    buffer_load_dwordx4 v130, s[44:47], s24 offen offset:1024 sc1 lds
    ds_read_b128 v[96:99], v132 offset:24576
    ds_read_b128 v[100:103], v132 offset:25600
    v_mfma_f32_16x16x32_bf16 v[12:15], a[92:95], v[108:111], v[12:15]
    v_mul_f32 v64, v64, v142
    v_mfma_f32_16x16x32_bf16 v[8:11], a[84:87], v[108:111], v[8:11]
    v_mul_f32 v65, v65, v142
    v_mfma_f32_16x16x32_bf16 v[8:11], a[80:83], v[104:107], v[8:11]
    v_mul_f32 v66, v66, v142
    s_waitcnt lgkmcnt(4)
    v_mfma_f32_16x16x32_bf16 v[16:19], a[80:83], v[112:115], v[16:19]
    v_mul_f32 v67, v67, v142
    ds_read_b128 v[104:107], v132 offset:26624
    ds_read_b128 v[108:111], v132 offset:27648
    v_mfma_f32_16x16x32_bf16 v[16:19], a[84:87], v[116:119], v[16:19]
    v_mul_f32 v76, v72, v150
    buffer_load_dwordx4 v130, s[44:47], s24 offen offset:2048 sc1 lds
    v_mfma_f32_16x16x32_bf16 v[20:23], a[92:95], v[116:119], v[20:23]
    v_mul_f32 v77, v73, v150
    v_mfma_f32_16x16x32_bf16 v[20:23], a[88:91], v[112:115], v[20:23]
    v_mul_f32 v78, v74, v150
    s_waitcnt lgkmcnt(4)
    v_mfma_f32_16x16x32_bf16 v[28:31], a[88:91], v[120:123], v[28:31]
    v_mul_f32 v79, v75, v150
    ds_read_b128 v[112:115], v132 offset:28672
    ds_read_b128 v[116:119], v132 offset:29696
    v_mfma_f32_16x16x32_bf16 v[28:31], a[92:95], v[124:127], v[28:31]
    v_mul_f32 v72, v72, v142
    v_mfma_f32_16x16x32_bf16 v[24:27], a[84:87], v[124:127], v[24:27]
    v_mul_f32 v73, v73, v142
    buffer_load_dwordx4 v130, s[44:47], s24 offen offset:3072 sc1 lds
    v_mfma_f32_16x16x32_bf16 v[24:27], a[80:83], v[120:123], v[24:27]
    v_mul_f32 v74, v74, v142
    s_waitcnt lgkmcnt(4)
    v_mfma_f32_16x16x32_bf16 v[32:35], a[80:83], v[96:99], v[32:35]
    v_mul_f32 v75, v75, v142
    ds_read_b128 v[120:123], v132 offset:30720
    ds_read_b128 v[124:127], v132 offset:31744
    v_mfma_f32_16x16x32_bf16 v[32:35], a[84:87], v[100:103], v[32:35]
    v_mul_f32 v84, v80, v150
    v_mfma_f32_16x16x32_bf16 v[36:39], a[92:95], v[100:103], v[36:39]
    v_mul_f32 v85, v81, v150
    s_waitcnt vmcnt(8)
    s_barrier
    v_mfma_f32_16x16x32_bf16 v[36:39], a[88:91], v[96:99], v[36:39]
    v_mul_f32 v86, v82, v150
    s_add_u32 s25, s25, 2048
    buffer_load_dwordx4 a[112:115], v128, s[44:47], s25 offen offset:0 sc1
    s_waitcnt lgkmcnt(4)
    v_mfma_f32_16x16x32_bf16 v[44:47], a[88:91], v[104:107], v[44:47]
    v_mul_f32 v87, v83, v150
    ds_read_b128 v[96:99], v131 offset:0
    ds_read_b128 v[100:103], v131 offset:1024
    v_mfma_f32_16x16x32_bf16 v[44:47], a[92:95], v[108:111], v[44:47]
    v_mul_f32 v80, v80, v142
    v_mfma_f32_16x16x32_bf16 v[40:43], a[84:87], v[108:111], v[40:43]
    v_mul_f32 v81, v81, v142
    v_mfma_f32_16x16x32_bf16 v[40:43], a[80:83], v[104:107], v[40:43]
    v_mul_f32 v82, v82, v142
    s_waitcnt lgkmcnt(4)
    v_mfma_f32_16x16x32_bf16 v[48:51], a[80:83], v[112:115], v[48:51]
    v_mul_f32 v83, v83, v142
    buffer_load_dwordx4 a[116:119], v128, s[44:47], s25 offen offset:1024 sc1
    ds_read_b128 v[104:107], v131 offset:2048
    ds_read_b128 v[108:111], v131 offset:3072
    v_mfma_f32_16x16x32_bf16 v[48:51], a[84:87], v[116:119], v[48:51]
    v_mul_f32 v92, v88, v150
    v_mfma_f32_16x16x32_bf16 v[52:55], a[92:95], v[116:119], v[52:55]
    v_mul_f32 v93, v89, v150
    v_mfma_f32_16x16x32_bf16 v[52:55], a[88:91], v[112:115], v[52:55]
    v_mul_f32 v94, v90, v150
    s_waitcnt lgkmcnt(4)
    v_mfma_f32_16x16x32_bf16 v[60:63], a[88:91], v[120:123], v[60:63]
    v_mul_f32 v95, v91, v150
    ds_read_b128 v[112:115], v131 offset:4096
    ds_read_b128 v[116:119], v131 offset:5120
    v_mfma_f32_16x16x32_bf16 v[60:63], a[92:95], v[124:127], v[60:63]
    v_mul_f32 v88, v88, v142
    buffer_load_dwordx4 a[120:123], v129, s[44:47], s25 offen offset:0 sc1
    v_mfma_f32_16x16x32_bf16 v[56:59], a[84:87], v[124:127], v[56:59]
    v_mul_f32 v89, v89, v142
    v_mfma_f32_16x16x32_bf16 v[56:59], a[80:83], v[120:123], v[56:59]
    v_mul_f32 v90, v90, v142
    ds_read_b128 v[120:123], v131 offset:6144
    ds_read_b128 v[124:127], v131 offset:7168
    s_waitcnt vmcnt(7) lgkmcnt(6)
    v_mfma_f32_16x16x32_bf16 v[0:3], a[96:99], v[96:99], v[0:3]
    v_mul_f32 v91, v91, v142
    v_mfma_f32_16x16x32_bf16 v[0:3], a[100:103], v[100:103], v[0:3]
    s_mov_b32 s52, 0x358637bd
    v_mfma_f32_16x16x32_bf16 v[4:7], a[108:111], v[100:103], v[4:7]
    s_mov_b32 s53, 0x358637bd
    buffer_load_dwordx4 a[124:127], v129, s[44:47], s25 offen offset:1024 sc1
    v_mfma_f32_16x16x32_bf16 v[4:7], a[104:107], v[96:99], v[4:7]
    s_mov_b32 s54, 0x3fb8aa3b
    s_waitcnt lgkmcnt(4)
    v_mfma_f32_16x16x32_bf16 v[12:15], a[104:107], v[104:107], v[12:15]
    v_mul_f32 v158, s54, v162
    ds_read_b128 v[96:99], v131 offset:8192
    ds_read_b128 v[100:103], v131 offset:9216
    v_mfma_f32_16x16x32_bf16 v[12:15], a[108:111], v[108:111], v[12:15]
    v_mul_f32 v159, s54, v163
    v_mfma_f32_16x16x32_bf16 v[8:11], a[100:103], v[108:111], v[8:11]
    v_mul_f32 v160, s54, v164
    v_mfma_f32_16x16x32_bf16 v[8:11], a[96:99], v[104:107], v[8:11]
    v_mul_f32 v161, s54, v165
    s_add_u32 m0, s26, 32768
    s_add_u32 s24, s24, 16384
    buffer_load_dwordx4 v130, s[44:47], s24 offen offset:0 sc1 lds
    s_waitcnt lgkmcnt(4)
    v_mfma_f32_16x16x32_bf16 v[16:19], a[96:99], v[112:115], v[16:19]
    v_mul_f32 v142, s54, v146
    ds_read_b128 v[104:107], v131 offset:10240
    ds_read_b128 v[108:111], v131 offset:11264
    v_mfma_f32_16x16x32_bf16 v[16:19], a[100:103], v[116:119], v[16:19]
    v_mul_f32 v166, s54, v170
    v_mfma_f32_16x16x32_bf16 v[20:23], a[108:111], v[116:119], v[20:23]
    v_mul_f32 v167, s54, v171
    v_mfma_f32_16x16x32_bf16 v[20:23], a[104:107], v[112:115], v[20:23]
    v_mul_f32 v168, s54, v172
    s_waitcnt lgkmcnt(4)
    v_mfma_f32_16x16x32_bf16 v[28:31], a[104:107], v[120:123], v[28:31]
    v_mul_f32 v169, s54, v173
    buffer_load_dwordx4 v130, s[44:47], s24 offen offset:1024 sc1 lds
    ds_read_b128 v[112:115], v131 offset:12288
    ds_read_b128 v[116:119], v131 offset:13312
    v_mfma_f32_16x16x32_bf16 v[28:31], a[108:111], v[124:127], v[28:31]
    v_mul_f32 v150, s54, v154
    v_mfma_f32_16x16x32_bf16 v[24:27], a[100:103], v[124:127], v[24:27]
    v_mov_b32 v140, 1.0
    v_mfma_f32_16x16x32_bf16 v[24:27], a[96:99], v[120:123], v[24:27]
    v_mov_b32 v141, 1.0
    s_waitcnt lgkmcnt(4)
    v_mfma_f32_16x16x32_bf16 v[32:35], a[96:99], v[96:99], v[32:35]
    v_mov_b32 v246, 0x3f803f80
    ds_read_b128 v[120:123], v131 offset:14336
    ds_read_b128 v[124:127], v131 offset:15360
    v_mfma_f32_16x16x32_bf16 v[32:35], a[100:103], v[100:103], v[32:35]
    v_mov_b32 v247, 0x3f803f80
    buffer_load_dwordx4 v130, s[44:47], s24 offen offset:2048 sc1 lds
    v_mfma_f32_16x16x32_bf16 v[36:39], a[108:111], v[100:103], v[36:39]
    v_mov_b32 v248, 0x3f803f80
    s_waitcnt vmcnt(7)
    s_barrier
    v_mfma_f32_16x16x32_bf16 v[36:39], a[104:107], v[96:99], v[36:39]
    v_mov_b32 v249, 0x3f803f80
    s_waitcnt lgkmcnt(4)
    v_mfma_f32_16x16x32_bf16 v[44:47], a[104:107], v[104:107], v[44:47]
    v_mov_b32 v250, 0x358637bd
    ds_read_b128 v[96:99], v131 offset:16384
    ds_read_b128 v[100:103], v131 offset:17408
    v_mfma_f32_16x16x32_bf16 v[44:47], a[108:111], v[108:111], v[44:47]
    v_mov_b32 v251, 0x358637bd
    v_mfma_f32_16x16x32_bf16 v[40:43], a[100:103], v[108:111], v[40:43]
    v_mov_b32 v252, 0x358637bd
    buffer_load_dwordx4 v130, s[44:47], s24 offen offset:3072 sc1 lds
    v_mfma_f32_16x16x32_bf16 v[40:43], a[96:99], v[104:107], v[40:43]
    v_mov_b32 v253, 0x358637bd
    s_waitcnt lgkmcnt(4)
    v_mfma_f32_16x16x32_bf16 v[48:51], a[96:99], v[112:115], v[48:51]
    s_mul_i32 s55, s34, 8448
    ds_read_b128 v[104:107], v131 offset:18432
    ds_read_b128 v[108:111], v131 offset:19456
    v_mfma_f32_16x16x32_bf16 v[48:51], a[100:103], v[116:119], v[48:51]
    s_add_u32 s55, s55, 100352
    v_mfma_f32_16x16x32_bf16 v[52:55], a[108:111], v[116:119], v[52:55]
    v_add_u32 v254, s55, v128
    v_mfma_f32_16x16x32_bf16 v[52:55], a[104:107], v[112:115], v[52:55]
    v_lshl_add_u32 v255, v135, 4, s55
    s_add_u32 s25, s25, 2048
    buffer_load_dwordx4 a[128:131], v128, s[44:47], s25 offen offset:0 sc1
    s_waitcnt lgkmcnt(4)
    v_mfma_f32_16x16x32_bf16 v[60:63], a[104:107], v[120:123], v[60:63]
    v_add_u32 v138, 100352, v137
    ds_read_b128 v[112:115], v131 offset:20480
    ds_read_b128 v[116:119], v131 offset:21504
    v_mfma_f32_16x16x32_bf16 v[60:63], a[108:111], v[124:127], v[60:63]
    s_lshl_b32 s56, s38, 13
    v_mfma_f32_16x16x32_bf16 v[56:59], a[100:103], v[124:127], v[56:59]
    s_add_u32 s56, s56, 54067200
    v_mfma_f32_16x16x32_bf16 v[56:59], a[96:99], v[120:123], v[56:59]
    s_add_u32 s57, s56, 4096
    buffer_load_dwordx4 a[132:135], v128, s[44:47], s25 offen offset:1024 sc1
    ds_read_b128 v[120:123], v131 offset:22528
    ds_read_b128 v[124:127], v131 offset:23552
    s_waitcnt vmcnt(6) lgkmcnt(6)
    v_mfma_f32_16x16x32_bf16 v[0:3], a[112:115], v[96:99], v[0:3]
    s_lshl_b32 s59, s38, 7
    v_mfma_f32_16x16x32_bf16 v[0:3], a[116:119], v[100:103], v[0:3]
    s_add_u32 s59, s59, 54337536
    v_mfma_f32_16x16x32_bf16 v[4:7], a[124:127], v[100:103], v[4:7]
    s_lshl_b32 s58, s38, 8
    v_mfma_f32_16x16x32_bf16 v[4:7], a[120:123], v[96:99], v[4:7]
    s_add_u32 s58, s58, 54198272
    s_waitcnt lgkmcnt(4)
    v_mfma_f32_16x16x32_bf16 v[12:15], a[120:123], v[104:107], v[12:15]
    s_lshl_b32 s60, s42, 15
    buffer_load_dwordx4 a[136:139], v129, s[44:47], s25 offen offset:0 sc1
    ds_read_b128 v[96:99], v131 offset:24576
    ds_read_b128 v[100:103], v131 offset:25600
    v_mfma_f32_16x16x32_bf16 v[12:15], a[124:127], v[108:111], v[12:15]
    s_lshl_b32 s61, s38, 11
    v_mfma_f32_16x16x32_bf16 v[8:11], a[116:119], v[108:111], v[8:11]
    s_add_u32 s60, s60, s61
    v_mfma_f32_16x16x32_bf16 v[8:11], a[112:115], v[104:107], v[8:11]
    s_add_u32 s60, s60, 4194304
    s_waitcnt lgkmcnt(4)
    v_mfma_f32_16x16x32_bf16 v[16:19], a[112:115], v[112:115], v[16:19]
    s_add_u32 s61, s60, 32768
    ds_read_b128 v[104:107], v131 offset:26624
    ds_read_b128 v[108:111], v131 offset:27648
    v_mfma_f32_16x16x32_bf16 v[16:19], a[116:119], v[116:119], v[16:19]
    v_min_u32 v184, 1, v133
    buffer_load_dwordx4 a[140:143], v129, s[44:47], s25 offen offset:1024 sc1
    v_mfma_f32_16x16x32_bf16 v[20:23], a[124:127], v[116:119], v[20:23]
    v_lshlrev_b32 v184, 26, v184
    v_mfma_f32_16x16x32_bf16 v[20:23], a[120:123], v[112:115], v[20:23]
    v_mov_b32 v185, 1
    s_waitcnt lgkmcnt(4)
    v_mfma_f32_16x16x32_bf16 v[28:31], a[120:123], v[120:123], v[28:31]
    v_mov_b32 v134, 0
    ds_read_b128 v[112:115], v131 offset:28672
    ds_read_b128 v[116:119], v131 offset:29696
    v_mfma_f32_16x16x32_bf16 v[28:31], a[124:127], v[124:127], v[28:31]
    s_lshl_b32 s40, s34, 11
    v_mfma_f32_16x16x32_bf16 v[24:27], a[116:119], v[124:127], v[24:27]
    s_add_u32 s40, s40, s56
    s_add_u32 m0, s26, 49152
    s_add_u32 s24, s24, 16384
    buffer_load_dwordx4 v130, s[44:47], s24 offen offset:0 sc1 lds
    v_mfma_f32_16x16x32_bf16 v[24:27], a[112:115], v[120:123], v[24:27]
    s_lshl_b32 s41, s34, 10
    s_waitcnt lgkmcnt(4)
    v_mfma_f32_16x16x32_bf16 v[32:35], a[112:115], v[96:99], v[32:35]
    s_add_u32 s41, s41, 155648
    ds_read_b128 v[120:123], v131 offset:30720
    ds_read_b128 v[124:127], v131 offset:31744
    v_mfma_f32_16x16x32_bf16 v[32:35], a[116:119], v[100:103], v[32:35]
    v_add_u32 v139, s41, v128
    v_mfma_f32_16x16x32_bf16 v[36:39], a[124:127], v[100:103], v[36:39]
    v_add_u32 v186, 155648, v128
    s_waitcnt vmcnt(5)
    s_barrier
    v_mfma_f32_16x16x32_bf16 v[36:39], a[120:123], v[96:99], v[36:39]
    v_lshlrev_b32 v135, 4, v135
    buffer_load_dwordx4 v130, s[44:47], s24 offen offset:1024 sc1 lds
    s_waitcnt lgkmcnt(4)
    v_mfma_f32_16x16x32_bf16 v[44:47], a[120:123], v[104:107], v[44:47]
    s_lshl_b32 s18, s37, 7
    ds_read_b128 v[96:99], v131 offset:32768
    ds_read_b128 v[100:103], v131 offset:33792
    v_mfma_f32_16x16x32_bf16 v[44:47], a[124:127], v[108:111], v[44:47]
    s_add_u32 s18, s18, 54339584
    v_mfma_f32_16x16x32_bf16 v[40:43], a[116:119], v[108:111], v[40:43]
    s_and_b32 s35, s2, 7
    v_mfma_f32_16x16x32_bf16 v[40:43], a[112:115], v[104:107], v[40:43]
    s_lshr_b32 s36, s2, 3
    s_waitcnt lgkmcnt(4)
    v_mfma_f32_16x16x32_bf16 v[48:51], a[112:115], v[112:115], v[48:51]
    s_lshr_b32 s37, s35, 1
    buffer_load_dwordx4 v130, s[44:47], s24 offen offset:2048 sc1 lds
    ds_read_b128 v[104:107], v131 offset:34816
    ds_read_b128 v[108:111], v131 offset:35840
    v_mfma_f32_16x16x32_bf16 v[48:51], a[116:119], v[116:119], v[48:51]
    s_lshl_b32 s37, s37, 2
    v_mfma_f32_16x16x32_bf16 v[52:55], a[124:127], v[116:119], v[52:55]
    s_lshr_b32 s38, s36, 3
    v_mfma_f32_16x16x32_bf16 v[52:55], a[120:123], v[112:115], v[52:55]
    s_add_u32 s37, s37, s38
    s_waitcnt lgkmcnt(4)
    v_mfma_f32_16x16x32_bf16 v[60:63], a[120:123], v[120:123], v[60:63]
    s_and_b32 s38, s35, 1
    ds_read_b128 v[112:115], v131 offset:36864
    ds_read_b128 v[116:119], v131 offset:37888
    v_mfma_f32_16x16x32_bf16 v[60:63], a[124:127], v[124:127], v[60:63]
    s_lshl_b32 s38, s38, 3
    buffer_load_dwordx4 v130, s[44:47], s24 offen offset:3072 sc1 lds
    v_mfma_f32_16x16x32_bf16 v[56:59], a[116:119], v[124:127], v[56:59]
    s_and_b32 s39, s36, 7
    v_mfma_f32_16x16x32_bf16 v[56:59], a[112:115], v[120:123], v[56:59]
    s_add_u32 s38, s38, s39
    ds_read_b128 v[120:123], v131 offset:38912
    ds_read_b128 v[124:127], v131 offset:39936
    s_waitcnt vmcnt(4) lgkmcnt(6)
    v_mfma_f32_16x16x32_bf16 v[0:3], a[128:131], v[96:99], v[0:3]
    s_lshl_b32 s42, s37, 3
    v_mfma_f32_16x16x32_bf16 v[0:3], a[132:135], v[100:103], v[0:3]
    s_lshl_b32 s43, s34, 1
    v_mfma_f32_16x16x32_bf16 v[4:7], a[140:143], v[100:103], v[4:7]
    s_add_u32 s42, s42, s43
    s_add_u32 s25, s25, 2048
    buffer_load_dwordx4 a[144:147], v128, s[44:47], s25 offen offset:0 sc1
    v_mfma_f32_16x16x32_bf16 v[4:7], a[136:139], v[96:99], v[4:7]
    s_lshl_b32 s20, s38, 17
    s_waitcnt lgkmcnt(4)
    v_mfma_f32_16x16x32_bf16 v[12:15], a[136:139], v[104:107], v[12:15]
    s_add_u32 s20, s20, 29360128
    ds_read_b128 v[96:99], v131 offset:40960
    ds_read_b128 v[100:103], v131 offset:41984
    v_mfma_f32_16x16x32_bf16 v[12:15], a[140:143], v[108:111], v[12:15]
    s_lshl_b32 s21, s34, 11
    v_mfma_f32_16x16x32_bf16 v[8:11], a[132:135], v[108:111], v[8:11]
    v_add_u32 v187, s21, v128
    v_mfma_f32_16x16x32_bf16 v[8:11], a[128:131], v[104:107], v[8:11]
    s_lshl_b32 s22, s37, 7
    buffer_load_dwordx4 a[148:151], v128, s[44:47], s25 offen offset:1024 sc1
    s_waitcnt lgkmcnt(4)
    v_mfma_f32_16x16x32_bf16 v[16:19], a[128:131], v[112:115], v[16:19]
    s_add_u32 s22, s22, 54339584
    ds_read_b128 v[104:107], v131 offset:43008
    ds_read_b128 v[108:111], v131 offset:44032
    v_mfma_f32_16x16x32_bf16 v[16:19], a[132:135], v[116:119], v[16:19]
    s_lshl_b32 s23, s42, 15
    v_mfma_f32_16x16x32_bf16 v[20:23], a[140:143], v[116:119], v[20:23]
    s_add_u32 s23, s23, 4194304
    v_mfma_f32_16x16x32_bf16 v[20:23], a[136:139], v[112:115], v[20:23]
    v_add_u32 v188, 65536, v128
    s_waitcnt lgkmcnt(4)
    v_mfma_f32_16x16x32_bf16 v[28:31], a[136:139], v[120:123], v[28:31]
    v_add_u32 v189, 131072, v128
    buffer_load_dwordx4 a[152:155], v129, s[44:47], s25 offen offset:0 sc1
    ds_read_b128 v[112:115], v131 offset:45056
    ds_read_b128 v[116:119], v131 offset:46080
    v_mfma_f32_16x16x32_bf16 v[28:31], a[140:143], v[124:127], v[28:31]
    v_mfma_f32_16x16x32_bf16 v[24:27], a[132:135], v[124:127], v[24:27]
    v_mfma_f32_16x16x32_bf16 v[24:27], a[128:131], v[120:123], v[24:27]
    ds_read_b128 v[120:123], v131 offset:47104
    s_waitcnt lgkmcnt(5)
    v_mfma_f32_16x16x32_bf16 v[32:35], a[128:131], v[96:99], v[32:35]
    buffer_load_dwordx4 a[156:159], v129, s[44:47], s25 offen offset:1024 sc1
    ds_read_b128 v[124:127], v131 offset:48128
    v_mfma_f32_16x16x32_bf16 v[32:35], a[132:135], v[100:103], v[32:35]
    v_mfma_f32_16x16x32_bf16 v[36:39], a[140:143], v[100:103], v[36:39]
    s_waitcnt vmcnt(4)
    s_barrier
    v_mfma_f32_16x16x32_bf16 v[36:39], a[136:139], v[96:99], v[36:39]
    ds_read_b128 v[96:99], v131 offset:49152
    s_waitcnt lgkmcnt(5)
    v_mfma_f32_16x16x32_bf16 v[44:47], a[136:139], v[104:107], v[44:47]
    s_add_u32 m0, s26, 65536
    s_add_u32 s24, s24, 16384
    buffer_load_dwordx4 v130, s[44:47], s24 offen offset:0 sc1 lds
    ds_read_b128 v[100:103], v131 offset:50176
    v_mfma_f32_16x16x32_bf16 v[44:47], a[140:143], v[108:111], v[44:47]
    v_mfma_f32_16x16x32_bf16 v[40:43], a[132:135], v[108:111], v[40:43]
    v_mfma_f32_16x16x32_bf16 v[40:43], a[128:131], v[104:107], v[40:43]
    ds_read_b128 v[104:107], v131 offset:51200
    s_waitcnt lgkmcnt(5)
    v_mfma_f32_16x16x32_bf16 v[48:51], a[128:131], v[112:115], v[48:51]
    buffer_load_dwordx4 v130, s[44:47], s24 offen offset:1024 sc1 lds
    ds_read_b128 v[108:111], v131 offset:52224
    v_mfma_f32_16x16x32_bf16 v[48:51], a[132:135], v[116:119], v[48:51]
    v_mfma_f32_16x16x32_bf16 v[52:55], a[140:143], v[116:119], v[52:55]
    v_mfma_f32_16x16x32_bf16 v[52:55], a[136:139], v[112:115], v[52:55]
    ds_read_b128 v[112:115], v131 offset:53248
    s_waitcnt lgkmcnt(5)
    v_mfma_f32_16x16x32_bf16 v[60:63], a[136:139], v[120:123], v[60:63]
    buffer_load_dwordx4 v130, s[44:47], s24 offen offset:2048 sc1 lds
    ds_read_b128 v[116:119], v131 offset:54272
    v_mfma_f32_16x16x32_bf16 v[60:63], a[140:143], v[124:127], v[60:63]
    v_mfma_f32_16x16x32_bf16 v[56:59], a[132:135], v[124:127], v[56:59]
    v_mfma_f32_16x16x32_bf16 v[56:59], a[128:131], v[120:123], v[56:59]
    buffer_load_dwordx4 v130, s[44:47], s24 offen offset:3072 sc1 lds
    ds_read_b128 v[120:123], v131 offset:55296
    ds_read_b128 v[124:127], v131 offset:56320
    s_waitcnt vmcnt(4) lgkmcnt(6)
    v_mfma_f32_16x16x32_bf16 v[0:3], a[144:147], v[96:99], v[0:3]
    v_mfma_f32_16x16x32_bf16 v[0:3], a[148:151], v[100:103], v[0:3]
    v_mfma_f32_16x16x32_bf16 v[4:7], a[156:159], v[100:103], v[4:7]
    s_add_u32 s25, s25, 2048
    buffer_load_dwordx4 a[160:163], v128, s[44:47], s25 offen offset:0 sc1
    v_mfma_f32_16x16x32_bf16 v[4:7], a[152:155], v[96:99], v[4:7]
    ds_read_b128 v[96:99], v131 offset:57344
    s_waitcnt lgkmcnt(5)
    v_mfma_f32_16x16x32_bf16 v[12:15], a[152:155], v[104:107], v[12:15]
    ds_read_b128 v[100:103], v131 offset:58368
    v_mfma_f32_16x16x32_bf16 v[12:15], a[156:159], v[108:111], v[12:15]
    buffer_load_dwordx4 a[164:167], v128, s[44:47], s25 offen offset:1024 sc1
    v_mfma_f32_16x16x32_bf16 v[8:11], a[148:151], v[108:111], v[8:11]
    v_mfma_f32_16x16x32_bf16 v[8:11], a[144:147], v[104:107], v[8:11]
    ds_read_b128 v[104:107], v131 offset:59392
    s_waitcnt lgkmcnt(5)
    v_mfma_f32_16x16x32_bf16 v[16:19], a[144:147], v[112:115], v[16:19]
    buffer_load_dwordx4 a[168:171], v129, s[44:47], s25 offen offset:0 sc1
    ds_read_b128 v[108:111], v131 offset:60416
    v_mfma_f32_16x16x32_bf16 v[16:19], a[148:151], v[116:119], v[16:19]
    v_mfma_f32_16x16x32_bf16 v[20:23], a[156:159], v[116:119], v[20:23]
    v_mfma_f32_16x16x32_bf16 v[20:23], a[152:155], v[112:115], v[20:23]
    ds_read_b128 v[112:115], v131 offset:61440
    s_waitcnt lgkmcnt(5)
    v_mfma_f32_16x16x32_bf16 v[28:31], a[152:155], v[120:123], v[28:31]
    buffer_load_dwordx4 a[172:175], v129, s[44:47], s25 offen offset:1024 sc1
    ds_read_b128 v[116:119], v131 offset:62464
    v_mfma_f32_16x16x32_bf16 v[28:31], a[156:159], v[124:127], v[28:31]
    v_mfma_f32_16x16x32_bf16 v[24:27], a[148:151], v[124:127], v[24:27]
    v_mfma_f32_16x16x32_bf16 v[24:27], a[144:147], v[120:123], v[24:27]
    ds_read_b128 v[120:123], v131 offset:63488
    s_waitcnt lgkmcnt(5)
    v_mfma_f32_16x16x32_bf16 v[32:35], a[144:147], v[96:99], v[32:35]
    s_add_u32 m0, s26, 81920
    s_add_u32 s24, s24, 16384
    buffer_load_dwordx4 v130, s[44:47], s24 offen offset:0 sc1 lds
    ds_read_b128 v[124:127], v131 offset:64512
    v_mfma_f32_16x16x32_bf16 v[32:35], a[148:151], v[100:103], v[32:35]
    v_mfma_f32_16x16x32_bf16 v[36:39], a[156:159], v[100:103], v[36:39]
    s_waitcnt vmcnt(5)
    s_barrier
    v_mfma_f32_16x16x32_bf16 v[36:39], a[152:155], v[96:99], v[36:39]
    ds_read_b128 v[96:99], v132 offset:0
    s_waitcnt lgkmcnt(5)
    v_mfma_f32_16x16x32_bf16 v[44:47], a[152:155], v[104:107], v[44:47]
    buffer_load_dwordx4 v130, s[44:47], s24 offen offset:1024 sc1 lds
    ds_read_b128 v[100:103], v132 offset:1024
    v_mfma_f32_16x16x32_bf16 v[44:47], a[156:159], v[108:111], v[44:47]
    v_mfma_f32_16x16x32_bf16 v[40:43], a[148:151], v[108:111], v[40:43]
    v_mfma_f32_16x16x32_bf16 v[40:43], a[144:147], v[104:107], v[40:43]
    ds_read_b128 v[104:107], v132 offset:2048
    s_waitcnt lgkmcnt(5)
    v_mfma_f32_16x16x32_bf16 v[48:51], a[144:147], v[112:115], v[48:51]
    buffer_load_dwordx4 v130, s[44:47], s24 offen offset:2048 sc1 lds
    ds_read_b128 v[108:111], v132 offset:3072
    v_mfma_f32_16x16x32_bf16 v[48:51], a[148:151], v[116:119], v[48:51]
    v_mfma_f32_16x16x32_bf16 v[52:55], a[156:159], v[116:119], v[52:55]
    v_mfma_f32_16x16x32_bf16 v[52:55], a[152:155], v[112:115], v[52:55]
    ds_read_b128 v[112:115], v132 offset:4096
    s_waitcnt lgkmcnt(5)
    v_mfma_f32_16x16x32_bf16 v[60:63], a[152:155], v[120:123], v[60:63]
    buffer_load_dwordx4 v130, s[44:47], s24 offen offset:3072 sc1 lds
    ds_read_b128 v[116:119], v132 offset:5120
    v_mfma_f32_16x16x32_bf16 v[60:63], a[156:159], v[124:127], v[60:63]
    v_mfma_f32_16x16x32_bf16 v[56:59], a[148:151], v[124:127], v[56:59]
    v_mfma_f32_16x16x32_bf16 v[56:59], a[144:147], v[120:123], v[56:59]
    s_add_u32 s25, s25, 2048
    buffer_load_dwordx4 a[176:179], v128, s[44:47], s25 offen offset:0 sc1
    ds_read_b128 v[120:123], v132 offset:6144
    ds_read_b128 v[124:127], v132 offset:7168
    s_waitcnt vmcnt(5) lgkmcnt(6)
    v_mfma_f32_16x16x32_bf16 v[0:3], a[160:163], v[96:99], v[0:3]
    v_mfma_f32_16x16x32_bf16 v[0:3], a[164:167], v[100:103], v[0:3]
    v_mfma_f32_16x16x32_bf16 v[4:7], a[172:175], v[100:103], v[4:7]
    buffer_load_dwordx4 a[180:183], v128, s[44:47], s25 offen offset:1024 sc1
    v_mfma_f32_16x16x32_bf16 v[4:7], a[168:171], v[96:99], v[4:7]
    ds_read_b128 v[96:99], v132 offset:8192
    s_waitcnt lgkmcnt(5)
    v_mfma_f32_16x16x32_bf16 v[12:15], a[168:171], v[104:107], v[12:15]
    ds_read_b128 v[100:103], v132 offset:9216
    v_mfma_f32_16x16x32_bf16 v[12:15], a[172:175], v[108:111], v[12:15]
    buffer_load_dwordx4 a[184:187], v129, s[44:47], s25 offen offset:0 sc1
    v_mfma_f32_16x16x32_bf16 v[8:11], a[164:167], v[108:111], v[8:11]
    v_mfma_f32_16x16x32_bf16 v[8:11], a[160:163], v[104:107], v[8:11]
    ds_read_b128 v[104:107], v132 offset:10240
    s_waitcnt lgkmcnt(5)
    v_mfma_f32_16x16x32_bf16 v[16:19], a[160:163], v[112:115], v[16:19]
    buffer_load_dwordx4 a[188:191], v129, s[44:47], s25 offen offset:1024 sc1
    ds_read_b128 v[108:111], v132 offset:11264
    v_mfma_f32_16x16x32_bf16 v[16:19], a[164:167], v[116:119], v[16:19]
    v_mfma_f32_16x16x32_bf16 v[20:23], a[172:175], v[116:119], v[20:23]
    v_mfma_f32_16x16x32_bf16 v[20:23], a[168:171], v[112:115], v[20:23]
    ds_read_b128 v[112:115], v132 offset:12288
    s_waitcnt lgkmcnt(5)
    v_mfma_f32_16x16x32_bf16 v[28:31], a[168:171], v[120:123], v[28:31]
    s_add_u32 m0, s26, 0
    s_add_u32 s24, s24, 16384
    buffer_load_dwordx4 v130, s[44:47], s24 offen offset:0 sc1 lds
    ds_read_b128 v[116:119], v132 offset:13312
    v_mfma_f32_16x16x32_bf16 v[28:31], a[172:175], v[124:127], v[28:31]
    v_mfma_f32_16x16x32_bf16 v[24:27], a[164:167], v[124:127], v[24:27]
    v_mfma_f32_16x16x32_bf16 v[24:27], a[160:163], v[120:123], v[24:27]
    ds_read_b128 v[120:123], v132 offset:14336
    s_waitcnt lgkmcnt(5)
    v_mfma_f32_16x16x32_bf16 v[32:35], a[160:163], v[96:99], v[32:35]
    buffer_load_dwordx4 v130, s[44:47], s24 offen offset:1024 sc1 lds
    ds_read_b128 v[124:127], v132 offset:15360
    v_mfma_f32_16x16x32_bf16 v[32:35], a[164:167], v[100:103], v[32:35]
    v_mfma_f32_16x16x32_bf16 v[36:39], a[172:175], v[100:103], v[36:39]
    s_waitcnt vmcnt(6)
    s_barrier
    v_mfma_f32_16x16x32_bf16 v[36:39], a[168:171], v[96:99], v[36:39]
    ds_read_b128 v[96:99], v132 offset:16384
    s_waitcnt lgkmcnt(5)
    v_mfma_f32_16x16x32_bf16 v[44:47], a[168:171], v[104:107], v[44:47]
    buffer_load_dwordx4 v130, s[44:47], s24 offen offset:2048 sc1 lds
    ds_read_b128 v[100:103], v132 offset:17408
    v_mfma_f32_16x16x32_bf16 v[44:47], a[172:175], v[108:111], v[44:47]
    v_mfma_f32_16x16x32_bf16 v[40:43], a[164:167], v[108:111], v[40:43]
    v_mfma_f32_16x16x32_bf16 v[40:43], a[160:163], v[104:107], v[40:43]
    ds_read_b128 v[104:107], v132 offset:18432
    s_waitcnt lgkmcnt(5)
    v_mfma_f32_16x16x32_bf16 v[48:51], a[160:163], v[112:115], v[48:51]
    buffer_load_dwordx4 v130, s[44:47], s24 offen offset:3072 sc1 lds
    ds_read_b128 v[108:111], v132 offset:19456
    v_mfma_f32_16x16x32_bf16 v[48:51], a[164:167], v[116:119], v[48:51]
    v_mfma_f32_16x16x32_bf16 v[52:55], a[172:175], v[116:119], v[52:55]
    v_mfma_f32_16x16x32_bf16 v[52:55], a[168:171], v[112:115], v[52:55]
    ds_read_b128 v[112:115], v132 offset:20480
    s_waitcnt lgkmcnt(5)
    v_mfma_f32_16x16x32_bf16 v[60:63], a[168:171], v[120:123], v[60:63]
    s_add_u32 s25, s25, 2048
    buffer_load_dwordx4 a[192:195], v128, s[44:47], s25 offen offset:0 sc1
    ds_read_b128 v[116:119], v132 offset:21504
    v_mfma_f32_16x16x32_bf16 v[60:63], a[172:175], v[124:127], v[60:63]
    v_mfma_f32_16x16x32_bf16 v[56:59], a[164:167], v[124:127], v[56:59]
    v_mfma_f32_16x16x32_bf16 v[56:59], a[160:163], v[120:123], v[56:59]
    buffer_load_dwordx4 a[196:199], v128, s[44:47], s25 offen offset:1024 sc1
    ds_read_b128 v[120:123], v132 offset:22528
    ds_read_b128 v[124:127], v132 offset:23552
    s_waitcnt vmcnt(6) lgkmcnt(6)
    v_mfma_f32_16x16x32_bf16 v[0:3], a[176:179], v[96:99], v[0:3]
    v_mfma_f32_16x16x32_bf16 v[0:3], a[180:183], v[100:103], v[0:3]
    s_cmp_eq_u32 s34, 0
    s_cselect_b32 s62, s58, 0x7ff00000
    s_cselect_b32 s63, s59, 0x7ff00000
    s_cselect_b32 s19, s18, 0x7ff00000
    v_mfma_f32_16x16x32_bf16 v[4:7], a[188:191], v[100:103], v[4:7]
    buffer_load_dwordx4 a[200:203], v129, s[44:47], s25 offen offset:0 sc1
    v_mfma_f32_16x16x32_bf16 v[4:7], a[184:187], v[96:99], v[4:7]
    ds_read_b128 v[96:99], v132 offset:24576
    s_waitcnt lgkmcnt(5)
    v_mfma_f32_16x16x32_bf16 v[12:15], a[184:187], v[104:107], v[12:15]
    ds_read_b128 v[100:103], v132 offset:25600
    v_mfma_f32_16x16x32_bf16 v[12:15], a[188:191], v[108:111], v[12:15]
    buffer_load_dwordx4 a[204:207], v129, s[44:47], s25 offen offset:1024 sc1
    v_mfma_f32_16x16x32_bf16 v[8:11], a[180:183], v[108:111], v[8:11]
    v_mfma_f32_16x16x32_bf16 v[8:11], a[176:179], v[104:107], v[8:11]
    ds_read_b128 v[104:107], v132 offset:26624
    s_waitcnt lgkmcnt(5)
    v_mfma_f32_16x16x32_bf16 v[16:19], a[176:179], v[112:115], v[16:19]
    s_add_u32 m0, s26, 16384
    s_add_u32 s24, s24, 16384
    buffer_load_dwordx4 v130, s[44:47], s24 offen offset:0 sc1 lds
    ds_read_b128 v[108:111], v132 offset:27648
    v_mfma_f32_16x16x32_bf16 v[16:19], a[180:183], v[116:119], v[16:19]
    v_mfma_f32_16x16x32_bf16 v[20:23], a[188:191], v[116:119], v[20:23]
    v_mfma_f32_16x16x32_bf16 v[20:23], a[184:187], v[112:115], v[20:23]
    ds_read_b128 v[112:115], v132 offset:28672
    s_waitcnt lgkmcnt(5)
    v_mfma_f32_16x16x32_bf16 v[28:31], a[184:187], v[120:123], v[28:31]
    buffer_load_dwordx4 v130, s[44:47], s24 offen offset:1024 sc1 lds
    ds_read_b128 v[116:119], v132 offset:29696
    v_mfma_f32_16x16x32_bf16 v[28:31], a[188:191], v[124:127], v[28:31]
    v_mfma_f32_16x16x32_bf16 v[24:27], a[180:183], v[124:127], v[24:27]
    v_mfma_f32_16x16x32_bf16 v[24:27], a[176:179], v[120:123], v[24:27]
    ds_read_b128 v[120:123], v132 offset:30720
    s_waitcnt lgkmcnt(5)
    v_mfma_f32_16x16x32_bf16 v[32:35], a[176:179], v[96:99], v[32:35]
    buffer_load_dwordx4 v130, s[44:47], s24 offen offset:2048 sc1 lds
    ds_read_b128 v[124:127], v132 offset:31744
    v_mfma_f32_16x16x32_bf16 v[32:35], a[180:183], v[100:103], v[32:35]
    v_mfma_f32_16x16x32_bf16 v[36:39], a[188:191], v[100:103], v[36:39]
    s_waitcnt vmcnt(7)
    s_barrier
    v_mfma_f32_16x16x32_bf16 v[36:39], a[184:187], v[96:99], v[36:39]
    ds_read_b128 v[96:99], v131 offset:0
    s_waitcnt lgkmcnt(5)
    v_mfma_f32_16x16x32_bf16 v[44:47], a[184:187], v[104:107], v[44:47]
    buffer_load_dwordx4 v130, s[44:47], s24 offen offset:3072 sc1 lds
    ds_read_b128 v[100:103], v131 offset:1024
    v_mfma_f32_16x16x32_bf16 v[44:47], a[188:191], v[108:111], v[44:47]
    v_mfma_f32_16x16x32_bf16 v[40:43], a[180:183], v[108:111], v[40:43]
    v_mfma_f32_16x16x32_bf16 v[40:43], a[176:179], v[104:107], v[40:43]
    ds_read_b128 v[104:107], v131 offset:2048
    s_waitcnt lgkmcnt(5)
    v_mfma_f32_16x16x32_bf16 v[48:51], a[176:179], v[112:115], v[48:51]
    s_add_u32 s25, s25, 2048
    buffer_load_dwordx4 a[208:211], v128, s[44:47], s25 offen offset:0 sc1
    ds_read_b128 v[108:111], v131 offset:3072
    v_mfma_f32_16x16x32_bf16 v[48:51], a[180:183], v[116:119], v[48:51]
    v_mfma_f32_16x16x32_bf16 v[52:55], a[188:191], v[116:119], v[52:55]
    v_mfma_f32_16x16x32_bf16 v[52:55], a[184:187], v[112:115], v[52:55]
    ds_read_b128 v[112:115], v131 offset:4096
    s_waitcnt lgkmcnt(5)
    v_mfma_f32_16x16x32_bf16 v[60:63], a[184:187], v[120:123], v[60:63]
    buffer_load_dwordx4 a[212:215], v128, s[44:47], s25 offen offset:1024 sc1
    ds_read_b128 v[116:119], v131 offset:5120
    v_mfma_f32_16x16x32_bf16 v[60:63], a[188:191], v[124:127], v[60:63]
    v_mfma_f32_16x16x32_bf16 v[56:59], a[180:183], v[124:127], v[56:59]
    v_mfma_f32_16x16x32_bf16 v[56:59], a[176:179], v[120:123], v[56:59]
    buffer_load_dwordx4 a[216:219], v129, s[44:47], s25 offen offset:0 sc1
    ds_read_b128 v[120:123], v131 offset:6144
    ds_read_b128 v[124:127], v131 offset:7168
    s_waitcnt vmcnt(7) lgkmcnt(6)
    v_mfma_f32_16x16x32_bf16 v[0:3], a[192:195], v[96:99], v[0:3]
    buffer_load_dwordx4 a[220:223], v129, s[44:47], s25 offen offset:1024 sc1
    v_mfma_f32_16x16x32_bf16 v[0:3], a[196:199], v[100:103], v[0:3]
    s_add_u32 m0, s26, 32768
    s_add_u32 s24, s24, 16384
    buffer_load_dwordx4 v130, s[44:47], s24 offen offset:0 sc1 lds
    v_mfma_f32_16x16x32_bf16 v[4:7], a[204:207], v[100:103], v[4:7]
    buffer_load_dwordx4 v130, s[44:47], s24 offen offset:1024 sc1 lds
    v_mfma_f32_16x16x32_bf16 v[4:7], a[200:203], v[96:99], v[4:7]
    ds_read_b128 v[96:99], v131 offset:8192
    s_waitcnt lgkmcnt(5)
    v_mfma_f32_16x16x32_bf16 v[12:15], a[200:203], v[104:107], v[12:15]
    buffer_load_dwordx4 v130, s[44:47], s24 offen offset:2048 sc1 lds
    ds_read_b128 v[100:103], v131 offset:9216
    v_mfma_f32_16x16x32_bf16 v[12:15], a[204:207], v[108:111], v[12:15]
    buffer_load_dwordx4 v130, s[44:47], s24 offen offset:3072 sc1 lds
    v_mfma_f32_16x16x32_bf16 v[8:11], a[196:199], v[108:111], v[8:11]
    s_add_u32 s25, s25, 2048
    buffer_load_dwordx4 a[224:227], v128, s[44:47], s25 offen offset:0 sc1
    v_mfma_f32_16x16x32_bf16 v[8:11], a[192:195], v[104:107], v[8:11]
    ds_read_b128 v[104:107], v131 offset:10240
    s_waitcnt lgkmcnt(5)
    v_mfma_f32_16x16x32_bf16 v[16:19], a[192:195], v[112:115], v[16:19]
    buffer_load_dwordx4 a[228:231], v128, s[44:47], s25 offen offset:1024 sc1
    ds_read_b128 v[108:111], v131 offset:11264
    v_mfma_f32_16x16x32_bf16 v[16:19], a[196:199], v[116:119], v[16:19]
    buffer_load_dwordx4 a[232:235], v129, s[44:47], s25 offen offset:0 sc1
    v_mfma_f32_16x16x32_bf16 v[20:23], a[204:207], v[116:119], v[20:23]
    buffer_load_dwordx4 a[236:239], v129, s[44:47], s25 offen offset:1024 sc1
    v_mfma_f32_16x16x32_bf16 v[20:23], a[200:203], v[112:115], v[20:23]
    ds_read_b128 v[112:115], v131 offset:12288
    s_waitcnt lgkmcnt(5)
    v_mfma_f32_16x16x32_bf16 v[28:31], a[200:203], v[120:123], v[28:31]
    s_add_u32 m0, s26, 49152
    s_add_u32 s24, s24, 16384
    buffer_load_dwordx4 v130, s[44:47], s24 offen offset:0 sc1 lds
    ds_read_b128 v[116:119], v131 offset:13312
    v_mfma_f32_16x16x32_bf16 v[28:31], a[204:207], v[124:127], v[28:31]
    buffer_load_dwordx4 v130, s[44:47], s24 offen offset:1024 sc1 lds
    v_mfma_f32_16x16x32_bf16 v[24:27], a[196:199], v[124:127], v[24:27]
    buffer_load_dwordx4 v130, s[44:47], s24 offen offset:2048 sc1 lds
    v_mfma_f32_16x16x32_bf16 v[24:27], a[192:195], v[120:123], v[24:27]
    ds_read_b128 v[120:123], v131 offset:14336
    s_waitcnt lgkmcnt(5)
    v_mfma_f32_16x16x32_bf16 v[32:35], a[192:195], v[96:99], v[32:35]
    buffer_load_dwordx4 v130, s[44:47], s24 offen offset:3072 sc1 lds
    ds_read_b128 v[124:127], v131 offset:15360
    v_mfma_f32_16x16x32_bf16 v[32:35], a[196:199], v[100:103], v[32:35]
    s_add_u32 s25, s25, 2048
    buffer_load_dwordx4 a[240:243], v128, s[44:47], s25 offen offset:0 sc1
    v_mfma_f32_16x16x32_bf16 v[36:39], a[204:207], v[100:103], v[36:39]
    buffer_load_dwordx4 a[244:247], v128, s[44:47], s25 offen offset:1024 sc1
    s_waitcnt vmcnt(18)
    s_barrier
    v_mfma_f32_16x16x32_bf16 v[36:39], a[200:203], v[96:99], v[36:39]
    ds_read_b128 v[96:99], v131 offset:16384
    s_waitcnt lgkmcnt(5)
    v_mfma_f32_16x16x32_bf16 v[44:47], a[200:203], v[104:107], v[44:47]
    buffer_load_dwordx4 a[248:251], v129, s[44:47], s25 offen offset:0 sc1
    ds_read_b128 v[100:103], v131 offset:17408
    v_mfma_f32_16x16x32_bf16 v[44:47], a[204:207], v[108:111], v[44:47]
    s_add_u32 m0, s26, 65536
    s_add_u32 s24, s24, 16384
    buffer_load_dwordx4 v130, s[44:47], s24 offen offset:0 sc1 lds
    v_mfma_f32_16x16x32_bf16 v[40:43], a[196:199], v[108:111], v[40:43]
    s_add_u32 m0, s26, 65536
    s_nop 0
    buffer_load_dwordx4 v130, s[44:47], s24 offen offset:1024 sc1 lds
    v_mfma_f32_16x16x32_bf16 v[40:43], a[192:195], v[104:107], v[40:43]
    ds_read_b128 v[104:107], v131 offset:18432
    s_waitcnt lgkmcnt(5)
    v_mfma_f32_16x16x32_bf16 v[48:51], a[192:195], v[112:115], v[48:51]
    s_add_u32 m0, s26, 65536
    s_nop 0
    buffer_load_dwordx4 v130, s[44:47], s24 offen offset:2048 sc1 lds
    ds_read_b128 v[108:111], v131 offset:19456
    v_mfma_f32_16x16x32_bf16 v[48:51], a[196:199], v[116:119], v[48:51]
    s_add_u32 m0, s26, 65536
    s_nop 0
    buffer_load_dwordx4 v130, s[44:47], s24 offen offset:3072 sc1 lds
    v_mfma_f32_16x16x32_bf16 v[52:55], a[204:207], v[116:119], v[52:55]
    s_add_u32 m0, s26, 81920
    s_add_u32 s24, s24, 16384
    buffer_load_dwordx4 v130, s[44:47], s24 offen offset:0 sc1 lds
    v_mfma_f32_16x16x32_bf16 v[52:55], a[200:203], v[112:115], v[52:55]
    ds_read_b128 v[112:115], v131 offset:20480
    s_waitcnt lgkmcnt(5)
    v_mfma_f32_16x16x32_bf16 v[60:63], a[200:203], v[120:123], v[60:63]
    buffer_load_dwordx4 a[252:255], v129, s[44:47], s25 offen offset:1024 sc1
    ds_read_b128 v[116:119], v131 offset:21504
    v_mfma_f32_16x16x32_bf16 v[60:63], a[204:207], v[124:127], v[60:63]
    s_add_u32 m0, s26, 81920
    s_nop 0
    buffer_load_dwordx4 v130, s[44:47], s24 offen offset:1024 sc1 lds
    v_mfma_f32_16x16x32_bf16 v[56:59], a[196:199], v[124:127], v[56:59]
    v_mfma_f32_16x16x32_bf16 v[56:59], a[192:195], v[120:123], v[56:59]
    ds_read_b128 v[120:123], v131 offset:22528
    ds_read_b128 v[124:127], v131 offset:23552
    s_waitcnt vmcnt(22) lgkmcnt(6)
    v_mfma_f32_16x16x32_bf16 v[0:3], a[208:211], v[96:99], v[0:3]
    v_mfma_f32_16x16x32_bf16 v[0:3], a[212:215], v[100:103], v[0:3]
    v_mfma_f32_16x16x32_bf16 v[4:7], a[220:223], v[100:103], v[4:7]
    s_add_u32 m0, s26, 81920
    s_nop 0
    buffer_load_dwordx4 v130, s[44:47], s24 offen offset:2048 sc1 lds
    v_mfma_f32_16x16x32_bf16 v[4:7], a[216:219], v[96:99], v[4:7]
    ds_read_b128 v[96:99], v131 offset:24576
    s_waitcnt lgkmcnt(5)
    v_mfma_f32_16x16x32_bf16 v[12:15], a[216:219], v[104:107], v[12:15]
    ds_read_b128 v[100:103], v131 offset:25600
    v_mfma_f32_16x16x32_bf16 v[12:15], a[220:223], v[108:111], v[12:15]
    v_mfma_f32_16x16x32_bf16 v[8:11], a[212:215], v[108:111], v[8:11]
    v_mfma_f32_16x16x32_bf16 v[8:11], a[208:211], v[104:107], v[8:11]
    ds_read_b128 v[104:107], v131 offset:26624
    s_waitcnt lgkmcnt(5)
    v_mfma_f32_16x16x32_bf16 v[16:19], a[208:211], v[112:115], v[16:19]
    ds_read_b128 v[108:111], v131 offset:27648
    v_mfma_f32_16x16x32_bf16 v[16:19], a[212:215], v[116:119], v[16:19]
    s_add_u32 m0, s26, 81920
    s_nop 0
    buffer_load_dwordx4 v130, s[44:47], s24 offen offset:3072 sc1 lds
    v_mfma_f32_16x16x32_bf16 v[20:23], a[220:223], v[116:119], v[20:23]
    v_mfma_f32_16x16x32_bf16 v[20:23], a[216:219], v[112:115], v[20:23]
    ds_read_b128 v[112:115], v131 offset:28672
    s_waitcnt lgkmcnt(5)
    v_mfma_f32_16x16x32_bf16 v[28:31], a[216:219], v[120:123], v[28:31]
    ds_read_b128 v[116:119], v131 offset:29696
    v_mfma_f32_16x16x32_bf16 v[28:31], a[220:223], v[124:127], v[28:31]
    v_mfma_f32_16x16x32_bf16 v[24:27], a[212:215], v[124:127], v[24:27]
    v_mfma_f32_16x16x32_bf16 v[24:27], a[208:211], v[120:123], v[24:27]
    ds_read_b128 v[120:123], v131 offset:30720
    s_waitcnt lgkmcnt(5)
    v_mfma_f32_16x16x32_bf16 v[32:35], a[208:211], v[96:99], v[32:35]
    ds_read_b128 v[124:127], v131 offset:31744
    v_mfma_f32_16x16x32_bf16 v[32:35], a[212:215], v[100:103], v[32:35]
    v_mfma_f32_16x16x32_bf16 v[36:39], a[220:223], v[100:103], v[36:39]
    s_waitcnt vmcnt(20)
    s_barrier
    v_mfma_f32_16x16x32_bf16 v[36:39], a[216:219], v[96:99], v[36:39]
    ds_read_b128 v[96:99], v131 offset:32768
    s_waitcnt lgkmcnt(5)
    v_mfma_f32_16x16x32_bf16 v[44:47], a[216:219], v[104:107], v[44:47]
    s_add_u32 m0, s26, 0
    s_add_u32 s24, s24, 16384
    buffer_load_dwordx4 v130, s[44:47], s24 offen offset:0 sc1 lds
    ds_read_b128 v[100:103], v131 offset:33792
    v_mfma_f32_16x16x32_bf16 v[44:47], a[220:223], v[108:111], v[44:47]
    v_mfma_f32_16x16x32_bf16 v[40:43], a[212:215], v[108:111], v[40:43]
    v_mfma_f32_16x16x32_bf16 v[40:43], a[208:211], v[104:107], v[40:43]
    ds_read_b128 v[104:107], v131 offset:34816
    s_waitcnt lgkmcnt(5)
    v_mfma_f32_16x16x32_bf16 v[48:51], a[208:211], v[112:115], v[48:51]
    ds_read_b128 v[108:111], v131 offset:35840
    v_mfma_f32_16x16x32_bf16 v[48:51], a[212:215], v[116:119], v[48:51]
    v_mfma_f32_16x16x32_bf16 v[52:55], a[220:223], v[116:119], v[52:55]
    v_mfma_f32_16x16x32_bf16 v[52:55], a[216:219], v[112:115], v[52:55]
    ds_read_b128 v[112:115], v131 offset:36864
    s_waitcnt lgkmcnt(5)
    v_mfma_f32_16x16x32_bf16 v[60:63], a[216:219], v[120:123], v[60:63]
    s_add_u32 m0, s26, 0
    s_nop 0
    buffer_load_dwordx4 v130, s[44:47], s24 offen offset:1024 sc1 lds
    ds_read_b128 v[116:119], v131 offset:37888
    v_mfma_f32_16x16x32_bf16 v[60:63], a[220:223], v[124:127], v[60:63]
    v_mfma_f32_16x16x32_bf16 v[56:59], a[212:215], v[124:127], v[56:59]
    v_mfma_f32_16x16x32_bf16 v[56:59], a[208:211], v[120:123], v[56:59]
    ds_read_b128 v[120:123], v131 offset:38912
    ds_read_b128 v[124:127], v131 offset:39936
    s_waitcnt vmcnt(18) lgkmcnt(6)
    v_mfma_f32_16x16x32_bf16 v[0:3], a[224:227], v[96:99], v[0:3]
    v_mfma_f32_16x16x32_bf16 v[0:3], a[228:231], v[100:103], v[0:3]
    v_mfma_f32_16x16x32_bf16 v[4:7], a[236:239], v[100:103], v[4:7]
    s_add_u32 m0, s26, 0
    s_nop 0
    buffer_load_dwordx4 v130, s[44:47], s24 offen offset:2048 sc1 lds
    v_mfma_f32_16x16x32_bf16 v[4:7], a[232:235], v[96:99], v[4:7]
    ds_read_b128 v[96:99], v131 offset:40960
    s_waitcnt lgkmcnt(5)
    v_mfma_f32_16x16x32_bf16 v[12:15], a[232:235], v[104:107], v[12:15]
    ds_read_b128 v[100:103], v131 offset:41984
    v_mfma_f32_16x16x32_bf16 v[12:15], a[236:239], v[108:111], v[12:15]
    v_mfma_f32_16x16x32_bf16 v[8:11], a[228:231], v[108:111], v[8:11]
    v_mfma_f32_16x16x32_bf16 v[8:11], a[224:227], v[104:107], v[8:11]
    ds_read_b128 v[104:107], v131 offset:43008
    s_waitcnt lgkmcnt(5)
    v_mfma_f32_16x16x32_bf16 v[16:19], a[224:227], v[112:115], v[16:19]
    ds_read_b128 v[108:111], v131 offset:44032
    v_mfma_f32_16x16x32_bf16 v[16:19], a[228:231], v[116:119], v[16:19]
    s_add_u32 m0, s26, 0
    s_nop 0
    buffer_load_dwordx4 v130, s[44:47], s24 offen offset:3072 sc1 lds
    v_mfma_f32_16x16x32_bf16 v[20:23], a[236:239], v[116:119], v[20:23]
    v_mfma_f32_16x16x32_bf16 v[20:23], a[232:235], v[112:115], v[20:23]
    ds_read_b128 v[112:115], v131 offset:45056
    s_waitcnt lgkmcnt(5)
    v_mfma_f32_16x16x32_bf16 v[28:31], a[232:235], v[120:123], v[28:31]
    ds_read_b128 v[116:119], v131 offset:46080
    v_mfma_f32_16x16x32_bf16 v[28:31], a[236:239], v[124:127], v[28:31]
    v_mfma_f32_16x16x32_bf16 v[24:27], a[228:231], v[124:127], v[24:27]
    v_mfma_f32_16x16x32_bf16 v[24:27], a[224:227], v[120:123], v[24:27]
    ds_read_b128 v[120:123], v131 offset:47104
    s_waitcnt lgkmcnt(5)
    v_mfma_f32_16x16x32_bf16 v[32:35], a[224:227], v[96:99], v[32:35]
    ds_read_b128 v[124:127], v131 offset:48128
    v_mfma_f32_16x16x32_bf16 v[32:35], a[228:231], v[100:103], v[32:35]
    v_mfma_f32_16x16x32_bf16 v[36:39], a[236:239], v[100:103], v[36:39]
    s_waitcnt vmcnt(16)
    s_barrier
    v_mfma_f32_16x16x32_bf16 v[36:39], a[232:235], v[96:99], v[36:39]
    ds_read_b128 v[96:99], v131 offset:49152
    s_waitcnt lgkmcnt(5)
    v_mfma_f32_16x16x32_bf16 v[44:47], a[232:235], v[104:107], v[44:47]
    s_add_u32 m0, s26, 16384
    s_add_u32 s24, s24, 16384
    buffer_load_dwordx4 v130, s[44:47], s24 offen offset:0 sc1 lds
    ds_read_b128 v[100:103], v131 offset:50176
    v_mfma_f32_16x16x32_bf16 v[44:47], a[236:239], v[108:111], v[44:47]
    v_mfma_f32_16x16x32_bf16 v[40:43], a[228:231], v[108:111], v[40:43]
    v_mfma_f32_16x16x32_bf16 v[40:43], a[224:227], v[104:107], v[40:43]
    ds_read_b128 v[104:107], v131 offset:51200
    s_waitcnt lgkmcnt(5)
    v_mfma_f32_16x16x32_bf16 v[48:51], a[224:227], v[112:115], v[48:51]
    ds_read_b128 v[108:111], v131 offset:52224
    v_mfma_f32_16x16x32_bf16 v[48:51], a[228:231], v[116:119], v[48:51]
    v_mfma_f32_16x16x32_bf16 v[52:55], a[236:239], v[116:119], v[52:55]
    v_mfma_f32_16x16x32_bf16 v[52:55], a[232:235], v[112:115], v[52:55]
    ds_read_b128 v[112:115], v131 offset:53248
    s_waitcnt lgkmcnt(5)
    v_mfma_f32_16x16x32_bf16 v[60:63], a[232:235], v[120:123], v[60:63]
    s_add_u32 m0, s26, 16384
    s_nop 0
    buffer_load_dwordx4 v130, s[44:47], s24 offen offset:1024 sc1 lds
    ds_read_b128 v[116:119], v131 offset:54272
    v_mfma_f32_16x16x32_bf16 v[60:63], a[236:239], v[124:127], v[60:63]
    v_mfma_f32_16x16x32_bf16 v[56:59], a[228:231], v[124:127], v[56:59]
    v_mfma_f32_16x16x32_bf16 v[56:59], a[224:227], v[120:123], v[56:59]
    ds_read_b128 v[120:123], v131 offset:55296
    ds_read_b128 v[124:127], v131 offset:56320
    s_waitcnt vmcnt(9) lgkmcnt(6)
    v_mfma_f32_16x16x32_bf16 v[0:3], a[240:243], v[96:99], v[0:3]
    v_mfma_f32_16x16x32_bf16 v[0:3], a[244:247], v[100:103], v[0:3]
    v_mfma_f32_16x16x32_bf16 v[4:7], a[252:255], v[100:103], v[4:7]
    s_add_u32 m0, s26, 16384
    s_nop 0
    buffer_load_dwordx4 v130, s[44:47], s24 offen offset:2048 sc1 lds
    v_mfma_f32_16x16x32_bf16 v[4:7], a[248:251], v[96:99], v[4:7]
    ds_read_b128 v[96:99], v131 offset:57344
    s_waitcnt lgkmcnt(5)
    v_mfma_f32_16x16x32_bf16 v[12:15], a[248:251], v[104:107], v[12:15]
    ds_read_b128 v[100:103], v131 offset:58368
    v_mfma_f32_16x16x32_bf16 v[12:15], a[252:255], v[108:111], v[12:15]
    v_mfma_f32_16x16x32_bf16 v[8:11], a[244:247], v[108:111], v[8:11]
    v_mfma_f32_16x16x32_bf16 v[8:11], a[240:243], v[104:107], v[8:11]
    ds_read_b128 v[104:107], v131 offset:59392
    s_waitcnt lgkmcnt(5)
    v_mfma_f32_16x16x32_bf16 v[16:19], a[240:243], v[112:115], v[16:19]
    ds_read_b128 v[108:111], v131 offset:60416
    v_mfma_f32_16x16x32_bf16 v[16:19], a[244:247], v[116:119], v[16:19]
    s_add_u32 m0, s26, 16384
    s_nop 0
    buffer_load_dwordx4 v130, s[44:47], s24 offen offset:3072 sc1 lds
    v_mfma_f32_16x16x32_bf16 v[20:23], a[252:255], v[116:119], v[20:23]
    v_mfma_f32_16x16x32_bf16 v[20:23], a[248:251], v[112:115], v[20:23]
    ds_read_b128 v[112:115], v131 offset:61440
    s_waitcnt lgkmcnt(5)
    v_mfma_f32_16x16x32_bf16 v[28:31], a[248:251], v[120:123], v[28:31]
    ds_read_b128 v[116:119], v131 offset:62464
    v_mfma_f32_16x16x32_bf16 v[28:31], a[252:255], v[124:127], v[28:31]
    v_mfma_f32_16x16x32_bf16 v[24:27], a[244:247], v[124:127], v[24:27]
    v_mfma_f32_16x16x32_bf16 v[24:27], a[240:243], v[120:123], v[24:27]
    ds_read_b128 v[120:123], v131 offset:63488
    s_waitcnt lgkmcnt(5)
    v_mfma_f32_16x16x32_bf16 v[32:35], a[240:243], v[96:99], v[32:35]
    ds_read_b128 v[124:127], v131 offset:64512
    v_mfma_f32_16x16x32_bf16 v[32:35], a[244:247], v[100:103], v[32:35]
    v_mfma_f32_16x16x32_bf16 v[36:39], a[252:255], v[100:103], v[36:39]
    s_barrier
    v_mfma_f32_16x16x32_bf16 v[36:39], a[248:251], v[96:99], v[36:39]
    v_pk_mul_f32 v[238:239], v[0:1], v[158:159]
    v_pk_mul_f32 v[240:241], v[2:3], v[160:161]
    v_exp_f32_e64 v238, v238 clamp
    v_exp_f32_e64 v239, v239 clamp
    v_exp_f32_e64 v240, v240 clamp
    v_exp_f32_e64 v241, v241 clamp
    v_pk_fma_f32 v[0:1], v[0:1], v[162:163], v[140:141]
    v_pk_fma_f32 v[2:3], v[2:3], v[164:165], v[140:141]
    s_waitcnt lgkmcnt(4)
    v_mfma_f32_16x16x32_bf16 v[44:47], a[248:251], v[104:107], v[44:47]
    v_max_f32 v0, v0, v238
    v_max_f32 v1, v1, v239
    v_max_f32 v2, v2, v240
    v_max_f32 v3, v3, v241
    v_pk_add_f32 v[0:1], v[0:1], s[52:53]
    v_pk_add_f32 v[2:3], v[2:3], s[52:53]
    v_cvt_pk_bf16_f32 v0, v0, v1
    v_cvt_pk_bf16_f32 v1, v2, v3
    ds_read_b128 v[96:99], v132 offset:0
    ds_read_b128 v[100:103], v132 offset:1024
    v_mfma_f32_16x16x32_bf16 v[44:47], a[252:255], v[108:111], v[44:47]
    v_pk_mul_f32 v[242:243], v[4:5], v[166:167]
    v_pk_mul_f32 v[244:245], v[6:7], v[168:169]
    v_exp_f32_e64 v242, v242 clamp
    v_exp_f32_e64 v243, v243 clamp
    v_exp_f32_e64 v244, v244 clamp
    v_exp_f32_e64 v245, v245 clamp
    v_pk_fma_f32 v[4:5], v[4:5], v[170:171], v[140:141]
    v_pk_fma_f32 v[6:7], v[6:7], v[172:173], v[140:141]
    v_mfma_f32_16x16x32_bf16 v[40:43], a[244:247], v[108:111], v[40:43]
    v_max_f32 v4, v4, v242
    v_max_f32 v5, v5, v243
    v_max_f32 v6, v6, v244
    v_max_f32 v7, v7, v245
    v_pk_add_f32 v[4:5], v[4:5], s[52:53]
    v_pk_add_f32 v[6:7], v[6:7], s[52:53]
    v_cvt_pk_bf16_f32 v2, v4, v5
    v_cvt_pk_bf16_f32 v3, v6, v7
    s_add_u32 m0, s26, 32768
    s_add_u32 s24, s24, 16384
    buffer_load_dwordx4 v130, s[44:47], s24 offen offset:0 sc1 lds
    v_mfma_f32_16x16x32_bf16 v[40:43], a[240:243], v[104:107], v[40:43]
    v_pk_mul_f32 v[238:239], v[8:9], v[158:159]
    v_pk_mul_f32 v[240:241], v[10:11], v[160:161]
    v_exp_f32_e64 v238, v238 clamp
    v_exp_f32_e64 v239, v239 clamp
    v_exp_f32_e64 v240, v240 clamp
    v_exp_f32_e64 v241, v241 clamp
    v_pk_fma_f32 v[8:9], v[8:9], v[162:163], v[140:141]
    v_pk_fma_f32 v[10:11], v[10:11], v[164:165], v[140:141]
    s_waitcnt lgkmcnt(4)
    v_mfma_f32_16x16x32_bf16 v[48:51], a[240:243], v[112:115], v[48:51]
    v_max_f32 v8, v8, v238
    v_max_f32 v9, v9, v239
    v_max_f32 v10, v10, v240
    v_max_f32 v11, v11, v241
    v_pk_add_f32 v[8:9], v[8:9], s[52:53]
    v_pk_add_f32 v[10:11], v[10:11], s[52:53]
    v_cvt_pk_bf16_f32 v8, v8, v9
    v_cvt_pk_bf16_f32 v9, v10, v11
    ds_read_b128 v[104:107], v132 offset:2048
    ds_read_b128 v[108:111], v132 offset:3072
    v_mfma_f32_16x16x32_bf16 v[48:51], a[244:247], v[116:119], v[48:51]
    v_pk_mul_f32 v[242:243], v[12:13], v[166:167]
    v_pk_mul_f32 v[244:245], v[14:15], v[168:169]
    v_exp_f32_e64 v242, v242 clamp
    v_exp_f32_e64 v243, v243 clamp
    v_exp_f32_e64 v244, v244 clamp
    v_exp_f32_e64 v245, v245 clamp
    v_pk_fma_f32 v[12:13], v[12:13], v[170:171], v[140:141]
    v_pk_fma_f32 v[14:15], v[14:15], v[172:173], v[140:141]
    v_mfma_f32_16x16x32_bf16 v[52:55], a[252:255], v[116:119], v[52:55]
    v_max_f32 v12, v12, v242
    v_max_f32 v13, v13, v243
    v_max_f32 v14, v14, v244
    v_max_f32 v15, v15, v245
    v_pk_add_f32 v[12:13], v[12:13], s[52:53]
    v_pk_add_f32 v[14:15], v[14:15], s[52:53]
    v_cvt_pk_bf16_f32 v10, v12, v13
    v_cvt_pk_bf16_f32 v11, v14, v15
    v_mfma_f32_16x16x32_bf16 v[52:55], a[248:251], v[112:115], v[52:55]
    v_pk_mul_f32 v[238:239], v[16:17], v[158:159]
    v_pk_mul_f32 v[240:241], v[18:19], v[160:161]
    v_exp_f32_e64 v238, v238 clamp
    v_exp_f32_e64 v239, v239 clamp
    v_exp_f32_e64 v240, v240 clamp
    v_exp_f32_e64 v241, v241 clamp
    v_pk_fma_f32 v[16:17], v[16:17], v[162:163], v[140:141]
    v_pk_fma_f32 v[18:19], v[18:19], v[164:165], v[140:141]
    s_waitcnt lgkmcnt(4)
    v_mfma_f32_16x16x32_bf16 v[60:63], a[248:251], v[120:123], v[60:63]
    v_max_f32 v16, v16, v238
    v_max_f32 v17, v17, v239
    v_max_f32 v18, v18, v240
    v_max_f32 v19, v19, v241
    v_pk_add_f32 v[16:17], v[16:17], s[52:53]
    v_pk_add_f32 v[18:19], v[18:19], s[52:53]
    v_cvt_pk_bf16_f32 v16, v16, v17
    v_cvt_pk_bf16_f32 v17, v18, v19
    ds_read_b128 v[112:115], v132 offset:4096
    ds_read_b128 v[116:119], v132 offset:5120
    v_mfma_f32_16x16x32_bf16 v[60:63], a[252:255], v[124:127], v[60:63]
    v_pk_mul_f32 v[242:243], v[20:21], v[166:167]
    v_pk_mul_f32 v[244:245], v[22:23], v[168:169]
    v_exp_f32_e64 v242, v242 clamp
    v_exp_f32_e64 v243, v243 clamp
    v_exp_f32_e64 v244, v244 clamp
    v_exp_f32_e64 v245, v245 clamp
    v_pk_fma_f32 v[20:21], v[20:21], v[170:171], v[140:141]
    v_pk_fma_f32 v[22:23], v[22:23], v[172:173], v[140:141]
    s_add_u32 m0, s26, 32768
    s_nop 0
    buffer_load_dwordx4 v130, s[44:47], s24 offen offset:1024 sc1 lds
    v_mfma_f32_16x16x32_bf16 v[56:59], a[244:247], v[124:127], v[56:59]
    v_max_f32 v20, v20, v242
    v_max_f32 v21, v21, v243
    v_max_f32 v22, v22, v244
    v_max_f32 v23, v23, v245
    v_pk_add_f32 v[20:21], v[20:21], s[52:53]
    v_pk_add_f32 v[22:23], v[22:23], s[52:53]
    v_cvt_pk_bf16_f32 v18, v20, v21
    v_cvt_pk_bf16_f32 v19, v22, v23
    v_mfma_f32_16x16x32_bf16 v[56:59], a[240:243], v[120:123], v[56:59]
    v_pk_mul_f32 v[238:239], v[24:25], v[158:159]
    v_pk_mul_f32 v[240:241], v[26:27], v[160:161]
    v_exp_f32_e64 v238, v238 clamp
    v_exp_f32_e64 v239, v239 clamp
    v_exp_f32_e64 v240, v240 clamp
    v_exp_f32_e64 v241, v241 clamp
    v_pk_fma_f32 v[24:25], v[24:25], v[162:163], v[140:141]
    v_pk_fma_f32 v[26:27], v[26:27], v[164:165], v[140:141]
    ds_read_b128 v[120:123], v132 offset:6144
    ds_read_b128 v[124:127], v132 offset:7168
    s_waitcnt lgkmcnt(6)
    v_mfma_f32_16x16x32_bf16 v[64:67], v[96:99], a[0:3], v[64:67]
    v_max_f32 v24, v24, v238
    v_max_f32 v25, v25, v239
    v_max_f32 v26, v26, v240
    v_max_f32 v27, v27, v241
    v_pk_add_f32 v[24:25], v[24:25], s[52:53]
    v_pk_add_f32 v[26:27], v[26:27], s[52:53]
    v_cvt_pk_bf16_f32 v24, v24, v25
    v_cvt_pk_bf16_f32 v25, v26, v27
    v_mfma_f32_16x16x32_bf16 v[64:67], v[100:103], a[4:7], v[64:67]
    v_pk_mul_f32 v[242:243], v[28:29], v[166:167]
    v_pk_mul_f32 v[244:245], v[30:31], v[168:169]
    v_exp_f32_e64 v242, v242 clamp
    v_exp_f32_e64 v243, v243 clamp
    v_exp_f32_e64 v244, v244 clamp
    v_exp_f32_e64 v245, v245 clamp
    v_pk_fma_f32 v[28:29], v[28:29], v[170:171], v[140:141]
    v_pk_fma_f32 v[30:31], v[30:31], v[172:173], v[140:141]
    v_mfma_f32_16x16x32_bf16 v[68:71], v[100:103], a[12:15], v[68:71]
    v_max_f32 v28, v28, v242
    v_max_f32 v29, v29, v243
    v_max_f32 v30, v30, v244
    v_max_f32 v31, v31, v245
    v_pk_add_f32 v[28:29], v[28:29], s[52:53]
    v_pk_add_f32 v[30:31], v[30:31], s[52:53]
    v_cvt_pk_bf16_f32 v26, v28, v29
    v_cvt_pk_bf16_f32 v27, v30, v31
    v_mfma_f32_16x16x32_bf16 v[68:71], v[96:99], a[8:11], v[68:71]
    v_pk_mul_f32 v[32:33], v[32:33], v[162:163]
    v_pk_mul_f32 v[34:35], v[34:35], v[164:165]
    v_cvt_pk_bf16_f32 v32, v32, v33
    v_cvt_pk_bf16_f32 v33, v34, v35
    v_pk_mul_f32 v[36:37], v[36:37], v[170:171]
    v_pk_mul_f32 v[38:39], v[38:39], v[172:173]
    v_cvt_pk_bf16_f32 v34, v36, v37
    v_cvt_pk_bf16_f32 v35, v38, v39
    s_waitcnt lgkmcnt(4)
    v_mfma_f32_16x16x32_bf16 v[68:71], v[104:107], a[24:27], v[68:71]
    v_pk_mul_f32 v[40:41], v[40:41], v[162:163]
    v_pk_mul_f32 v[42:43], v[42:43], v[164:165]
    v_cvt_pk_bf16_f32 v40, v40, v41
    v_cvt_pk_bf16_f32 v41, v42, v43
    v_pk_mul_f32 v[44:45], v[44:45], v[170:171]
    v_pk_mul_f32 v[46:47], v[46:47], v[172:173]
    v_cvt_pk_bf16_f32 v42, v44, v45
    v_cvt_pk_bf16_f32 v43, v46, v47
    s_add_u32 m0, s26, 32768
    s_nop 0
    buffer_load_dwordx4 v130, s[44:47], s24 offen offset:2048 sc1 lds
    ds_read_b128 v[96:99], v132 offset:8192
    ds_read_b128 v[100:103], v132 offset:9216
    v_mfma_f32_16x16x32_bf16 v[68:71], v[108:111], a[28:31], v[68:71]
    v_pk_mul_f32 v[48:49], v[48:49], v[162:163]
    v_pk_mul_f32 v[50:51], v[50:51], v[164:165]
    v_cvt_pk_bf16_f32 v48, v48, v49
    v_cvt_pk_bf16_f32 v49, v50, v51
    v_pk_mul_f32 v[52:53], v[52:53], v[170:171]
    v_pk_mul_f32 v[54:55], v[54:55], v[172:173]
    v_cvt_pk_bf16_f32 v50, v52, v53
    v_cvt_pk_bf16_f32 v51, v54, v55
    v_mfma_f32_16x16x32_bf16 v[64:67], v[108:111], a[20:23], v[64:67]
    v_pk_mul_f32 v[56:57], v[56:57], v[162:163]
    v_pk_mul_f32 v[58:59], v[58:59], v[164:165]
    v_cvt_pk_bf16_f32 v56, v56, v57
    v_cvt_pk_bf16_f32 v57, v58, v59
    v_pk_mul_f32 v[60:61], v[60:61], v[170:171]
    v_pk_mul_f32 v[62:63], v[62:63], v[172:173]
    v_cvt_pk_bf16_f32 v58, v60, v61
    v_cvt_pk_bf16_f32 v59, v62, v63
    v_mfma_f32_16x16x32_bf16 v[64:67], v[104:107], a[16:19], v[64:67]
    ds_read_b128 v[104:107], v132 offset:10240
    s_waitcnt lgkmcnt(5)
    v_mfma_f32_16x16x32_bf16 v[64:67], v[112:115], a[32:35], v[64:67]
    v_mfma_f32_16x16x32_bf16 v[190:193], v[0:3], v[32:35], 0
    ds_read_b128 v[108:111], v132 offset:11264
    v_mfma_f32_16x16x32_bf16 v[64:67], v[116:119], a[36:39], v[64:67]
    v_mfma_f32_16x16x32_bf16 v[194:197], v[8:11], v[32:35], 0
    s_add_u32 m0, s26, 32768
    s_nop 0
    buffer_load_dwordx4 v130, s[44:47], s24 offen offset:3072 sc1 lds
    v_mfma_f32_16x16x32_bf16 v[68:71], v[116:119], a[44:47], v[68:71]
    v_mfma_f32_16x16x32_bf16 v[198:201], v[0:3], v[40:43], 0
    v_mfma_f32_16x16x32_bf16 v[68:71], v[112:115], a[40:43], v[68:71]
    v_mfma_f32_16x16x32_bf16 v[202:205], v[8:11], v[40:43], 0
    ds_read_b128 v[112:115], v132 offset:12288
    s_waitcnt lgkmcnt(5)
    v_mfma_f32_16x16x32_bf16 v[68:71], v[120:123], a[56:59], v[68:71]
    v_mfma_f32_16x16x32_bf16 v[222:225], v[0:3], v[246:249], 0
    ds_read_b128 v[116:119], v132 offset:13312
    v_mfma_f32_16x16x32_bf16 v[68:71], v[124:127], a[60:63], v[68:71]
    v_mfma_f32_16x16x32_bf16 v[226:229], v[8:11], v[246:249], 0
    v_mfma_f32_16x16x32_bf16 v[64:67], v[124:127], a[52:55], v[64:67]
    v_mfma_f32_16x16x32_bf16 v[206:209], v[16:19], v[48:51], 0
    ds_write_b128 v254, v[190:193] offset:0
    v_mfma_f32_16x16x32_bf16 v[64:67], v[120:123], a[48:51], v[64:67]
    v_mfma_f32_16x16x32_bf16 v[210:213], v[24:27], v[48:51], 0
    ds_write_b128 v254, v[194:197] offset:1024
    s_waitcnt lgkmcnt(6)
    v_mfma_f32_16x16x32_bf16 v[64:67], v[96:99], a[64:67], v[64:67]
    v_mfma_f32_16x16x32_bf16 v[214:217], v[16:19], v[56:59], 0
    ds_write_b128 v254, v[198:201] offset:2048
    ds_read_b128 v[120:123], v132 offset:14336
    ds_read_b128 v[124:127], v132 offset:15360
    v_mfma_f32_16x16x32_bf16 v[64:67], v[100:103], a[68:71], v[64:67]
    v_mfma_f32_16x16x32_bf16 v[218:221], v[24:27], v[56:59], 0
    ds_write_b128 v254, v[202:205] offset:3072
    v_mfma_f32_16x16x32_bf16 v[68:71], v[100:103], a[76:79], v[68:71]
    v_mfma_f32_16x16x32_bf16 v[230:233], v[16:19], v[246:249], 0
    ds_write_b128 v254, v[206:209] offset:4096
    s_waitcnt vmcnt(12)
    s_barrier
    v_mfma_f32_16x16x32_bf16 v[68:71], v[96:99], a[72:75], v[68:71]
    v_mfma_f32_16x16x32_bf16 v[234:237], v[24:27], v[246:249], 0
    ds_write_b128 v254, v[210:213] offset:5120
    s_waitcnt lgkmcnt(8)
    v_mfma_f32_16x16x32_bf16 v[68:71], v[104:107], a[88:91], v[68:71]
    ds_write_b128 v254, v[214:217] offset:6144
    ds_read_b128 v[96:99], v132 offset:16384
    ds_read_b128 v[100:103], v132 offset:17408
    v_mfma_f32_16x16x32_bf16 v[68:71], v[108:111], a[92:95], v[68:71]
    ds_write_b128 v254, v[218:221] offset:7168
    v_mfma_f32_16x16x32_bf16 v[64:67], v[108:111], a[84:87], v[64:67]
    s_add_u32 m0, s26, 49152
    s_add_u32 s24, s24, 16384
    buffer_load_dwordx4 v130, s[44:47], s24 offen offset:0 sc1 lds
    v_mfma_f32_16x16x32_bf16 v[64:67], v[104:107], a[80:83], v[64:67]
    ds_read_b128 v[104:107], v132 offset:18432
    v_mfma_f32_16x16x32_bf16 v[64:67], v[112:115], a[96:99], v[64:67]
    ds_write_b128 v255, v[222:225] offset:8192
    ds_read_b128 v[108:111], v132 offset:19456
    v_mfma_f32_16x16x32_bf16 v[64:67], v[116:119], a[100:103], v[64:67]
    ds_write_b128 v255, v[226:229] offset:8256
    v_mfma_f32_16x16x32_bf16 v[68:71], v[116:119], a[108:111], v[68:71]
    ds_write_b128 v255, v[230:233] offset:8320
    v_mfma_f32_16x16x32_bf16 v[68:71], v[112:115], a[104:107], v[68:71]
    ds_write_b128 v255, v[234:237] offset:8384
    s_waitcnt lgkmcnt(8)
    v_mfma_f32_16x16x32_bf16 v[68:71], v[120:123], a[120:123], v[68:71]
    s_add_u32 m0, s26, 49152
    s_nop 0
    buffer_load_dwordx4 v130, s[44:47], s24 offen offset:1024 sc1 lds
    ds_read_b128 v[112:115], v132 offset:20480
    ds_read_b128 v[116:119], v132 offset:21504
    v_mfma_f32_16x16x32_bf16 v[68:71], v[124:127], a[124:127], v[68:71]
    v_mfma_f32_16x16x32_bf16 v[64:67], v[124:127], a[116:119], v[64:67]
    v_mfma_f32_16x16x32_bf16 v[64:67], v[120:123], a[112:115], v[64:67]
    ds_read_b128 v[120:123], v132 offset:22528
    ds_read_b128 v[124:127], v132 offset:23552
    s_waitcnt lgkmcnt(8)
    v_mfma_f32_16x16x32_bf16 v[64:67], v[96:99], a[128:131], v[64:67]
    s_waitcnt lgkmcnt(4)
    s_barrier
    v_mfma_f32_16x16x32_bf16 v[64:67], v[100:103], a[132:135], v[64:67]
    ds_read2st64_b32 v[190:191], v138 offset0:0 offset1:33
    ds_read2st64_b32 v[192:193], v138 offset0:66 offset1:99
    v_mfma_f32_16x16x32_bf16 v[68:71], v[100:103], a[140:143], v[68:71]
    ds_read2st64_b32 v[194:195], v138 offset0:4 offset1:37
    ds_read2st64_b32 v[196:197], v138 offset0:70 offset1:103
    v_mfma_f32_16x16x32_bf16 v[68:71], v[96:99], a[136:139], v[68:71]
    ds_read2st64_b32 v[198:199], v138 offset0:8 offset1:41
    ds_read2st64_b32 v[200:201], v138 offset0:74 offset1:107
    v_mfma_f32_16x16x32_bf16 v[68:71], v[104:107], a[152:155], v[68:71]
    ds_read2st64_b32 v[202:203], v138 offset0:12 offset1:45
    ds_read2st64_b32 v[204:205], v138 offset0:78 offset1:111
    s_add_u32 m0, s26, 49152
    s_nop 0
    buffer_load_dwordx4 v130, s[44:47], s24 offen offset:2048 sc1 lds
    ds_read_b128 v[96:99], v132 offset:24576
    ds_read_b128 v[100:103], v132 offset:25600
    v_mfma_f32_16x16x32_bf16 v[68:71], v[108:111], a[156:159], v[68:71]
    ds_read2st64_b32 v[206:207], v138 offset0:16 offset1:49
    ds_read2st64_b32 v[208:209], v138 offset0:82 offset1:115
    v_mfma_f32_16x16x32_bf16 v[64:67], v[108:111], a[148:151], v[64:67]
    ds_read2st64_b32 v[210:211], v138 offset0:20 offset1:53
    ds_read2st64_b32 v[212:213], v138 offset0:86 offset1:119
    v_mfma_f32_16x16x32_bf16 v[64:67], v[104:107], a[144:147], v[64:67]
    ds_read2st64_b32 v[214:215], v138 offset0:24 offset1:57
    ds_read2st64_b32 v[216:217], v138 offset0:90 offset1:123
    s_waitcnt lgkmcnt(8)
    v_mfma_f32_16x16x32_bf16 v[64:67], v[112:115], a[160:163], v[64:67]
    ds_read2st64_b32 v[218:219], v138 offset0:28 offset1:61
    ds_read2st64_b32 v[220:221], v138 offset0:94 offset1:127
    ds_read_b128 v[104:107], v132 offset:26624
    ds_read_b128 v[108:111], v132 offset:27648
    v_mfma_f32_16x16x32_bf16 v[64:67], v[116:119], a[164:167], v[64:67]
    ds_read2st64_b32 v[222:223], v138 offset0:32 offset1:65
    ds_read2st64_b32 v[224:225], v138 offset0:98 offset1:131
    v_mfma_f32_16x16x32_bf16 v[68:71], v[116:119], a[172:175], v[68:71]
    v_add_f32 v190, v190, v191
    v_add_f32 v192, v192, v193
    v_add_f32 v190, v190, v192
    v_mfma_f32_16x16x32_bf16 v[68:71], v[112:115], a[168:171], v[68:71]
    buffer_atomic_add_f32 v190, v137, s[44:47], s56 offen offset:0
    s_add_u32 m0, s26, 49152
    s_nop 0
    buffer_load_dwordx4 v130, s[44:47], s24 offen offset:3072 sc1 lds
    v_mfma_f32_16x16x32_bf16 v[68:71], v[120:123], a[184:187], v[68:71]
    v_add_f32 v194, v194, v195
    v_add_f32 v196, v196, v197
    v_add_f32 v194, v194, v196
    ds_read_b128 v[112:115], v132 offset:28672
    ds_read_b128 v[116:119], v132 offset:29696
    v_mfma_f32_16x16x32_bf16 v[68:71], v[124:127], a[188:191], v[68:71]
    buffer_atomic_add_f32 v194, v137, s[44:47], s56 offen offset:1024
    v_mfma_f32_16x16x32_bf16 v[64:67], v[124:127], a[180:183], v[64:67]
    v_add_f32 v198, v198, v199
    v_add_f32 v200, v200, v201
    v_add_f32 v198, v198, v200
    v_mfma_f32_16x16x32_bf16 v[64:67], v[120:123], a[176:179], v[64:67]
    buffer_atomic_add_f32 v198, v137, s[44:47], s56 offen offset:2048
    s_waitcnt lgkmcnt(8)
    v_mfma_f32_16x16x32_bf16 v[64:67], v[96:99], a[192:195], v[64:67]
    v_add_f32 v202, v202, v203
    v_add_f32 v204, v204, v205
    v_add_f32 v202, v202, v204
    ds_read_b128 v[120:123], v132 offset:30720
    ds_read_b128 v[124:127], v132 offset:31744
    v_mfma_f32_16x16x32_bf16 v[64:67], v[100:103], a[196:199], v[64:67]
    buffer_atomic_add_f32 v202, v137, s[44:47], s56 offen offset:3072
    v_mfma_f32_16x16x32_bf16 v[68:71], v[100:103], a[204:207], v[68:71]
    v_add_f32 v206, v206, v207
    v_add_f32 v208, v208, v209
    v_add_f32 v206, v206, v208
    s_waitcnt vmcnt(16)
    s_barrier
    v_mfma_f32_16x16x32_bf16 v[68:71], v[96:99], a[200:203], v[68:71]
    buffer_atomic_add_f32 v206, v137, s[44:47], s57 offen offset:0
    s_waitcnt lgkmcnt(6)
    v_mfma_f32_16x16x32_bf16 v[68:71], v[104:107], a[216:219], v[68:71]
    v_add_f32 v210, v210, v211
    v_add_f32 v212, v212, v213
    v_add_f32 v210, v210, v212
    ds_read_b128 v[96:99], v131 offset:0
    ds_read_b128 v[100:103], v131 offset:1024
    v_mfma_f32_16x16x32_bf16 v[68:71], v[108:111], a[220:223], v[68:71]
    buffer_atomic_add_f32 v210, v137, s[44:47], s57 offen offset:1024
    v_mfma_f32_16x16x32_bf16 v[64:67], v[108:111], a[212:215], v[64:67]
    v_add_f32 v214, v214, v215
    v_add_f32 v216, v216, v217
    v_add_f32 v214, v214, v216
    s_add_u32 m0, s26, 65536
    s_add_u32 s24, s24, 16384
    buffer_load_dwordx4 v130, s[44:47], s24 offen offset:0 sc1 lds
    v_mfma_f32_16x16x32_bf16 v[64:67], v[104:107], a[208:211], v[64:67]
    buffer_atomic_add_f32 v214, v137, s[44:47], s57 offen offset:2048
    s_waitcnt lgkmcnt(4)
    v_mfma_f32_16x16x32_bf16 v[64:67], v[112:115], a[224:227], v[64:67]
    v_add_f32 v218, v218, v219
    v_add_f32 v220, v220, v221
    v_add_f32 v218, v218, v220
    ds_read_b128 v[104:107], v131 offset:2048
    ds_read_b128 v[108:111], v131 offset:3072
    v_mfma_f32_16x16x32_bf16 v[64:67], v[116:119], a[228:231], v[64:67]
    buffer_atomic_add_f32 v218, v137, s[44:47], s57 offen offset:3072
    v_mfma_f32_16x16x32_bf16 v[68:71], v[116:119], a[236:239], v[68:71]
    v_add_f32 v222, v222, v223
    v_add_f32 v224, v224, v225
    v_add_f32 v222, v222, v224
    v_mfma_f32_16x16x32_bf16 v[68:71], v[112:115], a[232:235], v[68:71]
    buffer_atomic_add_f32 v222, v137, s[44:47], s62 offen
    s_waitcnt lgkmcnt(4)
    v_mfma_f32_16x16x32_bf16 v[68:71], v[120:123], a[248:251], v[68:71]
    s_add_u32 m0, s26, 65536
    s_nop 0
    buffer_load_dwordx4 v130, s[44:47], s24 offen offset:1024 sc1 lds
    ds_read_b128 v[112:115], v131 offset:4096
    ds_read_b128 v[116:119], v131 offset:5120
    v_mfma_f32_16x16x32_bf16 v[68:71], v[124:127], a[252:255], v[68:71]
    v_mfma_f32_16x16x32_bf16 v[64:67], v[124:127], a[244:247], v[64:67]
    v_mfma_f32_16x16x32_bf16 v[64:67], v[120:123], a[240:243], v[64:67]
    ds_read_b128 v[120:123], v131 offset:6144
    ds_read_b128 v[124:127], v131 offset:7168
    s_waitcnt lgkmcnt(6)
    v_mfma_f32_16x16x32_bf16 v[72:75], v[96:99], a[0:3], v[72:75]
    v_mfma_f32_16x16x32_bf16 v[72:75], v[100:103], a[4:7], v[72:75]
    v_mfma_f32_16x16x32_bf16 v[76:79], v[100:103], a[12:15], v[76:79]
    s_add_u32 m0, s26, 65536
    s_nop 0
    buffer_load_dwordx4 v130, s[44:47], s24 offen offset:2048 sc1 lds
    v_mfma_f32_16x16x32_bf16 v[76:79], v[96:99], a[8:11], v[76:79]
    ds_read_b128 v[96:99], v131 offset:8192
    s_waitcnt lgkmcnt(5)
    v_mfma_f32_16x16x32_bf16 v[76:79], v[104:107], a[24:27], v[76:79]
    ds_read_b128 v[100:103], v131 offset:9216
    v_mfma_f32_16x16x32_bf16 v[76:79], v[108:111], a[28:31], v[76:79]
    v_mul_f32 v242, v68, v150
    v_mfma_f32_16x16x32_bf16 v[72:75], v[108:111], a[20:23], v[72:75]
    v_mul_f32 v243, v69, v150
    v_mfma_f32_16x16x32_bf16 v[72:75], v[104:107], a[16:19], v[72:75]
    v_mul_f32 v244, v70, v150
    s_waitcnt lgkmcnt(4)
    v_mfma_f32_16x16x32_bf16 v[72:75], v[112:115], a[32:35], v[72:75]
    v_mul_f32 v245, v71, v150
    ds_read_b128 v[104:107], v131 offset:10240
    ds_read_b128 v[108:111], v131 offset:11264
    v_mfma_f32_16x16x32_bf16 v[72:75], v[116:119], a[36:39], v[72:75]
    v_exp_f32_e64 v242, v242 clamp
    v_mfma_f32_16x16x32_bf16 v[76:79], v[116:119], a[44:47], v[76:79]
    v_exp_f32_e64 v243, v243 clamp
    v_mfma_f32_16x16x32_bf16 v[76:79], v[112:115], a[40:43], v[76:79]
    v_exp_f32_e64 v244, v244 clamp
    s_add_u32 m0, s26, 65536
    s_nop 0
    buffer_load_dwordx4 v130, s[44:47], s24 offen offset:3072 sc1 lds
    s_waitcnt lgkmcnt(4)
    v_mfma_f32_16x16x32_bf16 v[76:79], v[120:123], a[56:59], v[76:79]
    v_exp_f32_e64 v245, v245 clamp
    ds_read_b128 v[112:115], v131 offset:12288
    ds_read_b128 v[116:119], v131 offset:13312
    v_mfma_f32_16x16x32_bf16 v[76:79], v[124:127], a[60:63], v[76:79]
    v_fma_f32 v68, v68, v154, 1.0
    v_mfma_f32_16x16x32_bf16 v[72:75], v[124:127], a[52:55], v[72:75]
    v_fma_f32 v69, v69, v154, 1.0
    v_mfma_f32_16x16x32_bf16 v[72:75], v[120:123], a[48:51], v[72:75]
    v_fma_f32 v70, v70, v154, 1.0
    s_waitcnt lgkmcnt(4)
    v_mfma_f32_16x16x32_bf16 v[72:75], v[96:99], a[64:67], v[72:75]
    v_fma_f32 v71, v71, v154, 1.0
    ds_read_b128 v[120:123], v131 offset:14336
    ds_read_b128 v[124:127], v131 offset:15360
    v_mfma_f32_16x16x32_bf16 v[72:75], v[100:103], a[68:71], v[72:75]
    v_max_f32 v68, v68, v242
    v_mfma_f32_16x16x32_bf16 v[76:79], v[100:103], a[76:79], v[76:79]
    v_max_f32 v69, v69, v243
    s_waitcnt vmcnt(21)
    s_barrier
    v_mfma_f32_16x16x32_bf16 v[76:79], v[96:99], a[72:75], v[76:79]
    v_max_f32 v70, v70, v244
    s_waitcnt lgkmcnt(4)
    v_mfma_f32_16x16x32_bf16 v[76:79], v[104:107], a[88:91], v[76:79]
    v_max_f32 v71, v71, v245
    ds_read_b128 v[96:99], v131 offset:16384
    ds_read_b128 v[100:103], v131 offset:17408
    v_mfma_f32_16x16x32_bf16 v[76:79], v[108:111], a[92:95], v[76:79]
    v_add_f32 v68, s52, v68
    v_mfma_f32_16x16x32_bf16 v[72:75], v[108:111], a[84:87], v[72:75]
    v_add_f32 v69, s52, v69
    s_add_u32 m0, s26, 81920
    s_add_u32 s24, s24, 16384
    buffer_load_dwordx4 v130, s[44:47], s24 offen offset:0 sc1 lds
    v_mfma_f32_16x16x32_bf16 v[72:75], v[104:107], a[80:83], v[72:75]
    v_add_f32 v70, s52, v70
    s_waitcnt lgkmcnt(4)
    v_mfma_f32_16x16x32_bf16 v[72:75], v[112:115], a[96:99], v[72:75]
    v_add_f32 v71, s52, v71
    ds_read_b128 v[104:107], v131 offset:18432
    ds_read_b128 v[108:111], v131 offset:19456
    v_mfma_f32_16x16x32_bf16 v[72:75], v[116:119], a[100:103], v[72:75]
    v_cvt_pk_bf16_f32 v68, v68, v69
    v_mfma_f32_16x16x32_bf16 v[76:79], v[116:119], a[108:111], v[76:79]
    v_cvt_pk_bf16_f32 v69, v70, v71
    v_mfma_f32_16x16x32_bf16 v[76:79], v[112:115], a[104:107], v[76:79]
    v_mul_f32 v238, v64, v142
    s_waitcnt lgkmcnt(4)
    v_mfma_f32_16x16x32_bf16 v[76:79], v[120:123], a[120:123], v[76:79]
    v_mul_f32 v239, v65, v142
    ds_read_b128 v[112:115], v131 offset:20480
    ds_read_b128 v[116:119], v131 offset:21504
    v_mfma_f32_16x16x32_bf16 v[76:79], v[124:127], a[124:127], v[76:79]
    v_mul_f32 v240, v66, v142
    s_add_u32 m0, s26, 81920
    s_nop 0
    buffer_load_dwordx4 v130, s[44:47], s24 offen offset:1024 sc1 lds
    v_mfma_f32_16x16x32_bf16 v[72:75], v[124:127], a[116:119], v[72:75]
    v_mul_f32 v241, v67, v142
    v_mfma_f32_16x16x32_bf16 v[72:75], v[120:123], a[112:115], v[72:75]
    v_exp_f32_e64 v238, v238 clamp
    ds_read_b128 v[120:123], v131 offset:22528
    ds_read_b128 v[124:127], v131 offset:23552
    s_waitcnt lgkmcnt(6)
    v_mfma_f32_16x16x32_bf16 v[72:75], v[96:99], a[128:131], v[72:75]
    v_exp_f32_e64 v239, v239 clamp
    v_mfma_f32_16x16x32_bf16 v[72:75], v[100:103], a[132:135], v[72:75]
    v_exp_f32_e64 v240, v240 clamp
    v_mfma_f32_16x16x32_bf16 v[76:79], v[100:103], a[140:143], v[76:79]
    v_exp_f32_e64 v241, v241 clamp
    v_mfma_f32_16x16x32_bf16 v[76:79], v[96:99], a[136:139], v[76:79]
    v_fma_f32 v64, v64, v146, 1.0
    s_waitcnt lgkmcnt(4)
    v_mfma_f32_16x16x32_bf16 v[76:79], v[104:107], a[152:155], v[76:79]
    v_fma_f32 v65, v65, v146, 1.0
    s_add_u32 m0, s26, 81920
    s_nop 0
    buffer_load_dwordx4 v130, s[44:47], s24 offen offset:2048 sc1 lds
    ds_read_b128 v[96:99], v131 offset:24576
    ds_read_b128 v[100:103], v131 offset:25600
    v_mfma_f32_16x16x32_bf16 v[76:79], v[108:111], a[156:159], v[76:79]
    v_fma_f32 v66, v66, v146, 1.0
    v_mfma_f32_16x16x32_bf16 v[72:75], v[108:111], a[148:151], v[72:75]
    v_fma_f32 v67, v67, v146, 1.0
    v_mfma_f32_16x16x32_bf16 v[72:75], v[104:107], a[144:147], v[72:75]
    v_max_f32 v64, v64, v238
    s_waitcnt lgkmcnt(4)
    v_mfma_f32_16x16x32_bf16 v[72:75], v[112:115], a[160:163], v[72:75]
    v_max_f32 v65, v65, v239
    ds_read_b128 v[104:107], v131 offset:26624
    ds_read_b128 v[108:111], v131 offset:27648
    v_mfma_f32_16x16x32_bf16 v[72:75], v[116:119], a[164:167], v[72:75]
    v_max_f32 v66, v66, v240
    v_mfma_f32_16x16x32_bf16 v[76:79], v[116:119], a[172:175], v[76:79]
    v_max_f32 v67, v67, v241
    v_mfma_f32_16x16x32_bf16 v[76:79], v[112:115], a[168:171], v[76:79]
    v_add_f32 v64, s52, v64
    s_add_u32 m0, s26, 81920
    s_nop 0
    buffer_load_dwordx4 v130, s[44:47], s24 offen offset:3072 sc1 lds
    s_waitcnt lgkmcnt(4)
    v_mfma_f32_16x16x32_bf16 v[76:79], v[120:123], a[184:187], v[76:79]
    v_add_f32 v65, s52, v65
    ds_read_b128 v[112:115], v131 offset:28672
    ds_read_b128 v[116:119], v131 offset:29696
    v_mfma_f32_16x16x32_bf16 v[76:79], v[124:127], a[188:191], v[76:79]
    v_add_f32 v66, s52, v66
    v_mfma_f32_16x16x32_bf16 v[72:75], v[124:127], a[180:183], v[72:75]
    v_add_f32 v67, s52, v67
    v_mfma_f32_16x16x32_bf16 v[72:75], v[120:123], a[176:179], v[72:75]
    v_cvt_pk_bf16_f32 v64, v64, v65
    s_waitcnt lgkmcnt(4)
    v_mfma_f32_16x16x32_bf16 v[72:75], v[96:99], a[192:195], v[72:75]
    v_cvt_pk_bf16_f32 v65, v66, v67
    ds_read_b128 v[120:123], v131 offset:30720
    ds_read_b128 v[124:127], v131 offset:31744
    v_mfma_f32_16x16x32_bf16 v[72:75], v[100:103], a[196:199], v[72:75]
    v_mfma_f32_16x16x32_bf16 v[76:79], v[100:103], a[204:207], v[76:79]
    s_waitcnt vmcnt(21)
    s_barrier
    v_mfma_f32_16x16x32_bf16 v[76:79], v[96:99], a[200:203], v[76:79]
    ds_read_b128 v[96:99], v131 offset:32768
    s_waitcnt lgkmcnt(5)
    v_mfma_f32_16x16x32_bf16 v[76:79], v[104:107], a[216:219], v[76:79]
    ds_read_b128 v[100:103], v131 offset:33792
    v_mfma_f32_16x16x32_bf16 v[76:79], v[108:111], a[220:223], v[76:79]
    v_mfma_f32_16x16x32_bf16 v[72:75], v[108:111], a[212:215], v[72:75]
    v_mfma_f32_16x16x32_bf16 v[72:75], v[104:107], a[208:211], v[72:75]
    ds_read_b128 v[104:107], v131 offset:34816
    s_waitcnt lgkmcnt(5)
    v_mfma_f32_16x16x32_bf16 v[72:75], v[112:115], a[224:227], v[72:75]
    ds_read_b128 v[108:111], v131 offset:35840
    v_mfma_f32_16x16x32_bf16 v[72:75], v[116:119], a[228:231], v[72:75]
    v_mfma_f32_16x16x32_bf16 v[76:79], v[116:119], a[236:239], v[76:79]
    v_mfma_f32_16x16x32_bf16 v[76:79], v[112:115], a[232:235], v[76:79]
    ds_read_b128 v[112:115], v131 offset:36864
    s_waitcnt lgkmcnt(5)
    v_mfma_f32_16x16x32_bf16 v[76:79], v[120:123], a[248:251], v[76:79]
    ds_read_b128 v[116:119], v131 offset:37888
    v_mfma_f32_16x16x32_bf16 v[76:79], v[124:127], a[252:255], v[76:79]
    v_mfma_f32_16x16x32_bf16 v[72:75], v[124:127], a[244:247], v[72:75]
    v_mfma_f32_16x16x32_bf16 v[72:75], v[120:123], a[240:243], v[72:75]
    ds_read_b128 v[120:123], v131 offset:38912
    ds_read_b128 v[124:127], v131 offset:39936
    s_waitcnt lgkmcnt(6)
    v_mfma_f32_16x16x32_bf16 v[80:83], v[96:99], a[0:3], v[80:83]
    v_mfma_f32_16x16x32_bf16 v[80:83], v[100:103], a[4:7], v[80:83]
    v_mfma_f32_16x16x32_bf16 v[84:87], v[100:103], a[12:15], v[84:87]
    v_mfma_f32_16x16x32_bf16 v[84:87], v[96:99], a[8:11], v[84:87]
    ds_read_b128 v[96:99], v131 offset:40960
    s_waitcnt lgkmcnt(5)
    v_mfma_f32_16x16x32_bf16 v[84:87], v[104:107], a[24:27], v[84:87]
    ds_read_b128 v[100:103], v131 offset:41984
    v_mfma_f32_16x16x32_bf16 v[84:87], v[108:111], a[28:31], v[84:87]
    v_mul_f32 v242, v76, v150
    v_mfma_f32_16x16x32_bf16 v[80:83], v[108:111], a[20:23], v[80:83]
    v_mul_f32 v243, v77, v150
    v_mfma_f32_16x16x32_bf16 v[80:83], v[104:107], a[16:19], v[80:83]
    v_mul_f32 v244, v78, v150
    s_waitcnt lgkmcnt(4)
    v_mfma_f32_16x16x32_bf16 v[80:83], v[112:115], a[32:35], v[80:83]
    v_mul_f32 v245, v79, v150
    ds_read_b128 v[104:107], v131 offset:43008
    ds_read_b128 v[108:111], v131 offset:44032
    v_mfma_f32_16x16x32_bf16 v[80:83], v[116:119], a[36:39], v[80:83]
    v_exp_f32_e64 v242, v242 clamp
    v_mfma_f32_16x16x32_bf16 v[84:87], v[116:119], a[44:47], v[84:87]
    v_exp_f32_e64 v243, v243 clamp
    v_mfma_f32_16x16x32_bf16 v[84:87], v[112:115], a[40:43], v[84:87]
    v_exp_f32_e64 v244, v244 clamp
    s_waitcnt lgkmcnt(4)
    v_mfma_f32_16x16x32_bf16 v[84:87], v[120:123], a[56:59], v[84:87]
    v_exp_f32_e64 v245, v245 clamp
    ds_read_b128 v[112:115], v131 offset:45056
    ds_read_b128 v[116:119], v131 offset:46080
    v_mfma_f32_16x16x32_bf16 v[84:87], v[124:127], a[60:63], v[84:87]
    v_fma_f32 v76, v76, v154, 1.0
    v_mfma_f32_16x16x32_bf16 v[80:83], v[124:127], a[52:55], v[80:83]
    v_fma_f32 v77, v77, v154, 1.0
    v_mfma_f32_16x16x32_bf16 v[80:83], v[120:123], a[48:51], v[80:83]
    v_fma_f32 v78, v78, v154, 1.0
    s_waitcnt lgkmcnt(4)
    v_mfma_f32_16x16x32_bf16 v[80:83], v[96:99], a[64:67], v[80:83]
    v_fma_f32 v79, v79, v154, 1.0
    ds_read_b128 v[120:123], v131 offset:47104
    ds_read_b128 v[124:127], v131 offset:48128
    v_mfma_f32_16x16x32_bf16 v[80:83], v[100:103], a[68:71], v[80:83]
    v_max_f32 v76, v76, v242
    v_mfma_f32_16x16x32_bf16 v[84:87], v[100:103], a[76:79], v[84:87]
    v_max_f32 v77, v77, v243
    s_waitcnt vmcnt(16)
    s_barrier
    v_mfma_f32_16x16x32_bf16 v[84:87], v[96:99], a[72:75], v[84:87]
    v_max_f32 v78, v78, v244
    s_waitcnt lgkmcnt(4)
    v_mfma_f32_16x16x32_bf16 v[84:87], v[104:107], a[88:91], v[84:87]
    v_max_f32 v79, v79, v245
    ds_read_b128 v[96:99], v131 offset:49152
    ds_read_b128 v[100:103], v131 offset:50176
    v_mfma_f32_16x16x32_bf16 v[84:87], v[108:111], a[92:95], v[84:87]
    v_add_f32 v76, s52, v76
    v_mfma_f32_16x16x32_bf16 v[80:83], v[108:111], a[84:87], v[80:83]
    v_add_f32 v77, s52, v77
    v_mfma_f32_16x16x32_bf16 v[80:83], v[104:107], a[80:83], v[80:83]
    v_add_f32 v78, s52, v78
    s_waitcnt lgkmcnt(4)
    v_mfma_f32_16x16x32_bf16 v[80:83], v[112:115], a[96:99], v[80:83]
    v_add_f32 v79, s52, v79
    ds_read_b128 v[104:107], v131 offset:51200
    ds_read_b128 v[108:111], v131 offset:52224
    v_mfma_f32_16x16x32_bf16 v[80:83], v[116:119], a[100:103], v[80:83]
    v_cvt_pk_bf16_f32 v70, v76, v77
    v_mfma_f32_16x16x32_bf16 v[84:87], v[116:119], a[108:111], v[84:87]
    v_cvt_pk_bf16_f32 v71, v78, v79
    v_mfma_f32_16x16x32_bf16 v[84:87], v[112:115], a[104:107], v[84:87]
    v_mul_f32 v238, v72, v142
    s_waitcnt lgkmcnt(4)
    v_mfma_f32_16x16x32_bf16 v[84:87], v[120:123], a[120:123], v[84:87]
    v_mul_f32 v239, v73, v142
    ds_read_b128 v[112:115], v131 offset:53248
    ds_read_b128 v[116:119], v131 offset:54272
    v_mfma_f32_16x16x32_bf16 v[84:87], v[124:127], a[124:127], v[84:87]
    v_mul_f32 v240, v74, v142
    v_mfma_f32_16x16x32_bf16 v[80:83], v[124:127], a[116:119], v[80:83]
    v_mul_f32 v241, v75, v142
    v_mfma_f32_16x16x32_bf16 v[80:83], v[120:123], a[112:115], v[80:83]
    v_exp_f32_e64 v238, v238 clamp
    ds_read_b128 v[120:123], v131 offset:55296
    ds_read_b128 v[124:127], v131 offset:56320
    s_waitcnt lgkmcnt(6)
    v_mfma_f32_16x16x32_bf16 v[80:83], v[96:99], a[128:131], v[80:83]
    v_exp_f32_e64 v239, v239 clamp
    v_mfma_f32_16x16x32_bf16 v[80:83], v[100:103], a[132:135], v[80:83]
    v_exp_f32_e64 v240, v240 clamp
    v_mfma_f32_16x16x32_bf16 v[84:87], v[100:103], a[140:143], v[84:87]
    v_exp_f32_e64 v241, v241 clamp
    v_mfma_f32_16x16x32_bf16 v[84:87], v[96:99], a[136:139], v[84:87]
    v_fma_f32 v72, v72, v146, 1.0
    s_waitcnt lgkmcnt(4)
    v_mfma_f32_16x16x32_bf16 v[84:87], v[104:107], a[152:155], v[84:87]
    v_fma_f32 v73, v73, v146, 1.0
    ds_read_b128 v[96:99], v131 offset:57344
    ds_read_b128 v[100:103], v131 offset:58368
    v_mfma_f32_16x16x32_bf16 v[84:87], v[108:111], a[156:159], v[84:87]
    v_fma_f32 v74, v74, v146, 1.0
    v_mfma_f32_16x16x32_bf16 v[80:83], v[108:111], a[148:151], v[80:83]
    v_fma_f32 v75, v75, v146, 1.0
    v_mfma_f32_16x16x32_bf16 v[80:83], v[104:107], a[144:147], v[80:83]
    v_max_f32 v72, v72, v238
    s_waitcnt lgkmcnt(4)
    v_mfma_f32_16x16x32_bf16 v[80:83], v[112:115], a[160:163], v[80:83]
    v_max_f32 v73, v73, v239
    ds_read_b128 v[104:107], v131 offset:59392
    ds_read_b128 v[108:111], v131 offset:60416
    v_mfma_f32_16x16x32_bf16 v[80:83], v[116:119], a[164:167], v[80:83]
    v_max_f32 v74, v74, v240
    v_mfma_f32_16x16x32_bf16 v[84:87], v[116:119], a[172:175], v[84:87]
    v_max_f32 v75, v75, v241
    v_mfma_f32_16x16x32_bf16 v[84:87], v[112:115], a[168:171], v[84:87]
    v_add_f32 v72, s52, v72
    s_waitcnt lgkmcnt(4)
    v_mfma_f32_16x16x32_bf16 v[84:87], v[120:123], a[184:187], v[84:87]
    v_add_f32 v73, s52, v73
    ds_read_b128 v[112:115], v131 offset:61440
    ds_read_b128 v[116:119], v131 offset:62464
    v_mfma_f32_16x16x32_bf16 v[84:87], v[124:127], a[188:191], v[84:87]
    v_add_f32 v74, s52, v74
    v_mfma_f32_16x16x32_bf16 v[80:83], v[124:127], a[180:183], v[80:83]
    v_add_f32 v75, s52, v75
    v_mfma_f32_16x16x32_bf16 v[80:83], v[120:123], a[176:179], v[80:83]
    v_cvt_pk_bf16_f32 v66, v72, v73
    s_waitcnt vmcnt(0)
    s_barrier
    s_waitcnt lgkmcnt(4)
    v_mfma_f32_16x16x32_bf16 v[80:83], v[96:99], a[192:195], v[80:83]
    v_cvt_pk_bf16_f32 v67, v74, v75
    buffer_atomic_add v185, v184, s[44:47], s63 offen sc1
    ds_read_b128 v[120:123], v131 offset:63488
    ds_read_b128 v[124:127], v131 offset:64512
    v_mfma_f32_16x16x32_bf16 v[80:83], v[100:103], a[196:199], v[80:83]
    v_mfma_f32_16x16x32_bf16 v[84:87], v[100:103], a[204:207], v[84:87]
    s_add_u32 m0, s21, 98304
    s_nop 0
    buffer_load_dwordx4 v187, s[44:47], s20 offen offset:0 sc1 lds
    s_waitcnt vmcnt(6)
    s_barrier
    v_mfma_f32_16x16x32_bf16 v[84:87], v[96:99], a[200:203], v[84:87]
    ds_read_b128 v[96:99], v132 offset:0
    s_waitcnt lgkmcnt(5)
    v_mfma_f32_16x16x32_bf16 v[84:87], v[104:107], a[216:219], v[84:87]
    ds_read_b128 v[100:103], v132 offset:1024
    v_mfma_f32_16x16x32_bf16 v[84:87], v[108:111], a[220:223], v[84:87]
    s_add_u32 m0, s21, 98304
    s_nop 0
    buffer_load_dwordx4 v187, s[44:47], s20 offen offset:1024 sc1 lds
    v_mfma_f32_16x16x32_bf16 v[80:83], v[108:111], a[212:215], v[80:83]
    v_mfma_f32_16x16x32_bf16 v[80:83], v[104:107], a[208:211], v[80:83]
    ds_read_b128 v[104:107], v132 offset:2048
    s_waitcnt lgkmcnt(5)
    v_mfma_f32_16x16x32_bf16 v[80:83], v[112:115], a[224:227], v[80:83]
    s_add_u32 m0, s21, 106496
    s_add_u32 s20, s20, 8192
    buffer_load_dwordx4 v187, s[44:47], s20 offen offset:0 sc1 lds
    ds_read_b128 v[108:111], v132 offset:3072
    v_mfma_f32_16x16x32_bf16 v[80:83], v[116:119], a[228:231], v[80:83]
    v_mfma_f32_16x16x32_bf16 v[84:87], v[116:119], a[236:239], v[84:87]
    v_mfma_f32_16x16x32_bf16 v[84:87], v[112:115], a[232:235], v[84:87]
    s_add_u32 m0, s21, 106496
    s_nop 0
    buffer_load_dwordx4 v187, s[44:47], s20 offen offset:1024 sc1 lds
    s_waitcnt lgkmcnt(4)
    v_mfma_f32_16x16x32_bf16 v[84:87], v[120:123], a[248:251], v[84:87]
    ds_read_b128 v[112:115], v132 offset:4096
    ds_read_b128 v[116:119], v132 offset:5120
    v_mfma_f32_16x16x32_bf16 v[84:87], v[124:127], a[252:255], v[84:87]
    v_mfma_f32_16x16x32_bf16 v[80:83], v[124:127], a[244:247], v[80:83]
    s_add_u32 m0, s21, 114688
    s_add_u32 s20, s20, 8192
    buffer_load_dwordx4 v187, s[44:47], s20 offen offset:0 sc1 lds
    v_mfma_f32_16x16x32_bf16 v[80:83], v[120:123], a[240:243], v[80:83]
    ds_read_b128 v[120:123], v132 offset:6144
    ds_read_b128 v[124:127], v132 offset:7168
    s_waitcnt lgkmcnt(6)
    v_mfma_f32_16x16x32_bf16 v[88:91], v[96:99], a[0:3], v[88:91]
    v_mfma_f32_16x16x32_bf16 v[88:91], v[100:103], a[4:7], v[88:91]
    s_add_u32 m0, s21, 114688
    s_nop 0
    buffer_load_dwordx4 v187, s[44:47], s20 offen offset:1024 sc1 lds
    v_mfma_f32_16x16x32_bf16 v[92:95], v[100:103], a[12:15], v[92:95]
    v_mfma_f32_16x16x32_bf16 v[92:95], v[96:99], a[8:11], v[92:95]
    ds_read_b128 v[96:99], v132 offset:8192
    s_waitcnt lgkmcnt(5)
    v_mfma_f32_16x16x32_bf16 v[92:95], v[104:107], a[24:27], v[92:95]
    s_add_u32 m0, s21, 122880
    s_add_u32 s20, s20, 8192
    buffer_load_dwordx4 v187, s[44:47], s20 offen offset:0 sc1 lds
    ds_read_b128 v[100:103], v132 offset:9216
    v_mfma_f32_16x16x32_bf16 v[92:95], v[108:111], a[28:31], v[92:95]
    v_mul_f32 v242, v84, v150
    v_mfma_f32_16x16x32_bf16 v[88:91], v[108:111], a[20:23], v[88:91]
    v_mul_f32 v243, v85, v150
    v_mfma_f32_16x16x32_bf16 v[88:91], v[104:107], a[16:19], v[88:91]
    v_mul_f32 v244, v86, v150
    s_add_u32 m0, s21, 122880
    s_nop 0
    buffer_load_dwordx4 v187, s[44:47], s20 offen offset:1024 sc1 lds
    s_waitcnt lgkmcnt(4)
    v_mfma_f32_16x16x32_bf16 v[88:91], v[112:115], a[32:35], v[88:91]
    v_mul_f32 v245, v87, v150
    ds_read_b128 v[104:107], v132 offset:10240
    ds_read_b128 v[108:111], v132 offset:11264
    v_mfma_f32_16x16x32_bf16 v[88:91], v[116:119], a[36:39], v[88:91]
    v_exp_f32_e64 v242, v242 clamp
    v_mfma_f32_16x16x32_bf16 v[92:95], v[116:119], a[44:47], v[92:95]
    v_exp_f32_e64 v243, v243 clamp
    s_add_u32 m0, s21, 131072
    s_add_u32 s20, s20, 8192
    buffer_load_dwordx4 v187, s[44:47], s20 offen offset:0 sc1 lds
    v_mfma_f32_16x16x32_bf16 v[92:95], v[112:115], a[40:43], v[92:95]
    v_exp_f32_e64 v244, v244 clamp
    s_waitcnt lgkmcnt(4)
    v_mfma_f32_16x16x32_bf16 v[92:95], v[120:123], a[56:59], v[92:95]
    v_exp_f32_e64 v245, v245 clamp
    ds_read_b128 v[112:115], v132 offset:12288
    ds_read_b128 v[116:119], v132 offset:13312
    v_mfma_f32_16x16x32_bf16 v[92:95], v[124:127], a[60:63], v[92:95]
    v_fma_f32 v84, v84, v154, 1.0
    s_add_u32 m0, s21, 131072
    s_nop 0
    buffer_load_dwordx4 v187, s[44:47], s20 offen offset:1024 sc1 lds
    v_mfma_f32_16x16x32_bf16 v[88:91], v[124:127], a[52:55], v[88:91]
    v_fma_f32 v85, v85, v154, 1.0
    v_mfma_f32_16x16x32_bf16 v[88:91], v[120:123], a[48:51], v[88:91]
    v_fma_f32 v86, v86, v154, 1.0
    s_waitcnt lgkmcnt(4)
    v_mfma_f32_16x16x32_bf16 v[88:91], v[96:99], a[64:67], v[88:91]
    v_fma_f32 v87, v87, v154, 1.0
    s_add_u32 m0, s21, 139264
    s_add_u32 s20, s20, 8192
    buffer_load_dwordx4 v187, s[44:47], s20 offen offset:0 sc1 lds
    ds_read_b128 v[120:123], v132 offset:14336
    ds_read_b128 v[124:127], v132 offset:15360
    v_mfma_f32_16x16x32_bf16 v[88:91], v[100:103], a[68:71], v[88:91]
    v_max_f32 v84, v84, v242
    v_mfma_f32_16x16x32_bf16 v[92:95], v[100:103], a[76:79], v[92:95]
    v_max_f32 v85, v85, v243
    s_waitcnt vmcnt(12)
    s_barrier
    v_mfma_f32_16x16x32_bf16 v[92:95], v[96:99], a[72:75], v[92:95]
    v_max_f32 v86, v86, v244
    s_add_u32 m0, s21, 139264
    s_nop 0
    buffer_load_dwordx4 v187, s[44:47], s20 offen offset:1024 sc1 lds
    s_waitcnt lgkmcnt(4)
    v_mfma_f32_16x16x32_bf16 v[92:95], v[104:107], a[88:91], v[92:95]
    v_max_f32 v87, v87, v245
    ds_read_b128 v[96:99], v132 offset:16384
    ds_read_b128 v[100:103], v132 offset:17408
    v_mfma_f32_16x16x32_bf16 v[92:95], v[108:111], a[92:95], v[92:95]
    v_add_f32 v84, s52, v84
    v_mfma_f32_16x16x32_bf16 v[88:91], v[108:111], a[84:87], v[88:91]
    v_add_f32 v85, s52, v85
    s_add_u32 m0, s21, 147456
    s_add_u32 s20, s20, 8192
    buffer_load_dwordx4 v187, s[44:47], s20 offen offset:0 sc1 lds
    v_mfma_f32_16x16x32_bf16 v[88:91], v[104:107], a[80:83], v[88:91]
    v_add_f32 v86, s52, v86
    s_waitcnt lgkmcnt(4)
    v_mfma_f32_16x16x32_bf16 v[88:91], v[112:115], a[96:99], v[88:91]
    v_add_f32 v87, s52, v87
    ds_read_b128 v[104:107], v132 offset:18432
    ds_read_b128 v[108:111], v132 offset:19456
    v_mfma_f32_16x16x32_bf16 v[88:91], v[116:119], a[100:103], v[88:91]
    v_cvt_pk_bf16_f32 v84, v84, v85
    s_add_u32 m0, s21, 147456
    s_nop 0
    buffer_load_dwordx4 v187, s[44:47], s20 offen offset:1024 sc1 lds
    v_mfma_f32_16x16x32_bf16 v[92:95], v[116:119], a[108:111], v[92:95]
    v_cvt_pk_bf16_f32 v85, v86, v87
    v_mfma_f32_16x16x32_bf16 v[92:95], v[112:115], a[104:107], v[92:95]
    v_mul_f32 v238, v80, v142
    s_waitcnt lgkmcnt(4)
    v_mfma_f32_16x16x32_bf16 v[92:95], v[120:123], a[120:123], v[92:95]
    v_mul_f32 v239, v81, v142
    buffer_load_dword v136, v134, s[44:47], s59 offen sc1
    s_add_u32 m0, s21, 0
    s_add_u32 s20, s20, 8192
    buffer_load_dwordx4 v187, s[44:47], s20 offen offset:0 sc1 lds
    ds_read_b128 v[112:115], v132 offset:20480
    ds_read_b128 v[116:119], v132 offset:21504
    v_mfma_f32_16x16x32_bf16 v[92:95], v[124:127], a[124:127], v[92:95]
    v_mul_f32 v240, v82, v142
    v_mfma_f32_16x16x32_bf16 v[88:91], v[124:127], a[116:119], v[88:91]
    v_mul_f32 v241, v83, v142
    v_mfma_f32_16x16x32_bf16 v[88:91], v[120:123], a[112:115], v[88:91]
    v_exp_f32_e64 v238, v238 clamp
    s_add_u32 m0, s21, 0
    s_nop 0
    buffer_load_dwordx4 v187, s[44:47], s20 offen offset:1024 sc1 lds
    ds_read_b128 v[120:123], v132 offset:22528
    ds_read_b128 v[124:127], v132 offset:23552
    s_waitcnt lgkmcnt(6)
    v_mfma_f32_16x16x32_bf16 v[88:91], v[96:99], a[128:131], v[88:91]
    v_exp_f32_e64 v239, v239 clamp
    v_mfma_f32_16x16x32_bf16 v[88:91], v[100:103], a[132:135], v[88:91]
    v_exp_f32_e64 v240, v240 clamp
    v_mfma_f32_16x16x32_bf16 v[92:95], v[100:103], a[140:143], v[92:95]
    v_exp_f32_e64 v241, v241 clamp
    s_add_u32 m0, s21, 8192
    s_add_u32 s20, s20, 8192
    buffer_load_dwordx4 v187, s[44:47], s20 offen offset:0 sc1 lds
    v_mfma_f32_16x16x32_bf16 v[92:95], v[96:99], a[136:139], v[92:95]
    v_fma_f32 v80, v80, v146, 1.0
    s_waitcnt lgkmcnt(4)
    v_mfma_f32_16x16x32_bf16 v[92:95], v[104:107], a[152:155], v[92:95]
    v_fma_f32 v81, v81, v146, 1.0
    ds_read_b128 v[96:99], v132 offset:24576
    ds_read_b128 v[100:103], v132 offset:25600
    v_mfma_f32_16x16x32_bf16 v[92:95], v[108:111], a[156:159], v[92:95]
    v_fma_f32 v82, v82, v146, 1.0
    s_add_u32 m0, s21, 8192
    s_nop 0
    buffer_load_dwordx4 v187, s[44:47], s20 offen offset:1024 sc1 lds
    v_mfma_f32_16x16x32_bf16 v[88:91], v[108:111], a[148:151], v[88:91]
    v_fma_f32 v83, v83, v146, 1.0
    v_mfma_f32_16x16x32_bf16 v[88:91], v[104:107], a[144:147], v[88:91]
    v_max_f32 v80, v80, v238
    s_waitcnt lgkmcnt(4)
    v_mfma_f32_16x16x32_bf16 v[88:91], v[112:115], a[160:163], v[88:91]
    v_max_f32 v81, v81, v239
    s_add_u32 m0, s21, 16384
    s_add_u32 s20, s20, 8192
    buffer_load_dwordx4 v187, s[44:47], s20 offen offset:0 sc1 lds
    ds_read_b128 v[104:107], v132 offset:26624
    ds_read_b128 v[108:111], v132 offset:27648
    v_mfma_f32_16x16x32_bf16 v[88:91], v[116:119], a[164:167], v[88:91]
    v_max_f32 v82, v82, v240
    v_mfma_f32_16x16x32_bf16 v[92:95], v[116:119], a[172:175], v[92:95]
    v_max_f32 v83, v83, v241
    v_mfma_f32_16x16x32_bf16 v[92:95], v[112:115], a[168:171], v[92:95]
    v_add_f32 v80, s52, v80
    s_add_u32 m0, s21, 16384
    s_nop 0
    buffer_load_dwordx4 v187, s[44:47], s20 offen offset:1024 sc1 lds
    s_waitcnt lgkmcnt(4)
    v_mfma_f32_16x16x32_bf16 v[92:95], v[120:123], a[184:187], v[92:95]
    v_add_f32 v81, s52, v81
    ds_read_b128 v[112:115], v132 offset:28672
    ds_read_b128 v[116:119], v132 offset:29696
    v_mfma_f32_16x16x32_bf16 v[92:95], v[124:127], a[188:191], v[92:95]
    v_add_f32 v82, s52, v82
    v_mfma_f32_16x16x32_bf16 v[88:91], v[124:127], a[180:183], v[88:91]
    v_add_f32 v83, s52, v83
    v_mfma_f32_16x16x32_bf16 v[88:91], v[120:123], a[176:179], v[88:91]
    v_cvt_pk_bf16_f32 v80, v80, v81
    s_waitcnt lgkmcnt(4)
    v_mfma_f32_16x16x32_bf16 v[88:91], v[96:99], a[192:195], v[88:91]
    v_cvt_pk_bf16_f32 v81, v82, v83
    ds_read_b128 v[120:123], v132 offset:30720
    ds_read_b128 v[124:127], v132 offset:31744
    v_mfma_f32_16x16x32_bf16 v[88:91], v[100:103], a[196:199], v[88:91]
    v_mfma_f32_16x16x32_bf16 v[92:95], v[100:103], a[204:207], v[92:95]
    v_mfma_f32_16x16x32_bf16 v[92:95], v[96:99], a[200:203], v[92:95]
    s_waitcnt lgkmcnt(4)
    v_mfma_f32_16x16x32_bf16 v[92:95], v[104:107], a[216:219], v[92:95]
    v_mfma_f32_16x16x32_bf16 v[92:95], v[108:111], a[220:223], v[92:95]
    v_mfma_f32_16x16x32_bf16 v[88:91], v[108:111], a[212:215], v[88:91]
    v_mfma_f32_16x16x32_bf16 v[88:91], v[104:107], a[208:211], v[88:91]
    s_waitcnt lgkmcnt(2)
    v_mfma_f32_16x16x32_bf16 v[88:91], v[112:115], a[224:227], v[88:91]
    v_mfma_f32_16x16x32_bf16 v[88:91], v[116:119], a[228:231], v[88:91]
    v_mfma_f32_16x16x32_bf16 v[92:95], v[116:119], a[236:239], v[92:95]
    v_mfma_f32_16x16x32_bf16 v[92:95], v[112:115], a[232:235], v[92:95]
    s_waitcnt lgkmcnt(0)
    v_mfma_f32_16x16x32_bf16 v[92:95], v[120:123], a[248:251], v[92:95]
    v_mfma_f32_16x16x32_bf16 v[92:95], v[124:127], a[252:255], v[92:95]
    v_mfma_f32_16x16x32_bf16 v[88:91], v[124:127], a[244:247], v[88:91]
    v_mfma_f32_16x16x32_bf16 v[88:91], v[120:123], a[240:243], v[88:91]
    s_waitcnt vmcnt(0)
    v_readfirstlane_b32 s16, v136
    s_cmp_ge_u32 s16, 16
    s_cbranch_scc1 PEa01
    v_mov_b32 v134, 0
    s_mov_b32 s17, 0
Pa01:
    buffer_load_dword v136, v134, s[44:47], s59 offen sc1
    s_waitcnt vmcnt(0)
    v_readfirstlane_b32 s16, v136
    s_cmp_ge_u32 s16, 16
    s_cbranch_scc1 PEa01
    s_sleep 1
    s_add_u32 s17, s17, 1
    s_cmp_lt_u32 s17, 0x40000
    s_cbranch_scc1 Pa01
PEa01:
    buffer_load_dwordx4 v[190:193], v128, s[44:47], s40 offen sc1
    buffer_load_dwordx4 v[194:197], v128, s[44:47], s40 offen offset:1024 sc1
    buffer_load_dwordx4 v[198:201], v135, s[44:47], s58 offen offset:0 sc1
    buffer_load_dwordx4 v[202:205], v135, s[44:47], s58 offen offset:64 sc1
    buffer_load_dwordx4 v[206:209], v135, s[44:47], s58 offen offset:128 sc1
    buffer_load_dwordx4 v[210:213], v135, s[44:47], s58 offen offset:192 sc1
    v_mul_f32 v242, v92, v150
    v_mul_f32 v243, v93, v150
    v_mul_f32 v244, v94, v150
    v_mul_f32 v245, v95, v150
    v_exp_f32_e64 v242, v242 clamp
    v_exp_f32_e64 v243, v243 clamp
    v_exp_f32_e64 v244, v244 clamp
    v_exp_f32_e64 v245, v245 clamp
    v_fma_f32 v92, v92, v154, 1.0
    v_fma_f32 v93, v93, v154, 1.0
    v_fma_f32 v94, v94, v154, 1.0
    v_fma_f32 v95, v95, v154, 1.0
    v_max_f32 v92, v92, v242
    v_max_f32 v93, v93, v243
    v_max_f32 v94, v94, v244
    v_max_f32 v95, v95, v245
    v_add_f32 v92, s52, v92
    v_add_f32 v93, s52, v93
    v_add_f32 v94, s52, v94
    v_add_f32 v95, s52, v95
    v_cvt_pk_bf16_f32 v86, v92, v93
    v_cvt_pk_bf16_f32 v87, v94, v95
    v_mul_f32 v238, v88, v142
    v_mul_f32 v239, v89, v142
    v_mul_f32 v240, v90, v142
    v_mul_f32 v241, v91, v142
    v_exp_f32_e64 v238, v238 clamp
    v_exp_f32_e64 v239, v239 clamp
    v_exp_f32_e64 v240, v240 clamp
    v_exp_f32_e64 v241, v241 clamp
    v_fma_f32 v88, v88, v146, 1.0
    v_fma_f32 v89, v89, v146, 1.0
    v_fma_f32 v90, v90, v146, 1.0
    v_fma_f32 v91, v91, v146, 1.0
    v_max_f32 v88, v88, v238
    v_max_f32 v89, v89, v239
    v_max_f32 v90, v90, v240
    v_max_f32 v91, v91, v241
    v_add_f32 v88, s52, v88
    v_add_f32 v89, s52, v89
    v_add_f32 v90, s52, v90
    v_add_f32 v91, s52, v91
    v_cvt_pk_bf16_f32 v82, v88, v89
    v_cvt_pk_bf16_f32 v83, v90, v91
    s_waitcnt vmcnt(4)
    v_cvt_pk_bf16_f32 v190, v190, v191
    v_cvt_pk_bf16_f32 v191, v192, v193
    v_cvt_pk_bf16_f32 v192, v194, v195
    v_cvt_pk_bf16_f32 v193, v196, v197
    ds_write_b128 v139, v[190:193]
    s_waitcnt vmcnt(0)
    v_cvt_pk_bf16_f32 v198, v198, v199
    v_cvt_pk_bf16_f32 v199, v200, v201
    v_cvt_pk_bf16_f32 v200, v202, v203
    v_cvt_pk_bf16_f32 v201, v204, v205
    v_cvt_pk_bf16_f32 v206, v206, v207
    v_cvt_pk_bf16_f32 v207, v208, v209
    v_cvt_pk_bf16_f32 v208, v210, v211
    v_cvt_pk_bf16_f32 v209, v212, v213
    s_waitcnt lgkmcnt(0)
    s_barrier
    ds_read_b128 v[214:217], v186 offset:0
    ds_read_b128 v[218:221], v186 offset:1024
    ds_read_b128 v[222:225], v186 offset:2048
    ds_read_b128 v[226:229], v186 offset:3072
    v_mfma_f32_16x16x32_bf16 v[24:27], v[198:201], v[64:67], v[250:253]
    v_mfma_f32_16x16x32_bf16 v[36:39], v[198:201], v[68:71], v[250:253]
    v_mfma_f32_16x16x32_bf16 v[48:51], v[206:209], v[80:83], v[250:253]
    v_mfma_f32_16x16x32_bf16 v[60:63], v[206:209], v[84:87], v[250:253]
    s_waitcnt lgkmcnt(3)
    v_mfma_f32_16x16x32_bf16 v[16:19], v[214:217], v[64:67], 0
    v_mfma_f32_16x16x32_bf16 v[28:31], v[214:217], v[68:71], 0
    s_waitcnt lgkmcnt(2)
    v_mfma_f32_16x16x32_bf16 v[20:23], v[218:221], v[64:67], 0
    v_mfma_f32_16x16x32_bf16 v[32:35], v[218:221], v[68:71], 0
    s_waitcnt lgkmcnt(1)
    v_mfma_f32_16x16x32_bf16 v[40:43], v[222:225], v[80:83], 0
    v_mfma_f32_16x16x32_bf16 v[52:55], v[222:225], v[84:87], 0
    s_waitcnt lgkmcnt(0)
    v_mfma_f32_16x16x32_bf16 v[44:47], v[226:229], v[80:83], 0
    v_mfma_f32_16x16x32_bf16 v[56:59], v[226:229], v[84:87], 0
    v_rcp_f32 v24, v24
    v_rcp_f32 v36, v36
    v_rcp_f32 v48, v48
    v_rcp_f32 v60, v60
    v_pk_mul_f32 v[16:17], v[16:17], v[24:25] op_sel_hi:[1,0]
    v_pk_mul_f32 v[18:19], v[18:19], v[24:25] op_sel_hi:[1,0]
    v_pk_mul_f32 v[20:21], v[20:21], v[24:25] op_sel_hi:[1,0]
    v_pk_mul_f32 v[22:23], v[22:23], v[24:25] op_sel_hi:[1,0]
    v_cvt_pk_bf16_f32 v0, v16, v17
    v_cvt_pk_bf16_f32 v1, v18, v19
    v_cvt_pk_bf16_f32 v2, v20, v21
    v_cvt_pk_bf16_f32 v3, v22, v23
    buffer_store_dwordx4 v[0:3], v128, s[44:47], s60 offen offset:0 sc1
    v_pk_mul_f32 v[28:29], v[28:29], v[36:37] op_sel_hi:[1,0]
    v_pk_mul_f32 v[30:31], v[30:31], v[36:37] op_sel_hi:[1,0]
    v_pk_mul_f32 v[32:33], v[32:33], v[36:37] op_sel_hi:[1,0]
    v_pk_mul_f32 v[34:35], v[34:35], v[36:37] op_sel_hi:[1,0]
    v_cvt_pk_bf16_f32 v4, v28, v29
    v_cvt_pk_bf16_f32 v5, v30, v31
    v_cvt_pk_bf16_f32 v6, v32, v33
    v_cvt_pk_bf16_f32 v7, v34, v35
    buffer_store_dwordx4 v[4:7], v128, s[44:47], s61 offen offset:0 sc1
    v_pk_mul_f32 v[40:41], v[40:41], v[48:49] op_sel_hi:[1,0]
    v_pk_mul_f32 v[42:43], v[42:43], v[48:49] op_sel_hi:[1,0]
    v_pk_mul_f32 v[44:45], v[44:45], v[48:49] op_sel_hi:[1,0]
    v_pk_mul_f32 v[46:47], v[46:47], v[48:49] op_sel_hi:[1,0]
    v_cvt_pk_bf16_f32 v8, v40, v41
    v_cvt_pk_bf16_f32 v9, v42, v43
    v_cvt_pk_bf16_f32 v10, v44, v45
    v_cvt_pk_bf16_f32 v11, v46, v47
    buffer_store_dwordx4 v[8:11], v128, s[44:47], s60 offen offset:1024 sc1
    v_pk_mul_f32 v[52:53], v[52:53], v[60:61] op_sel_hi:[1,0]
    v_pk_mul_f32 v[54:55], v[54:55], v[60:61] op_sel_hi:[1,0]
    v_pk_mul_f32 v[56:57], v[56:57], v[60:61] op_sel_hi:[1,0]
    v_pk_mul_f32 v[58:59], v[58:59], v[60:61] op_sel_hi:[1,0]
    v_cvt_pk_bf16_f32 v12, v52, v53
    v_cvt_pk_bf16_f32 v13, v54, v55
    v_cvt_pk_bf16_f32 v14, v56, v57
    v_cvt_pk_bf16_f32 v15, v58, v59
    buffer_store_dwordx4 v[12:15], v128, s[44:47], s61 offen offset:1024 sc1
    v_and_b32 v158, 31, v133
    v_and_b32 v164, 15, v133
    v_lshrrev_b32 v165, 4, v133
    v_lshlrev_b32 v159, 4, v164
    v_lshl_add_u32 v159, v165, 2, v159
    v_mov_b32 v162, 0x3f803f80
    s_lshl_b32 s54, s42, 15
    s_lshl_b32 s55, s38, 11
    s_add_u32 s48, s54, s55
    s_add_u32 s49, s48, 32768
    s_lshl_b32 s54, s42, 11
    s_lshl_b32 s55, s38, 8
    s_add_u32 s52, s54, s55
    s_add_u32 s52, s52, 53739520
    s_add_u32 s53, s54, 0
    s_waitcnt vmcnt(0)
    s_barrier
    buffer_atomic_add v185, v184, s[44:47], s19 offen sc1
    s_add_u32 m0, s21, 24576
    s_add_u32 s20, s20, 8192
    buffer_load_dwordx4 v187, s[44:47], s20 offen offset:0 sc1 lds
    s_add_u32 m0, s21, 24576
    s_nop 0
    buffer_load_dwordx4 v187, s[44:47], s20 offen offset:1024 sc1 lds
    s_add_u32 m0, s21, 32768
    s_add_u32 s20, s20, 8192
    buffer_load_dwordx4 v187, s[44:47], s20 offen offset:0 sc1 lds
    s_add_u32 m0, s21, 32768
    s_nop 0
    buffer_load_dwordx4 v187, s[44:47], s20 offen offset:1024 sc1 lds
    s_add_u32 m0, s21, 40960
    s_add_u32 s20, s20, 8192
    buffer_load_dwordx4 v187, s[44:47], s20 offen offset:0 sc1 lds
    s_add_u32 m0, s21, 40960
    s_nop 0
    buffer_load_dwordx4 v187, s[44:47], s20 offen offset:1024 sc1 lds
    s_add_u32 m0, s21, 49152
    s_add_u32 s20, s20, 8192
    buffer_load_dwordx4 v187, s[44:47], s20 offen offset:0 sc1 lds
    s_add_u32 m0, s21, 49152
    s_nop 0
    buffer_load_dwordx4 v187, s[44:47], s20 offen offset:1024 sc1 lds
    s_add_u32 m0, s21, 57344
    s_add_u32 s20, s20, 8192
    buffer_load_dwordx4 v187, s[44:47], s20 offen offset:0 sc1 lds
    s_add_u32 m0, s21, 57344
    s_nop 0
    buffer_load_dwordx4 v187, s[44:47], s20 offen offset:1024 sc1 lds
    s_add_u32 m0, s21, 65536
    s_add_u32 s20, s20, 8192
    buffer_load_dwordx4 v187, s[44:47], s20 offen offset:0 sc1 lds
    s_add_u32 m0, s21, 65536
    s_nop 0
    buffer_load_dwordx4 v187, s[44:47], s20 offen offset:1024 sc1 lds
    buffer_load_dwordx4 v[190:193], v128, s[44:47], s48 offen offset:0 sc1
    buffer_load_dwordx4 v[194:197], v128, s[44:47], s48 offen offset:1024 sc1
    buffer_load_dwordx4 v[198:201], v128, s[44:47], s49 offen offset:0 sc1
    buffer_load_dwordx4 v[202:205], v128, s[44:47], s49 offen offset:1024 sc1
    ds_read_b128 v[32:35], v188 offset:32768
    ds_read_b128 v[36:39], v188 offset:33792
    ds_read_b128 v[40:43], v188 offset:34816
    ds_read_b128 v[44:47], v188 offset:35840
    ds_read_b128 v[48:51], v188 offset:36864
    ds_read_b128 v[52:55], v188 offset:37888
    ds_read_b128 v[56:59], v188 offset:38912
    ds_read_b128 v[60:63], v188 offset:39936
    s_cmp_lg_u32 s34, 0
    s_cbranch_scc1 PEa02
    v_mov_b32 v134, 0
    s_mov_b32 s17, 0
Pa02:
    buffer_load_dword v136, v134, s[44:47], s22 offen sc1
    s_waitcnt vmcnt(0)
    v_readfirstlane_b32 s16, v136
    s_cmp_ge_u32 s16, 16
    s_cbranch_scc1 PEa02
    s_sleep 4
    s_add_u32 s17, s17, 1
    s_cmp_lt_u32 s17, 0x40000
    s_cbranch_scc1 Pa02
PEa02:
    s_waitcnt vmcnt(0)
    s_barrier
    buffer_load_dwordx4 a[0:3], v128, s[44:47], s23 offen offset:0 sc1
    buffer_load_dwordx4 a[4:7], v128, s[44:47], s23 offen offset:1024 sc1
    buffer_load_dwordx4 a[8:11], v129, s[44:47], s23 offen offset:0 sc1
    buffer_load_dwordx4 a[12:15], v129, s[44:47], s23 offen offset:1024 sc1
    s_add_u32 s23, s23, 2048
    buffer_load_dwordx4 a[16:19], v128, s[44:47], s23 offen offset:0 sc1
    buffer_load_dwordx4 a[20:23], v128, s[44:47], s23 offen offset:1024 sc1
    buffer_load_dwordx4 a[24:27], v129, s[44:47], s23 offen offset:0 sc1
    buffer_load_dwordx4 a[28:31], v129, s[44:47], s23 offen offset:1024 sc1
    s_add_u32 s23, s23, 2048
    buffer_load_dwordx4 a[32:35], v128, s[44:47], s23 offen offset:0 sc1
    buffer_load_dwordx4 a[36:39], v128, s[44:47], s23 offen offset:1024 sc1
    buffer_load_dwordx4 a[40:43], v129, s[44:47], s23 offen offset:0 sc1
    buffer_load_dwordx4 a[44:47], v129, s[44:47], s23 offen offset:1024 sc1
    v_lshlrev_b32 v0, 16, v190
    v_and_b32 v1, 0xffff0000, v190
    v_lshlrev_b32 v2, 16, v191
    v_and_b32 v3, 0xffff0000, v191
    v_lshlrev_b32 v4, 16, v198
    v_and_b32 v5, 0xffff0000, v198
    v_lshlrev_b32 v6, 16, v199
    v_and_b32 v7, 0xffff0000, v199
    v_lshlrev_b32 v8, 16, v192
    v_and_b32 v9, 0xffff0000, v192
    v_lshlrev_b32 v10, 16, v193
    v_and_b32 v11, 0xffff0000, v193
    v_lshlrev_b32 v12, 16, v200
    v_and_b32 v13, 0xffff0000, v200
    v_lshlrev_b32 v14, 16, v201
    v_and_b32 v15, 0xffff0000, v201
    v_lshlrev_b32 v16, 16, v194
    v_and_b32 v17, 0xffff0000, v194
    v_lshlrev_b32 v18, 16, v195
    v_and_b32 v19, 0xffff0000, v195
    v_lshlrev_b32 v20, 16, v202
    v_and_b32 v21, 0xffff0000, v202
    v_lshlrev_b32 v22, 16, v203
    v_and_b32 v23, 0xffff0000, v203
    v_lshlrev_b32 v24, 16, v196
    v_and_b32 v25, 0xffff0000, v196
    v_lshlrev_b32 v26, 16, v197
    v_and_b32 v27, 0xffff0000, v197
    v_lshlrev_b32 v28, 16, v204
    v_and_b32 v29, 0xffff0000, v204
    v_lshlrev_b32 v30, 16, v205
    v_and_b32 v31, 0xffff0000, v205
    s_waitcnt lgkmcnt(0)
    s_waitcnt vmcnt(10)
    v_mfma_f32_16x16x32_bf16 v[0:3], v[32:35], a[0:3], v[0:3]
    ds_read_b128 v[64:67], v188 offset:40960
    v_mfma_f32_16x16x32_bf16 v[0:3], v[36:39], a[4:7], v[0:3]
    s_add_u32 s23, s23, 2048
    buffer_load_dwordx4 a[48:51], v128, s[44:47], s23 offen offset:0 sc1
    s_waitcnt vmcnt(9)
    v_mfma_f32_16x16x32_bf16 v[4:7], v[36:39], a[12:15], v[4:7]
    ds_read_b128 v[68:71], v188 offset:41984
    v_mfma_f32_16x16x32_bf16 v[4:7], v[32:35], a[8:11], v[4:7]
    v_mfma_f32_16x16x32_bf16 v[12:15], v[40:43], a[8:11], v[12:15]
    buffer_load_dwordx4 a[52:55], v128, s[44:47], s23 offen offset:1024 sc1
    v_mfma_f32_16x16x32_bf16 v[12:15], v[44:47], a[12:15], v[12:15]
    ds_read_b128 v[72:75], v188 offset:43008
    v_mfma_f32_16x16x32_bf16 v[8:11], v[44:47], a[4:7], v[8:11]
    buffer_load_dwordx4 a[56:59], v129, s[44:47], s23 offen offset:0 sc1
    v_mfma_f32_16x16x32_bf16 v[8:11], v[40:43], a[0:3], v[8:11]
    v_mfma_f32_16x16x32_bf16 v[16:19], v[48:51], a[0:3], v[16:19]
    ds_read_b128 v[76:79], v188 offset:44032
    v_mfma_f32_16x16x32_bf16 v[16:19], v[52:55], a[4:7], v[16:19]
    buffer_load_dwordx4 a[60:63], v129, s[44:47], s23 offen offset:1024 sc1
    v_mfma_f32_16x16x32_bf16 v[20:23], v[52:55], a[12:15], v[20:23]
    ds_read_b128 v[80:83], v188 offset:45056
    v_mfma_f32_16x16x32_bf16 v[20:23], v[48:51], a[8:11], v[20:23]
    v_mfma_f32_16x16x32_bf16 v[28:31], v[56:59], a[8:11], v[28:31]
    ds_read_b128 v[84:87], v188 offset:46080
    v_mfma_f32_16x16x32_bf16 v[28:31], v[60:63], a[12:15], v[28:31]
    ds_read_b128 v[88:91], v188 offset:47104
    v_mfma_f32_16x16x32_bf16 v[24:27], v[60:63], a[4:7], v[24:27]
    ds_read_b128 v[92:95], v188 offset:48128
    v_mfma_f32_16x16x32_bf16 v[24:27], v[56:59], a[0:3], v[24:27]
    s_waitcnt vmcnt(10) lgkmcnt(6)
    v_mfma_f32_16x16x32_bf16 v[0:3], v[64:67], a[16:19], v[0:3]
    ds_read_b128 v[32:35], v188 offset:49152
    v_mfma_f32_16x16x32_bf16 v[0:3], v[68:71], a[20:23], v[0:3]
    s_add_u32 s23, s23, 2048
    buffer_load_dwordx4 a[64:67], v128, s[44:47], s23 offen offset:0 sc1
    s_waitcnt vmcnt(9)
    v_mfma_f32_16x16x32_bf16 v[4:7], v[68:71], a[28:31], v[4:7]
    ds_read_b128 v[36:39], v188 offset:50176
    v_mfma_f32_16x16x32_bf16 v[4:7], v[64:67], a[24:27], v[4:7]
    s_waitcnt lgkmcnt(6)
    v_mfma_f32_16x16x32_bf16 v[12:15], v[72:75], a[24:27], v[12:15]
    buffer_load_dwordx4 a[68:71], v128, s[44:47], s23 offen offset:1024 sc1
    v_mfma_f32_16x16x32_bf16 v[12:15], v[76:79], a[28:31], v[12:15]
    ds_read_b128 v[40:43], v188 offset:51200
    v_mfma_f32_16x16x32_bf16 v[8:11], v[76:79], a[20:23], v[8:11]
    buffer_load_dwordx4 a[72:75], v129, s[44:47], s23 offen offset:0 sc1
    v_mfma_f32_16x16x32_bf16 v[8:11], v[72:75], a[16:19], v[8:11]
    s_waitcnt lgkmcnt(5)
    v_mfma_f32_16x16x32_bf16 v[16:19], v[80:83], a[16:19], v[16:19]
    ds_read_b128 v[44:47], v188 offset:52224
    v_mfma_f32_16x16x32_bf16 v[16:19], v[84:87], a[20:23], v[16:19]
    buffer_load_dwordx4 a[76:79], v129, s[44:47], s23 offen offset:1024 sc1
    v_mfma_f32_16x16x32_bf16 v[20:23], v[84:87], a[28:31], v[20:23]
    ds_read_b128 v[48:51], v188 offset:53248
    v_mfma_f32_16x16x32_bf16 v[20:23], v[80:83], a[24:27], v[20:23]
    s_waitcnt lgkmcnt(5)
    v_mfma_f32_16x16x32_bf16 v[28:31], v[88:91], a[24:27], v[28:31]
    ds_read_b128 v[52:55], v188 offset:54272
    v_mfma_f32_16x16x32_bf16 v[28:31], v[92:95], a[28:31], v[28:31]
    ds_read_b128 v[56:59], v188 offset:55296
    v_mfma_f32_16x16x32_bf16 v[24:27], v[92:95], a[20:23], v[24:27]
    ds_read_b128 v[60:63], v188 offset:56320
    v_mfma_f32_16x16x32_bf16 v[24:27], v[88:91], a[16:19], v[24:27]
    s_waitcnt vmcnt(10) lgkmcnt(6)
    v_mfma_f32_16x16x32_bf16 v[0:3], v[32:35], a[32:35], v[0:3]
    ds_read_b128 v[64:67], v188 offset:57344
    v_mfma_f32_16x16x32_bf16 v[0:3], v[36:39], a[36:39], v[0:3]
    s_add_u32 s23, s23, 2048
    buffer_load_dwordx4 a[80:83], v128, s[44:47], s23 offen offset:0 sc1
    s_waitcnt vmcnt(9)
    v_mfma_f32_16x16x32_bf16 v[4:7], v[36:39], a[44:47], v[4:7]
    ds_read_b128 v[68:71], v188 offset:58368
    v_mfma_f32_16x16x32_bf16 v[4:7], v[32:35], a[40:43], v[4:7]
    s_waitcnt lgkmcnt(6)
    v_mfma_f32_16x16x32_bf16 v[12:15], v[40:43], a[40:43], v[12:15]
    buffer_load_dwordx4 a[84:87], v128, s[44:47], s23 offen offset:1024 sc1
    v_mfma_f32_16x16x32_bf16 v[12:15], v[44:47], a[44:47], v[12:15]
    ds_read_b128 v[72:75], v188 offset:59392
    v_mfma_f32_16x16x32_bf16 v[8:11], v[44:47], a[36:39], v[8:11]
    buffer_load_dwordx4 a[88:91], v129, s[44:47], s23 offen offset:0 sc1
    v_mfma_f32_16x16x32_bf16 v[8:11], v[40:43], a[32:35], v[8:11]
    s_waitcnt lgkmcnt(5)
    v_mfma_f32_16x16x32_bf16 v[16:19], v[48:51], a[32:35], v[16:19]
    ds_read_b128 v[76:79], v188 offset:60416
    v_mfma_f32_16x16x32_bf16 v[16:19], v[52:55], a[36:39], v[16:19]
    buffer_load_dwordx4 a[92:95], v129, s[44:47], s23 offen offset:1024 sc1
    v_mfma_f32_16x16x32_bf16 v[20:23], v[52:55], a[44:47], v[20:23]
    ds_read_b128 v[80:83], v188 offset:61440
    v_mfma_f32_16x16x32_bf16 v[20:23], v[48:51], a[40:43], v[20:23]
    s_waitcnt lgkmcnt(5)
    v_mfma_f32_16x16x32_bf16 v[28:31], v[56:59], a[40:43], v[28:31]
    ds_read_b128 v[84:87], v188 offset:62464
    v_mfma_f32_16x16x32_bf16 v[28:31], v[60:63], a[44:47], v[28:31]
    ds_read_b128 v[88:91], v188 offset:63488
    v_mfma_f32_16x16x32_bf16 v[24:27], v[60:63], a[36:39], v[24:27]
    ds_read_b128 v[92:95], v188 offset:64512
    v_mfma_f32_16x16x32_bf16 v[24:27], v[56:59], a[32:35], v[24:27]
    s_waitcnt vmcnt(10) lgkmcnt(6)
    v_mfma_f32_16x16x32_bf16 v[0:3], v[64:67], a[48:51], v[0:3]
    ds_read_b128 v[32:35], v189 offset:0
    v_mfma_f32_16x16x32_bf16 v[0:3], v[68:71], a[52:55], v[0:3]
    s_add_u32 s23, s23, 2048
    buffer_load_dwordx4 a[96:99], v128, s[44:47], s23 offen offset:0 sc1
    s_waitcnt vmcnt(9)
    v_mfma_f32_16x16x32_bf16 v[4:7], v[68:71], a[60:63], v[4:7]
    ds_read_b128 v[36:39], v189 offset:1024
    v_mfma_f32_16x16x32_bf16 v[4:7], v[64:67], a[56:59], v[4:7]
    s_waitcnt lgkmcnt(6)
    v_mfma_f32_16x16x32_bf16 v[12:15], v[72:75], a[56:59], v[12:15]
    buffer_load_dwordx4 a[100:103], v128, s[44:47], s23 offen offset:1024 sc1
    v_mfma_f32_16x16x32_bf16 v[12:15], v[76:79], a[60:63], v[12:15]
    ds_read_b128 v[40:43], v189 offset:2048
    v_mfma_f32_16x16x32_bf16 v[8:11], v[76:79], a[52:55], v[8:11]
    buffer_load_dwordx4 a[104:107], v129, s[44:47], s23 offen offset:0 sc1
    v_mfma_f32_16x16x32_bf16 v[8:11], v[72:75], a[48:51], v[8:11]
    s_waitcnt lgkmcnt(5)
    v_mfma_f32_16x16x32_bf16 v[16:19], v[80:83], a[48:51], v[16:19]
    ds_read_b128 v[44:47], v189 offset:3072
    v_mfma_f32_16x16x32_bf16 v[16:19], v[84:87], a[52:55], v[16:19]
    buffer_load_dwordx4 a[108:111], v129, s[44:47], s23 offen offset:1024 sc1
    v_mfma_f32_16x16x32_bf16 v[20:23], v[84:87], a[60:63], v[20:23]
    ds_read_b128 v[48:51], v189 offset:4096
    v_mfma_f32_16x16x32_bf16 v[20:23], v[80:83], a[56:59], v[20:23]
    s_waitcnt lgkmcnt(5)
    v_mfma_f32_16x16x32_bf16 v[28:31], v[88:91], a[56:59], v[28:31]
    ds_read_b128 v[52:55], v189 offset:5120
    v_mfma_f32_16x16x32_bf16 v[28:31], v[92:95], a[60:63], v[28:31]
    ds_read_b128 v[56:59], v189 offset:6144
    v_mfma_f32_16x16x32_bf16 v[24:27], v[92:95], a[52:55], v[24:27]
    ds_read_b128 v[60:63], v189 offset:7168
    v_mfma_f32_16x16x32_bf16 v[24:27], v[88:91], a[48:51], v[24:27]
    s_waitcnt vmcnt(10) lgkmcnt(6)
    v_mfma_f32_16x16x32_bf16 v[0:3], v[32:35], a[64:67], v[0:3]
    ds_read_b128 v[64:67], v189 offset:8192
    v_mfma_f32_16x16x32_bf16 v[0:3], v[36:39], a[68:71], v[0:3]
    s_add_u32 s23, s23, 2048
    buffer_load_dwordx4 a[112:115], v128, s[44:47], s23 offen offset:0 sc1
    s_waitcnt vmcnt(9)
    v_mfma_f32_16x16x32_bf16 v[4:7], v[36:39], a[76:79], v[4:7]
    ds_read_b128 v[68:71], v189 offset:9216
    v_mfma_f32_16x16x32_bf16 v[4:7], v[32:35], a[72:75], v[4:7]
    s_waitcnt lgkmcnt(6)
    v_mfma_f32_16x16x32_bf16 v[12:15], v[40:43], a[72:75], v[12:15]
    buffer_load_dwordx4 a[116:119], v128, s[44:47], s23 offen offset:1024 sc1
    v_mfma_f32_16x16x32_bf16 v[12:15], v[44:47], a[76:79], v[12:15]
    ds_read_b128 v[72:75], v189 offset:10240
    v_mfma_f32_16x16x32_bf16 v[8:11], v[44:47], a[68:71], v[8:11]
    buffer_load_dwordx4 a[120:123], v129, s[44:47], s23 offen offset:0 sc1
    v_mfma_f32_16x16x32_bf16 v[8:11], v[40:43], a[64:67], v[8:11]
    s_waitcnt lgkmcnt(5)
    v_mfma_f32_16x16x32_bf16 v[16:19], v[48:51], a[64:67], v[16:19]
    ds_read_b128 v[76:79], v189 offset:11264
    v_mfma_f32_16x16x32_bf16 v[16:19], v[52:55], a[68:71], v[16:19]
    buffer_load_dwordx4 a[124:127], v129, s[44:47], s23 offen offset:1024 sc1
    v_mfma_f32_16x16x32_bf16 v[20:23], v[52:55], a[76:79], v[20:23]
    ds_read_b128 v[80:83], v189 offset:12288
    v_mfma_f32_16x16x32_bf16 v[20:23], v[48:51], a[72:75], v[20:23]
    s_waitcnt lgkmcnt(5)
    v_mfma_f32_16x16x32_bf16 v[28:31], v[56:59], a[72:75], v[28:31]
    ds_read_b128 v[84:87], v189 offset:13312
    v_mfma_f32_16x16x32_bf16 v[28:31], v[60:63], a[76:79], v[28:31]
    ds_read_b128 v[88:91], v189 offset:14336
    v_mfma_f32_16x16x32_bf16 v[24:27], v[60:63], a[68:71], v[24:27]
    ds_read_b128 v[92:95], v189 offset:15360
    v_mfma_f32_16x16x32_bf16 v[24:27], v[56:59], a[64:67], v[24:27]
    s_waitcnt vmcnt(10) lgkmcnt(6)
    v_mfma_f32_16x16x32_bf16 v[0:3], v[64:67], a[80:83], v[0:3]
    ds_read_b128 v[32:35], v189 offset:16384
    v_mfma_f32_16x16x32_bf16 v[0:3], v[68:71], a[84:87], v[0:3]
    s_add_u32 s23, s23, 2048
    buffer_load_dwordx4 a[128:131], v128, s[44:47], s23 offen offset:0 sc1
    s_waitcnt vmcnt(9)
    v_mfma_f32_16x16x32_bf16 v[4:7], v[68:71], a[92:95], v[4:7]
    ds_read_b128 v[36:39], v189 offset:17408
    v_mfma_f32_16x16x32_bf16 v[4:7], v[64:67], a[88:91], v[4:7]
    s_waitcnt lgkmcnt(6)
    v_mfma_f32_16x16x32_bf16 v[12:15], v[72:75], a[88:91], v[12:15]
    buffer_load_dwordx4 a[132:135], v128, s[44:47], s23 offen offset:1024 sc1
    v_mfma_f32_16x16x32_bf16 v[12:15], v[76:79], a[92:95], v[12:15]
    ds_read_b128 v[40:43], v189 offset:18432
    v_mfma_f32_16x16x32_bf16 v[8:11], v[76:79], a[84:87], v[8:11]
    buffer_load_dwordx4 a[136:139], v129, s[44:47], s23 offen offset:0 sc1
    v_mfma_f32_16x16x32_bf16 v[8:11], v[72:75], a[80:83], v[8:11]
    s_waitcnt lgkmcnt(5)
    v_mfma_f32_16x16x32_bf16 v[16:19], v[80:83], a[80:83], v[16:19]
    ds_read_b128 v[44:47], v189 offset:19456
    v_mfma_f32_16x16x32_bf16 v[16:19], v[84:87], a[84:87], v[16:19]
    buffer_load_dwordx4 a[140:143], v129, s[44:47], s23 offen offset:1024 sc1
    v_mfma_f32_16x16x32_bf16 v[20:23], v[84:87], a[92:95], v[20:23]
    ds_read_b128 v[48:51], v189 offset:20480
    v_mfma_f32_16x16x32_bf16 v[20:23], v[80:83], a[88:91], v[20:23]
    s_waitcnt lgkmcnt(5)
    v_mfma_f32_16x16x32_bf16 v[28:31], v[88:91], a[88:91], v[28:31]
    ds_read_b128 v[52:55], v189 offset:21504
    v_mfma_f32_16x16x32_bf16 v[28:31], v[92:95], a[92:95], v[28:31]
    ds_read_b128 v[56:59], v189 offset:22528
    v_mfma_f32_16x16x32_bf16 v[24:27], v[92:95], a[84:87], v[24:27]
    ds_read_b128 v[60:63], v189 offset:23552
    v_mfma_f32_16x16x32_bf16 v[24:27], v[88:91], a[80:83], v[24:27]
    s_waitcnt vmcnt(10) lgkmcnt(6)
    v_mfma_f32_16x16x32_bf16 v[0:3], v[32:35], a[96:99], v[0:3]
    ds_read_b128 v[64:67], v128 offset:0
    v_mfma_f32_16x16x32_bf16 v[0:3], v[36:39], a[100:103], v[0:3]
    s_add_u32 s23, s23, 2048
    buffer_load_dwordx4 a[144:147], v128, s[44:47], s23 offen offset:0 sc1
    s_waitcnt vmcnt(9)
    v_mfma_f32_16x16x32_bf16 v[4:7], v[36:39], a[108:111], v[4:7]
    ds_read_b128 v[68:71], v128 offset:1024
    v_mfma_f32_16x16x32_bf16 v[4:7], v[32:35], a[104:107], v[4:7]
    s_waitcnt lgkmcnt(6)
    v_mfma_f32_16x16x32_bf16 v[12:15], v[40:43], a[104:107], v[12:15]
    buffer_load_dwordx4 a[148:151], v128, s[44:47], s23 offen offset:1024 sc1
    v_mfma_f32_16x16x32_bf16 v[12:15], v[44:47], a[108:111], v[12:15]
    ds_read_b128 v[72:75], v128 offset:2048
    v_mfma_f32_16x16x32_bf16 v[8:11], v[44:47], a[100:103], v[8:11]
    buffer_load_dwordx4 a[152:155], v129, s[44:47], s23 offen offset:0 sc1
    v_mfma_f32_16x16x32_bf16 v[8:11], v[40:43], a[96:99], v[8:11]
    s_waitcnt lgkmcnt(5)
    v_mfma_f32_16x16x32_bf16 v[16:19], v[48:51], a[96:99], v[16:19]
    ds_read_b128 v[76:79], v128 offset:3072
    v_mfma_f32_16x16x32_bf16 v[16:19], v[52:55], a[100:103], v[16:19]
    buffer_load_dwordx4 a[156:159], v129, s[44:47], s23 offen offset:1024 sc1
    v_mfma_f32_16x16x32_bf16 v[20:23], v[52:55], a[108:111], v[20:23]
    ds_read_b128 v[80:83], v128 offset:4096
    v_mfma_f32_16x16x32_bf16 v[20:23], v[48:51], a[104:107], v[20:23]
    s_waitcnt lgkmcnt(5)
    v_mfma_f32_16x16x32_bf16 v[28:31], v[56:59], a[104:107], v[28:31]
    ds_read_b128 v[84:87], v128 offset:5120
    v_mfma_f32_16x16x32_bf16 v[28:31], v[60:63], a[108:111], v[28:31]
    ds_read_b128 v[88:91], v128 offset:6144
    v_mfma_f32_16x16x32_bf16 v[24:27], v[60:63], a[100:103], v[24:27]
    ds_read_b128 v[92:95], v128 offset:7168
    v_mfma_f32_16x16x32_bf16 v[24:27], v[56:59], a[96:99], v[24:27]
    s_waitcnt vmcnt(10) lgkmcnt(6)
    v_mfma_f32_16x16x32_bf16 v[0:3], v[64:67], a[112:115], v[0:3]
    ds_read_b128 v[32:35], v128 offset:8192
    v_mfma_f32_16x16x32_bf16 v[0:3], v[68:71], a[116:119], v[0:3]
    s_add_u32 s23, s23, 2048
    buffer_load_dwordx4 a[160:163], v128, s[44:47], s23 offen offset:0 sc1
    s_waitcnt vmcnt(9)
    v_mfma_f32_16x16x32_bf16 v[4:7], v[68:71], a[124:127], v[4:7]
    ds_read_b128 v[36:39], v128 offset:9216
    v_mfma_f32_16x16x32_bf16 v[4:7], v[64:67], a[120:123], v[4:7]
    s_waitcnt lgkmcnt(6)
    v_mfma_f32_16x16x32_bf16 v[12:15], v[72:75], a[120:123], v[12:15]
    buffer_load_dwordx4 a[164:167], v128, s[44:47], s23 offen offset:1024 sc1
    v_mfma_f32_16x16x32_bf16 v[12:15], v[76:79], a[124:127], v[12:15]
    ds_read_b128 v[40:43], v128 offset:10240
    v_mfma_f32_16x16x32_bf16 v[8:11], v[76:79], a[116:119], v[8:11]
    buffer_load_dwordx4 a[168:171], v129, s[44:47], s23 offen offset:0 sc1
    v_mfma_f32_16x16x32_bf16 v[8:11], v[72:75], a[112:115], v[8:11]
    s_waitcnt lgkmcnt(5)
    v_mfma_f32_16x16x32_bf16 v[16:19], v[80:83], a[112:115], v[16:19]
    ds_read_b128 v[44:47], v128 offset:11264
    v_mfma_f32_16x16x32_bf16 v[16:19], v[84:87], a[116:119], v[16:19]
    buffer_load_dwordx4 a[172:175], v129, s[44:47], s23 offen offset:1024 sc1
    v_mfma_f32_16x16x32_bf16 v[20:23], v[84:87], a[124:127], v[20:23]
    ds_read_b128 v[48:51], v128 offset:12288
    v_mfma_f32_16x16x32_bf16 v[20:23], v[80:83], a[120:123], v[20:23]
    s_waitcnt lgkmcnt(5)
    v_mfma_f32_16x16x32_bf16 v[28:31], v[88:91], a[120:123], v[28:31]
    ds_read_b128 v[52:55], v128 offset:13312
    v_mfma_f32_16x16x32_bf16 v[28:31], v[92:95], a[124:127], v[28:31]
    ds_read_b128 v[56:59], v128 offset:14336
    v_mfma_f32_16x16x32_bf16 v[24:27], v[92:95], a[116:119], v[24:27]
    ds_read_b128 v[60:63], v128 offset:15360
    v_mfma_f32_16x16x32_bf16 v[24:27], v[88:91], a[112:115], v[24:27]
    s_waitcnt vmcnt(10) lgkmcnt(6)
    v_mfma_f32_16x16x32_bf16 v[0:3], v[32:35], a[128:131], v[0:3]
    ds_read_b128 v[64:67], v128 offset:16384
    v_mfma_f32_16x16x32_bf16 v[0:3], v[36:39], a[132:135], v[0:3]
    s_add_u32 s23, s23, 2048
    buffer_load_dwordx4 a[176:179], v128, s[44:47], s23 offen offset:0 sc1
    s_waitcnt vmcnt(9)
    v_mfma_f32_16x16x32_bf16 v[4:7], v[36:39], a[140:143], v[4:7]
    ds_read_b128 v[68:71], v128 offset:17408
    v_mfma_f32_16x16x32_bf16 v[4:7], v[32:35], a[136:139], v[4:7]
    s_waitcnt lgkmcnt(6)
    v_mfma_f32_16x16x32_bf16 v[12:15], v[40:43], a[136:139], v[12:15]
    buffer_load_dwordx4 a[180:183], v128, s[44:47], s23 offen offset:1024 sc1
    v_mfma_f32_16x16x32_bf16 v[12:15], v[44:47], a[140:143], v[12:15]
    ds_read_b128 v[72:75], v128 offset:18432
    v_mfma_f32_16x16x32_bf16 v[8:11], v[44:47], a[132:135], v[8:11]
    buffer_load_dwordx4 a[184:187], v129, s[44:47], s23 offen offset:0 sc1
    v_mfma_f32_16x16x32_bf16 v[8:11], v[40:43], a[128:131], v[8:11]
    s_waitcnt lgkmcnt(5)
    v_mfma_f32_16x16x32_bf16 v[16:19], v[48:51], a[128:131], v[16:19]
    ds_read_b128 v[76:79], v128 offset:19456
    v_mfma_f32_16x16x32_bf16 v[16:19], v[52:55], a[132:135], v[16:19]
    buffer_load_dwordx4 a[188:191], v129, s[44:47], s23 offen offset:1024 sc1
    v_mfma_f32_16x16x32_bf16 v[20:23], v[52:55], a[140:143], v[20:23]
    ds_read_b128 v[80:83], v128 offset:20480
    v_mfma_f32_16x16x32_bf16 v[20:23], v[48:51], a[136:139], v[20:23]
    s_waitcnt lgkmcnt(5)
    v_mfma_f32_16x16x32_bf16 v[28:31], v[56:59], a[136:139], v[28:31]
    ds_read_b128 v[84:87], v128 offset:21504
    v_mfma_f32_16x16x32_bf16 v[28:31], v[60:63], a[140:143], v[28:31]
    ds_read_b128 v[88:91], v128 offset:22528
    v_mfma_f32_16x16x32_bf16 v[24:27], v[60:63], a[132:135], v[24:27]
    ds_read_b128 v[92:95], v128 offset:23552
    v_mfma_f32_16x16x32_bf16 v[24:27], v[56:59], a[128:131], v[24:27]
    s_barrier
    s_waitcnt vmcnt(10) lgkmcnt(6)
    v_mfma_f32_16x16x32_bf16 v[0:3], v[64:67], a[144:147], v[0:3]
    ds_read_b128 v[32:35], v128 offset:24576
    v_mfma_f32_16x16x32_bf16 v[0:3], v[68:71], a[148:151], v[0:3]
    s_add_u32 s23, s23, 2048
    buffer_load_dwordx4 a[192:195], v128, s[44:47], s23 offen offset:0 sc1
    s_waitcnt vmcnt(9)
    v_mfma_f32_16x16x32_bf16 v[4:7], v[68:71], a[156:159], v[4:7]
    ds_read_b128 v[36:39], v128 offset:25600
    v_mfma_f32_16x16x32_bf16 v[4:7], v[64:67], a[152:155], v[4:7]
    s_waitcnt lgkmcnt(6)
    v_mfma_f32_16x16x32_bf16 v[12:15], v[72:75], a[152:155], v[12:15]
    buffer_load_dwordx4 a[196:199], v128, s[44:47], s23 offen offset:1024 sc1
    v_mfma_f32_16x16x32_bf16 v[12:15], v[76:79], a[156:159], v[12:15]
    ds_read_b128 v[40:43], v128 offset:26624
    v_mfma_f32_16x16x32_bf16 v[8:11], v[76:79], a[148:151], v[8:11]
    buffer_load_dwordx4 a[200:203], v129, s[44:47], s23 offen offset:0 sc1
    v_mfma_f32_16x16x32_bf16 v[8:11], v[72:75], a[144:147], v[8:11]
    s_waitcnt lgkmcnt(5)
    v_mfma_f32_16x16x32_bf16 v[16:19], v[80:83], a[144:147], v[16:19]
    ds_read_b128 v[44:47], v128 offset:27648
    v_mfma_f32_16x16x32_bf16 v[16:19], v[84:87], a[148:151], v[16:19]
    buffer_load_dwordx4 a[204:207], v129, s[44:47], s23 offen offset:1024 sc1
    v_mfma_f32_16x16x32_bf16 v[20:23], v[84:87], a[156:159], v[20:23]
    ds_read_b128 v[48:51], v128 offset:28672
    v_mfma_f32_16x16x32_bf16 v[20:23], v[80:83], a[152:155], v[20:23]
    s_waitcnt lgkmcnt(5)
    v_mfma_f32_16x16x32_bf16 v[28:31], v[88:91], a[152:155], v[28:31]
    ds_read_b128 v[52:55], v128 offset:29696
    v_mfma_f32_16x16x32_bf16 v[28:31], v[92:95], a[156:159], v[28:31]
    ds_read_b128 v[56:59], v128 offset:30720
    v_mfma_f32_16x16x32_bf16 v[24:27], v[92:95], a[148:151], v[24:27]
    ds_read_b128 v[60:63], v128 offset:31744
    v_mfma_f32_16x16x32_bf16 v[24:27], v[88:91], a[144:147], v[24:27]
    s_waitcnt vmcnt(10) lgkmcnt(6)
    v_mfma_f32_16x16x32_bf16 v[0:3], v[32:35], a[160:163], v[0:3]
    ds_read_b128 v[64:67], v128 offset:32768
    v_mfma_f32_16x16x32_bf16 v[0:3], v[36:39], a[164:167], v[0:3]
    s_add_u32 s23, s23, 2048
    buffer_load_dwordx4 a[208:211], v128, s[44:47], s23 offen offset:0 sc1
    s_waitcnt vmcnt(9)
    v_mfma_f32_16x16x32_bf16 v[4:7], v[36:39], a[172:175], v[4:7]
    ds_read_b128 v[68:71], v128 offset:33792
    v_mfma_f32_16x16x32_bf16 v[4:7], v[32:35], a[168:171], v[4:7]
    s_waitcnt lgkmcnt(6)
    v_mfma_f32_16x16x32_bf16 v[12:15], v[40:43], a[168:171], v[12:15]
    buffer_load_dwordx4 a[212:215], v128, s[44:47], s23 offen offset:1024 sc1
    v_mfma_f32_16x16x32_bf16 v[12:15], v[44:47], a[172:175], v[12:15]
    ds_read_b128 v[72:75], v128 offset:34816
    v_mfma_f32_16x16x32_bf16 v[8:11], v[44:47], a[164:167], v[8:11]
    buffer_load_dwordx4 a[216:219], v129, s[44:47], s23 offen offset:0 sc1
    v_mfma_f32_16x16x32_bf16 v[8:11], v[40:43], a[160:163], v[8:11]
    s_waitcnt lgkmcnt(5)
    v_mfma_f32_16x16x32_bf16 v[16:19], v[48:51], a[160:163], v[16:19]
    ds_read_b128 v[76:79], v128 offset:35840
    v_mfma_f32_16x16x32_bf16 v[16:19], v[52:55], a[164:167], v[16:19]
    buffer_load_dwordx4 a[220:223], v129, s[44:47], s23 offen offset:1024 sc1
    v_mfma_f32_16x16x32_bf16 v[20:23], v[52:55], a[172:175], v[20:23]
    ds_read_b128 v[80:83], v128 offset:36864
    v_mfma_f32_16x16x32_bf16 v[20:23], v[48:51], a[168:171], v[20:23]
    s_waitcnt lgkmcnt(5)
    v_mfma_f32_16x16x32_bf16 v[28:31], v[56:59], a[168:171], v[28:31]
    ds_read_b128 v[84:87], v128 offset:37888
    v_mfma_f32_16x16x32_bf16 v[28:31], v[60:63], a[172:175], v[28:31]
    ds_read_b128 v[88:91], v128 offset:38912
    v_mfma_f32_16x16x32_bf16 v[24:27], v[60:63], a[164:167], v[24:27]
    ds_read_b128 v[92:95], v128 offset:39936
    v_mfma_f32_16x16x32_bf16 v[24:27], v[56:59], a[160:163], v[24:27]
    s_waitcnt vmcnt(10) lgkmcnt(6)
    v_mfma_f32_16x16x32_bf16 v[0:3], v[64:67], a[176:179], v[0:3]
    ds_read_b128 v[32:35], v128 offset:40960
    v_mfma_f32_16x16x32_bf16 v[0:3], v[68:71], a[180:183], v[0:3]
    s_add_u32 s23, s23, 2048
    buffer_load_dwordx4 a[224:227], v128, s[44:47], s23 offen offset:0 sc1
    s_waitcnt vmcnt(9)
    v_mfma_f32_16x16x32_bf16 v[4:7], v[68:71], a[188:191], v[4:7]
    ds_read_b128 v[36:39], v128 offset:41984
    v_mfma_f32_16x16x32_bf16 v[4:7], v[64:67], a[184:187], v[4:7]
    s_waitcnt lgkmcnt(6)
    v_mfma_f32_16x16x32_bf16 v[12:15], v[72:75], a[184:187], v[12:15]
    buffer_load_dwordx4 a[228:231], v128, s[44:47], s23 offen offset:1024 sc1
    v_mfma_f32_16x16x32_bf16 v[12:15], v[76:79], a[188:191], v[12:15]
    ds_read_b128 v[40:43], v128 offset:43008
    v_mfma_f32_16x16x32_bf16 v[8:11], v[76:79], a[180:183], v[8:11]
    buffer_load_dwordx4 a[232:235], v129, s[44:47], s23 offen offset:0 sc1
    v_mfma_f32_16x16x32_bf16 v[8:11], v[72:75], a[176:179], v[8:11]
    s_waitcnt lgkmcnt(5)
    v_mfma_f32_16x16x32_bf16 v[16:19], v[80:83], a[176:179], v[16:19]
    ds_read_b128 v[44:47], v128 offset:44032
    v_mfma_f32_16x16x32_bf16 v[16:19], v[84:87], a[180:183], v[16:19]
    buffer_load_dwordx4 a[236:239], v129, s[44:47], s23 offen offset:1024 sc1
    v_mfma_f32_16x16x32_bf16 v[20:23], v[84:87], a[188:191], v[20:23]
    ds_read_b128 v[48:51], v128 offset:45056
    v_mfma_f32_16x16x32_bf16 v[20:23], v[80:83], a[184:187], v[20:23]
    s_waitcnt lgkmcnt(5)
    v_mfma_f32_16x16x32_bf16 v[28:31], v[88:91], a[184:187], v[28:31]
    ds_read_b128 v[52:55], v128 offset:46080
    v_mfma_f32_16x16x32_bf16 v[28:31], v[92:95], a[188:191], v[28:31]
    ds_read_b128 v[56:59], v128 offset:47104
    v_mfma_f32_16x16x32_bf16 v[24:27], v[92:95], a[180:183], v[24:27]
    ds_read_b128 v[60:63], v128 offset:48128
    v_mfma_f32_16x16x32_bf16 v[24:27], v[88:91], a[176:179], v[24:27]
    s_waitcnt vmcnt(10) lgkmcnt(6)
    v_mfma_f32_16x16x32_bf16 v[0:3], v[32:35], a[192:195], v[0:3]
    ds_read_b128 v[64:67], v128 offset:49152
    v_mfma_f32_16x16x32_bf16 v[0:3], v[36:39], a[196:199], v[0:3]
    s_add_u32 s23, s23, 2048
    buffer_load_dwordx4 a[240:243], v128, s[44:47], s23 offen offset:0 sc1
    s_waitcnt vmcnt(9)
    v_mfma_f32_16x16x32_bf16 v[4:7], v[36:39], a[204:207], v[4:7]
    ds_read_b128 v[68:71], v128 offset:50176
    v_mfma_f32_16x16x32_bf16 v[4:7], v[32:35], a[200:203], v[4:7]
    s_waitcnt lgkmcnt(6)
    v_mfma_f32_16x16x32_bf16 v[12:15], v[40:43], a[200:203], v[12:15]
    buffer_load_dwordx4 a[244:247], v128, s[44:47], s23 offen offset:1024 sc1
    v_mfma_f32_16x16x32_bf16 v[12:15], v[44:47], a[204:207], v[12:15]
    ds_read_b128 v[72:75], v128 offset:51200
    v_mfma_f32_16x16x32_bf16 v[8:11], v[44:47], a[196:199], v[8:11]
    buffer_load_dwordx4 a[248:251], v129, s[44:47], s23 offen offset:0 sc1
    v_mfma_f32_16x16x32_bf16 v[8:11], v[40:43], a[192:195], v[8:11]
    s_waitcnt lgkmcnt(5)
    v_mfma_f32_16x16x32_bf16 v[16:19], v[48:51], a[192:195], v[16:19]
    ds_read_b128 v[76:79], v128 offset:52224
    v_mfma_f32_16x16x32_bf16 v[16:19], v[52:55], a[196:199], v[16:19]
    buffer_load_dwordx4 a[252:255], v129, s[44:47], s23 offen offset:1024 sc1
    v_mfma_f32_16x16x32_bf16 v[20:23], v[52:55], a[204:207], v[20:23]
    ds_read_b128 v[80:83], v128 offset:53248
    v_mfma_f32_16x16x32_bf16 v[20:23], v[48:51], a[200:203], v[20:23]
    s_waitcnt lgkmcnt(5)
    v_mfma_f32_16x16x32_bf16 v[28:31], v[56:59], a[200:203], v[28:31]
    ds_read_b128 v[84:87], v128 offset:54272
    v_mfma_f32_16x16x32_bf16 v[28:31], v[60:63], a[204:207], v[28:31]
    ds_read_b128 v[88:91], v128 offset:55296
    v_mfma_f32_16x16x32_bf16 v[24:27], v[60:63], a[196:199], v[24:27]
    ds_read_b128 v[92:95], v128 offset:56320
    v_mfma_f32_16x16x32_bf16 v[24:27], v[56:59], a[192:195], v[24:27]
    s_waitcnt vmcnt(10) lgkmcnt(6)
    v_mfma_f32_16x16x32_bf16 v[0:3], v[64:67], a[208:211], v[0:3]
    ds_read_b128 v[32:35], v128 offset:57344
    v_mfma_f32_16x16x32_bf16 v[0:3], v[68:71], a[212:215], v[0:3]
    s_waitcnt vmcnt(8)
    v_mfma_f32_16x16x32_bf16 v[4:7], v[68:71], a[220:223], v[4:7]
    ds_read_b128 v[36:39], v128 offset:58368
    v_mfma_f32_16x16x32_bf16 v[4:7], v[64:67], a[216:219], v[4:7]
    s_waitcnt lgkmcnt(6)
    v_mfma_f32_16x16x32_bf16 v[12:15], v[72:75], a[216:219], v[12:15]
    ds_read_b128 v[40:43], v128 offset:59392
    v_mfma_f32_16x16x32_bf16 v[12:15], v[76:79], a[220:223], v[12:15]
    v_mfma_f32_16x16x32_bf16 v[8:11], v[76:79], a[212:215], v[8:11]
    ds_read_b128 v[44:47], v128 offset:60416
    v_mfma_f32_16x16x32_bf16 v[8:11], v[72:75], a[208:211], v[8:11]
    s_waitcnt lgkmcnt(6)
    v_mfma_f32_16x16x32_bf16 v[16:19], v[80:83], a[208:211], v[16:19]
    ds_read_b128 v[48:51], v128 offset:61440
    v_mfma_f32_16x16x32_bf16 v[16:19], v[84:87], a[212:215], v[16:19]
    v_mfma_f32_16x16x32_bf16 v[20:23], v[84:87], a[220:223], v[20:23]
    ds_read_b128 v[52:55], v128 offset:62464
    v_mfma_f32_16x16x32_bf16 v[20:23], v[80:83], a[216:219], v[20:23]
    s_waitcnt lgkmcnt(6)
    v_mfma_f32_16x16x32_bf16 v[28:31], v[88:91], a[216:219], v[28:31]
    ds_read_b128 v[56:59], v128 offset:63488
    v_mfma_f32_16x16x32_bf16 v[28:31], v[92:95], a[220:223], v[28:31]
    v_mfma_f32_16x16x32_bf16 v[24:27], v[92:95], a[212:215], v[24:27]
    ds_read_b128 v[60:63], v128 offset:64512
    v_mfma_f32_16x16x32_bf16 v[24:27], v[88:91], a[208:211], v[24:27]
    s_lshr_b32 s12, s2, 3
    s_and_b32 s12, s12, 31
    s_lshl_b32 s12, s12, 10
    v_and_b32 v164, 7, v133
    v_lshlrev_b32 v164, 7, v164
    v_add_u32 v164, s12, v164
    s_getpc_b64 s[10:11]
    s_add_u32 s10, s10, PH_u0@rel32@lo+4
    s_addc_u32 s11, s11, PH_u0@rel32@hi+12
    v_min_u32 v165, END_PH_u0-PH_u0-4, v164
    global_load_dword v165, v165, s[10:11]
    s_waitcnt vmcnt(7) lgkmcnt(6)
    v_mfma_f32_16x16x32_bf16 v[0:3], v[32:35], a[224:227], v[0:3]
    ds_read_b128 v[64:67], v188 offset:0
    v_mfma_f32_16x16x32_bf16 v[0:3], v[36:39], a[228:231], v[0:3]
    s_waitcnt vmcnt(5)
    v_mfma_f32_16x16x32_bf16 v[4:7], v[36:39], a[236:239], v[4:7]
    ds_read_b128 v[68:71], v188 offset:1024
    v_mfma_f32_16x16x32_bf16 v[4:7], v[32:35], a[232:235], v[4:7]
    s_waitcnt lgkmcnt(6)
    v_mfma_f32_16x16x32_bf16 v[12:15], v[40:43], a[232:235], v[12:15]
    ds_read_b128 v[72:75], v188 offset:2048
    v_mfma_f32_16x16x32_bf16 v[12:15], v[44:47], a[236:239], v[12:15]
    v_mfma_f32_16x16x32_bf16 v[8:11], v[44:47], a[228:231], v[8:11]
    ds_read_b128 v[76:79], v188 offset:3072
    v_mfma_f32_16x16x32_bf16 v[8:11], v[40:43], a[224:227], v[8:11]
    s_waitcnt lgkmcnt(6)
    v_mfma_f32_16x16x32_bf16 v[16:19], v[48:51], a[224:227], v[16:19]
    ds_read_b128 v[80:83], v188 offset:4096
    v_mfma_f32_16x16x32_bf16 v[16:19], v[52:55], a[228:231], v[16:19]
    v_mfma_f32_16x16x32_bf16 v[20:23], v[52:55], a[236:239], v[20:23]
    ds_read_b128 v[84:87], v188 offset:5120
    v_mfma_f32_16x16x32_bf16 v[20:23], v[48:51], a[232:235], v[20:23]
    s_waitcnt lgkmcnt(6)
    v_mfma_f32_16x16x32_bf16 v[28:31], v[56:59], a[232:235], v[28:31]
    ds_read_b128 v[88:91], v188 offset:6144
    v_mfma_f32_16x16x32_bf16 v[28:31], v[60:63], a[236:239], v[28:31]
    v_mfma_f32_16x16x32_bf16 v[24:27], v[60:63], a[228:231], v[24:27]
    ds_read_b128 v[92:95], v188 offset:7168
    v_mfma_f32_16x16x32_bf16 v[24:27], v[56:59], a[224:227], v[24:27]
    s_waitcnt vmcnt(3) lgkmcnt(6)
    v_mfma_f32_16x16x32_bf16 v[0:3], v[64:67], a[240:243], v[0:3]
    v_mfma_f32_16x16x32_bf16 v[0:3], v[68:71], a[244:247], v[0:3]
    s_waitcnt vmcnt(1)
    v_mfma_f32_16x16x32_bf16 v[4:7], v[68:71], a[252:255], v[4:7]
    v_mfma_f32_16x16x32_bf16 v[4:7], v[64:67], a[248:251], v[4:7]
    s_waitcnt lgkmcnt(4)
    v_mfma_f32_16x16x32_bf16 v[12:15], v[72:75], a[248:251], v[12:15]
    v_mfma_f32_16x16x32_bf16 v[12:15], v[76:79], a[252:255], v[12:15]
    v_mfma_f32_16x16x32_bf16 v[8:11], v[76:79], a[244:247], v[8:11]
    v_mfma_f32_16x16x32_bf16 v[8:11], v[72:75], a[240:243], v[8:11]
    s_waitcnt lgkmcnt(2)
    v_mfma_f32_16x16x32_bf16 v[16:19], v[80:83], a[240:243], v[16:19]
    v_mfma_f32_16x16x32_bf16 v[16:19], v[84:87], a[244:247], v[16:19]
    v_mfma_f32_16x16x32_bf16 v[20:23], v[84:87], a[252:255], v[20:23]
    v_mfma_f32_16x16x32_bf16 v[20:23], v[80:83], a[248:251], v[20:23]
    s_waitcnt lgkmcnt(0)
    v_mfma_f32_16x16x32_bf16 v[28:31], v[88:91], a[248:251], v[28:31]
    v_mfma_f32_16x16x32_bf16 v[28:31], v[92:95], a[252:255], v[28:31]
    v_mfma_f32_16x16x32_bf16 v[24:27], v[92:95], a[244:247], v[24:27]
    v_mfma_f32_16x16x32_bf16 v[24:27], v[88:91], a[240:243], v[24:27]
    s_nop 7
    v_mov_b32 v214, 0
    v_mov_b32 v215, 0
    v_cvt_pk_bf16_f32 v190, v0, v1
    v_cvt_pk_bf16_f32 v191, v2, v3
    v_cvt_pk_bf16_f32 v192, v8, v9
    v_cvt_pk_bf16_f32 v193, v10, v11
    buffer_store_dwordx4 v[190:193], v128, s[44:47], s48 offen offset:0 sc1
    v_dot2_f32_bf16 v214, v190, v162, v214
    v_dot2_f32_bf16 v214, v191, v162, v214
    v_dot2_f32_bf16 v214, v192, v162, v214
    v_dot2_f32_bf16 v214, v193, v162, v214
    v_dot2_f32_bf16 v215, v190, v190, v215
    v_dot2_f32_bf16 v215, v191, v191, v215
    v_dot2_f32_bf16 v215, v192, v192, v215
    v_dot2_f32_bf16 v215, v193, v193, v215
    v_cvt_pk_bf16_f32 v194, v16, v17
    v_cvt_pk_bf16_f32 v195, v18, v19
    v_cvt_pk_bf16_f32 v196, v24, v25
    v_cvt_pk_bf16_f32 v197, v26, v27
    buffer_store_dwordx4 v[194:197], v128, s[44:47], s48 offen offset:1024 sc1
    v_dot2_f32_bf16 v214, v194, v162, v214
    v_dot2_f32_bf16 v214, v195, v162, v214
    v_dot2_f32_bf16 v214, v196, v162, v214
    v_dot2_f32_bf16 v214, v197, v162, v214
    v_dot2_f32_bf16 v215, v194, v194, v215
    v_dot2_f32_bf16 v215, v195, v195, v215
    v_dot2_f32_bf16 v215, v196, v196, v215
    v_dot2_f32_bf16 v215, v197, v197, v215
    v_mov_b32 v216, 0
    v_mov_b32 v217, 0
    v_cvt_pk_bf16_f32 v198, v4, v5
    v_cvt_pk_bf16_f32 v199, v6, v7
    v_cvt_pk_bf16_f32 v200, v12, v13
    v_cvt_pk_bf16_f32 v201, v14, v15
    buffer_store_dwordx4 v[198:201], v128, s[44:47], s49 offen offset:0 sc1
    v_dot2_f32_bf16 v216, v198, v162, v216
    v_dot2_f32_bf16 v216, v199, v162, v216
    v_dot2_f32_bf16 v216, v200, v162, v216
    v_dot2_f32_bf16 v216, v201, v162, v216
    v_dot2_f32_bf16 v217, v198, v198, v217
    v_dot2_f32_bf16 v217, v199, v199, v217
    v_dot2_f32_bf16 v217, v200, v200, v217
    v_dot2_f32_bf16 v217, v201, v201, v217
    v_cvt_pk_bf16_f32 v202, v20, v21
    v_cvt_pk_bf16_f32 v203, v22, v23
    v_cvt_pk_bf16_f32 v204, v28, v29
    v_cvt_pk_bf16_f32 v205, v30, v31
    buffer_store_dwordx4 v[202:205], v128, s[44:47], s49 offen offset:1024 sc1
    v_dot2_f32_bf16 v216, v202, v162, v216
    v_dot2_f32_bf16 v216, v203, v162, v216
    v_dot2_f32_bf16 v216, v204, v162, v216
    v_dot2_f32_bf16 v216, v205, v162, v216
    v_dot2_f32_bf16 v217, v202, v202, v217
    v_dot2_f32_bf16 v217, v203, v203, v217
    v_dot2_f32_bf16 v217, v204, v204, v217
    v_dot2_f32_bf16 v217, v205, v205, v217
    s_nop 2
    v_mov_b32 v206, v214
    v_mov_b32 v207, v215
    v_mov_b32 v208, v216
    v_mov_b32 v209, v217
    s_nop 1
    s_nop 1
    s_nop 1
    s_nop 1
    v_permlane32_swap_b32 v214, v206
    v_permlane32_swap_b32 v215, v207
    v_permlane32_swap_b32 v216, v208
    v_permlane32_swap_b32 v217, v209
    v_add_f32 v214, v214, v206
    v_add_f32 v215, v215, v207
    v_add_f32 v216, v216, v208
    v_add_f32 v217, v217, v209
    v_mov_b32 v206, v214
    v_mov_b32 v207, v215
    v_mov_b32 v208, v216
    v_mov_b32 v209, v217
    s_nop 1
    s_nop 1
    s_nop 1
    s_nop 1
    v_permlane16_swap_b32 v214, v206
    v_permlane16_swap_b32 v215, v207
    v_permlane16_swap_b32 v216, v208
    v_permlane16_swap_b32 v217, v209
    v_add_f32 v214, v214, v206
    v_add_f32 v215, v215, v207
    v_add_f32 v216, v216, v208
    v_add_f32 v217, v217, v209
    v_cmp_gt_u32 vcc, 16, v158
    s_nop 1
    v_cndmask_b32 v206, v215, v214, vcc
    v_cndmask_b32 v207, v217, v216, vcc
    v_cmp_gt_u32 vcc, 512, v128
    s_nop 1
    v_cndmask_b32 v206, v207, v206, vcc
    buffer_store_dword v206, v159, s[44:47], s52 offen sc1
    s_lshr_b32 s19, s37, 1
    s_lshl_b32 s19, s19, 7
    s_add_u32 s19, s19, 54341632
    v_min_u32 v134, 1, v133
    v_lshlrev_b32 v134, 26, v134
    v_mov_b32 v135, 1
    s_cmp_eq_u32 s34, 0
    s_cselect_b32 s18, s19, 0x7ff00000
    s_waitcnt vmcnt(0)
    s_barrier
    buffer_atomic_add v135, v134, s[44:47], s18 offen sc1
END_PH_a0:
PH_u0:
    v_mbcnt_lo_u32_b32 v232, -1, 0
    v_mbcnt_hi_u32_b32 v232, -1, v232
    s_and_b32 s35, s2, 7
    s_lshr_b32 s36, s2, 3
    s_lshr_b32 s37, s35, 2
    s_lshl_b32 s37, s37, 2
    s_lshr_b32 s38, s36, 3
    s_add_u32 s37, s37, s38
    s_and_b32 s38, s35, 3
    s_lshl_b32 s38, s38, 3
    s_and_b32 s39, s36, 7
    s_add_u32 s38, s38, s39
    s_and_b32 s53, s38, 1
    s_lshl_b32 s42, s37, 4
    s_lshl_b32 s43, s34, 2
    s_add_u32 s42, s42, s43
    v_lshrrev_b32 v233, 5, v232
    s_lshl_b32 s40, s34, 1
    s_add_u32 s40, s40, s53
    v_add_u32 v233, s40, v233
    v_subrev_u32 v235, 7, v233
    v_min_u32 v233, v233, v235
    v_lshlrev_b32 v233, 6, v233
    v_and_b32 v235, 15, v232
    v_lshl_add_u32 v233, v235, 2, v233
    v_bfe_u32 v234, v232, 4, 1
    v_mul_u32_u24 v234, 14336, v234
    v_add_u32 v237, v233, v234
    s_mul_i32 s49, s38, 448
    s_add_u32 s49, s49, 54394880
    v_lshrrev_b32 v234, 4, v232
    s_lshl_b32 s48, s42, 11
    s_add_u32 s48, s48, 53739520
    s_add_u32 s41, s48, 4096
    v_lshlrev_b32 v224, 4, v232
    v_add_u32 v225, 32768, v224
    v_add_u32 v226, 65536, v224
    v_add_u32 v227, 98304, v224
    s_mul_i32 s26, s34, 7168
    v_add_u32 v228, s26, v224
    v_add_u32 v229, 4096, v228
    s_lshl_b32 s25, s42, 15
    s_mul_i32 s24, s38, 458752
    s_add_u32 s24, s24, 31457280
    buffer_load_dword v128, v237, s[44:47], s49 offen sc1
    s_add_u32 s49, s49, 28672
    buffer_load_dword v129, v237, s[44:47], s49 offen sc1
    s_add_u32 s49, s49, 28672
    buffer_load_dword v130, v237, s[44:47], s49 offen sc1
    s_add_u32 s49, s49, 28672
    buffer_load_dword v131, v237, s[44:47], s49 offen sc1
    s_add_u32 s49, s49, 28672
    buffer_load_dword v132, v237, s[44:47], s49 offen sc1
    s_add_u32 s49, s49, 28672
    buffer_load_dword v133, v237, s[44:47], s49 offen sc1
    s_add_u32 s49, s49, 28672
    buffer_load_dword v134, v237, s[44:47], s49 offen sc1
    s_add_u32 s49, s49, 28672
    buffer_load_dword v135, v237, s[44:47], s49 offen sc1
    s_add_u32 s49, s49, 28672
    buffer_load_dword v136, v237, s[44:47], s49 offen sc1
    s_add_u32 s49, s49, 28672
    buffer_load_dword v137, v237, s[44:47], s49 offen sc1
    s_add_u32 s49, s49, 28672
    buffer_load_dword v138, v237, s[44:47], s49 offen sc1
    s_add_u32 s49, s49, 28672
    buffer_load_dword v139, v237, s[44:47], s49 offen sc1
    s_add_u32 s49, s49, 28672
    buffer_load_dword v140, v237, s[44:47], s49 offen sc1
    s_add_u32 s49, s49, 28672
    buffer_load_dword v141, v237, s[44:47], s49 offen sc1
    s_add_u32 s49, s49, 28672
    buffer_load_dword v142, v237, s[44:47], s49 offen sc1
    s_add_u32 s49, s49, 28672
    buffer_load_dword v143, v237, s[44:47], s49 offen sc1
    s_add_u32 m0, s26, 0
    s_nop 0
    buffer_load_dwordx4 v228, s[44:47], s24 offen offset:0 sc1 lds
    s_add_u32 m0, s26, 0
    s_nop 0
    buffer_load_dwordx4 v228, s[44:47], s24 offen offset:1024 sc1 lds
    s_add_u32 m0, s26, 0
    s_nop 0
    buffer_load_dwordx4 v228, s[44:47], s24 offen offset:2048 sc1 lds
    s_add_u32 m0, s26, 0
    s_nop 0
    buffer_load_dwordx4 v228, s[44:47], s24 offen offset:3072 sc1 lds
    s_add_u32 m0, s26, 4096
    s_nop 0
    buffer_load_dwordx4 v229, s[44:47], s24 offen offset:0 sc1 lds
    s_add_u32 m0, s26, 4096
    s_nop 0
    buffer_load_dwordx4 v229, s[44:47], s24 offen offset:1024 sc1 lds
    s_add_u32 m0, s26, 4096
    s_nop 0
    buffer_load_dwordx4 v229, s[44:47], s24 offen offset:2048 sc1 lds
    s_add_u32 m0, s26, 28672
    s_add_u32 s24, s24, 28672
    buffer_load_dwordx4 v228, s[44:47], s24 offen offset:0 sc1 lds
    s_add_u32 m0, s26, 28672
    s_nop 0
    buffer_load_dwordx4 v228, s[44:47], s24 offen offset:1024 sc1 lds
    s_add_u32 m0, s26, 28672
    s_nop 0
    buffer_load_dwordx4 v228, s[44:47], s24 offen offset:2048 sc1 lds
    s_add_u32 m0, s26, 28672
    s_nop 0
    buffer_load_dwordx4 v228, s[44:47], s24 offen offset:3072 sc1 lds
    s_add_u32 m0, s26, 32768
    s_nop 0
    buffer_load_dwordx4 v229, s[44:47], s24 offen offset:0 sc1 lds
    s_add_u32 m0, s26, 32768
    s_nop 0
    buffer_load_dwordx4 v229, s[44:47], s24 offen offset:1024 sc1 lds
    s_add_u32 m0, s26, 32768
    s_nop 0
    buffer_load_dwordx4 v229, s[44:47], s24 offen offset:2048 sc1 lds
    s_add_u32 m0, s26, 57344
    s_add_u32 s24, s24, 28672
    buffer_load_dwordx4 v228, s[44:47], s24 offen offset:0 sc1 lds
    s_add_u32 m0, s26, 57344
    s_nop 0
    buffer_load_dwordx4 v228, s[44:47], s24 offen offset:1024 sc1 lds
    s_add_u32 m0, s26, 57344
    s_nop 0
    buffer_load_dwordx4 v228, s[44:47], s24 offen offset:2048 sc1 lds
    s_add_u32 m0, s26, 57344
    s_nop 0
    buffer_load_dwordx4 v228, s[44:47], s24 offen offset:3072 sc1 lds
    s_add_u32 m0, s26, 61440
    s_nop 0
    buffer_load_dwordx4 v229, s[44:47], s24 offen offset:0 sc1 lds
    s_add_u32 m0, s26, 61440
    s_nop 0
    buffer_load_dwordx4 v229, s[44:47], s24 offen offset:1024 sc1 lds
    s_add_u32 m0, s26, 61440
    s_nop 0
    buffer_load_dwordx4 v229, s[44:47], s24 offen offset:2048 sc1 lds
    s_lshl_b32 s40, s34, 8
    s_add_u32 s40, s40, 114688
    v_lshl_add_u32 v238, v232, 2, s40
    v_lshlrev_b32 v237, 4, v234
    v_add_u32 v237, 114688, v237
    v_mov_b32 v230, v224
    v_add_u32 v231, 57344, v224
    s_mul_i32 s50, s42, 114688
    s_add_u32 s50, s50, 8388608
    s_mul_i32 s55, s38, 7
    s_add_u32 s51, s55, s53
    s_lshr_b32 s51, s51, 1
    s_lshl_b32 s51, s51, 10
    s_add_u32 s51, s51, s50
    s_lshr_b32 s52, s55, 1
    s_lshl_b32 s52, s52, 10
    s_add_u32 s52, s52, s50
    s_cmp_eq_u32 s53, 0
    s_cselect_b32 s55, 3072, 8
    s_add_u32 s52, s52, s55
    s_add_u32 s56, s51, 114688
    s_add_u32 s57, s52, 114688
    s_add_u32 s58, s51, 229376
    s_add_u32 s59, s52, 229376
    s_add_u32 s60, s51, 344064
    s_add_u32 s61, s52, 344064
    s_waitcnt vmcnt(21)
    v_add_f32 v128, v128, v136
    v_add_f32 v129, v129, v137
    v_add_f32 v130, v130, v138
    v_add_f32 v131, v131, v139
    v_add_f32 v132, v132, v140
    v_add_f32 v133, v133, v141
    v_add_f32 v134, v134, v142
    v_add_f32 v135, v135, v143
    v_add_f32 v128, v128, v132
    v_add_f32 v129, v129, v133
    v_add_f32 v130, v130, v134
    v_add_f32 v131, v131, v135
    v_add_f32 v128, v128, v130
    v_add_f32 v129, v129, v131
    v_add_f32 v128, v128, v129
    ds_write_b32 v238, v128
    s_waitcnt lgkmcnt(0)
    s_barrier
    ds_read_b128 v[0:3], v237 offset:0
    ds_read_b128 v[16:19], v237 offset:64
    ds_read_b128 v[32:35], v237 offset:128
    ds_read_b128 v[48:51], v237 offset:192
    ds_read_b128 v[64:67], v237 offset:256
    ds_read_b128 v[80:83], v237 offset:320
    ds_read_b128 v[96:99], v237 offset:384
    ds_read_b128 v[112:115], v237 offset:448
    ds_read_b128 v[128:131], v237 offset:512
    ds_read_b128 v[144:147], v237 offset:576
    ds_read_b128 v[160:163], v237 offset:640
    ds_read_b128 v[176:179], v237 offset:704
    ds_read_b128 v[192:195], v237 offset:768
    ds_read_b128 v[208:211], v237 offset:832
    s_lshl_b32 s19, s37, 7
    s_add_u32 s19, s19, 54341632
    s_cmp_lg_u32 s34, 0
    s_cbranch_scc1 PEu0g
    v_mov_b32 v233, 0
    s_mov_b32 s17, 0
Pu0g:
    buffer_load_dword v235, v233, s[44:47], s19 offen sc1
    s_waitcnt vmcnt(0)
    v_readfirstlane_b32 s16, v235
    s_cmp_ge_u32 s16, 32
    s_cbranch_scc1 PEu0g
    s_sleep 4
    s_add_u32 s17, s17, 1
    s_cmp_lt_u32 s17, 0x40000
    s_cbranch_scc1 Pu0g
PEu0g:
    s_waitcnt vmcnt(0)
    s_barrier
    buffer_load_dwordx4 v[4:7], v224, s[44:47], s48 offen offset:0 sc1
    buffer_load_dwordx4 v[20:23], v224, s[44:47], s48 offen offset:1024 sc1
    buffer_load_dwordx4 v[36:39], v224, s[44:47], s48 offen offset:2048 sc1
    buffer_load_dwordx4 v[52:55], v224, s[44:47], s48 offen offset:3072 sc1
    buffer_load_dwordx4 v[68:71], v224, s[44:47], s41 offen offset:0 sc1
    buffer_load_dwordx4 v[84:87], v224, s[44:47], s41 offen offset:1024 sc1
    buffer_load_dwordx4 v[100:103], v224, s[44:47], s41 offen offset:2048 sc1
    buffer_load_dwordx4 v[116:119], v224, s[44:47], s41 offen offset:3072 sc1
    buffer_load_dwordx4 a[0:3], v224, s[44:47], s25 offen offset:0 sc1
    buffer_load_dwordx4 a[4:7], v224, s[44:47], s25 offen offset:1024 sc1
    buffer_load_dwordx4 a[8:11], v225, s[44:47], s25 offen offset:0 sc1
    buffer_load_dwordx4 a[12:15], v225, s[44:47], s25 offen offset:1024 sc1
    buffer_load_dwordx4 a[16:19], v226, s[44:47], s25 offen offset:0 sc1
    buffer_load_dwordx4 a[20:23], v226, s[44:47], s25 offen offset:1024 sc1
    buffer_load_dwordx4 a[24:27], v227, s[44:47], s25 offen offset:0 sc1
    buffer_load_dwordx4 a[28:31], v227, s[44:47], s25 offen offset:1024 sc1
    s_waitcnt vmcnt(8)
    v_add_f32 v240, v4, v20
    v_add_f32 v244, v6, v22
    v_add_f32 v248, v68, v84
    v_add_f32 v252, v70, v86
    v_add_f32 v241, v36, v52
    v_add_f32 v245, v38, v54
    v_add_f32 v249, v100, v116
    v_add_f32 v253, v102, v118
    v_add_f32 v240, v240, v241
    v_add_f32 v244, v244, v245
    v_add_f32 v248, v248, v249
    v_add_f32 v252, v252, v253
    v_mov_b32 v241, v240
    v_mov_b32 v245, v244
    v_mov_b32 v249, v248
    v_mov_b32 v253, v252
    v_permlane32_swap_b32 v240, v241
    v_permlane32_swap_b32 v244, v245
    v_permlane32_swap_b32 v248, v249
    v_permlane32_swap_b32 v252, v253
    v_add_f32 v240, v240, v241
    v_add_f32 v244, v244, v245
    v_add_f32 v248, v248, v249
    v_add_f32 v252, v252, v253
    v_mov_b32 v241, v240
    v_mov_b32 v245, v244
    v_mov_b32 v249, v248
    v_mov_b32 v253, v252
    v_permlane16_swap_b32 v240, v241
    v_permlane16_swap_b32 v244, v245
    v_permlane16_swap_b32 v248, v249
    v_permlane16_swap_b32 v252, v253
    v_add_f32 v240, v240, v241
    v_add_f32 v244, v244, v245
    v_add_f32 v248, v248, v249
    v_add_f32 v252, v252, v253
    v_mul_f32 v240, 0xba800000, v240
    v_mul_f32 v244, 0xba800000, v244
    v_mul_f32 v248, 0xba800000, v248
    v_mul_f32 v252, 0xba800000, v252
    v_cvt_pk_bf16_f32 v240, v240, v240
    v_cvt_pk_bf16_f32 v244, v244, v244
    v_cvt_pk_bf16_f32 v248, v248, v248
    v_cvt_pk_bf16_f32 v252, v252, v252
    v_and_b32 v240, 0xffff0000, v240
    v_and_b32 v244, 0xffff0000, v244
    v_and_b32 v248, 0xffff0000, v248
    v_and_b32 v252, 0xffff0000, v252
    s_waitcnt lgkmcnt(0)
    v_pk_mul_f32 v[12:13], v[0:1], v[252:253] op_sel_hi:[1,0]
    v_pk_mul_f32 v[14:15], v[2:3], v[252:253] op_sel_hi:[1,0]
    v_pk_mul_f32 v[8:9], v[0:1], v[248:249] op_sel_hi:[1,0]
    v_pk_mul_f32 v[10:11], v[2:3], v[248:249] op_sel_hi:[1,0]
    v_pk_mul_f32 v[4:5], v[0:1], v[244:245] op_sel_hi:[1,0]
    v_pk_mul_f32 v[6:7], v[2:3], v[244:245] op_sel_hi:[1,0]
    v_pk_mul_f32 v[0:1], v[0:1], v[240:241] op_sel_hi:[1,0]
    v_pk_mul_f32 v[2:3], v[2:3], v[240:241] op_sel_hi:[1,0]
    v_pk_mul_f32 v[28:29], v[16:17], v[252:253] op_sel_hi:[1,0]
    v_pk_mul_f32 v[30:31], v[18:19], v[252:253] op_sel_hi:[1,0]
    v_pk_mul_f32 v[24:25], v[16:17], v[248:249] op_sel_hi:[1,0]
    v_pk_mul_f32 v[26:27], v[18:19], v[248:249] op_sel_hi:[1,0]
    v_pk_mul_f32 v[20:21], v[16:17], v[244:245] op_sel_hi:[1,0]
    v_pk_mul_f32 v[22:23], v[18:19], v[244:245] op_sel_hi:[1,0]
    v_pk_mul_f32 v[16:17], v[16:17], v[240:241] op_sel_hi:[1,0]
    v_pk_mul_f32 v[18:19], v[18:19], v[240:241] op_sel_hi:[1,0]
    v_pk_mul_f32 v[44:45], v[32:33], v[252:253] op_sel_hi:[1,0]
    v_pk_mul_f32 v[46:47], v[34:35], v[252:253] op_sel_hi:[1,0]
    v_pk_mul_f32 v[40:41], v[32:33], v[248:249] op_sel_hi:[1,0]
    v_pk_mul_f32 v[42:43], v[34:35], v[248:249] op_sel_hi:[1,0]
    v_pk_mul_f32 v[36:37], v[32:33], v[244:245] op_sel_hi:[1,0]
    v_pk_mul_f32 v[38:39], v[34:35], v[244:245] op_sel_hi:[1,0]
    v_pk_mul_f32 v[32:33], v[32:33], v[240:241] op_sel_hi:[1,0]
    v_pk_mul_f32 v[34:35], v[34:35], v[240:241] op_sel_hi:[1,0]
    v_pk_mul_f32 v[60:61], v[48:49], v[252:253] op_sel_hi:[1,0]
    v_pk_mul_f32 v[62:63], v[50:51], v[252:253] op_sel_hi:[1,0]
    v_pk_mul_f32 v[56:57], v[48:49], v[248:249] op_sel_hi:[1,0]
    v_pk_mul_f32 v[58:59], v[50:51], v[248:249] op_sel_hi:[1,0]
    v_pk_mul_f32 v[52:53], v[48:49], v[244:245] op_sel_hi:[1,0]
    v_pk_mul_f32 v[54:55], v[50:51], v[244:245] op_sel_hi:[1,0]
    v_pk_mul_f32 v[48:49], v[48:49], v[240:241] op_sel_hi:[1,0]
    v_pk_mul_f32 v[50:51], v[50:51], v[240:241] op_sel_hi:[1,0]
    v_pk_mul_f32 v[76:77], v[64:65], v[252:253] op_sel_hi:[1,0]
    v_pk_mul_f32 v[78:79], v[66:67], v[252:253] op_sel_hi:[1,0]
    v_pk_mul_f32 v[72:73], v[64:65], v[248:249] op_sel_hi:[1,0]
    v_pk_mul_f32 v[74:75], v[66:67], v[248:249] op_sel_hi:[1,0]
    v_pk_mul_f32 v[68:69], v[64:65], v[244:245] op_sel_hi:[1,0]
    v_pk_mul_f32 v[70:71], v[66:67], v[244:245] op_sel_hi:[1,0]
    v_pk_mul_f32 v[64:65], v[64:65], v[240:241] op_sel_hi:[1,0]
    v_pk_mul_f32 v[66:67], v[66:67], v[240:241] op_sel_hi:[1,0]
    v_pk_mul_f32 v[92:93], v[80:81], v[252:253] op_sel_hi:[1,0]
    v_pk_mul_f32 v[94:95], v[82:83], v[252:253] op_sel_hi:[1,0]
    v_pk_mul_f32 v[88:89], v[80:81], v[248:249] op_sel_hi:[1,0]
    v_pk_mul_f32 v[90:91], v[82:83], v[248:249] op_sel_hi:[1,0]
    v_pk_mul_f32 v[84:85], v[80:81], v[244:245] op_sel_hi:[1,0]
    v_pk_mul_f32 v[86:87], v[82:83], v[244:245] op_sel_hi:[1,0]
    v_pk_mul_f32 v[80:81], v[80:81], v[240:241] op_sel_hi:[1,0]
    v_pk_mul_f32 v[82:83], v[82:83], v[240:241] op_sel_hi:[1,0]
    v_pk_mul_f32 v[108:109], v[96:97], v[252:253] op_sel_hi:[1,0]
    v_pk_mul_f32 v[110:111], v[98:99], v[252:253] op_sel_hi:[1,0]
    v_pk_mul_f32 v[104:105], v[96:97], v[248:249] op_sel_hi:[1,0]
    v_pk_mul_f32 v[106:107], v[98:99], v[248:249] op_sel_hi:[1,0]
    v_pk_mul_f32 v[100:101], v[96:97], v[244:245] op_sel_hi:[1,0]
    v_pk_mul_f32 v[102:103], v[98:99], v[244:245] op_sel_hi:[1,0]
    v_pk_mul_f32 v[96:97], v[96:97], v[240:241] op_sel_hi:[1,0]
    v_pk_mul_f32 v[98:99], v[98:99], v[240:241] op_sel_hi:[1,0]
    v_pk_mul_f32 v[124:125], v[112:113], v[252:253] op_sel_hi:[1,0]
    v_pk_mul_f32 v[126:127], v[114:115], v[252:253] op_sel_hi:[1,0]
    v_pk_mul_f32 v[120:121], v[112:113], v[248:249] op_sel_hi:[1,0]
    v_pk_mul_f32 v[122:123], v[114:115], v[248:249] op_sel_hi:[1,0]
    v_pk_mul_f32 v[116:117], v[112:113], v[244:245] op_sel_hi:[1,0]
    v_pk_mul_f32 v[118:119], v[114:115], v[244:245] op_sel_hi:[1,0]
    v_pk_mul_f32 v[112:113], v[112:113], v[240:241] op_sel_hi:[1,0]
    v_pk_mul_f32 v[114:115], v[114:115], v[240:241] op_sel_hi:[1,0]
    v_pk_mul_f32 v[140:141], v[128:129], v[252:253] op_sel_hi:[1,0]
    v_pk_mul_f32 v[142:143], v[130:131], v[252:253] op_sel_hi:[1,0]
    v_pk_mul_f32 v[136:137], v[128:129], v[248:249] op_sel_hi:[1,0]
    v_pk_mul_f32 v[138:139], v[130:131], v[248:249] op_sel_hi:[1,0]
    v_pk_mul_f32 v[132:133], v[128:129], v[244:245] op_sel_hi:[1,0]
    v_pk_mul_f32 v[134:135], v[130:131], v[244:245] op_sel_hi:[1,0]
    v_pk_mul_f32 v[128:129], v[128:129], v[240:241] op_sel_hi:[1,0]
    v_pk_mul_f32 v[130:131], v[130:131], v[240:241] op_sel_hi:[1,0]
    v_pk_mul_f32 v[156:157], v[144:145], v[252:253] op_sel_hi:[1,0]
    v_pk_mul_f32 v[158:159], v[146:147], v[252:253] op_sel_hi:[1,0]
    v_pk_mul_f32 v[152:153], v[144:145], v[248:249] op_sel_hi:[1,0]
    v_pk_mul_f32 v[154:155], v[146:147], v[248:249] op_sel_hi:[1,0]
    v_pk_mul_f32 v[148:149], v[144:145], v[244:245] op_sel_hi:[1,0]
    v_pk_mul_f32 v[150:151], v[146:147], v[244:245] op_sel_hi:[1,0]
    v_pk_mul_f32 v[144:145], v[144:145], v[240:241] op_sel_hi:[1,0]
    v_pk_mul_f32 v[146:147], v[146:147], v[240:241] op_sel_hi:[1,0]
    v_pk_mul_f32 v[172:173], v[160:161], v[252:253] op_sel_hi:[1,0]
    v_pk_mul_f32 v[174:175], v[162:163], v[252:253] op_sel_hi:[1,0]
    v_pk_mul_f32 v[168:169], v[160:161], v[248:249] op_sel_hi:[1,0]
    v_pk_mul_f32 v[170:171], v[162:163], v[248:249] op_sel_hi:[1,0]
    v_pk_mul_f32 v[164:165], v[160:161], v[244:245] op_sel_hi:[1,0]
    v_pk_mul_f32 v[166:167], v[162:163], v[244:245] op_sel_hi:[1,0]
    v_pk_mul_f32 v[160:161], v[160:161], v[240:241] op_sel_hi:[1,0]
    v_pk_mul_f32 v[162:163], v[162:163], v[240:241] op_sel_hi:[1,0]
    v_pk_mul_f32 v[188:189], v[176:177], v[252:253] op_sel_hi:[1,0]
    v_pk_mul_f32 v[190:191], v[178:179], v[252:253] op_sel_hi:[1,0]
    v_pk_mul_f32 v[184:185], v[176:177], v[248:249] op_sel_hi:[1,0]
    v_pk_mul_f32 v[186:187], v[178:179], v[248:249] op_sel_hi:[1,0]
    v_pk_mul_f32 v[180:181], v[176:177], v[244:245] op_sel_hi:[1,0]
    v_pk_mul_f32 v[182:183], v[178:179], v[244:245] op_sel_hi:[1,0]
    v_pk_mul_f32 v[176:177], v[176:177], v[240:241] op_sel_hi:[1,0]
    v_pk_mul_f32 v[178:179], v[178:179], v[240:241] op_sel_hi:[1,0]
    v_pk_mul_f32 v[204:205], v[192:193], v[252:253] op_sel_hi:[1,0]
    v_pk_mul_f32 v[206:207], v[194:195], v[252:253] op_sel_hi:[1,0]
    v_pk_mul_f32 v[200:201], v[192:193], v[248:249] op_sel_hi:[1,0]
    v_pk_mul_f32 v[202:203], v[194:195], v[248:249] op_sel_hi:[1,0]
    v_pk_mul_f32 v[196:197], v[192:193], v[244:245] op_sel_hi:[1,0]
    v_pk_mul_f32 v[198:199], v[194:195], v[244:245] op_sel_hi:[1,0]
    v_pk_mul_f32 v[192:193], v[192:193], v[240:241] op_sel_hi:[1,0]
    v_pk_mul_f32 v[194:195], v[194:195], v[240:241] op_sel_hi:[1,0]
    v_pk_mul_f32 v[220:221], v[208:209], v[252:253] op_sel_hi:[1,0]
    v_pk_mul_f32 v[222:223], v[210:211], v[252:253] op_sel_hi:[1,0]
    v_pk_mul_f32 v[216:217], v[208:209], v[248:249] op_sel_hi:[1,0]
    v_pk_mul_f32 v[218:219], v[210:211], v[248:249] op_sel_hi:[1,0]
    v_pk_mul_f32 v[212:213], v[208:209], v[244:245] op_sel_hi:[1,0]
    v_pk_mul_f32 v[214:215], v[210:211], v[244:245] op_sel_hi:[1,0]
    v_pk_mul_f32 v[208:209], v[208:209], v[240:241] op_sel_hi:[1,0]
    v_pk_mul_f32 v[210:211], v[210:211], v[240:241] op_sel_hi:[1,0]
    s_waitcnt vmcnt(22)
    s_barrier
    ds_read_b128 a[128:131], v230 offset:0
    ds_read_b128 a[132:135], v230 offset:1024
    ds_read_b128 a[136:139], v230 offset:2048
    ds_read_b128 a[140:143], v230 offset:3072
    ds_read_b128 a[144:147], v230 offset:4096
    ds_read_b128 a[148:151], v230 offset:5120
    ds_read_b128 a[152:155], v230 offset:6144
    ds_read_b128 a[156:159], v230 offset:7168
    s_waitcnt vmcnt(6) lgkmcnt(6)
    v_mfma_f32_16x16x32_bf16 v[0:3], a[128:131], a[0:3], v[0:3]
    s_add_u32 s25, s25, 2048
    buffer_load_dwordx4 a[32:35], v224, s[44:47], s25 offen offset:0 sc1
    v_mfma_f32_16x16x32_bf16 v[0:3], a[132:135], a[4:7], v[0:3]
    s_waitcnt vmcnt(5)
    v_mfma_f32_16x16x32_bf16 v[4:7], a[132:135], a[12:15], v[4:7]
    v_mfma_f32_16x16x32_bf16 v[4:7], a[128:131], a[8:11], v[4:7]
    s_waitcnt vmcnt(3)
    v_mfma_f32_16x16x32_bf16 v[8:11], a[128:131], a[16:19], v[8:11]
    buffer_load_dwordx4 a[36:39], v224, s[44:47], s25 offen offset:1024 sc1
    v_mfma_f32_16x16x32_bf16 v[8:11], a[132:135], a[20:23], v[8:11]
    s_waitcnt vmcnt(2)
    v_mfma_f32_16x16x32_bf16 v[12:15], a[132:135], a[28:31], v[12:15]
    v_mfma_f32_16x16x32_bf16 v[12:15], a[128:131], a[24:27], v[12:15]
    ds_read_b128 a[128:131], v230 offset:8192
    s_waitcnt lgkmcnt(5)
    v_mfma_f32_16x16x32_bf16 v[28:31], a[136:139], a[24:27], v[28:31]
    buffer_load_dwordx4 a[40:43], v225, s[44:47], s25 offen offset:0 sc1
    v_mfma_f32_16x16x32_bf16 v[28:31], a[140:143], a[28:31], v[28:31]
    ds_read_b128 a[132:135], v230 offset:9216
    v_mfma_f32_16x16x32_bf16 v[24:27], a[140:143], a[20:23], v[24:27]
    v_mfma_f32_16x16x32_bf16 v[24:27], a[136:139], a[16:19], v[24:27]
    v_mfma_f32_16x16x32_bf16 v[20:23], a[136:139], a[8:11], v[20:23]
    buffer_load_dwordx4 a[44:47], v225, s[44:47], s25 offen offset:1024 sc1
    v_mfma_f32_16x16x32_bf16 v[20:23], a[140:143], a[12:15], v[20:23]
    v_mfma_f32_16x16x32_bf16 v[16:19], a[140:143], a[4:7], v[16:19]
    v_mfma_f32_16x16x32_bf16 v[16:19], a[136:139], a[0:3], v[16:19]
    ds_read_b128 a[136:139], v230 offset:10240
    s_waitcnt lgkmcnt(5)
    v_mfma_f32_16x16x32_bf16 v[32:35], a[144:147], a[0:3], v[32:35]
    buffer_load_dwordx4 a[48:51], v226, s[44:47], s25 offen offset:0 sc1
    v_mfma_f32_16x16x32_bf16 v[32:35], a[148:151], a[4:7], v[32:35]
    ds_read_b128 a[140:143], v230 offset:11264
    v_mfma_f32_16x16x32_bf16 v[36:39], a[148:151], a[12:15], v[36:39]
    v_mfma_f32_16x16x32_bf16 v[36:39], a[144:147], a[8:11], v[36:39]
    v_mfma_f32_16x16x32_bf16 v[40:43], a[144:147], a[16:19], v[40:43]
    buffer_load_dwordx4 a[52:55], v226, s[44:47], s25 offen offset:1024 sc1
    v_mfma_f32_16x16x32_bf16 v[40:43], a[148:151], a[20:23], v[40:43]
    v_mfma_f32_16x16x32_bf16 v[44:47], a[148:151], a[28:31], v[44:47]
    v_mfma_f32_16x16x32_bf16 v[44:47], a[144:147], a[24:27], v[44:47]
    ds_read_b128 a[144:147], v230 offset:12288
    s_waitcnt lgkmcnt(5)
    v_mfma_f32_16x16x32_bf16 v[60:63], a[152:155], a[24:27], v[60:63]
    buffer_load_dwordx4 a[56:59], v227, s[44:47], s25 offen offset:0 sc1
    v_mfma_f32_16x16x32_bf16 v[60:63], a[156:159], a[28:31], v[60:63]
    ds_read_b128 a[148:151], v230 offset:13312
    v_mfma_f32_16x16x32_bf16 v[56:59], a[156:159], a[20:23], v[56:59]
    v_mfma_f32_16x16x32_bf16 v[56:59], a[152:155], a[16:19], v[56:59]
    v_mfma_f32_16x16x32_bf16 v[52:55], a[152:155], a[8:11], v[52:55]
    buffer_load_dwordx4 a[60:63], v227, s[44:47], s25 offen offset:1024 sc1
    v_mfma_f32_16x16x32_bf16 v[52:55], a[156:159], a[12:15], v[52:55]
    v_mfma_f32_16x16x32_bf16 v[48:51], a[156:159], a[4:7], v[48:51]
    v_mfma_f32_16x16x32_bf16 v[48:51], a[152:155], a[0:3], v[48:51]
    ds_read_b128 a[152:155], v230 offset:14336
    s_waitcnt lgkmcnt(5)
    v_mfma_f32_16x16x32_bf16 v[64:67], a[128:131], a[0:3], v[64:67]
    s_add_u32 s25, s25, 2048
    buffer_load_dwordx4 a[64:67], v224, s[44:47], s25 offen offset:0 sc1
    v_mfma_f32_16x16x32_bf16 v[64:67], a[132:135], a[4:7], v[64:67]
    ds_read_b128 a[156:159], v230 offset:15360
    v_mfma_f32_16x16x32_bf16 v[68:71], a[132:135], a[12:15], v[68:71]
    v_mfma_f32_16x16x32_bf16 v[68:71], a[128:131], a[8:11], v[68:71]
    v_mfma_f32_16x16x32_bf16 v[72:75], a[128:131], a[16:19], v[72:75]
    buffer_load_dwordx4 a[68:71], v224, s[44:47], s25 offen offset:1024 sc1
    v_mfma_f32_16x16x32_bf16 v[72:75], a[132:135], a[20:23], v[72:75]
    v_mfma_f32_16x16x32_bf16 v[76:79], a[132:135], a[28:31], v[76:79]
    v_mfma_f32_16x16x32_bf16 v[76:79], a[128:131], a[24:27], v[76:79]
    ds_read_b128 a[128:131], v230 offset:16384
    s_waitcnt lgkmcnt(5)
    v_mfma_f32_16x16x32_bf16 v[92:95], a[136:139], a[24:27], v[92:95]
    buffer_load_dwordx4 a[72:75], v225, s[44:47], s25 offen offset:0 sc1
    v_mfma_f32_16x16x32_bf16 v[92:95], a[140:143], a[28:31], v[92:95]
    ds_read_b128 a[132:135], v230 offset:17408
    v_mfma_f32_16x16x32_bf16 v[88:91], a[140:143], a[20:23], v[88:91]
    v_mfma_f32_16x16x32_bf16 v[88:91], a[136:139], a[16:19], v[88:91]
    v_mfma_f32_16x16x32_bf16 v[84:87], a[136:139], a[8:11], v[84:87]
    buffer_load_dwordx4 a[76:79], v225, s[44:47], s25 offen offset:1024 sc1
    v_mfma_f32_16x16x32_bf16 v[84:87], a[140:143], a[12:15], v[84:87]
    v_mfma_f32_16x16x32_bf16 v[80:83], a[140:143], a[4:7], v[80:83]
    v_mfma_f32_16x16x32_bf16 v[80:83], a[136:139], a[0:3], v[80:83]
    ds_read_b128 a[136:139], v230 offset:18432
    s_waitcnt lgkmcnt(5)
    v_mfma_f32_16x16x32_bf16 v[96:99], a[144:147], a[0:3], v[96:99]
    buffer_load_dwordx4 a[80:83], v226, s[44:47], s25 offen offset:0 sc1
    v_mfma_f32_16x16x32_bf16 v[96:99], a[148:151], a[4:7], v[96:99]
    ds_read_b128 a[140:143], v230 offset:19456
    v_mfma_f32_16x16x32_bf16 v[100:103], a[148:151], a[12:15], v[100:103]
    v_mfma_f32_16x16x32_bf16 v[100:103], a[144:147], a[8:11], v[100:103]
    v_mfma_f32_16x16x32_bf16 v[104:107], a[144:147], a[16:19], v[104:107]
    buffer_load_dwordx4 a[84:87], v226, s[44:47], s25 offen offset:1024 sc1
    v_mfma_f32_16x16x32_bf16 v[104:107], a[148:151], a[20:23], v[104:107]
    v_mfma_f32_16x16x32_bf16 v[108:111], a[148:151], a[28:31], v[108:111]
    v_mfma_f32_16x16x32_bf16 v[108:111], a[144:147], a[24:27], v[108:111]
    ds_read_b128 a[144:147], v230 offset:20480
    s_waitcnt lgkmcnt(5)
    v_mfma_f32_16x16x32_bf16 v[124:127], a[152:155], a[24:27], v[124:127]
    buffer_load_dwordx4 a[88:91], v227, s[44:47], s25 offen offset:0 sc1
    v_mfma_f32_16x16x32_bf16 v[124:127], a[156:159], a[28:31], v[124:127]
    ds_read_b128 a[148:151], v230 offset:21504
    v_mfma_f32_16x16x32_bf16 v[120:123], a[156:159], a[20:23], v[120:123]
    v_mfma_f32_16x16x32_bf16 v[120:123], a[152:155], a[16:19], v[120:123]
    v_mfma_f32_16x16x32_bf16 v[116:119], a[152:155], a[8:11], v[116:119]
    buffer_load_dwordx4 a[92:95], v227, s[44:47], s25 offen offset:1024 sc1
    v_mfma_f32_16x16x32_bf16 v[116:119], a[156:159], a[12:15], v[116:119]
    v_mfma_f32_16x16x32_bf16 v[112:115], a[156:159], a[4:7], v[112:115]
    v_mfma_f32_16x16x32_bf16 v[112:115], a[152:155], a[0:3], v[112:115]
    ds_read_b128 a[152:155], v230 offset:22528
    s_waitcnt lgkmcnt(5)
    v_mfma_f32_16x16x32_bf16 v[128:131], a[128:131], a[0:3], v[128:131]
    s_add_u32 s25, s25, 2048
    buffer_load_dwordx4 a[96:99], v224, s[44:47], s25 offen offset:0 sc1
    v_mfma_f32_16x16x32_bf16 v[128:131], a[132:135], a[4:7], v[128:131]
    ds_read_b128 a[156:159], v230 offset:23552
    v_mfma_f32_16x16x32_bf16 v[132:135], a[132:135], a[12:15], v[132:135]
    v_mfma_f32_16x16x32_bf16 v[132:135], a[128:131], a[8:11], v[132:135]
    v_mfma_f32_16x16x32_bf16 v[136:139], a[128:131], a[16:19], v[136:139]
    buffer_load_dwordx4 a[100:103], v224, s[44:47], s25 offen offset:1024 sc1
    v_mfma_f32_16x16x32_bf16 v[136:139], a[132:135], a[20:23], v[136:139]
    v_mfma_f32_16x16x32_bf16 v[140:143], a[132:135], a[28:31], v[140:143]
    v_mfma_f32_16x16x32_bf16 v[140:143], a[128:131], a[24:27], v[140:143]
    ds_read_b128 a[128:131], v230 offset:24576
    s_waitcnt lgkmcnt(5)
    v_mfma_f32_16x16x32_bf16 v[156:159], a[136:139], a[24:27], v[156:159]
    buffer_load_dwordx4 a[104:107], v225, s[44:47], s25 offen offset:0 sc1
    v_mfma_f32_16x16x32_bf16 v[156:159], a[140:143], a[28:31], v[156:159]
    ds_read_b128 a[132:135], v230 offset:25600
    v_mfma_f32_16x16x32_bf16 v[152:155], a[140:143], a[20:23], v[152:155]
    v_mfma_f32_16x16x32_bf16 v[152:155], a[136:139], a[16:19], v[152:155]
    v_mfma_f32_16x16x32_bf16 v[148:151], a[136:139], a[8:11], v[148:151]
    buffer_load_dwordx4 a[108:111], v225, s[44:47], s25 offen offset:1024 sc1
    v_mfma_f32_16x16x32_bf16 v[148:151], a[140:143], a[12:15], v[148:151]
    v_mfma_f32_16x16x32_bf16 v[144:147], a[140:143], a[4:7], v[144:147]
    v_mfma_f32_16x16x32_bf16 v[144:147], a[136:139], a[0:3], v[144:147]
    ds_read_b128 a[136:139], v230 offset:26624
    s_waitcnt lgkmcnt(5)
    v_mfma_f32_16x16x32_bf16 v[160:163], a[144:147], a[0:3], v[160:163]
    buffer_load_dwordx4 a[112:115], v226, s[44:47], s25 offen offset:0 sc1
    v_mfma_f32_16x16x32_bf16 v[160:163], a[148:151], a[4:7], v[160:163]
    ds_read_b128 a[140:143], v230 offset:27648
    v_mfma_f32_16x16x32_bf16 v[164:167], a[148:151], a[12:15], v[164:167]
    v_mfma_f32_16x16x32_bf16 v[164:167], a[144:147], a[8:11], v[164:167]
    v_mfma_f32_16x16x32_bf16 v[168:171], a[144:147], a[16:19], v[168:171]
    buffer_load_dwordx4 a[116:119], v226, s[44:47], s25 offen offset:1024 sc1
    v_mfma_f32_16x16x32_bf16 v[168:171], a[148:151], a[20:23], v[168:171]
    v_mfma_f32_16x16x32_bf16 v[172:175], a[148:151], a[28:31], v[172:175]
    s_barrier
    v_mfma_f32_16x16x32_bf16 v[172:175], a[144:147], a[24:27], v[172:175]
    ds_read_b128 a[144:147], v230 offset:28672
    s_waitcnt lgkmcnt(5)
    v_mfma_f32_16x16x32_bf16 v[188:191], a[152:155], a[24:27], v[188:191]
    s_add_u32 m0, s26, 86016
    s_add_u32 s24, s24, 28672
    buffer_load_dwordx4 v228, s[44:47], s24 offen offset:0 sc1 lds
    v_mfma_f32_16x16x32_bf16 v[188:191], a[156:159], a[28:31], v[188:191]
    ds_read_b128 a[148:151], v230 offset:29696
    v_mfma_f32_16x16x32_bf16 v[184:187], a[156:159], a[20:23], v[184:187]
    v_mfma_f32_16x16x32_bf16 v[184:187], a[152:155], a[16:19], v[184:187]
    v_mfma_f32_16x16x32_bf16 v[180:183], a[152:155], a[8:11], v[180:183]
    buffer_load_dwordx4 a[120:123], v227, s[44:47], s25 offen offset:0 sc1
    v_mfma_f32_16x16x32_bf16 v[180:183], a[156:159], a[12:15], v[180:183]
    v_mfma_f32_16x16x32_bf16 v[176:179], a[156:159], a[4:7], v[176:179]
    v_mfma_f32_16x16x32_bf16 v[176:179], a[152:155], a[0:3], v[176:179]
    ds_read_b128 a[152:155], v230 offset:30720
    s_waitcnt lgkmcnt(5)
    v_mfma_f32_16x16x32_bf16 v[192:195], a[128:131], a[0:3], v[192:195]
    ds_read_b128 a[156:159], v230 offset:31744
    v_mfma_f32_16x16x32_bf16 v[192:195], a[132:135], a[4:7], v[192:195]
    v_mfma_f32_16x16x32_bf16 v[196:199], a[132:135], a[12:15], v[196:199]
    v_mfma_f32_16x16x32_bf16 v[196:199], a[128:131], a[8:11], v[196:199]
    v_mfma_f32_16x16x32_bf16 v[200:203], a[128:131], a[16:19], v[200:203]
    v_mfma_f32_16x16x32_bf16 v[200:203], a[132:135], a[20:23], v[200:203]
    v_mfma_f32_16x16x32_bf16 v[204:207], a[132:135], a[28:31], v[204:207]
    s_add_u32 m0, s26, 86016
    s_nop 0
    buffer_load_dwordx4 v228, s[44:47], s24 offen offset:1024 sc1 lds
    v_mfma_f32_16x16x32_bf16 v[204:207], a[128:131], a[24:27], v[204:207]
    ds_read_b128 a[128:131], v230 offset:32768
    s_waitcnt lgkmcnt(5)
    v_mfma_f32_16x16x32_bf16 v[220:223], a[136:139], a[24:27], v[220:223]
    ds_read_b128 a[132:135], v230 offset:33792
    v_mfma_f32_16x16x32_bf16 v[220:223], a[140:143], a[28:31], v[220:223]
    v_mfma_f32_16x16x32_bf16 v[216:219], a[140:143], a[20:23], v[216:219]
    buffer_load_dwordx4 a[124:127], v227, s[44:47], s25 offen offset:1024 sc1
    v_mfma_f32_16x16x32_bf16 v[216:219], a[136:139], a[16:19], v[216:219]
    v_mfma_f32_16x16x32_bf16 v[212:215], a[136:139], a[8:11], v[212:215]
    v_mfma_f32_16x16x32_bf16 v[212:215], a[140:143], a[12:15], v[212:215]
    v_mfma_f32_16x16x32_bf16 v[208:211], a[140:143], a[4:7], v[208:211]
    v_mfma_f32_16x16x32_bf16 v[208:211], a[136:139], a[0:3], v[208:211]
    ds_read_b128 a[136:139], v230 offset:34816
    ds_read_b128 a[140:143], v230 offset:35840
    s_waitcnt vmcnt(24) lgkmcnt(6)
    v_mfma_f32_16x16x32_bf16 v[0:3], a[144:147], a[32:35], v[0:3]
    v_mfma_f32_16x16x32_bf16 v[0:3], a[148:151], a[36:39], v[0:3]
    s_waitcnt vmcnt(22)
    v_mfma_f32_16x16x32_bf16 v[4:7], a[148:151], a[44:47], v[4:7]
    v_lshrrev_b32 v233, 3, v232
    v_mfma_f32_16x16x32_bf16 v[4:7], a[144:147], a[40:43], v[4:7]
    v_bfe_u32 v234, v232, 4, 2
    s_waitcnt vmcnt(20)
    v_mfma_f32_16x16x32_bf16 v[8:11], a[144:147], a[48:51], v[8:11]
    v_lshlrev_b32 v234, 1, v234
    v_mfma_f32_16x16x32_bf16 v[8:11], a[148:151], a[52:55], v[8:11]
    v_and_b32 v235, 7, v232
    s_waitcnt vmcnt(18)
    v_mfma_f32_16x16x32_bf16 v[12:15], a[148:151], a[60:63], v[12:15]
    v_xor_b32 v234, v234, v235
    s_add_u32 m0, s26, 86016
    s_nop 0
    buffer_load_dwordx4 v228, s[44:47], s24 offen offset:2048 sc1 lds
    v_mfma_f32_16x16x32_bf16 v[12:15], a[144:147], a[56:59], v[12:15]
    v_lshlrev_b32 v234, 4, v234
    s_waitcnt lgkmcnt(4)
    v_mfma_f32_16x16x32_bf16 v[28:31], a[152:155], a[56:59], v[28:31]
    v_mul_u32_u24 v233, 2048, v233
    v_mfma_f32_16x16x32_bf16 v[28:31], a[156:159], a[60:63], v[28:31]
    v_add_u32 v241, v233, v234
    v_mfma_f32_16x16x32_bf16 v[24:27], a[156:159], a[52:55], v[24:27]
    v_lshrrev_b32 v233, 2, v232
    v_mfma_f32_16x16x32_bf16 v[24:27], a[152:155], a[48:51], v[24:27]
    v_lshlrev_b32 v233, 7, v233
    v_mfma_f32_16x16x32_bf16 v[20:23], a[152:155], a[40:43], v[20:23]
    v_and_b32 v234, 3, v232
    s_add_u32 s25, s25, 2048
    buffer_load_dwordx4 a[0:3], v224, s[44:47], s25 offen offset:0 sc1
    ds_read_b128 a[144:147], v230 offset:36864
    ds_read_b128 a[148:151], v230 offset:37888
    v_mfma_f32_16x16x32_bf16 v[20:23], a[156:159], a[44:47], v[20:23]
    v_lshl_add_u32 v233, v234, 3, v233
    v_mfma_f32_16x16x32_bf16 v[16:19], a[156:159], a[36:39], v[16:19]
    v_bfe_u32 v234, v232, 3, 2
    v_mfma_f32_16x16x32_bf16 v[16:19], a[152:155], a[32:35], v[16:19]
    v_xor_b32 v235, 0, v234
    s_waitcnt lgkmcnt(4)
    v_mfma_f32_16x16x32_bf16 v[32:35], a[128:131], a[32:35], v[32:35]
    v_lshl_add_u32 v236, v235, 5, v233
    v_mfma_f32_16x16x32_bf16 v[32:35], a[132:135], a[36:39], v[32:35]
    v_xor_b32 v235, 1, v234
    v_mfma_f32_16x16x32_bf16 v[36:39], a[132:135], a[44:47], v[36:39]
    v_lshl_add_u32 v237, v235, 5, v233
    v_mfma_f32_16x16x32_bf16 v[36:39], a[128:131], a[40:43], v[36:39]
    v_xor_b32 v235, 2, v234
    v_mfma_f32_16x16x32_bf16 v[40:43], a[128:131], a[48:51], v[40:43]
    v_lshl_add_u32 v238, v235, 5, v233
    s_add_u32 m0, s26, 86016
    s_nop 0
    buffer_load_dwordx4 v228, s[44:47], s24 offen offset:3072 sc1 lds
    ds_read_b128 a[152:155], v230 offset:38912
    ds_read_b128 a[156:159], v230 offset:39936
    v_mfma_f32_16x16x32_bf16 v[40:43], a[132:135], a[52:55], v[40:43]
    v_xor_b32 v235, 3, v234
    v_mfma_f32_16x16x32_bf16 v[44:47], a[132:135], a[60:63], v[44:47]
    v_lshl_add_u32 v239, v235, 5, v233
    v_mfma_f32_16x16x32_bf16 v[44:47], a[128:131], a[56:59], v[44:47]
    s_lshl_b32 s21, s34, 13
    s_waitcnt lgkmcnt(4)
    v_mfma_f32_16x16x32_bf16 v[60:63], a[136:139], a[56:59], v[60:63]
    s_add_u32 s21, s21, 115712
    v_mfma_f32_16x16x32_bf16 v[60:63], a[140:143], a[60:63], v[60:63]
    v_add_u32 v236, s21, v236
    v_mfma_f32_16x16x32_bf16 v[56:59], a[140:143], a[52:55], v[56:59]
    v_add_u32 v237, s21, v237
    buffer_load_dwordx4 a[4:7], v224, s[44:47], s25 offen offset:1024 sc1
    v_mfma_f32_16x16x32_bf16 v[56:59], a[136:139], a[48:51], v[56:59]
    v_add_u32 v238, s21, v238
    v_mfma_f32_16x16x32_bf16 v[52:55], a[136:139], a[40:43], v[52:55]
    v_add_u32 v239, s21, v239
    ds_read_b128 a[128:131], v230 offset:40960
    ds_read_b128 a[132:135], v230 offset:41984
    v_mfma_f32_16x16x32_bf16 v[52:55], a[140:143], a[44:47], v[52:55]
    s_lshl_b32 s22, s2, 2
    v_mfma_f32_16x16x32_bf16 v[48:51], a[140:143], a[36:39], v[48:51]
    s_add_u32 s22, s22, s34
    v_mfma_f32_16x16x32_bf16 v[48:51], a[136:139], a[32:35], v[48:51]
    s_lshr_b32 s23, s22, 4
    s_waitcnt lgkmcnt(4)
    v_mfma_f32_16x16x32_bf16 v[64:67], a[144:147], a[32:35], v[64:67]
    s_and_b32 s22, s22, 15
    v_mfma_f32_16x16x32_bf16 v[64:67], a[148:151], a[36:39], v[64:67]
    s_mov_b32 s4, s28
    v_mfma_f32_16x16x32_bf16 v[68:71], a[148:151], a[44:47], v[68:71]
    s_mov_b32 s5, s29
    v_mfma_f32_16x16x32_bf16 v[68:71], a[144:147], a[40:43], v[68:71]
    s_mov_b32 s6, 7340032
    s_add_u32 m0, s26, 90112
    s_nop 0
    buffer_load_dwordx4 v229, s[44:47], s24 offen offset:0 sc1 lds
    v_mfma_f32_16x16x32_bf16 v[72:75], a[144:147], a[48:51], v[72:75]
    s_mov_b32 s7, 0x20000
    ds_read_b128 a[136:139], v230 offset:43008
    ds_read_b128 a[140:143], v230 offset:44032
    v_mfma_f32_16x16x32_bf16 v[72:75], a[148:151], a[52:55], v[72:75]
    s_lshl_b32 s20, s23, 17
    v_mfma_f32_16x16x32_bf16 v[76:79], a[148:151], a[60:63], v[76:79]
    s_lshl_b32 s8, s22, 7
    v_mfma_f32_16x16x32_bf16 v[76:79], a[144:147], a[56:59], v[76:79]
    s_add_u32 s20, s20, s8
    s_waitcnt lgkmcnt(4)
    v_mfma_f32_16x16x32_bf16 v[92:95], a[152:155], a[56:59], v[92:95]
    s_mul_i32 s8, s22, 458752
    v_mfma_f32_16x16x32_bf16 v[92:95], a[156:159], a[60:63], v[92:95]
    s_lshl_b32 s9, s23, 13
    buffer_load_dwordx4 a[8:11], v225, s[44:47], s25 offen offset:0 sc1
    v_mfma_f32_16x16x32_bf16 v[88:91], a[156:159], a[52:55], v[88:91]
    s_add_u32 s8, s8, s9
    v_mfma_f32_16x16x32_bf16 v[88:91], a[152:155], a[48:51], v[88:91]
    s_add_u32 s8, s8, 46137344
    v_mfma_f32_16x16x32_bf16 v[84:87], a[152:155], a[40:43], v[84:87]
    s_and_b32 s13, s2, 3
    ds_read_b128 a[144:147], v230 offset:45056
    ds_read_b128 a[148:151], v230 offset:46080
    v_mfma_f32_16x16x32_bf16 v[84:87], a[156:159], a[44:47], v[84:87]
    s_lshl_b32 s13, s13, 7
    v_mfma_f32_16x16x32_bf16 v[80:83], a[156:159], a[36:39], v[80:83]
    s_add_u32 s13, s13, 54347776
    v_mfma_f32_16x16x32_bf16 v[80:83], a[152:155], a[32:35], v[80:83]
    v_min_u32 v242, 1, v232
    s_waitcnt lgkmcnt(4)
    v_mfma_f32_16x16x32_bf16 v[96:99], a[128:131], a[32:35], v[96:99]
    v_lshlrev_b32 v242, 26, v242
    v_mfma_f32_16x16x32_bf16 v[96:99], a[132:135], a[36:39], v[96:99]
    v_mov_b32 v243, 1
    s_add_u32 m0, s26, 90112
    s_nop 0
    buffer_load_dwordx4 v229, s[44:47], s24 offen offset:1024 sc1 lds
    v_mfma_f32_16x16x32_bf16 v[100:103], a[132:135], a[44:47], v[100:103]
    s_cmp_ge_u32 s23, 56
    s_cselect_b32 s8, 0x7ff00000, s8
    s_add_u32 s9, s8, 4096
    v_mfma_f32_16x16x32_bf16 v[100:103], a[128:131], a[40:43], v[100:103]
    s_cmp_eq_u32 s34, 0
    s_cselect_b32 s13, s13, 0x7ff00000
    v_mfma_f32_16x16x32_bf16 v[104:107], a[128:131], a[48:51], v[104:107]
    ds_read_b128 a[152:155], v230 offset:47104
    ds_read_b128 a[156:159], v230 offset:48128
    v_mfma_f32_16x16x32_bf16 v[104:107], a[132:135], a[52:55], v[104:107]
    buffer_load_dwordx4 a[12:15], v225, s[44:47], s25 offen offset:1024 sc1
    v_mfma_f32_16x16x32_bf16 v[108:111], a[132:135], a[60:63], v[108:111]
    v_mfma_f32_16x16x32_bf16 v[108:111], a[128:131], a[56:59], v[108:111]
    ds_read_b128 a[128:131], v230 offset:49152
    s_waitcnt lgkmcnt(5)
    v_mfma_f32_16x16x32_bf16 v[124:127], a[136:139], a[56:59], v[124:127]
    ds_read_b128 a[132:135], v230 offset:50176
    v_mfma_f32_16x16x32_bf16 v[124:127], a[140:143], a[60:63], v[124:127]
    v_mfma_f32_16x16x32_bf16 v[120:123], a[140:143], a[52:55], v[120:123]
    v_mfma_f32_16x16x32_bf16 v[120:123], a[136:139], a[48:51], v[120:123]
    v_mfma_f32_16x16x32_bf16 v[116:119], a[136:139], a[40:43], v[116:119]
    v_mfma_f32_16x16x32_bf16 v[116:119], a[140:143], a[44:47], v[116:119]
    s_add_u32 m0, s26, 90112
    s_nop 0
    buffer_load_dwordx4 v229, s[44:47], s24 offen offset:2048 sc1 lds
    v_mfma_f32_16x16x32_bf16 v[112:115], a[140:143], a[36:39], v[112:115]
    v_mfma_f32_16x16x32_bf16 v[112:115], a[136:139], a[32:35], v[112:115]
    ds_read_b128 a[136:139], v230 offset:51200
    s_waitcnt lgkmcnt(5)
    v_mfma_f32_16x16x32_bf16 v[128:131], a[144:147], a[32:35], v[128:131]
    ds_read_b128 a[140:143], v230 offset:52224
    v_mfma_f32_16x16x32_bf16 v[128:131], a[148:151], a[36:39], v[128:131]
    buffer_load_dwordx4 a[16:19], v226, s[44:47], s25 offen offset:0 sc1
    v_mfma_f32_16x16x32_bf16 v[132:135], a[148:151], a[44:47], v[132:135]
    v_mfma_f32_16x16x32_bf16 v[132:135], a[144:147], a[40:43], v[132:135]
    v_mfma_f32_16x16x32_bf16 v[136:139], a[144:147], a[48:51], v[136:139]
    v_mfma_f32_16x16x32_bf16 v[136:139], a[148:151], a[52:55], v[136:139]
    v_mfma_f32_16x16x32_bf16 v[140:143], a[148:151], a[60:63], v[140:143]
    v_mfma_f32_16x16x32_bf16 v[140:143], a[144:147], a[56:59], v[140:143]
    ds_read_b128 a[144:147], v230 offset:53248
    s_waitcnt lgkmcnt(5)
    v_mfma_f32_16x16x32_bf16 v[156:159], a[152:155], a[56:59], v[156:159]
    ds_read_b128 a[148:151], v230 offset:54272
    v_mfma_f32_16x16x32_bf16 v[156:159], a[156:159], a[60:63], v[156:159]
    v_mfma_f32_16x16x32_bf16 v[152:155], a[156:159], a[52:55], v[152:155]
    v_mfma_f32_16x16x32_bf16 v[152:155], a[152:155], a[48:51], v[152:155]
    v_mfma_f32_16x16x32_bf16 v[148:151], a[152:155], a[40:43], v[148:151]
    v_mfma_f32_16x16x32_bf16 v[148:151], a[156:159], a[44:47], v[148:151]
    buffer_load_dwordx4 a[20:23], v226, s[44:47], s25 offen offset:1024 sc1
    v_mfma_f32_16x16x32_bf16 v[144:147], a[156:159], a[36:39], v[144:147]
    v_mfma_f32_16x16x32_bf16 v[144:147], a[152:155], a[32:35], v[144:147]
    ds_read_b128 a[152:155], v230 offset:55296
    s_waitcnt lgkmcnt(5)
    v_mfma_f32_16x16x32_bf16 v[160:163], a[128:131], a[32:35], v[160:163]
    ds_read_b128 a[156:159], v230 offset:56320
    v_mfma_f32_16x16x32_bf16 v[160:163], a[132:135], a[36:39], v[160:163]
    v_mfma_f32_16x16x32_bf16 v[164:167], a[132:135], a[44:47], v[164:167]
    v_mfma_f32_16x16x32_bf16 v[164:167], a[128:131], a[40:43], v[164:167]
    v_mfma_f32_16x16x32_bf16 v[168:171], a[128:131], a[48:51], v[168:171]
    v_mfma_f32_16x16x32_bf16 v[168:171], a[132:135], a[52:55], v[168:171]
    v_mfma_f32_16x16x32_bf16 v[172:175], a[132:135], a[60:63], v[172:175]
    s_barrier
    v_mfma_f32_16x16x32_bf16 v[172:175], a[128:131], a[56:59], v[172:175]
    ds_read_b128 a[128:131], v231 offset:0
    s_waitcnt lgkmcnt(5)
    v_mfma_f32_16x16x32_bf16 v[188:191], a[136:139], a[56:59], v[188:191]
    s_add_u32 m0, s26, 0
    s_add_u32 s24, s24, 28672
    buffer_load_dwordx4 v228, s[44:47], s24 offen offset:0 sc1 lds
    v_mfma_f32_16x16x32_bf16 v[188:191], a[140:143], a[60:63], v[188:191]
    ds_read_b128 a[132:135], v231 offset:1024
    v_mfma_f32_16x16x32_bf16 v[184:187], a[140:143], a[52:55], v[184:187]
    v_mfma_f32_16x16x32_bf16 v[184:187], a[136:139], a[48:51], v[184:187]
    v_mfma_f32_16x16x32_bf16 v[180:183], a[136:139], a[40:43], v[180:183]
    buffer_load_dwordx4 a[24:27], v227, s[44:47], s25 offen offset:0 sc1
    v_mfma_f32_16x16x32_bf16 v[180:183], a[140:143], a[44:47], v[180:183]
    v_mfma_f32_16x16x32_bf16 v[176:179], a[140:143], a[36:39], v[176:179]
    v_mfma_f32_16x16x32_bf16 v[176:179], a[136:139], a[32:35], v[176:179]
    ds_read_b128 a[136:139], v231 offset:2048
    s_waitcnt lgkmcnt(5)
    v_mfma_f32_16x16x32_bf16 v[192:195], a[144:147], a[32:35], v[192:195]
    ds_read_b128 a[140:143], v231 offset:3072
    v_mfma_f32_16x16x32_bf16 v[192:195], a[148:151], a[36:39], v[192:195]
    v_mfma_f32_16x16x32_bf16 v[196:199], a[148:151], a[44:47], v[196:199]
    v_mfma_f32_16x16x32_bf16 v[196:199], a[144:147], a[40:43], v[196:199]
    v_mfma_f32_16x16x32_bf16 v[200:203], a[144:147], a[48:51], v[200:203]
    v_mfma_f32_16x16x32_bf16 v[200:203], a[148:151], a[52:55], v[200:203]
    v_mfma_f32_16x16x32_bf16 v[204:207], a[148:151], a[60:63], v[204:207]
    s_add_u32 m0, s26, 0
    s_nop 0
    buffer_load_dwordx4 v228, s[44:47], s24 offen offset:1024 sc1 lds
    v_mfma_f32_16x16x32_bf16 v[204:207], a[144:147], a[56:59], v[204:207]
    ds_read_b128 a[144:147], v231 offset:4096
    s_waitcnt lgkmcnt(5)
    v_mfma_f32_16x16x32_bf16 v[220:223], a[152:155], a[56:59], v[220:223]
    ds_read_b128 a[148:151], v231 offset:5120
    v_mfma_f32_16x16x32_bf16 v[220:223], a[156:159], a[60:63], v[220:223]
    v_mfma_f32_16x16x32_bf16 v[216:219], a[156:159], a[52:55], v[216:219]
    buffer_load_dwordx4 a[28:31], v227, s[44:47], s25 offen offset:1024 sc1
    v_mfma_f32_16x16x32_bf16 v[216:219], a[152:155], a[48:51], v[216:219]
    v_mfma_f32_16x16x32_bf16 v[212:215], a[152:155], a[40:43], v[212:215]
    v_mfma_f32_16x16x32_bf16 v[212:215], a[156:159], a[44:47], v[212:215]
    v_mfma_f32_16x16x32_bf16 v[208:211], a[156:159], a[36:39], v[208:211]
    v_mfma_f32_16x16x32_bf16 v[208:211], a[152:155], a[32:35], v[208:211]
    ds_read_b128 a[152:155], v231 offset:6144
    ds_read_b128 a[156:159], v231 offset:7168
    s_waitcnt vmcnt(25) lgkmcnt(6)
    v_mfma_f32_16x16x32_bf16 v[0:3], a[128:131], a[64:67], v[0:3]
    v_mfma_f32_16x16x32_bf16 v[0:3], a[132:135], a[68:71], v[0:3]
    v_mfma_f32_16x16x32_bf16 v[4:7], a[132:135], a[76:79], v[4:7]
    v_mfma_f32_16x16x32_bf16 v[4:7], a[128:131], a[72:75], v[4:7]
    v_mfma_f32_16x16x32_bf16 v[8:11], a[128:131], a[80:83], v[8:11]
    s_add_u32 m0, s26, 0
    s_nop 0
    buffer_load_dwordx4 v228, s[44:47], s24 offen offset:2048 sc1 lds
    v_mfma_f32_16x16x32_bf16 v[8:11], a[132:135], a[84:87], v[8:11]
    v_mfma_f32_16x16x32_bf16 v[12:15], a[132:135], a[92:95], v[12:15]
    v_mfma_f32_16x16x32_bf16 v[12:15], a[128:131], a[88:91], v[12:15]
    ds_read_b128 a[128:131], v231 offset:8192
    s_waitcnt lgkmcnt(5)
    v_mfma_f32_16x16x32_bf16 v[28:31], a[136:139], a[88:91], v[28:31]
    s_add_u32 s25, s25, 2048
    buffer_load_dwordx4 a[32:35], v224, s[44:47], s25 offen offset:0 sc1
    v_mfma_f32_16x16x32_bf16 v[28:31], a[140:143], a[92:95], v[28:31]
    ds_read_b128 a[132:135], v231 offset:9216
    v_mfma_f32_16x16x32_bf16 v[24:27], a[140:143], a[84:87], v[24:27]
    v_mfma_f32_16x16x32_bf16 v[24:27], a[136:139], a[80:83], v[24:27]
    v_mfma_f32_16x16x32_bf16 v[20:23], a[136:139], a[72:75], v[20:23]
    v_mfma_f32_16x16x32_bf16 v[20:23], a[140:143], a[76:79], v[20:23]
    v_mfma_f32_16x16x32_bf16 v[16:19], a[140:143], a[68:71], v[16:19]
    v_mfma_f32_16x16x32_bf16 v[16:19], a[136:139], a[64:67], v[16:19]
    ds_read_b128 a[136:139], v231 offset:10240
    s_waitcnt lgkmcnt(5)
    v_mfma_f32_16x16x32_bf16 v[32:35], a[144:147], a[64:67], v[32:35]
    ds_read_b128 a[140:143], v231 offset:11264
    v_mfma_f32_16x16x32_bf16 v[32:35], a[148:151], a[68:71], v[32:35]
    v_mfma_f32_16x16x32_bf16 v[36:39], a[148:151], a[76:79], v[36:39]
    s_add_u32 m0, s26, 0
    s_nop 0
    buffer_load_dwordx4 v228, s[44:47], s24 offen offset:3072 sc1 lds
    v_mfma_f32_16x16x32_bf16 v[36:39], a[144:147], a[72:75], v[36:39]
    v_mfma_f32_16x16x32_bf16 v[40:43], a[144:147], a[80:83], v[40:43]
    v_mfma_f32_16x16x32_bf16 v[40:43], a[148:151], a[84:87], v[40:43]
    v_mfma_f32_16x16x32_bf16 v[44:47], a[148:151], a[92:95], v[44:47]
    buffer_load_dwordx4 a[36:39], v224, s[44:47], s25 offen offset:1024 sc1
    v_mfma_f32_16x16x32_bf16 v[44:47], a[144:147], a[88:91], v[44:47]
    ds_read_b128 a[144:147], v231 offset:12288
    s_waitcnt lgkmcnt(5)
    v_mfma_f32_16x16x32_bf16 v[60:63], a[152:155], a[88:91], v[60:63]
    ds_read_b128 a[148:151], v231 offset:13312
    v_mfma_f32_16x16x32_bf16 v[60:63], a[156:159], a[92:95], v[60:63]
    v_mfma_f32_16x16x32_bf16 v[56:59], a[156:159], a[84:87], v[56:59]
    v_mfma_f32_16x16x32_bf16 v[56:59], a[152:155], a[80:83], v[56:59]
    v_mfma_f32_16x16x32_bf16 v[52:55], a[152:155], a[72:75], v[52:55]
    v_mfma_f32_16x16x32_bf16 v[52:55], a[156:159], a[76:79], v[52:55]
    v_mfma_f32_16x16x32_bf16 v[48:51], a[156:159], a[68:71], v[48:51]
    v_mfma_f32_16x16x32_bf16 v[48:51], a[152:155], a[64:67], v[48:51]
    ds_read_b128 a[152:155], v231 offset:14336
    s_waitcnt lgkmcnt(5)
    v_mfma_f32_16x16x32_bf16 v[64:67], a[128:131], a[64:67], v[64:67]
    ds_read_b128 a[156:159], v231 offset:15360
    v_mfma_f32_16x16x32_bf16 v[64:67], a[132:135], a[68:71], v[64:67]
    s_add_u32 m0, s26, 4096
    s_nop 0
    buffer_load_dwordx4 v229, s[44:47], s24 offen offset:0 sc1 lds
    v_mfma_f32_16x16x32_bf16 v[68:71], a[132:135], a[76:79], v[68:71]
    v_mfma_f32_16x16x32_bf16 v[68:71], a[128:131], a[72:75], v[68:71]
    v_mfma_f32_16x16x32_bf16 v[72:75], a[128:131], a[80:83], v[72:75]
    v_mfma_f32_16x16x32_bf16 v[72:75], a[132:135], a[84:87], v[72:75]
    buffer_load_dwordx4 a[40:43], v225, s[44:47], s25 offen offset:0 sc1
    v_mfma_f32_16x16x32_bf16 v[76:79], a[132:135], a[92:95], v[76:79]
    v_mfma_f32_16x16x32_bf16 v[76:79], a[128:131], a[88:91], v[76:79]
    ds_read_b128 a[128:131], v231 offset:16384
    s_waitcnt lgkmcnt(5)
    v_mfma_f32_16x16x32_bf16 v[92:95], a[136:139], a[88:91], v[92:95]
    ds_read_b128 a[132:135], v231 offset:17408
    v_mfma_f32_16x16x32_bf16 v[92:95], a[140:143], a[92:95], v[92:95]
    v_mfma_f32_16x16x32_bf16 v[88:91], a[140:143], a[84:87], v[88:91]
    v_mfma_f32_16x16x32_bf16 v[88:91], a[136:139], a[80:83], v[88:91]
    v_mfma_f32_16x16x32_bf16 v[84:87], a[136:139], a[72:75], v[84:87]
    v_mfma_f32_16x16x32_bf16 v[84:87], a[140:143], a[76:79], v[84:87]
    v_mfma_f32_16x16x32_bf16 v[80:83], a[140:143], a[68:71], v[80:83]
    v_mfma_f32_16x16x32_bf16 v[80:83], a[136:139], a[64:67], v[80:83]
    ds_read_b128 a[136:139], v231 offset:18432
    s_waitcnt lgkmcnt(5)
    v_mfma_f32_16x16x32_bf16 v[96:99], a[144:147], a[64:67], v[96:99]
    s_add_u32 m0, s26, 4096
    s_nop 0
    buffer_load_dwordx4 v229, s[44:47], s24 offen offset:1024 sc1 lds
    v_mfma_f32_16x16x32_bf16 v[96:99], a[148:151], a[68:71], v[96:99]
    ds_read_b128 a[140:143], v231 offset:19456
    v_mfma_f32_16x16x32_bf16 v[100:103], a[148:151], a[76:79], v[100:103]
    v_mfma_f32_16x16x32_bf16 v[100:103], a[144:147], a[72:75], v[100:103]
    v_mfma_f32_16x16x32_bf16 v[104:107], a[144:147], a[80:83], v[104:107]
    buffer_load_dwordx4 a[44:47], v225, s[44:47], s25 offen offset:1024 sc1
    v_mfma_f32_16x16x32_bf16 v[104:107], a[148:151], a[84:87], v[104:107]
    v_mfma_f32_16x16x32_bf16 v[108:111], a[148:151], a[92:95], v[108:111]
    v_mfma_f32_16x16x32_bf16 v[108:111], a[144:147], a[88:91], v[108:111]
    ds_read_b128 a[144:147], v231 offset:20480
    s_waitcnt lgkmcnt(5)
    v_mfma_f32_16x16x32_bf16 v[124:127], a[152:155], a[88:91], v[124:127]
    ds_read_b128 a[148:151], v231 offset:21504
    v_mfma_f32_16x16x32_bf16 v[124:127], a[156:159], a[92:95], v[124:127]
    v_mfma_f32_16x16x32_bf16 v[120:123], a[156:159], a[84:87], v[120:123]
    v_mfma_f32_16x16x32_bf16 v[120:123], a[152:155], a[80:83], v[120:123]
    v_mfma_f32_16x16x32_bf16 v[116:119], a[152:155], a[72:75], v[116:119]
    v_mfma_f32_16x16x32_bf16 v[116:119], a[156:159], a[76:79], v[116:119]
    s_add_u32 m0, s26, 4096
    s_nop 0
    buffer_load_dwordx4 v229, s[44:47], s24 offen offset:2048 sc1 lds
    v_mfma_f32_16x16x32_bf16 v[112:115], a[156:159], a[68:71], v[112:115]
    v_mfma_f32_16x16x32_bf16 v[112:115], a[152:155], a[64:67], v[112:115]
    ds_read_b128 a[152:155], v231 offset:22528
    s_waitcnt lgkmcnt(5)
    v_mfma_f32_16x16x32_bf16 v[128:131], a[128:131], a[64:67], v[128:131]
    ds_read_b128 a[156:159], v231 offset:23552
    v_mfma_f32_16x16x32_bf16 v[128:131], a[132:135], a[68:71], v[128:131]
    buffer_load_dwordx4 a[48:51], v226, s[44:47], s25 offen offset:0 sc1
    v_mfma_f32_16x16x32_bf16 v[132:135], a[132:135], a[76:79], v[132:135]
    v_mfma_f32_16x16x32_bf16 v[132:135], a[128:131], a[72:75], v[132:135]
    v_mfma_f32_16x16x32_bf16 v[136:139], a[128:131], a[80:83], v[136:139]
    v_mfma_f32_16x16x32_bf16 v[136:139], a[132:135], a[84:87], v[136:139]
    v_mfma_f32_16x16x32_bf16 v[140:143], a[132:135], a[92:95], v[140:143]
    v_mfma_f32_16x16x32_bf16 v[140:143], a[128:131], a[88:91], v[140:143]
    ds_read_b128 a[128:131], v231 offset:24576
    s_waitcnt lgkmcnt(5)
    v_mfma_f32_16x16x32_bf16 v[156:159], a[136:139], a[88:91], v[156:159]
    ds_read_b128 a[132:135], v231 offset:25600
    v_mfma_f32_16x16x32_bf16 v[156:159], a[140:143], a[92:95], v[156:159]
    v_mfma_f32_16x16x32_bf16 v[152:155], a[140:143], a[84:87], v[152:155]
    v_mfma_f32_16x16x32_bf16 v[152:155], a[136:139], a[80:83], v[152:155]
    v_mfma_f32_16x16x32_bf16 v[148:151], a[136:139], a[72:75], v[148:151]
    v_mfma_f32_16x16x32_bf16 v[148:151], a[140:143], a[76:79], v[148:151]
    buffer_load_dwordx4 a[52:55], v226, s[44:47], s25 offen offset:1024 sc1
    v_mfma_f32_16x16x32_bf16 v[144:147], a[140:143], a[68:71], v[144:147]
    v_mfma_f32_16x16x32_bf16 v[144:147], a[136:139], a[64:67], v[144:147]
    ds_read_b128 a[136:139], v231 offset:26624
    s_waitcnt lgkmcnt(5)
    v_mfma_f32_16x16x32_bf16 v[160:163], a[144:147], a[64:67], v[160:163]
    ds_read_b128 a[140:143], v231 offset:27648
    v_mfma_f32_16x16x32_bf16 v[160:163], a[148:151], a[68:71], v[160:163]
    v_mfma_f32_16x16x32_bf16 v[164:167], a[148:151], a[76:79], v[164:167]
    v_mfma_f32_16x16x32_bf16 v[164:167], a[144:147], a[72:75], v[164:167]
    v_mfma_f32_16x16x32_bf16 v[168:171], a[144:147], a[80:83], v[168:171]
    v_mfma_f32_16x16x32_bf16 v[168:171], a[148:151], a[84:87], v[168:171]
    v_mfma_f32_16x16x32_bf16 v[172:175], a[148:151], a[92:95], v[172:175]
    s_waitcnt vmcnt(17)
    s_barrier
    v_mfma_f32_16x16x32_bf16 v[172:175], a[144:147], a[88:91], v[172:175]
    ds_read_b128 a[144:147], v231 offset:28672
    s_waitcnt lgkmcnt(5)
    v_mfma_f32_16x16x32_bf16 v[188:191], a[152:155], a[88:91], v[188:191]
    s_add_u32 m0, s26, 28672
    s_add_u32 s24, s24, 28672
    buffer_load_dwordx4 v228, s[44:47], s24 offen offset:0 sc1 lds
    v_mfma_f32_16x16x32_bf16 v[188:191], a[156:159], a[92:95], v[188:191]
    ds_read_b128 a[148:151], v231 offset:29696
    v_mfma_f32_16x16x32_bf16 v[184:187], a[156:159], a[84:87], v[184:187]
    s_add_u32 m0, s21, 0
    s_nop 0
    buffer_load_dwordx4 v241, s[4:7], s20 offen nt lds
    v_mfma_f32_16x16x32_bf16 v[184:187], a[152:155], a[80:83], v[184:187]
    v_mfma_f32_16x16x32_bf16 v[180:183], a[152:155], a[72:75], v[180:183]
    s_add_u32 m0, s21, 1024
    s_add_u32 s20, s20, 16384
    buffer_load_dwordx4 v241, s[4:7], s20 offen nt lds
    v_mfma_f32_16x16x32_bf16 v[180:183], a[156:159], a[76:79], v[180:183]
    buffer_load_dwordx4 a[56:59], v227, s[44:47], s25 offen offset:0 sc1
    v_mfma_f32_16x16x32_bf16 v[176:179], a[156:159], a[68:71], v[176:179]
    s_add_u32 m0, s21, 2048
    s_add_u32 s20, s20, 16384
    buffer_load_dwordx4 v241, s[4:7], s20 offen nt lds
    v_mfma_f32_16x16x32_bf16 v[176:179], a[152:155], a[64:67], v[176:179]
    ds_read_b128 a[152:155], v231 offset:30720
    s_waitcnt lgkmcnt(5)
    v_mfma_f32_16x16x32_bf16 v[192:195], a[128:131], a[64:67], v[192:195]
    s_add_u32 m0, s21, 3072
    s_add_u32 s20, s20, 16384
    buffer_load_dwordx4 v241, s[4:7], s20 offen nt lds
    v_mfma_f32_16x16x32_bf16 v[192:195], a[132:135], a[68:71], v[192:195]
    ds_read_b128 a[156:159], v231 offset:31744
    v_mfma_f32_16x16x32_bf16 v[196:199], a[132:135], a[76:79], v[196:199]
    s_add_u32 m0, s21, 4096
    s_add_u32 s20, s20, 16384
    buffer_load_dwordx4 v241, s[4:7], s20 offen nt lds
    v_mfma_f32_16x16x32_bf16 v[196:199], a[128:131], a[72:75], v[196:199]
    v_mfma_f32_16x16x32_bf16 v[200:203], a[128:131], a[80:83], v[200:203]
    s_add_u32 m0, s21, 5120
    s_add_u32 s20, s20, 16384
    buffer_load_dwordx4 v241, s[4:7], s20 offen nt lds
    v_mfma_f32_16x16x32_bf16 v[200:203], a[132:135], a[84:87], v[200:203]
    v_mfma_f32_16x16x32_bf16 v[204:207], a[132:135], a[92:95], v[204:207]
    s_add_u32 m0, s21, 6144
    s_add_u32 s20, s20, 16384
    buffer_load_dwordx4 v241, s[4:7], s20 offen nt lds
    v_mfma_f32_16x16x32_bf16 v[204:207], a[128:131], a[88:91], v[204:207]
    ds_read_b128 a[128:131], v231 offset:32768
    s_waitcnt lgkmcnt(5)
    v_mfma_f32_16x16x32_bf16 v[220:223], a[136:139], a[88:91], v[220:223]
    s_add_u32 m0, s21, 7168
    s_add_u32 s20, s20, 16384
    buffer_load_dwordx4 v241, s[4:7], s20 offen nt lds
    s_add_u32 m0, s26, 28672
    s_nop 0
    buffer_load_dwordx4 v228, s[44:47], s24 offen offset:1024 sc1 lds
    v_mfma_f32_16x16x32_bf16 v[220:223], a[140:143], a[92:95], v[220:223]
    ds_read_b128 a[132:135], v231 offset:33792
    v_mfma_f32_16x16x32_bf16 v[216:219], a[140:143], a[84:87], v[216:219]
    v_mfma_f32_16x16x32_bf16 v[216:219], a[136:139], a[80:83], v[216:219]
    v_mfma_f32_16x16x32_bf16 v[212:215], a[136:139], a[72:75], v[212:215]
    buffer_load_dwordx4 a[60:63], v227, s[44:47], s25 offen offset:1024 sc1
    v_mfma_f32_16x16x32_bf16 v[212:215], a[140:143], a[76:79], v[212:215]
    v_mfma_f32_16x16x32_bf16 v[208:211], a[140:143], a[68:71], v[208:211]
    v_mfma_f32_16x16x32_bf16 v[208:211], a[136:139], a[64:67], v[208:211]
    ds_read_b128 a[136:139], v231 offset:34816
    ds_read_b128 a[140:143], v231 offset:35840
    s_waitcnt lgkmcnt(6)
    v_mfma_f32_16x16x32_bf16 v[0:3], a[144:147], a[96:99], v[0:3]
    v_mfma_f32_16x16x32_bf16 v[0:3], a[148:151], a[100:103], v[0:3]
    v_mfma_f32_16x16x32_bf16 v[4:7], a[148:151], a[108:111], v[4:7]
    v_mfma_f32_16x16x32_bf16 v[4:7], a[144:147], a[104:107], v[4:7]
    v_mfma_f32_16x16x32_bf16 v[8:11], a[144:147], a[112:115], v[8:11]
    s_add_u32 m0, s26, 28672
    s_nop 0
    buffer_load_dwordx4 v228, s[44:47], s24 offen offset:2048 sc1 lds
    v_mfma_f32_16x16x32_bf16 v[8:11], a[148:151], a[116:119], v[8:11]
    v_mfma_f32_16x16x32_bf16 v[12:15], a[148:151], a[124:127], v[12:15]
    v_mfma_f32_16x16x32_bf16 v[12:15], a[144:147], a[120:123], v[12:15]
    ds_read_b128 a[144:147], v231 offset:36864
    s_waitcnt lgkmcnt(5)
    v_mfma_f32_16x16x32_bf16 v[28:31], a[152:155], a[120:123], v[28:31]
    s_add_u32 s25, s25, 2048
    buffer_load_dwordx4 a[64:67], v224, s[44:47], s25 offen offset:0 sc1
    v_mfma_f32_16x16x32_bf16 v[28:31], a[156:159], a[124:127], v[28:31]
    ds_read_b128 a[148:151], v231 offset:37888
    v_mfma_f32_16x16x32_bf16 v[24:27], a[156:159], a[116:119], v[24:27]
    v_mfma_f32_16x16x32_bf16 v[24:27], a[152:155], a[112:115], v[24:27]
    v_mfma_f32_16x16x32_bf16 v[20:23], a[152:155], a[104:107], v[20:23]
    v_mfma_f32_16x16x32_bf16 v[20:23], a[156:159], a[108:111], v[20:23]
    v_mfma_f32_16x16x32_bf16 v[16:19], a[156:159], a[100:103], v[16:19]
    v_mfma_f32_16x16x32_bf16 v[16:19], a[152:155], a[96:99], v[16:19]
    ds_read_b128 a[152:155], v231 offset:38912
    s_waitcnt lgkmcnt(5)
    v_mfma_f32_16x16x32_bf16 v[32:35], a[128:131], a[96:99], v[32:35]
    ds_read_b128 a[156:159], v231 offset:39936
    v_mfma_f32_16x16x32_bf16 v[32:35], a[132:135], a[100:103], v[32:35]
    v_mfma_f32_16x16x32_bf16 v[36:39], a[132:135], a[108:111], v[36:39]
    s_add_u32 m0, s26, 28672
    s_nop 0
    buffer_load_dwordx4 v228, s[44:47], s24 offen offset:3072 sc1 lds
    v_mfma_f32_16x16x32_bf16 v[36:39], a[128:131], a[104:107], v[36:39]
    v_mfma_f32_16x16x32_bf16 v[40:43], a[128:131], a[112:115], v[40:43]
    v_mfma_f32_16x16x32_bf16 v[40:43], a[132:135], a[116:119], v[40:43]
    v_mfma_f32_16x16x32_bf16 v[44:47], a[132:135], a[124:127], v[44:47]
    buffer_load_dwordx4 a[68:71], v224, s[44:47], s25 offen offset:1024 sc1
    v_mfma_f32_16x16x32_bf16 v[44:47], a[128:131], a[120:123], v[44:47]
    ds_read_b128 a[128:131], v231 offset:40960
    s_waitcnt lgkmcnt(5)
    v_mfma_f32_16x16x32_bf16 v[60:63], a[136:139], a[120:123], v[60:63]
    ds_read_b128 a[132:135], v231 offset:41984
    v_mfma_f32_16x16x32_bf16 v[60:63], a[140:143], a[124:127], v[60:63]
    v_mfma_f32_16x16x32_bf16 v[56:59], a[140:143], a[116:119], v[56:59]
    v_mfma_f32_16x16x32_bf16 v[56:59], a[136:139], a[112:115], v[56:59]
    v_mfma_f32_16x16x32_bf16 v[52:55], a[136:139], a[104:107], v[52:55]
    v_mfma_f32_16x16x32_bf16 v[52:55], a[140:143], a[108:111], v[52:55]
    v_mfma_f32_16x16x32_bf16 v[48:51], a[140:143], a[100:103], v[48:51]
    v_mfma_f32_16x16x32_bf16 v[48:51], a[136:139], a[96:99], v[48:51]
    ds_read_b128 a[136:139], v231 offset:43008
    s_waitcnt lgkmcnt(5)
    v_mfma_f32_16x16x32_bf16 v[64:67], a[144:147], a[96:99], v[64:67]
    ds_read_b128 a[140:143], v231 offset:44032
    v_mfma_f32_16x16x32_bf16 v[64:67], a[148:151], a[100:103], v[64:67]
    s_add_u32 m0, s26, 32768
    s_nop 0
    buffer_load_dwordx4 v229, s[44:47], s24 offen offset:0 sc1 lds
    v_mfma_f32_16x16x32_bf16 v[68:71], a[148:151], a[108:111], v[68:71]
    v_mfma_f32_16x16x32_bf16 v[68:71], a[144:147], a[104:107], v[68:71]
    v_mfma_f32_16x16x32_bf16 v[72:75], a[144:147], a[112:115], v[72:75]
    v_mfma_f32_16x16x32_bf16 v[72:75], a[148:151], a[116:119], v[72:75]
    buffer_load_dwordx4 a[72:75], v225, s[44:47], s25 offen offset:0 sc1
    v_mfma_f32_16x16x32_bf16 v[76:79], a[148:151], a[124:127], v[76:79]
    v_mfma_f32_16x16x32_bf16 v[76:79], a[144:147], a[120:123], v[76:79]
    ds_read_b128 a[144:147], v231 offset:45056
    s_waitcnt lgkmcnt(5)
    v_mfma_f32_16x16x32_bf16 v[92:95], a[152:155], a[120:123], v[92:95]
    ds_read_b128 a[148:151], v231 offset:46080
    v_mfma_f32_16x16x32_bf16 v[92:95], a[156:159], a[124:127], v[92:95]
    v_mfma_f32_16x16x32_bf16 v[88:91], a[156:159], a[116:119], v[88:91]
    v_mfma_f32_16x16x32_bf16 v[88:91], a[152:155], a[112:115], v[88:91]
    v_mfma_f32_16x16x32_bf16 v[84:87], a[152:155], a[104:107], v[84:87]
    v_mfma_f32_16x16x32_bf16 v[84:87], a[156:159], a[108:111], v[84:87]
    v_mfma_f32_16x16x32_bf16 v[80:83], a[156:159], a[100:103], v[80:83]
    v_mfma_f32_16x16x32_bf16 v[80:83], a[152:155], a[96:99], v[80:83]
    ds_read_b128 a[152:155], v231 offset:47104
    s_waitcnt lgkmcnt(5)
    v_mfma_f32_16x16x32_bf16 v[96:99], a[128:131], a[96:99], v[96:99]
    s_add_u32 m0, s26, 32768
    s_nop 0
    buffer_load_dwordx4 v229, s[44:47], s24 offen offset:1024 sc1 lds
    v_mfma_f32_16x16x32_bf16 v[96:99], a[132:135], a[100:103], v[96:99]
    ds_read_b128 a[156:159], v231 offset:48128
    v_mfma_f32_16x16x32_bf16 v[100:103], a[132:135], a[108:111], v[100:103]
    v_mfma_f32_16x16x32_bf16 v[100:103], a[128:131], a[104:107], v[100:103]
    v_mfma_f32_16x16x32_bf16 v[104:107], a[128:131], a[112:115], v[104:107]
    buffer_load_dwordx4 a[76:79], v225, s[44:47], s25 offen offset:1024 sc1
    v_mfma_f32_16x16x32_bf16 v[104:107], a[132:135], a[116:119], v[104:107]
    v_mfma_f32_16x16x32_bf16 v[108:111], a[132:135], a[124:127], v[108:111]
    v_mfma_f32_16x16x32_bf16 v[108:111], a[128:131], a[120:123], v[108:111]
    ds_read_b128 a[128:131], v231 offset:49152
    s_waitcnt lgkmcnt(5)
    v_mfma_f32_16x16x32_bf16 v[124:127], a[136:139], a[120:123], v[124:127]
    ds_read_b128 a[132:135], v231 offset:50176
    v_mfma_f32_16x16x32_bf16 v[124:127], a[140:143], a[124:127], v[124:127]
    v_mfma_f32_16x16x32_bf16 v[120:123], a[140:143], a[116:119], v[120:123]
    v_mfma_f32_16x16x32_bf16 v[120:123], a[136:139], a[112:115], v[120:123]
    v_mfma_f32_16x16x32_bf16 v[116:119], a[136:139], a[104:107], v[116:119]
    v_mfma_f32_16x16x32_bf16 v[116:119], a[140:143], a[108:111], v[116:119]
    s_add_u32 m0, s26, 32768
    s_nop 0
    buffer_load_dwordx4 v229, s[44:47], s24 offen offset:2048 sc1 lds
    v_mfma_f32_16x16x32_bf16 v[112:115], a[140:143], a[100:103], v[112:115]
    v_mfma_f32_16x16x32_bf16 v[112:115], a[136:139], a[96:99], v[112:115]
    ds_read_b128 a[136:139], v231 offset:51200
    s_waitcnt lgkmcnt(5)
    v_mfma_f32_16x16x32_bf16 v[128:131], a[144:147], a[96:99], v[128:131]
    ds_read_b128 a[140:143], v231 offset:52224
    v_mfma_f32_16x16x32_bf16 v[128:131], a[148:151], a[100:103], v[128:131]
    buffer_load_dwordx4 a[80:83], v226, s[44:47], s25 offen offset:0 sc1
    v_mfma_f32_16x16x32_bf16 v[132:135], a[148:151], a[108:111], v[132:135]
    v_mfma_f32_16x16x32_bf16 v[132:135], a[144:147], a[104:107], v[132:135]
    v_mfma_f32_16x16x32_bf16 v[136:139], a[144:147], a[112:115], v[136:139]
    v_mfma_f32_16x16x32_bf16 v[136:139], a[148:151], a[116:119], v[136:139]
    v_mfma_f32_16x16x32_bf16 v[140:143], a[148:151], a[124:127], v[140:143]
    v_mfma_f32_16x16x32_bf16 v[140:143], a[144:147], a[120:123], v[140:143]
    ds_read_b128 a[144:147], v231 offset:53248
    s_waitcnt lgkmcnt(5)
    v_mfma_f32_16x16x32_bf16 v[156:159], a[152:155], a[120:123], v[156:159]
    ds_read_b128 a[148:151], v231 offset:54272
    v_mfma_f32_16x16x32_bf16 v[156:159], a[156:159], a[124:127], v[156:159]
    v_mfma_f32_16x16x32_bf16 v[152:155], a[156:159], a[116:119], v[152:155]
    v_mfma_f32_16x16x32_bf16 v[152:155], a[152:155], a[112:115], v[152:155]
    v_mfma_f32_16x16x32_bf16 v[148:151], a[152:155], a[104:107], v[148:151]
    v_mfma_f32_16x16x32_bf16 v[148:151], a[156:159], a[108:111], v[148:151]
    buffer_load_dwordx4 a[84:87], v226, s[44:47], s25 offen offset:1024 sc1
    v_mfma_f32_16x16x32_bf16 v[144:147], a[156:159], a[100:103], v[144:147]
    v_mfma_f32_16x16x32_bf16 v[144:147], a[152:155], a[96:99], v[144:147]
    ds_read_b128 a[152:155], v231 offset:55296
    s_waitcnt lgkmcnt(5)
    v_mfma_f32_16x16x32_bf16 v[160:163], a[128:131], a[96:99], v[160:163]
    ds_read_b128 a[156:159], v231 offset:56320
    v_mfma_f32_16x16x32_bf16 v[160:163], a[132:135], a[100:103], v[160:163]
    v_mfma_f32_16x16x32_bf16 v[164:167], a[132:135], a[108:111], v[164:167]
    v_mfma_f32_16x16x32_bf16 v[164:167], a[128:131], a[104:107], v[164:167]
    v_mfma_f32_16x16x32_bf16 v[168:171], a[128:131], a[112:115], v[168:171]
    v_mfma_f32_16x16x32_bf16 v[168:171], a[132:135], a[116:119], v[168:171]
    v_mfma_f32_16x16x32_bf16 v[172:175], a[132:135], a[124:127], v[172:175]
    s_waitcnt vmcnt(25)
    s_barrier
    v_mfma_f32_16x16x32_bf16 v[172:175], a[128:131], a[120:123], v[172:175]
    ds_read_b128 a[128:131], v230 offset:0
    s_waitcnt lgkmcnt(5)
    v_mfma_f32_16x16x32_bf16 v[188:191], a[136:139], a[120:123], v[188:191]
    s_add_u32 m0, s26, 57344
    s_add_u32 s24, s24, 28672
    buffer_load_dwordx4 v228, s[44:47], s24 offen offset:0 sc1 lds
    v_mfma_f32_16x16x32_bf16 v[188:191], a[140:143], a[124:127], v[188:191]
    ds_read_b128 a[132:135], v230 offset:1024
    v_mfma_f32_16x16x32_bf16 v[184:187], a[140:143], a[116:119], v[184:187]
    v_mfma_f32_16x16x32_bf16 v[184:187], a[136:139], a[112:115], v[184:187]
    v_mfma_f32_16x16x32_bf16 v[180:183], a[136:139], a[104:107], v[180:183]
    buffer_load_dwordx4 a[88:91], v227, s[44:47], s25 offen offset:0 sc1
    v_mfma_f32_16x16x32_bf16 v[180:183], a[140:143], a[108:111], v[180:183]
    v_mfma_f32_16x16x32_bf16 v[176:179], a[140:143], a[100:103], v[176:179]
    v_mfma_f32_16x16x32_bf16 v[176:179], a[136:139], a[96:99], v[176:179]
    ds_read_b128 a[136:139], v230 offset:2048
    s_waitcnt lgkmcnt(5)
    v_mfma_f32_16x16x32_bf16 v[192:195], a[144:147], a[96:99], v[192:195]
    ds_read_b128 a[140:143], v230 offset:3072
    v_mfma_f32_16x16x32_bf16 v[192:195], a[148:151], a[100:103], v[192:195]
    v_mfma_f32_16x16x32_bf16 v[196:199], a[148:151], a[108:111], v[196:199]
    v_mfma_f32_16x16x32_bf16 v[196:199], a[144:147], a[104:107], v[196:199]
    v_mfma_f32_16x16x32_bf16 v[200:203], a[144:147], a[112:115], v[200:203]
    v_mfma_f32_16x16x32_bf16 v[200:203], a[148:151], a[116:119], v[200:203]
    v_mfma_f32_16x16x32_bf16 v[204:207], a[148:151], a[124:127], v[204:207]
    s_add_u32 m0, s26, 57344
    s_nop 0
    buffer_load_dwordx4 v228, s[44:47], s24 offen offset:1024 sc1 lds
    v_mfma_f32_16x16x32_bf16 v[204:207], a[144:147], a[120:123], v[204:207]
    ds_read_b128 a[144:147], v230 offset:4096
    s_waitcnt lgkmcnt(5)
    v_mfma_f32_16x16x32_bf16 v[220:223], a[152:155], a[120:123], v[220:223]
    ds_read_b128 a[148:151], v230 offset:5120
    v_mfma_f32_16x16x32_bf16 v[220:223], a[156:159], a[124:127], v[220:223]
    v_mfma_f32_16x16x32_bf16 v[216:219], a[156:159], a[116:119], v[216:219]
    buffer_load_dwordx4 a[92:95], v227, s[44:47], s25 offen offset:1024 sc1
    v_mfma_f32_16x16x32_bf16 v[216:219], a[152:155], a[112:115], v[216:219]
    v_mfma_f32_16x16x32_bf16 v[212:215], a[152:155], a[104:107], v[212:215]
    v_mfma_f32_16x16x32_bf16 v[212:215], a[156:159], a[108:111], v[212:215]
    v_mfma_f32_16x16x32_bf16 v[208:211], a[156:159], a[100:103], v[208:211]
    v_mfma_f32_16x16x32_bf16 v[208:211], a[152:155], a[96:99], v[208:211]
    ds_read_b128 a[152:155], v230 offset:6144
    ds_read_b128 a[156:159], v230 offset:7168
    s_mov_b32 s27, 2
L_u0:
    s_waitcnt vmcnt(30) lgkmcnt(6)
    v_mfma_f32_16x16x32_bf16 v[0:3], a[128:131], a[0:3], v[0:3]
    v_mfma_f32_16x16x32_bf16 v[0:3], a[132:135], a[4:7], v[0:3]
    v_mfma_f32_16x16x32_bf16 v[4:7], a[132:135], a[12:15], v[4:7]
    v_mfma_f32_16x16x32_bf16 v[4:7], a[128:131], a[8:11], v[4:7]
    v_mfma_f32_16x16x32_bf16 v[8:11], a[128:131], a[16:19], v[8:11]
    s_add_u32 m0, s26, 57344
    s_nop 0
    buffer_load_dwordx4 v228, s[44:47], s24 offen offset:2048 sc1 lds
    v_mfma_f32_16x16x32_bf16 v[8:11], a[132:135], a[20:23], v[8:11]
    v_mfma_f32_16x16x32_bf16 v[12:15], a[132:135], a[28:31], v[12:15]
    v_mfma_f32_16x16x32_bf16 v[12:15], a[128:131], a[24:27], v[12:15]
    ds_read_b128 a[128:131], v230 offset:8192
    s_waitcnt lgkmcnt(5)
    v_mfma_f32_16x16x32_bf16 v[28:31], a[136:139], a[24:27], v[28:31]
    s_add_u32 s25, s25, 2048
    buffer_load_dwordx4 a[96:99], v224, s[44:47], s25 offen offset:0 sc1
    v_mfma_f32_16x16x32_bf16 v[28:31], a[140:143], a[28:31], v[28:31]
    ds_read_b128 a[132:135], v230 offset:9216
    v_mfma_f32_16x16x32_bf16 v[24:27], a[140:143], a[20:23], v[24:27]
    v_mfma_f32_16x16x32_bf16 v[24:27], a[136:139], a[16:19], v[24:27]
    v_mfma_f32_16x16x32_bf16 v[20:23], a[136:139], a[8:11], v[20:23]
    v_mfma_f32_16x16x32_bf16 v[20:23], a[140:143], a[12:15], v[20:23]
    v_mfma_f32_16x16x32_bf16 v[16:19], a[140:143], a[4:7], v[16:19]
    v_mfma_f32_16x16x32_bf16 v[16:19], a[136:139], a[0:3], v[16:19]
    ds_read_b128 a[136:139], v230 offset:10240
    s_waitcnt lgkmcnt(5)
    v_mfma_f32_16x16x32_bf16 v[32:35], a[144:147], a[0:3], v[32:35]
    ds_read_b128 a[140:143], v230 offset:11264
    v_mfma_f32_16x16x32_bf16 v[32:35], a[148:151], a[4:7], v[32:35]
    v_mfma_f32_16x16x32_bf16 v[36:39], a[148:151], a[12:15], v[36:39]
    s_add_u32 m0, s26, 57344
    s_nop 0
    buffer_load_dwordx4 v228, s[44:47], s24 offen offset:3072 sc1 lds
    v_mfma_f32_16x16x32_bf16 v[36:39], a[144:147], a[8:11], v[36:39]
    v_mfma_f32_16x16x32_bf16 v[40:43], a[144:147], a[16:19], v[40:43]
    v_mfma_f32_16x16x32_bf16 v[40:43], a[148:151], a[20:23], v[40:43]
    buffer_load_dwordx4 a[100:103], v224, s[44:47], s25 offen offset:1024 sc1
    v_mfma_f32_16x16x32_bf16 v[44:47], a[148:151], a[28:31], v[44:47]
    v_mfma_f32_16x16x32_bf16 v[44:47], a[144:147], a[24:27], v[44:47]
    ds_read_b128 a[144:147], v230 offset:12288
    s_waitcnt lgkmcnt(5)
    v_mfma_f32_16x16x32_bf16 v[60:63], a[152:155], a[24:27], v[60:63]
    ds_read_b128 a[148:151], v230 offset:13312
    v_mfma_f32_16x16x32_bf16 v[60:63], a[156:159], a[28:31], v[60:63]
    v_mfma_f32_16x16x32_bf16 v[56:59], a[156:159], a[20:23], v[56:59]
    v_mfma_f32_16x16x32_bf16 v[56:59], a[152:155], a[16:19], v[56:59]
    v_mfma_f32_16x16x32_bf16 v[52:55], a[152:155], a[8:11], v[52:55]
    v_mfma_f32_16x16x32_bf16 v[52:55], a[156:159], a[12:15], v[52:55]
    v_mfma_f32_16x16x32_bf16 v[48:51], a[156:159], a[4:7], v[48:51]
    v_mfma_f32_16x16x32_bf16 v[48:51], a[152:155], a[0:3], v[48:51]
    ds_read_b128 a[152:155], v230 offset:14336
    s_waitcnt lgkmcnt(5)
    v_mfma_f32_16x16x32_bf16 v[64:67], a[128:131], a[0:3], v[64:67]
    ds_read_b128 a[156:159], v230 offset:15360
    v_mfma_f32_16x16x32_bf16 v[64:67], a[132:135], a[4:7], v[64:67]
    s_add_u32 m0, s26, 61440
    s_nop 0
    buffer_load_dwordx4 v229, s[44:47], s24 offen offset:0 sc1 lds
    v_mfma_f32_16x16x32_bf16 v[68:71], a[132:135], a[12:15], v[68:71]
    v_mfma_f32_16x16x32_bf16 v[68:71], a[128:131], a[8:11], v[68:71]
    buffer_load_dwordx4 a[104:107], v225, s[44:47], s25 offen offset:0 sc1
    v_mfma_f32_16x16x32_bf16 v[72:75], a[128:131], a[16:19], v[72:75]
    v_mfma_f32_16x16x32_bf16 v[72:75], a[132:135], a[20:23], v[72:75]
    v_mfma_f32_16x16x32_bf16 v[76:79], a[132:135], a[28:31], v[76:79]
    v_mfma_f32_16x16x32_bf16 v[76:79], a[128:131], a[24:27], v[76:79]
    ds_read_b128 a[128:131], v230 offset:16384
    s_waitcnt lgkmcnt(5)
    v_mfma_f32_16x16x32_bf16 v[92:95], a[136:139], a[24:27], v[92:95]
    ds_read_b128 a[132:135], v230 offset:17408
    v_mfma_f32_16x16x32_bf16 v[92:95], a[140:143], a[28:31], v[92:95]
    v_mfma_f32_16x16x32_bf16 v[88:91], a[140:143], a[20:23], v[88:91]
    v_mfma_f32_16x16x32_bf16 v[88:91], a[136:139], a[16:19], v[88:91]
    v_mfma_f32_16x16x32_bf16 v[84:87], a[136:139], a[8:11], v[84:87]
    v_mfma_f32_16x16x32_bf16 v[84:87], a[140:143], a[12:15], v[84:87]
    v_mfma_f32_16x16x32_bf16 v[80:83], a[140:143], a[4:7], v[80:83]
    v_mfma_f32_16x16x32_bf16 v[80:83], a[136:139], a[0:3], v[80:83]
    ds_read_b128 a[136:139], v230 offset:18432
    s_waitcnt lgkmcnt(5)
    v_mfma_f32_16x16x32_bf16 v[96:99], a[144:147], a[0:3], v[96:99]
    s_add_u32 m0, s26, 61440
    s_nop 0
    buffer_load_dwordx4 v229, s[44:47], s24 offen offset:1024 sc1 lds
    v_mfma_f32_16x16x32_bf16 v[96:99], a[148:151], a[4:7], v[96:99]
    buffer_load_dwordx4 a[108:111], v225, s[44:47], s25 offen offset:1024 sc1
    v_mfma_f32_16x16x32_bf16 v[100:103], a[148:151], a[12:15], v[100:103]
    ds_read_b128 a[140:143], v230 offset:19456
    v_mfma_f32_16x16x32_bf16 v[100:103], a[144:147], a[8:11], v[100:103]
    v_mfma_f32_16x16x32_bf16 v[104:107], a[144:147], a[16:19], v[104:107]
    v_mfma_f32_16x16x32_bf16 v[104:107], a[148:151], a[20:23], v[104:107]
    v_mfma_f32_16x16x32_bf16 v[108:111], a[148:151], a[28:31], v[108:111]
    v_mfma_f32_16x16x32_bf16 v[108:111], a[144:147], a[24:27], v[108:111]
    ds_read_b128 a[144:147], v230 offset:20480
    s_waitcnt lgkmcnt(5)
    v_mfma_f32_16x16x32_bf16 v[124:127], a[152:155], a[24:27], v[124:127]
    ds_read_b128 a[148:151], v230 offset:21504
    v_mfma_f32_16x16x32_bf16 v[124:127], a[156:159], a[28:31], v[124:127]
    v_mfma_f32_16x16x32_bf16 v[120:123], a[156:159], a[20:23], v[120:123]
    v_mfma_f32_16x16x32_bf16 v[120:123], a[152:155], a[16:19], v[120:123]
    v_mfma_f32_16x16x32_bf16 v[116:119], a[152:155], a[8:11], v[116:119]
    v_mfma_f32_16x16x32_bf16 v[116:119], a[156:159], a[12:15], v[116:119]
    s_add_u32 m0, s26, 61440
    s_nop 0
    buffer_load_dwordx4 v229, s[44:47], s24 offen offset:2048 sc1 lds
    v_mfma_f32_16x16x32_bf16 v[112:115], a[156:159], a[4:7], v[112:115]
    v_mfma_f32_16x16x32_bf16 v[112:115], a[152:155], a[0:3], v[112:115]
    ds_read_b128 a[152:155], v230 offset:22528
    s_waitcnt lgkmcnt(5)
    v_mfma_f32_16x16x32_bf16 v[128:131], a[128:131], a[0:3], v[128:131]
    buffer_load_dwordx4 a[112:115], v226, s[44:47], s25 offen offset:0 sc1
    v_mfma_f32_16x16x32_bf16 v[128:131], a[132:135], a[4:7], v[128:131]
    ds_read_b128 a[156:159], v230 offset:23552
    v_mfma_f32_16x16x32_bf16 v[132:135], a[132:135], a[12:15], v[132:135]
    v_mfma_f32_16x16x32_bf16 v[132:135], a[128:131], a[8:11], v[132:135]
    v_mfma_f32_16x16x32_bf16 v[136:139], a[128:131], a[16:19], v[136:139]
    v_mfma_f32_16x16x32_bf16 v[136:139], a[132:135], a[20:23], v[136:139]
    v_mfma_f32_16x16x32_bf16 v[140:143], a[132:135], a[28:31], v[140:143]
    v_mfma_f32_16x16x32_bf16 v[140:143], a[128:131], a[24:27], v[140:143]
    ds_read_b128 a[128:131], v230 offset:24576
    s_waitcnt lgkmcnt(5)
    v_mfma_f32_16x16x32_bf16 v[156:159], a[136:139], a[24:27], v[156:159]
    ds_read_b128 a[132:135], v230 offset:25600
    v_mfma_f32_16x16x32_bf16 v[156:159], a[140:143], a[28:31], v[156:159]
    v_mfma_f32_16x16x32_bf16 v[152:155], a[140:143], a[20:23], v[152:155]
    v_mfma_f32_16x16x32_bf16 v[152:155], a[136:139], a[16:19], v[152:155]
    v_mfma_f32_16x16x32_bf16 v[148:151], a[136:139], a[8:11], v[148:151]
    v_mfma_f32_16x16x32_bf16 v[148:151], a[140:143], a[12:15], v[148:151]
    buffer_load_dwordx4 a[116:119], v226, s[44:47], s25 offen offset:1024 sc1
    v_mfma_f32_16x16x32_bf16 v[144:147], a[140:143], a[4:7], v[144:147]
    v_mfma_f32_16x16x32_bf16 v[144:147], a[136:139], a[0:3], v[144:147]
    ds_read_b128 a[136:139], v230 offset:26624
    s_waitcnt lgkmcnt(5)
    v_mfma_f32_16x16x32_bf16 v[160:163], a[144:147], a[0:3], v[160:163]
    ds_read_b128 a[140:143], v230 offset:27648
    v_mfma_f32_16x16x32_bf16 v[160:163], a[148:151], a[4:7], v[160:163]
    v_mfma_f32_16x16x32_bf16 v[164:167], a[148:151], a[12:15], v[164:167]
    v_mfma_f32_16x16x32_bf16 v[164:167], a[144:147], a[8:11], v[164:167]
    v_mfma_f32_16x16x32_bf16 v[168:171], a[144:147], a[16:19], v[168:171]
    v_mfma_f32_16x16x32_bf16 v[168:171], a[148:151], a[20:23], v[168:171]
    v_mfma_f32_16x16x32_bf16 v[172:175], a[148:151], a[28:31], v[172:175]
    s_waitcnt vmcnt(17)
    s_barrier
    v_mfma_f32_16x16x32_bf16 v[172:175], a[144:147], a[24:27], v[172:175]
    ds_read_b128 a[144:147], v230 offset:28672
    s_waitcnt lgkmcnt(5)
    v_mfma_f32_16x16x32_bf16 v[188:191], a[152:155], a[24:27], v[188:191]
    s_add_u32 m0, s26, 86016
    s_add_u32 s24, s24, 28672
    buffer_load_dwordx4 v228, s[44:47], s24 offen offset:0 sc1 lds
    v_mfma_f32_16x16x32_bf16 v[188:191], a[156:159], a[28:31], v[188:191]
    ds_read_b128 a[148:151], v230 offset:29696
    v_mfma_f32_16x16x32_bf16 v[184:187], a[156:159], a[20:23], v[184:187]
    v_mfma_f32_16x16x32_bf16 v[184:187], a[152:155], a[16:19], v[184:187]
    buffer_load_dwordx4 a[120:123], v227, s[44:47], s25 offen offset:0 sc1
    v_mfma_f32_16x16x32_bf16 v[180:183], a[152:155], a[8:11], v[180:183]
    v_mfma_f32_16x16x32_bf16 v[180:183], a[156:159], a[12:15], v[180:183]
    v_mfma_f32_16x16x32_bf16 v[176:179], a[156:159], a[4:7], v[176:179]
    v_mfma_f32_16x16x32_bf16 v[176:179], a[152:155], a[0:3], v[176:179]
    ds_read_b128 a[152:155], v230 offset:30720
    s_waitcnt lgkmcnt(5)
    v_mfma_f32_16x16x32_bf16 v[192:195], a[128:131], a[0:3], v[192:195]
    ds_read_b128 a[156:159], v230 offset:31744
    v_mfma_f32_16x16x32_bf16 v[192:195], a[132:135], a[4:7], v[192:195]
    v_mfma_f32_16x16x32_bf16 v[196:199], a[132:135], a[12:15], v[196:199]
    v_mfma_f32_16x16x32_bf16 v[196:199], a[128:131], a[8:11], v[196:199]
    v_mfma_f32_16x16x32_bf16 v[200:203], a[128:131], a[16:19], v[200:203]
    v_mfma_f32_16x16x32_bf16 v[200:203], a[132:135], a[20:23], v[200:203]
    v_mfma_f32_16x16x32_bf16 v[204:207], a[132:135], a[28:31], v[204:207]
    s_add_u32 m0, s26, 86016
    s_nop 0
    buffer_load_dwordx4 v228, s[44:47], s24 offen offset:1024 sc1 lds
    v_mfma_f32_16x16x32_bf16 v[204:207], a[128:131], a[24:27], v[204:207]
    ds_read_b128 a[128:131], v230 offset:32768
    s_waitcnt lgkmcnt(5)
    v_mfma_f32_16x16x32_bf16 v[220:223], a[136:139], a[24:27], v[220:223]
    ds_read_b128 a[132:135], v230 offset:33792
    v_mfma_f32_16x16x32_bf16 v[220:223], a[140:143], a[28:31], v[220:223]
    buffer_load_dwordx4 a[124:127], v227, s[44:47], s25 offen offset:1024 sc1
    v_mfma_f32_16x16x32_bf16 v[216:219], a[140:143], a[20:23], v[216:219]
    v_mfma_f32_16x16x32_bf16 v[216:219], a[136:139], a[16:19], v[216:219]
    v_mfma_f32_16x16x32_bf16 v[212:215], a[136:139], a[8:11], v[212:215]
    v_mfma_f32_16x16x32_bf16 v[212:215], a[140:143], a[12:15], v[212:215]
    v_mfma_f32_16x16x32_bf16 v[208:211], a[140:143], a[4:7], v[208:211]
    v_mfma_f32_16x16x32_bf16 v[208:211], a[136:139], a[0:3], v[208:211]
    ds_read_b128 a[136:139], v230 offset:34816
    ds_read_b128 a[140:143], v230 offset:35840
    s_waitcnt lgkmcnt(6)
    v_mfma_f32_16x16x32_bf16 v[0:3], a[144:147], a[32:35], v[0:3]
    v_mfma_f32_16x16x32_bf16 v[0:3], a[148:151], a[36:39], v[0:3]
    v_mfma_f32_16x16x32_bf16 v[4:7], a[148:151], a[44:47], v[4:7]
    v_mfma_f32_16x16x32_bf16 v[4:7], a[144:147], a[40:43], v[4:7]
    v_mfma_f32_16x16x32_bf16 v[8:11], a[144:147], a[48:51], v[8:11]
    s_add_u32 m0, s26, 86016
    s_nop 0
    buffer_load_dwordx4 v228, s[44:47], s24 offen offset:2048 sc1 lds
    v_mfma_f32_16x16x32_bf16 v[8:11], a[148:151], a[52:55], v[8:11]
    v_mfma_f32_16x16x32_bf16 v[12:15], a[148:151], a[60:63], v[12:15]
    v_mfma_f32_16x16x32_bf16 v[12:15], a[144:147], a[56:59], v[12:15]
    ds_read_b128 a[144:147], v230 offset:36864
    s_waitcnt lgkmcnt(5)
    v_mfma_f32_16x16x32_bf16 v[28:31], a[152:155], a[56:59], v[28:31]
    s_add_u32 s25, s25, 2048
    buffer_load_dwordx4 a[0:3], v224, s[44:47], s25 offen offset:0 sc1
    v_mfma_f32_16x16x32_bf16 v[28:31], a[156:159], a[60:63], v[28:31]
    ds_read_b128 a[148:151], v230 offset:37888
    v_mfma_f32_16x16x32_bf16 v[24:27], a[156:159], a[52:55], v[24:27]
    v_mfma_f32_16x16x32_bf16 v[24:27], a[152:155], a[48:51], v[24:27]
    v_mfma_f32_16x16x32_bf16 v[20:23], a[152:155], a[40:43], v[20:23]
    v_mfma_f32_16x16x32_bf16 v[20:23], a[156:159], a[44:47], v[20:23]
    v_mfma_f32_16x16x32_bf16 v[16:19], a[156:159], a[36:39], v[16:19]
    v_mfma_f32_16x16x32_bf16 v[16:19], a[152:155], a[32:35], v[16:19]
    ds_read_b128 a[152:155], v230 offset:38912
    s_waitcnt lgkmcnt(5)
    v_mfma_f32_16x16x32_bf16 v[32:35], a[128:131], a[32:35], v[32:35]
    ds_read_b128 a[156:159], v230 offset:39936
    v_mfma_f32_16x16x32_bf16 v[32:35], a[132:135], a[36:39], v[32:35]
    v_mfma_f32_16x16x32_bf16 v[36:39], a[132:135], a[44:47], v[36:39]
    s_add_u32 m0, s26, 86016
    s_nop 0
    buffer_load_dwordx4 v228, s[44:47], s24 offen offset:3072 sc1 lds
    v_mfma_f32_16x16x32_bf16 v[36:39], a[128:131], a[40:43], v[36:39]
    v_mfma_f32_16x16x32_bf16 v[40:43], a[128:131], a[48:51], v[40:43]
    v_mfma_f32_16x16x32_bf16 v[40:43], a[132:135], a[52:55], v[40:43]
    buffer_load_dwordx4 a[4:7], v224, s[44:47], s25 offen offset:1024 sc1
    v_mfma_f32_16x16x32_bf16 v[44:47], a[132:135], a[60:63], v[44:47]
    v_mfma_f32_16x16x32_bf16 v[44:47], a[128:131], a[56:59], v[44:47]
    ds_read_b128 a[128:131], v230 offset:40960
    s_waitcnt lgkmcnt(5)
    v_mfma_f32_16x16x32_bf16 v[60:63], a[136:139], a[56:59], v[60:63]
    ds_read_b128 a[132:135], v230 offset:41984
    v_mfma_f32_16x16x32_bf16 v[60:63], a[140:143], a[60:63], v[60:63]
    v_mfma_f32_16x16x32_bf16 v[56:59], a[140:143], a[52:55], v[56:59]
    v_mfma_f32_16x16x32_bf16 v[56:59], a[136:139], a[48:51], v[56:59]
    v_mfma_f32_16x16x32_bf16 v[52:55], a[136:139], a[40:43], v[52:55]
    v_mfma_f32_16x16x32_bf16 v[52:55], a[140:143], a[44:47], v[52:55]
    v_mfma_f32_16x16x32_bf16 v[48:51], a[140:143], a[36:39], v[48:51]
    v_mfma_f32_16x16x32_bf16 v[48:51], a[136:139], a[32:35], v[48:51]
    ds_read_b128 a[136:139], v230 offset:43008
    s_waitcnt lgkmcnt(5)
    v_mfma_f32_16x16x32_bf16 v[64:67], a[144:147], a[32:35], v[64:67]
    ds_read_b128 a[140:143], v230 offset:44032
    v_mfma_f32_16x16x32_bf16 v[64:67], a[148:151], a[36:39], v[64:67]
    s_add_u32 m0, s26, 90112
    s_nop 0
    buffer_load_dwordx4 v229, s[44:47], s24 offen offset:0 sc1 lds
    v_mfma_f32_16x16x32_bf16 v[68:71], a[148:151], a[44:47], v[68:71]
    v_mfma_f32_16x16x32_bf16 v[68:71], a[144:147], a[40:43], v[68:71]
    buffer_load_dwordx4 a[8:11], v225, s[44:47], s25 offen offset:0 sc1
    v_mfma_f32_16x16x32_bf16 v[72:75], a[144:147], a[48:51], v[72:75]
    v_mfma_f32_16x16x32_bf16 v[72:75], a[148:151], a[52:55], v[72:75]
    v_mfma_f32_16x16x32_bf16 v[76:79], a[148:151], a[60:63], v[76:79]
    v_mfma_f32_16x16x32_bf16 v[76:79], a[144:147], a[56:59], v[76:79]
    ds_read_b128 a[144:147], v230 offset:45056
    s_waitcnt lgkmcnt(5)
    v_mfma_f32_16x16x32_bf16 v[92:95], a[152:155], a[56:59], v[92:95]
    ds_read_b128 a[148:151], v230 offset:46080
    v_mfma_f32_16x16x32_bf16 v[92:95], a[156:159], a[60:63], v[92:95]
    v_mfma_f32_16x16x32_bf16 v[88:91], a[156:159], a[52:55], v[88:91]
    v_mfma_f32_16x16x32_bf16 v[88:91], a[152:155], a[48:51], v[88:91]
    v_mfma_f32_16x16x32_bf16 v[84:87], a[152:155], a[40:43], v[84:87]
    v_mfma_f32_16x16x32_bf16 v[84:87], a[156:159], a[44:47], v[84:87]
    v_mfma_f32_16x16x32_bf16 v[80:83], a[156:159], a[36:39], v[80:83]
    v_mfma_f32_16x16x32_bf16 v[80:83], a[152:155], a[32:35], v[80:83]
    ds_read_b128 a[152:155], v230 offset:47104
    s_waitcnt lgkmcnt(5)
    v_mfma_f32_16x16x32_bf16 v[96:99], a[128:131], a[32:35], v[96:99]
    s_add_u32 m0, s26, 90112
    s_nop 0
    buffer_load_dwordx4 v229, s[44:47], s24 offen offset:1024 sc1 lds
    v_mfma_f32_16x16x32_bf16 v[96:99], a[132:135], a[36:39], v[96:99]
    buffer_load_dwordx4 a[12:15], v225, s[44:47], s25 offen offset:1024 sc1
    v_mfma_f32_16x16x32_bf16 v[100:103], a[132:135], a[44:47], v[100:103]
    ds_read_b128 a[156:159], v230 offset:48128
    v_mfma_f32_16x16x32_bf16 v[100:103], a[128:131], a[40:43], v[100:103]
    v_mfma_f32_16x16x32_bf16 v[104:107], a[128:131], a[48:51], v[104:107]
    v_mfma_f32_16x16x32_bf16 v[104:107], a[132:135], a[52:55], v[104:107]
    v_mfma_f32_16x16x32_bf16 v[108:111], a[132:135], a[60:63], v[108:111]
    v_mfma_f32_16x16x32_bf16 v[108:111], a[128:131], a[56:59], v[108:111]
    ds_read_b128 a[128:131], v230 offset:49152
    s_waitcnt lgkmcnt(5)
    v_mfma_f32_16x16x32_bf16 v[124:127], a[136:139], a[56:59], v[124:127]
    ds_read_b128 a[132:135], v230 offset:50176
    v_mfma_f32_16x16x32_bf16 v[124:127], a[140:143], a[60:63], v[124:127]
    v_mfma_f32_16x16x32_bf16 v[120:123], a[140:143], a[52:55], v[120:123]
    v_mfma_f32_16x16x32_bf16 v[120:123], a[136:139], a[48:51], v[120:123]
    v_mfma_f32_16x16x32_bf16 v[116:119], a[136:139], a[40:43], v[116:119]
    v_mfma_f32_16x16x32_bf16 v[116:119], a[140:143], a[44:47], v[116:119]
    s_add_u32 m0, s26, 90112
    s_nop 0
    buffer_load_dwordx4 v229, s[44:47], s24 offen offset:2048 sc1 lds
    v_mfma_f32_16x16x32_bf16 v[112:115], a[140:143], a[36:39], v[112:115]
    v_mfma_f32_16x16x32_bf16 v[112:115], a[136:139], a[32:35], v[112:115]
    ds_read_b128 a[136:139], v230 offset:51200
    s_waitcnt lgkmcnt(5)
    v_mfma_f32_16x16x32_bf16 v[128:131], a[144:147], a[32:35], v[128:131]
    buffer_load_dwordx4 a[16:19], v226, s[44:47], s25 offen offset:0 sc1
    v_mfma_f32_16x16x32_bf16 v[128:131], a[148:151], a[36:39], v[128:131]
    ds_read_b128 a[140:143], v230 offset:52224
    v_mfma_f32_16x16x32_bf16 v[132:135], a[148:151], a[44:47], v[132:135]
    v_mfma_f32_16x16x32_bf16 v[132:135], a[144:147], a[40:43], v[132:135]
    v_mfma_f32_16x16x32_bf16 v[136:139], a[144:147], a[48:51], v[136:139]
    v_mfma_f32_16x16x32_bf16 v[136:139], a[148:151], a[52:55], v[136:139]
    v_mfma_f32_16x16x32_bf16 v[140:143], a[148:151], a[60:63], v[140:143]
    v_mfma_f32_16x16x32_bf16 v[140:143], a[144:147], a[56:59], v[140:143]
    ds_read_b128 a[144:147], v230 offset:53248
    s_waitcnt lgkmcnt(5)
    v_mfma_f32_16x16x32_bf16 v[156:159], a[152:155], a[56:59], v[156:159]
    ds_read_b128 a[148:151], v230 offset:54272
    v_mfma_f32_16x16x32_bf16 v[156:159], a[156:159], a[60:63], v[156:159]
    v_mfma_f32_16x16x32_bf16 v[152:155], a[156:159], a[52:55], v[152:155]
    v_mfma_f32_16x16x32_bf16 v[152:155], a[152:155], a[48:51], v[152:155]
    v_mfma_f32_16x16x32_bf16 v[148:151], a[152:155], a[40:43], v[148:151]
    v_mfma_f32_16x16x32_bf16 v[148:151], a[156:159], a[44:47], v[148:151]
    buffer_load_dwordx4 a[20:23], v226, s[44:47], s25 offen offset:1024 sc1
    v_mfma_f32_16x16x32_bf16 v[144:147], a[156:159], a[36:39], v[144:147]
    v_mfma_f32_16x16x32_bf16 v[144:147], a[152:155], a[32:35], v[144:147]
    ds_read_b128 a[152:155], v230 offset:55296
    s_waitcnt lgkmcnt(5)
    v_mfma_f32_16x16x32_bf16 v[160:163], a[128:131], a[32:35], v[160:163]
    ds_read_b128 a[156:159], v230 offset:56320
    v_mfma_f32_16x16x32_bf16 v[160:163], a[132:135], a[36:39], v[160:163]
    v_mfma_f32_16x16x32_bf16 v[164:167], a[132:135], a[44:47], v[164:167]
    v_mfma_f32_16x16x32_bf16 v[164:167], a[128:131], a[40:43], v[164:167]
    v_mfma_f32_16x16x32_bf16 v[168:171], a[128:131], a[48:51], v[168:171]
    v_mfma_f32_16x16x32_bf16 v[168:171], a[132:135], a[52:55], v[168:171]
    v_mfma_f32_16x16x32_bf16 v[172:175], a[132:135], a[60:63], v[172:175]
    s_waitcnt vmcnt(17)
    s_barrier
    v_mfma_f32_16x16x32_bf16 v[172:175], a[128:131], a[56:59], v[172:175]
    ds_read_b128 a[128:131], v231 offset:0
    s_waitcnt lgkmcnt(5)
    v_mfma_f32_16x16x32_bf16 v[188:191], a[136:139], a[56:59], v[188:191]
    s_add_u32 m0, s26, 0
    s_add_u32 s24, s24, 28672
    buffer_load_dwordx4 v228, s[44:47], s24 offen offset:0 sc1 lds
    v_mfma_f32_16x16x32_bf16 v[188:191], a[140:143], a[60:63], v[188:191]
    ds_read_b128 a[132:135], v231 offset:1024
    v_mfma_f32_16x16x32_bf16 v[184:187], a[140:143], a[52:55], v[184:187]
    v_mfma_f32_16x16x32_bf16 v[184:187], a[136:139], a[48:51], v[184:187]
    buffer_load_dwordx4 a[24:27], v227, s[44:47], s25 offen offset:0 sc1
    v_mfma_f32_16x16x32_bf16 v[180:183], a[136:139], a[40:43], v[180:183]
    v_mfma_f32_16x16x32_bf16 v[180:183], a[140:143], a[44:47], v[180:183]
    v_mfma_f32_16x16x32_bf16 v[176:179], a[140:143], a[36:39], v[176:179]
    v_mfma_f32_16x16x32_bf16 v[176:179], a[136:139], a[32:35], v[176:179]
    ds_read_b128 a[136:139], v231 offset:2048
    s_waitcnt lgkmcnt(5)
    v_mfma_f32_16x16x32_bf16 v[192:195], a[144:147], a[32:35], v[192:195]
    ds_read_b128 a[140:143], v231 offset:3072
    v_mfma_f32_16x16x32_bf16 v[192:195], a[148:151], a[36:39], v[192:195]
    v_mfma_f32_16x16x32_bf16 v[196:199], a[148:151], a[44:47], v[196:199]
    v_mfma_f32_16x16x32_bf16 v[196:199], a[144:147], a[40:43], v[196:199]
    v_mfma_f32_16x16x32_bf16 v[200:203], a[144:147], a[48:51], v[200:203]
    v_mfma_f32_16x16x32_bf16 v[200:203], a[148:151], a[52:55], v[200:203]
    v_mfma_f32_16x16x32_bf16 v[204:207], a[148:151], a[60:63], v[204:207]
    s_add_u32 m0, s26, 0
    s_nop 0
    buffer_load_dwordx4 v228, s[44:47], s24 offen offset:1024 sc1 lds
    v_mfma_f32_16x16x32_bf16 v[204:207], a[144:147], a[56:59], v[204:207]
    ds_read_b128 a[144:147], v231 offset:4096
    s_waitcnt lgkmcnt(5)
    v_mfma_f32_16x16x32_bf16 v[220:223], a[152:155], a[56:59], v[220:223]
    ds_read_b128 a[148:151], v231 offset:5120
    v_mfma_f32_16x16x32_bf16 v[220:223], a[156:159], a[60:63], v[220:223]
    buffer_load_dwordx4 a[28:31], v227, s[44:47], s25 offen offset:1024 sc1
    v_mfma_f32_16x16x32_bf16 v[216:219], a[156:159], a[52:55], v[216:219]
    v_mfma_f32_16x16x32_bf16 v[216:219], a[152:155], a[48:51], v[216:219]
    v_mfma_f32_16x16x32_bf16 v[212:215], a[152:155], a[40:43], v[212:215]
    v_mfma_f32_16x16x32_bf16 v[212:215], a[156:159], a[44:47], v[212:215]
    v_mfma_f32_16x16x32_bf16 v[208:211], a[156:159], a[36:39], v[208:211]
    v_mfma_f32_16x16x32_bf16 v[208:211], a[152:155], a[32:35], v[208:211]
    ds_read_b128 a[152:155], v231 offset:6144
    ds_read_b128 a[156:159], v231 offset:7168
    s_waitcnt lgkmcnt(6)
    v_mfma_f32_16x16x32_bf16 v[0:3], a[128:131], a[64:67], v[0:3]
    v_mfma_f32_16x16x32_bf16 v[0:3], a[132:135], a[68:71], v[0:3]
    v_mfma_f32_16x16x32_bf16 v[4:7], a[132:135], a[76:79], v[4:7]
    v_mfma_f32_16x16x32_bf16 v[4:7], a[128:131], a[72:75], v[4:7]
    v_mfma_f32_16x16x32_bf16 v[8:11], a[128:131], a[80:83], v[8:11]
    s_add_u32 m0, s26, 0
    s_nop 0
    buffer_load_dwordx4 v228, s[44:47], s24 offen offset:2048 sc1 lds
    v_mfma_f32_16x16x32_bf16 v[8:11], a[132:135], a[84:87], v[8:11]
    v_mfma_f32_16x16x32_bf16 v[12:15], a[132:135], a[92:95], v[12:15]
    v_mfma_f32_16x16x32_bf16 v[12:15], a[128:131], a[88:91], v[12:15]
    ds_read_b128 a[128:131], v231 offset:8192
    s_waitcnt lgkmcnt(5)
    v_mfma_f32_16x16x32_bf16 v[28:31], a[136:139], a[88:91], v[28:31]
    s_add_u32 s25, s25, 2048
    buffer_load_dwordx4 a[32:35], v224, s[44:47], s25 offen offset:0 sc1
    v_mfma_f32_16x16x32_bf16 v[28:31], a[140:143], a[92:95], v[28:31]
    ds_read_b128 a[132:135], v231 offset:9216
    v_mfma_f32_16x16x32_bf16 v[24:27], a[140:143], a[84:87], v[24:27]
    v_mfma_f32_16x16x32_bf16 v[24:27], a[136:139], a[80:83], v[24:27]
    v_mfma_f32_16x16x32_bf16 v[20:23], a[136:139], a[72:75], v[20:23]
    v_mfma_f32_16x16x32_bf16 v[20:23], a[140:143], a[76:79], v[20:23]
    v_mfma_f32_16x16x32_bf16 v[16:19], a[140:143], a[68:71], v[16:19]
    v_mfma_f32_16x16x32_bf16 v[16:19], a[136:139], a[64:67], v[16:19]
    ds_read_b128 a[136:139], v231 offset:10240
    s_waitcnt lgkmcnt(5)
    v_mfma_f32_16x16x32_bf16 v[32:35], a[144:147], a[64:67], v[32:35]
    ds_read_b128 a[140:143], v231 offset:11264
    v_mfma_f32_16x16x32_bf16 v[32:35], a[148:151], a[68:71], v[32:35]
    v_mfma_f32_16x16x32_bf16 v[36:39], a[148:151], a[76:79], v[36:39]
    s_add_u32 m0, s26, 0
    s_nop 0
    buffer_load_dwordx4 v228, s[44:47], s24 offen offset:3072 sc1 lds
    v_mfma_f32_16x16x32_bf16 v[36:39], a[144:147], a[72:75], v[36:39]
    v_mfma_f32_16x16x32_bf16 v[40:43], a[144:147], a[80:83], v[40:43]
    v_mfma_f32_16x16x32_bf16 v[40:43], a[148:151], a[84:87], v[40:43]
    buffer_load_dwordx4 a[36:39], v224, s[44:47], s25 offen offset:1024 sc1
    v_mfma_f32_16x16x32_bf16 v[44:47], a[148:151], a[92:95], v[44:47]
    v_mfma_f32_16x16x32_bf16 v[44:47], a[144:147], a[88:91], v[44:47]
    ds_read_b128 a[144:147], v231 offset:12288
    s_waitcnt lgkmcnt(5)
    v_mfma_f32_16x16x32_bf16 v[60:63], a[152:155], a[88:91], v[60:63]
    ds_read_b128 a[148:151], v231 offset:13312
    v_mfma_f32_16x16x32_bf16 v[60:63], a[156:159], a[92:95], v[60:63]
    v_mfma_f32_16x16x32_bf16 v[56:59], a[156:159], a[84:87], v[56:59]
    v_mfma_f32_16x16x32_bf16 v[56:59], a[152:155], a[80:83], v[56:59]
    v_mfma_f32_16x16x32_bf16 v[52:55], a[152:155], a[72:75], v[52:55]
    v_mfma_f32_16x16x32_bf16 v[52:55], a[156:159], a[76:79], v[52:55]
    v_mfma_f32_16x16x32_bf16 v[48:51], a[156:159], a[68:71], v[48:51]
    v_mfma_f32_16x16x32_bf16 v[48:51], a[152:155], a[64:67], v[48:51]
    ds_read_b128 a[152:155], v231 offset:14336
    s_waitcnt lgkmcnt(5)
    v_mfma_f32_16x16x32_bf16 v[64:67], a[128:131], a[64:67], v[64:67]
    ds_read_b128 a[156:159], v231 offset:15360
    v_mfma_f32_16x16x32_bf16 v[64:67], a[132:135], a[68:71], v[64:67]
    s_add_u32 m0, s26, 4096
    s_nop 0
    buffer_load_dwordx4 v229, s[44:47], s24 offen offset:0 sc1 lds
    v_mfma_f32_16x16x32_bf16 v[68:71], a[132:135], a[76:79], v[68:71]
    v_mfma_f32_16x16x32_bf16 v[68:71], a[128:131], a[72:75], v[68:71]
    buffer_load_dwordx4 a[40:43], v225, s[44:47], s25 offen offset:0 sc1
    v_mfma_f32_16x16x32_bf16 v[72:75], a[128:131], a[80:83], v[72:75]
    v_mfma_f32_16x16x32_bf16 v[72:75], a[132:135], a[84:87], v[72:75]
    v_mfma_f32_16x16x32_bf16 v[76:79], a[132:135], a[92:95], v[76:79]
    v_mfma_f32_16x16x32_bf16 v[76:79], a[128:131], a[88:91], v[76:79]
    ds_read_b128 a[128:131], v231 offset:16384
    s_waitcnt lgkmcnt(5)
    v_mfma_f32_16x16x32_bf16 v[92:95], a[136:139], a[88:91], v[92:95]
    ds_read_b128 a[132:135], v231 offset:17408
    v_mfma_f32_16x16x32_bf16 v[92:95], a[140:143], a[92:95], v[92:95]
    v_mfma_f32_16x16x32_bf16 v[88:91], a[140:143], a[84:87], v[88:91]
    v_mfma_f32_16x16x32_bf16 v[88:91], a[136:139], a[80:83], v[88:91]
    v_mfma_f32_16x16x32_bf16 v[84:87], a[136:139], a[72:75], v[84:87]
    v_mfma_f32_16x16x32_bf16 v[84:87], a[140:143], a[76:79], v[84:87]
    v_mfma_f32_16x16x32_bf16 v[80:83], a[140:143], a[68:71], v[80:83]
    v_mfma_f32_16x16x32_bf16 v[80:83], a[136:139], a[64:67], v[80:83]
    ds_read_b128 a[136:139], v231 offset:18432
    s_waitcnt lgkmcnt(5)
    v_mfma_f32_16x16x32_bf16 v[96:99], a[144:147], a[64:67], v[96:99]
    s_add_u32 m0, s26, 4096
    s_nop 0
    buffer_load_dwordx4 v229, s[44:47], s24 offen offset:1024 sc1 lds
    v_mfma_f32_16x16x32_bf16 v[96:99], a[148:151], a[68:71], v[96:99]
    buffer_load_dwordx4 a[44:47], v225, s[44:47], s25 offen offset:1024 sc1
    v_mfma_f32_16x16x32_bf16 v[100:103], a[148:151], a[76:79], v[100:103]
    ds_read_b128 a[140:143], v231 offset:19456
    v_mfma_f32_16x16x32_bf16 v[100:103], a[144:147], a[72:75], v[100:103]
    v_mfma_f32_16x16x32_bf16 v[104:107], a[144:147], a[80:83], v[104:107]
    v_mfma_f32_16x16x32_bf16 v[104:107], a[148:151], a[84:87], v[104:107]
    v_mfma_f32_16x16x32_bf16 v[108:111], a[148:151], a[92:95], v[108:111]
    v_mfma_f32_16x16x32_bf16 v[108:111], a[144:147], a[88:91], v[108:111]
    ds_read_b128 a[144:147], v231 offset:20480
    s_waitcnt lgkmcnt(5)
    v_mfma_f32_16x16x32_bf16 v[124:127], a[152:155], a[88:91], v[124:127]
    ds_read_b128 a[148:151], v231 offset:21504
    v_mfma_f32_16x16x32_bf16 v[124:127], a[156:159], a[92:95], v[124:127]
    v_mfma_f32_16x16x32_bf16 v[120:123], a[156:159], a[84:87], v[120:123]
    v_mfma_f32_16x16x32_bf16 v[120:123], a[152:155], a[80:83], v[120:123]
    v_mfma_f32_16x16x32_bf16 v[116:119], a[152:155], a[72:75], v[116:119]
    v_mfma_f32_16x16x32_bf16 v[116:119], a[156:159], a[76:79], v[116:119]
    s_add_u32 m0, s26, 4096
    s_nop 0
    buffer_load_dwordx4 v229, s[44:47], s24 offen offset:2048 sc1 lds
    v_mfma_f32_16x16x32_bf16 v[112:115], a[156:159], a[68:71], v[112:115]
    v_mfma_f32_16x16x32_bf16 v[112:115], a[152:155], a[64:67], v[112:115]
    ds_read_b128 a[152:155], v231 offset:22528
    s_waitcnt lgkmcnt(5)
    v_mfma_f32_16x16x32_bf16 v[128:131], a[128:131], a[64:67], v[128:131]
    buffer_load_dwordx4 a[48:51], v226, s[44:47], s25 offen offset:0 sc1
    v_mfma_f32_16x16x32_bf16 v[128:131], a[132:135], a[68:71], v[128:131]
    ds_read_b128 a[156:159], v231 offset:23552
    v_mfma_f32_16x16x32_bf16 v[132:135], a[132:135], a[76:79], v[132:135]
    v_mfma_f32_16x16x32_bf16 v[132:135], a[128:131], a[72:75], v[132:135]
    v_mfma_f32_16x16x32_bf16 v[136:139], a[128:131], a[80:83], v[136:139]
    v_mfma_f32_16x16x32_bf16 v[136:139], a[132:135], a[84:87], v[136:139]
    v_mfma_f32_16x16x32_bf16 v[140:143], a[132:135], a[92:95], v[140:143]
    v_mfma_f32_16x16x32_bf16 v[140:143], a[128:131], a[88:91], v[140:143]
    ds_read_b128 a[128:131], v231 offset:24576
    s_waitcnt lgkmcnt(5)
    v_mfma_f32_16x16x32_bf16 v[156:159], a[136:139], a[88:91], v[156:159]
    ds_read_b128 a[132:135], v231 offset:25600
    v_mfma_f32_16x16x32_bf16 v[156:159], a[140:143], a[92:95], v[156:159]
    v_mfma_f32_16x16x32_bf16 v[152:155], a[140:143], a[84:87], v[152:155]
    v_mfma_f32_16x16x32_bf16 v[152:155], a[136:139], a[80:83], v[152:155]
    v_mfma_f32_16x16x32_bf16 v[148:151], a[136:139], a[72:75], v[148:151]
    v_mfma_f32_16x16x32_bf16 v[148:151], a[140:143], a[76:79], v[148:151]
    buffer_load_dwordx4 a[52:55], v226, s[44:47], s25 offen offset:1024 sc1
    v_mfma_f32_16x16x32_bf16 v[144:147], a[140:143], a[68:71], v[144:147]
    v_mfma_f32_16x16x32_bf16 v[144:147], a[136:139], a[64:67], v[144:147]
    ds_read_b128 a[136:139], v231 offset:26624
    s_waitcnt lgkmcnt(5)
    v_mfma_f32_16x16x32_bf16 v[160:163], a[144:147], a[64:67], v[160:163]
    ds_read_b128 a[140:143], v231 offset:27648
    v_mfma_f32_16x16x32_bf16 v[160:163], a[148:151], a[68:71], v[160:163]
    v_mfma_f32_16x16x32_bf16 v[164:167], a[148:151], a[76:79], v[164:167]
    v_mfma_f32_16x16x32_bf16 v[164:167], a[144:147], a[72:75], v[164:167]
    v_mfma_f32_16x16x32_bf16 v[168:171], a[144:147], a[80:83], v[168:171]
    v_mfma_f32_16x16x32_bf16 v[168:171], a[148:151], a[84:87], v[168:171]
    v_mfma_f32_16x16x32_bf16 v[172:175], a[148:151], a[92:95], v[172:175]
    s_waitcnt vmcnt(17)
    s_barrier
    v_mfma_f32_16x16x32_bf16 v[172:175], a[144:147], a[88:91], v[172:175]
    ds_read_b128 a[144:147], v231 offset:28672
    s_waitcnt lgkmcnt(5)
    v_mfma_f32_16x16x32_bf16 v[188:191], a[152:155], a[88:91], v[188:191]
    s_add_u32 m0, s26, 28672
    s_add_u32 s24, s24, 28672
    buffer_load_dwordx4 v228, s[44:47], s24 offen offset:0 sc1 lds
    v_mfma_f32_16x16x32_bf16 v[188:191], a[156:159], a[92:95], v[188:191]
    ds_read_b128 a[148:151], v231 offset:29696
    v_mfma_f32_16x16x32_bf16 v[184:187], a[156:159], a[84:87], v[184:187]
    v_mfma_f32_16x16x32_bf16 v[184:187], a[152:155], a[80:83], v[184:187]
    buffer_load_dwordx4 a[56:59], v227, s[44:47], s25 offen offset:0 sc1
    v_mfma_f32_16x16x32_bf16 v[180:183], a[152:155], a[72:75], v[180:183]
    v_mfma_f32_16x16x32_bf16 v[180:183], a[156:159], a[76:79], v[180:183]
    v_mfma_f32_16x16x32_bf16 v[176:179], a[156:159], a[68:71], v[176:179]
    v_mfma_f32_16x16x32_bf16 v[176:179], a[152:155], a[64:67], v[176:179]
    ds_read_b128 a[152:155], v231 offset:30720
    s_waitcnt lgkmcnt(5)
    v_mfma_f32_16x16x32_bf16 v[192:195], a[128:131], a[64:67], v[192:195]
    ds_read_b128 a[156:159], v231 offset:31744
    v_mfma_f32_16x16x32_bf16 v[192:195], a[132:135], a[68:71], v[192:195]
    v_mfma_f32_16x16x32_bf16 v[196:199], a[132:135], a[76:79], v[196:199]
    v_mfma_f32_16x16x32_bf16 v[196:199], a[128:131], a[72:75], v[196:199]
    v_mfma_f32_16x16x32_bf16 v[200:203], a[128:131], a[80:83], v[200:203]
    v_mfma_f32_16x16x32_bf16 v[200:203], a[132:135], a[84:87], v[200:203]
    v_mfma_f32_16x16x32_bf16 v[204:207], a[132:135], a[92:95], v[204:207]
    s_add_u32 m0, s26, 28672
    s_nop 0
    buffer_load_dwordx4 v228, s[44:47], s24 offen offset:1024 sc1 lds
    v_mfma_f32_16x16x32_bf16 v[204:207], a[128:131], a[88:91], v[204:207]
    ds_read_b128 a[128:131], v231 offset:32768
    s_waitcnt lgkmcnt(5)
    v_mfma_f32_16x16x32_bf16 v[220:223], a[136:139], a[88:91], v[220:223]
    ds_read_b128 a[132:135], v231 offset:33792
    v_mfma_f32_16x16x32_bf16 v[220:223], a[140:143], a[92:95], v[220:223]
    buffer_load_dwordx4 a[60:63], v227, s[44:47], s25 offen offset:1024 sc1
    v_mfma_f32_16x16x32_bf16 v[216:219], a[140:143], a[84:87], v[216:219]
    v_mfma_f32_16x16x32_bf16 v[216:219], a[136:139], a[80:83], v[216:219]
    v_mfma_f32_16x16x32_bf16 v[212:215], a[136:139], a[72:75], v[212:215]
    v_mfma_f32_16x16x32_bf16 v[212:215], a[140:143], a[76:79], v[212:215]
    v_mfma_f32_16x16x32_bf16 v[208:211], a[140:143], a[68:71], v[208:211]
    v_mfma_f32_16x16x32_bf16 v[208:211], a[136:139], a[64:67], v[208:211]
    ds_read_b128 a[136:139], v231 offset:34816
    ds_read_b128 a[140:143], v231 offset:35840
    s_waitcnt lgkmcnt(6)
    v_mfma_f32_16x16x32_bf16 v[0:3], a[144:147], a[96:99], v[0:3]
    v_mfma_f32_16x16x32_bf16 v[0:3], a[148:151], a[100:103], v[0:3]
    v_mfma_f32_16x16x32_bf16 v[4:7], a[148:151], a[108:111], v[4:7]
    v_mfma_f32_16x16x32_bf16 v[4:7], a[144:147], a[104:107], v[4:7]
    v_mfma_f32_16x16x32_bf16 v[8:11], a[144:147], a[112:115], v[8:11]
    s_add_u32 m0, s26, 28672
    s_nop 0
    buffer_load_dwordx4 v228, s[44:47], s24 offen offset:2048 sc1 lds
    v_mfma_f32_16x16x32_bf16 v[8:11], a[148:151], a[116:119], v[8:11]
    v_mfma_f32_16x16x32_bf16 v[12:15], a[148:151], a[124:127], v[12:15]
    v_mfma_f32_16x16x32_bf16 v[12:15], a[144:147], a[120:123], v[12:15]
    ds_read_b128 a[144:147], v231 offset:36864
    s_waitcnt lgkmcnt(5)
    v_mfma_f32_16x16x32_bf16 v[28:31], a[152:155], a[120:123], v[28:31]
    s_add_u32 s25, s25, 2048
    buffer_load_dwordx4 a[64:67], v224, s[44:47], s25 offen offset:0 sc1
    v_mfma_f32_16x16x32_bf16 v[28:31], a[156:159], a[124:127], v[28:31]
    ds_read_b128 a[148:151], v231 offset:37888
    v_mfma_f32_16x16x32_bf16 v[24:27], a[156:159], a[116:119], v[24:27]
    v_mfma_f32_16x16x32_bf16 v[24:27], a[152:155], a[112:115], v[24:27]
    v_mfma_f32_16x16x32_bf16 v[20:23], a[152:155], a[104:107], v[20:23]
    v_mfma_f32_16x16x32_bf16 v[20:23], a[156:159], a[108:111], v[20:23]
    v_mfma_f32_16x16x32_bf16 v[16:19], a[156:159], a[100:103], v[16:19]
    v_mfma_f32_16x16x32_bf16 v[16:19], a[152:155], a[96:99], v[16:19]
    ds_read_b128 a[152:155], v231 offset:38912
    s_waitcnt lgkmcnt(5)
    v_mfma_f32_16x16x32_bf16 v[32:35], a[128:131], a[96:99], v[32:35]
    ds_read_b128 a[156:159], v231 offset:39936
    v_mfma_f32_16x16x32_bf16 v[32:35], a[132:135], a[100:103], v[32:35]
    v_mfma_f32_16x16x32_bf16 v[36:39], a[132:135], a[108:111], v[36:39]
    s_add_u32 m0, s26, 28672
    s_nop 0
    buffer_load_dwordx4 v228, s[44:47], s24 offen offset:3072 sc1 lds
    v_mfma_f32_16x16x32_bf16 v[36:39], a[128:131], a[104:107], v[36:39]
    v_mfma_f32_16x16x32_bf16 v[40:43], a[128:131], a[112:115], v[40:43]
    v_mfma_f32_16x16x32_bf16 v[40:43], a[132:135], a[116:119], v[40:43]
    buffer_load_dwordx4 a[68:71], v224, s[44:47], s25 offen offset:1024 sc1
    v_mfma_f32_16x16x32_bf16 v[44:47], a[132:135], a[124:127], v[44:47]
    v_mfma_f32_16x16x32_bf16 v[44:47], a[128:131], a[120:123], v[44:47]
    ds_read_b128 a[128:131], v231 offset:40960
    s_waitcnt lgkmcnt(5)
    v_mfma_f32_16x16x32_bf16 v[60:63], a[136:139], a[120:123], v[60:63]
    ds_read_b128 a[132:135], v231 offset:41984
    v_mfma_f32_16x16x32_bf16 v[60:63], a[140:143], a[124:127], v[60:63]
    v_mfma_f32_16x16x32_bf16 v[56:59], a[140:143], a[116:119], v[56:59]
    v_mfma_f32_16x16x32_bf16 v[56:59], a[136:139], a[112:115], v[56:59]
    v_mfma_f32_16x16x32_bf16 v[52:55], a[136:139], a[104:107], v[52:55]
    v_mfma_f32_16x16x32_bf16 v[52:55], a[140:143], a[108:111], v[52:55]
    v_mfma_f32_16x16x32_bf16 v[48:51], a[140:143], a[100:103], v[48:51]
    v_mfma_f32_16x16x32_bf16 v[48:51], a[136:139], a[96:99], v[48:51]
    ds_read_b128 a[136:139], v231 offset:43008
    s_waitcnt lgkmcnt(5)
    v_mfma_f32_16x16x32_bf16 v[64:67], a[144:147], a[96:99], v[64:67]
    ds_read_b128 a[140:143], v231 offset:44032
    v_mfma_f32_16x16x32_bf16 v[64:67], a[148:151], a[100:103], v[64:67]
    s_add_u32 m0, s26, 32768
    s_nop 0
    buffer_load_dwordx4 v229, s[44:47], s24 offen offset:0 sc1 lds
    v_mfma_f32_16x16x32_bf16 v[68:71], a[148:151], a[108:111], v[68:71]
    v_mfma_f32_16x16x32_bf16 v[68:71], a[144:147], a[104:107], v[68:71]
    buffer_load_dwordx4 a[72:75], v225, s[44:47], s25 offen offset:0 sc1
    v_mfma_f32_16x16x32_bf16 v[72:75], a[144:147], a[112:115], v[72:75]
    v_mfma_f32_16x16x32_bf16 v[72:75], a[148:151], a[116:119], v[72:75]
    v_mfma_f32_16x16x32_bf16 v[76:79], a[148:151], a[124:127], v[76:79]
    v_mfma_f32_16x16x32_bf16 v[76:79], a[144:147], a[120:123], v[76:79]
    ds_read_b128 a[144:147], v231 offset:45056
    s_waitcnt lgkmcnt(5)
    v_mfma_f32_16x16x32_bf16 v[92:95], a[152:155], a[120:123], v[92:95]
    ds_read_b128 a[148:151], v231 offset:46080
    v_mfma_f32_16x16x32_bf16 v[92:95], a[156:159], a[124:127], v[92:95]
    v_mfma_f32_16x16x32_bf16 v[88:91], a[156:159], a[116:119], v[88:91]
    v_mfma_f32_16x16x32_bf16 v[88:91], a[152:155], a[112:115], v[88:91]
    v_mfma_f32_16x16x32_bf16 v[84:87], a[152:155], a[104:107], v[84:87]
    v_mfma_f32_16x16x32_bf16 v[84:87], a[156:159], a[108:111], v[84:87]
    v_mfma_f32_16x16x32_bf16 v[80:83], a[156:159], a[100:103], v[80:83]
    v_mfma_f32_16x16x32_bf16 v[80:83], a[152:155], a[96:99], v[80:83]
    ds_read_b128 a[152:155], v231 offset:47104
    s_waitcnt lgkmcnt(5)
    v_mfma_f32_16x16x32_bf16 v[96:99], a[128:131], a[96:99], v[96:99]
    s_add_u32 m0, s26, 32768
    s_nop 0
    buffer_load_dwordx4 v229, s[44:47], s24 offen offset:1024 sc1 lds
    v_mfma_f32_16x16x32_bf16 v[96:99], a[132:135], a[100:103], v[96:99]
    buffer_load_dwordx4 a[76:79], v225, s[44:47], s25 offen offset:1024 sc1
    v_mfma_f32_16x16x32_bf16 v[100:103], a[132:135], a[108:111], v[100:103]
    ds_read_b128 a[156:159], v231 offset:48128
    v_mfma_f32_16x16x32_bf16 v[100:103], a[128:131], a[104:107], v[100:103]
    v_mfma_f32_16x16x32_bf16 v[104:107], a[128:131], a[112:115], v[104:107]
    v_mfma_f32_16x16x32_bf16 v[104:107], a[132:135], a[116:119], v[104:107]
    v_mfma_f32_16x16x32_bf16 v[108:111], a[132:135], a[124:127], v[108:111]
    v_mfma_f32_16x16x32_bf16 v[108:111], a[128:131], a[120:123], v[108:111]
    ds_read_b128 a[128:131], v231 offset:49152
    s_waitcnt lgkmcnt(5)
    v_mfma_f32_16x16x32_bf16 v[124:127], a[136:139], a[120:123], v[124:127]
    ds_read_b128 a[132:135], v231 offset:50176
    v_mfma_f32_16x16x32_bf16 v[124:127], a[140:143], a[124:127], v[124:127]
    v_mfma_f32_16x16x32_bf16 v[120:123], a[140:143], a[116:119], v[120:123]
    v_mfma_f32_16x16x32_bf16 v[120:123], a[136:139], a[112:115], v[120:123]
    v_mfma_f32_16x16x32_bf16 v[116:119], a[136:139], a[104:107], v[116:119]
    v_mfma_f32_16x16x32_bf16 v[116:119], a[140:143], a[108:111], v[116:119]
    s_add_u32 m0, s26, 32768
    s_nop 0
    buffer_load_dwordx4 v229, s[44:47], s24 offen offset:2048 sc1 lds
    v_mfma_f32_16x16x32_bf16 v[112:115], a[140:143], a[100:103], v[112:115]
    v_mfma_f32_16x16x32_bf16 v[112:115], a[136:139], a[96:99], v[112:115]
    ds_read_b128 a[136:139], v231 offset:51200
    s_waitcnt lgkmcnt(5)
    v_mfma_f32_16x16x32_bf16 v[128:131], a[144:147], a[96:99], v[128:131]
    buffer_load_dwordx4 a[80:83], v226, s[44:47], s25 offen offset:0 sc1
    v_mfma_f32_16x16x32_bf16 v[128:131], a[148:151], a[100:103], v[128:131]
    ds_read_b128 a[140:143], v231 offset:52224
    v_mfma_f32_16x16x32_bf16 v[132:135], a[148:151], a[108:111], v[132:135]
    v_mfma_f32_16x16x32_bf16 v[132:135], a[144:147], a[104:107], v[132:135]
    v_mfma_f32_16x16x32_bf16 v[136:139], a[144:147], a[112:115], v[136:139]
    v_mfma_f32_16x16x32_bf16 v[136:139], a[148:151], a[116:119], v[136:139]
    v_mfma_f32_16x16x32_bf16 v[140:143], a[148:151], a[124:127], v[140:143]
    v_mfma_f32_16x16x32_bf16 v[140:143], a[144:147], a[120:123], v[140:143]
    ds_read_b128 a[144:147], v231 offset:53248
    s_waitcnt lgkmcnt(5)
    v_mfma_f32_16x16x32_bf16 v[156:159], a[152:155], a[120:123], v[156:159]
    ds_read_b128 a[148:151], v231 offset:54272
    v_mfma_f32_16x16x32_bf16 v[156:159], a[156:159], a[124:127], v[156:159]
    v_mfma_f32_16x16x32_bf16 v[152:155], a[156:159], a[116:119], v[152:155]
    v_mfma_f32_16x16x32_bf16 v[152:155], a[152:155], a[112:115], v[152:155]
    v_mfma_f32_16x16x32_bf16 v[148:151], a[152:155], a[104:107], v[148:151]
    v_mfma_f32_16x16x32_bf16 v[148:151], a[156:159], a[108:111], v[148:151]
    buffer_load_dwordx4 a[84:87], v226, s[44:47], s25 offen offset:1024 sc1
    v_mfma_f32_16x16x32_bf16 v[144:147], a[156:159], a[100:103], v[144:147]
    v_mfma_f32_16x16x32_bf16 v[144:147], a[152:155], a[96:99], v[144:147]
    ds_read_b128 a[152:155], v231 offset:55296
    s_waitcnt lgkmcnt(5)
    v_mfma_f32_16x16x32_bf16 v[160:163], a[128:131], a[96:99], v[160:163]
    ds_read_b128 a[156:159], v231 offset:56320
    v_mfma_f32_16x16x32_bf16 v[160:163], a[132:135], a[100:103], v[160:163]
    v_mfma_f32_16x16x32_bf16 v[164:167], a[132:135], a[108:111], v[164:167]
    v_mfma_f32_16x16x32_bf16 v[164:167], a[128:131], a[104:107], v[164:167]
    v_mfma_f32_16x16x32_bf16 v[168:171], a[128:131], a[112:115], v[168:171]
    v_mfma_f32_16x16x32_bf16 v[168:171], a[132:135], a[116:119], v[168:171]
    v_mfma_f32_16x16x32_bf16 v[172:175], a[132:135], a[124:127], v[172:175]
    s_waitcnt vmcnt(17)
    s_barrier
    v_mfma_f32_16x16x32_bf16 v[172:175], a[128:131], a[120:123], v[172:175]
    ds_read_b128 a[128:131], v230 offset:0
    s_waitcnt lgkmcnt(5)
    v_mfma_f32_16x16x32_bf16 v[188:191], a[136:139], a[120:123], v[188:191]
    s_add_u32 m0, s26, 57344
    s_add_u32 s24, s24, 28672
    buffer_load_dwordx4 v228, s[44:47], s24 offen offset:0 sc1 lds
    v_mfma_f32_16x16x32_bf16 v[188:191], a[140:143], a[124:127], v[188:191]
    ds_read_b128 a[132:135], v230 offset:1024
    v_mfma_f32_16x16x32_bf16 v[184:187], a[140:143], a[116:119], v[184:187]
    v_mfma_f32_16x16x32_bf16 v[184:187], a[136:139], a[112:115], v[184:187]
    buffer_load_dwordx4 a[88:91], v227, s[44:47], s25 offen offset:0 sc1
    v_mfma_f32_16x16x32_bf16 v[180:183], a[136:139], a[104:107], v[180:183]
    v_mfma_f32_16x16x32_bf16 v[180:183], a[140:143], a[108:111], v[180:183]
    v_mfma_f32_16x16x32_bf16 v[176:179], a[140:143], a[100:103], v[176:179]
    v_mfma_f32_16x16x32_bf16 v[176:179], a[136:139], a[96:99], v[176:179]
    ds_read_b128 a[136:139], v230 offset:2048
    s_waitcnt lgkmcnt(5)
    v_mfma_f32_16x16x32_bf16 v[192:195], a[144:147], a[96:99], v[192:195]
    ds_read_b128 a[140:143], v230 offset:3072
    v_mfma_f32_16x16x32_bf16 v[192:195], a[148:151], a[100:103], v[192:195]
    v_mfma_f32_16x16x32_bf16 v[196:199], a[148:151], a[108:111], v[196:199]
    v_mfma_f32_16x16x32_bf16 v[196:199], a[144:147], a[104:107], v[196:199]
    v_mfma_f32_16x16x32_bf16 v[200:203], a[144:147], a[112:115], v[200:203]
    v_mfma_f32_16x16x32_bf16 v[200:203], a[148:151], a[116:119], v[200:203]
    v_mfma_f32_16x16x32_bf16 v[204:207], a[148:151], a[124:127], v[204:207]
    s_add_u32 m0, s26, 57344
    s_nop 0
    buffer_load_dwordx4 v228, s[44:47], s24 offen offset:1024 sc1 lds
    v_mfma_f32_16x16x32_bf16 v[204:207], a[144:147], a[120:123], v[204:207]
    ds_read_b128 a[144:147], v230 offset:4096
    s_waitcnt lgkmcnt(5)
    v_mfma_f32_16x16x32_bf16 v[220:223], a[152:155], a[120:123], v[220:223]
    ds_read_b128 a[148:151], v230 offset:5120
    v_mfma_f32_16x16x32_bf16 v[220:223], a[156:159], a[124:127], v[220:223]
    buffer_load_dwordx4 a[92:95], v227, s[44:47], s25 offen offset:1024 sc1
    v_mfma_f32_16x16x32_bf16 v[216:219], a[156:159], a[116:119], v[216:219]
    v_mfma_f32_16x16x32_bf16 v[216:219], a[152:155], a[112:115], v[216:219]
    v_mfma_f32_16x16x32_bf16 v[212:215], a[152:155], a[104:107], v[212:215]
    v_mfma_f32_16x16x32_bf16 v[212:215], a[156:159], a[108:111], v[212:215]
    v_mfma_f32_16x16x32_bf16 v[208:211], a[156:159], a[100:103], v[208:211]
    v_mfma_f32_16x16x32_bf16 v[208:211], a[152:155], a[96:99], v[208:211]
    ds_read_b128 a[152:155], v230 offset:6144
    ds_read_b128 a[156:159], v230 offset:7168
    s_sub_u32 s27, s27, 1
    s_cmp_lg_u32 s27, 0
    s_cbranch_scc1 L_u0
    s_waitcnt lgkmcnt(6)
    v_mfma_f32_16x16x32_bf16 v[0:3], a[128:131], a[0:3], v[0:3]
    v_mfma_f32_16x16x32_bf16 v[0:3], a[132:135], a[4:7], v[0:3]
    v_mfma_f32_16x16x32_bf16 v[4:7], a[132:135], a[12:15], v[4:7]
    v_mfma_f32_16x16x32_bf16 v[4:7], a[128:131], a[8:11], v[4:7]
    v_mfma_f32_16x16x32_bf16 v[8:11], a[128:131], a[16:19], v[8:11]
    ds_read_b64_tr_b16 a[160:161], v236 offset:0
    v_mfma_f32_16x16x32_bf16 v[8:11], a[132:135], a[20:23], v[8:11]
    ds_read_b64_tr_b16 a[162:163], v236 offset:2048
    v_mfma_f32_16x16x32_bf16 v[12:15], a[132:135], a[28:31], v[12:15]
    ds_read_b64_tr_b16 a[164:165], v236 offset:4096
    s_add_u32 m0, s26, 57344
    s_nop 0
    buffer_load_dwordx4 v228, s[44:47], s24 offen offset:2048 sc1 lds
    v_mfma_f32_16x16x32_bf16 v[12:15], a[128:131], a[24:27], v[12:15]
    ds_read_b64_tr_b16 a[166:167], v236 offset:6144
    s_waitcnt lgkmcnt(8)
    v_mfma_f32_16x16x32_bf16 v[28:31], a[136:139], a[24:27], v[28:31]
    ds_read_b64_tr_b16 a[168:169], v237 offset:0
    v_mfma_f32_16x16x32_bf16 v[28:31], a[140:143], a[28:31], v[28:31]
    ds_read_b64_tr_b16 a[170:171], v237 offset:2048
    s_add_u32 s25, s25, 2048
    buffer_load_dwordx4 a[96:99], v224, s[44:47], s25 offen offset:0 sc1
    v_mfma_f32_16x16x32_bf16 v[24:27], a[140:143], a[20:23], v[24:27]
    ds_read_b64_tr_b16 a[172:173], v237 offset:4096
    v_mfma_f32_16x16x32_bf16 v[24:27], a[136:139], a[16:19], v[24:27]
    ds_read_b64_tr_b16 a[174:175], v237 offset:6144
    v_mfma_f32_16x16x32_bf16 v[20:23], a[136:139], a[8:11], v[20:23]
    ds_read_b64_tr_b16 a[176:177], v238 offset:0
    ds_read_b128 a[128:131], v230 offset:8192
    ds_read_b128 a[132:135], v230 offset:9216
    v_mfma_f32_16x16x32_bf16 v[20:23], a[140:143], a[12:15], v[20:23]
    ds_read_b64_tr_b16 a[178:179], v238 offset:2048
    v_mfma_f32_16x16x32_bf16 v[16:19], a[140:143], a[4:7], v[16:19]
    ds_read_b64_tr_b16 a[180:181], v238 offset:4096
    v_mfma_f32_16x16x32_bf16 v[16:19], a[136:139], a[0:3], v[16:19]
    ds_read_b64_tr_b16 a[182:183], v238 offset:6144
    s_waitcnt lgkmcnt(8)
    v_mfma_f32_16x16x32_bf16 v[32:35], a[144:147], a[0:3], v[32:35]
    ds_read_b64_tr_b16 a[184:185], v239 offset:0
    v_mfma_f32_16x16x32_bf16 v[32:35], a[148:151], a[4:7], v[32:35]
    ds_read_b64_tr_b16 a[186:187], v239 offset:2048
    v_mfma_f32_16x16x32_bf16 v[36:39], a[148:151], a[12:15], v[36:39]
    ds_read_b64_tr_b16 a[188:189], v239 offset:4096
    v_mfma_f32_16x16x32_bf16 v[36:39], a[144:147], a[8:11], v[36:39]
    ds_read_b64_tr_b16 a[190:191], v239 offset:6144
    v_mfma_f32_16x16x32_bf16 v[40:43], a[144:147], a[16:19], v[40:43]
    s_add_u32 m0, s26, 57344
    s_nop 0
    buffer_load_dwordx4 v228, s[44:47], s24 offen offset:3072 sc1 lds
    ds_read_b128 a[136:139], v230 offset:10240
    ds_read_b128 a[140:143], v230 offset:11264
    v_mfma_f32_16x16x32_bf16 v[40:43], a[148:151], a[20:23], v[40:43]
    buffer_load_dwordx4 a[100:103], v224, s[44:47], s25 offen offset:1024 sc1
    v_mfma_f32_16x16x32_bf16 v[44:47], a[148:151], a[28:31], v[44:47]
    buffer_store_dwordx4 a[160:163], v224, s[44:47], s8 offen offset:0 sc1
    v_mfma_f32_16x16x32_bf16 v[44:47], a[144:147], a[24:27], v[44:47]
    ds_read_b128 a[144:147], v230 offset:12288
    v_mfma_f32_16x16x32_bf16 v[60:63], a[152:155], a[24:27], v[60:63]
    ds_read_b128 a[148:151], v230 offset:13312
    v_mfma_f32_16x16x32_bf16 v[60:63], a[156:159], a[28:31], v[60:63]
    buffer_store_dwordx4 a[164:167], v224, s[44:47], s8 offen offset:1024 sc1
    v_mfma_f32_16x16x32_bf16 v[56:59], a[156:159], a[20:23], v[56:59]
    v_mfma_f32_16x16x32_bf16 v[56:59], a[152:155], a[16:19], v[56:59]
    v_mfma_f32_16x16x32_bf16 v[52:55], a[152:155], a[8:11], v[52:55]
    buffer_store_dwordx4 a[168:171], v224, s[44:47], s8 offen offset:2048 sc1
    v_mfma_f32_16x16x32_bf16 v[52:55], a[156:159], a[12:15], v[52:55]
    v_mfma_f32_16x16x32_bf16 v[48:51], a[156:159], a[4:7], v[48:51]
    v_mfma_f32_16x16x32_bf16 v[48:51], a[152:155], a[0:3], v[48:51]
    s_waitcnt lgkmcnt(8)
    buffer_store_dwordx4 a[172:175], v224, s[44:47], s8 offen offset:3072 sc1
    v_mfma_f32_16x16x32_bf16 v[64:67], a[128:131], a[0:3], v[64:67]
    ds_read_b128 a[152:155], v230 offset:14336
    v_mfma_f32_16x16x32_bf16 v[64:67], a[132:135], a[4:7], v[64:67]
    s_add_u32 m0, s26, 61440
    s_nop 0
    buffer_load_dwordx4 v229, s[44:47], s24 offen offset:0 sc1 lds
    v_mfma_f32_16x16x32_bf16 v[68:71], a[132:135], a[12:15], v[68:71]
    buffer_store_dwordx4 a[176:179], v224, s[44:47], s9 offen offset:0 sc1
    v_mfma_f32_16x16x32_bf16 v[68:71], a[128:131], a[8:11], v[68:71]
    buffer_load_dwordx4 a[104:107], v225, s[44:47], s25 offen offset:0 sc1
    v_mfma_f32_16x16x32_bf16 v[72:75], a[128:131], a[16:19], v[72:75]
    ds_read_b128 a[156:159], v230 offset:15360
    v_mfma_f32_16x16x32_bf16 v[72:75], a[132:135], a[20:23], v[72:75]
    buffer_store_dwordx4 a[180:183], v224, s[44:47], s9 offen offset:1024 sc1
    v_mfma_f32_16x16x32_bf16 v[76:79], a[132:135], a[28:31], v[76:79]
    v_mfma_f32_16x16x32_bf16 v[76:79], a[128:131], a[24:27], v[76:79]
    ds_read_b128 a[128:131], v230 offset:16384
    s_waitcnt lgkmcnt(5)
    v_mfma_f32_16x16x32_bf16 v[92:95], a[136:139], a[24:27], v[92:95]
    buffer_store_dwordx4 a[184:187], v224, s[44:47], s9 offen offset:2048 sc1
    v_mfma_f32_16x16x32_bf16 v[92:95], a[140:143], a[28:31], v[92:95]
    ds_read_b128 a[132:135], v230 offset:17408
    v_mfma_f32_16x16x32_bf16 v[88:91], a[140:143], a[20:23], v[88:91]
    v_mfma_f32_16x16x32_bf16 v[88:91], a[136:139], a[16:19], v[88:91]
    buffer_store_dwordx4 a[188:191], v224, s[44:47], s9 offen offset:3072 sc1
    v_mfma_f32_16x16x32_bf16 v[84:87], a[136:139], a[8:11], v[84:87]
    v_mfma_f32_16x16x32_bf16 v[84:87], a[140:143], a[12:15], v[84:87]
    v_mfma_f32_16x16x32_bf16 v[80:83], a[140:143], a[4:7], v[80:83]
    v_mfma_f32_16x16x32_bf16 v[80:83], a[136:139], a[0:3], v[80:83]
    ds_read_b128 a[136:139], v230 offset:18432
    s_waitcnt lgkmcnt(5)
    v_mfma_f32_16x16x32_bf16 v[96:99], a[144:147], a[0:3], v[96:99]
    s_add_u32 m0, s26, 61440
    s_nop 0
    buffer_load_dwordx4 v229, s[44:47], s24 offen offset:1024 sc1 lds
    v_mfma_f32_16x16x32_bf16 v[96:99], a[148:151], a[4:7], v[96:99]
    buffer_load_dwordx4 a[108:111], v225, s[44:47], s25 offen offset:1024 sc1
    v_mfma_f32_16x16x32_bf16 v[100:103], a[148:151], a[12:15], v[100:103]
    ds_read_b128 a[140:143], v230 offset:19456
    v_mfma_f32_16x16x32_bf16 v[100:103], a[144:147], a[8:11], v[100:103]
    v_mfma_f32_16x16x32_bf16 v[104:107], a[144:147], a[16:19], v[104:107]
    v_mfma_f32_16x16x32_bf16 v[104:107], a[148:151], a[20:23], v[104:107]
    v_mfma_f32_16x16x32_bf16 v[108:111], a[148:151], a[28:31], v[108:111]
    v_mfma_f32_16x16x32_bf16 v[108:111], a[144:147], a[24:27], v[108:111]
    ds_read_b128 a[144:147], v230 offset:20480
    s_waitcnt lgkmcnt(5)
    v_mfma_f32_16x16x32_bf16 v[124:127], a[152:155], a[24:27], v[124:127]
    ds_read_b128 a[148:151], v230 offset:21504
    v_mfma_f32_16x16x32_bf16 v[124:127], a[156:159], a[28:31], v[124:127]
    v_mfma_f32_16x16x32_bf16 v[120:123], a[156:159], a[20:23], v[120:123]
    v_mfma_f32_16x16x32_bf16 v[120:123], a[152:155], a[16:19], v[120:123]
    v_mfma_f32_16x16x32_bf16 v[116:119], a[152:155], a[8:11], v[116:119]
    v_mfma_f32_16x16x32_bf16 v[116:119], a[156:159], a[12:15], v[116:119]
    s_add_u32 m0, s26, 61440
    s_nop 0
    buffer_load_dwordx4 v229, s[44:47], s24 offen offset:2048 sc1 lds
    v_mfma_f32_16x16x32_bf16 v[112:115], a[156:159], a[4:7], v[112:115]
    v_mfma_f32_16x16x32_bf16 v[112:115], a[152:155], a[0:3], v[112:115]
    ds_read_b128 a[152:155], v230 offset:22528
    s_waitcnt lgkmcnt(5)
    v_mfma_f32_16x16x32_bf16 v[128:131], a[128:131], a[0:3], v[128:131]
    buffer_load_dwordx4 a[112:115], v226, s[44:47], s25 offen offset:0 sc1
    v_mfma_f32_16x16x32_bf16 v[128:131], a[132:135], a[4:7], v[128:131]
    ds_read_b128 a[156:159], v230 offset:23552
    v_mfma_f32_16x16x32_bf16 v[132:135], a[132:135], a[12:15], v[132:135]
    v_mfma_f32_16x16x32_bf16 v[132:135], a[128:131], a[8:11], v[132:135]
    v_mfma_f32_16x16x32_bf16 v[136:139], a[128:131], a[16:19], v[136:139]
    v_mfma_f32_16x16x32_bf16 v[136:139], a[132:135], a[20:23], v[136:139]
    v_mfma_f32_16x16x32_bf16 v[140:143], a[132:135], a[28:31], v[140:143]
    v_mfma_f32_16x16x32_bf16 v[140:143], a[128:131], a[24:27], v[140:143]
    ds_read_b128 a[128:131], v230 offset:24576
    s_waitcnt lgkmcnt(5)
    v_mfma_f32_16x16x32_bf16 v[156:159], a[136:139], a[24:27], v[156:159]
    ds_read_b128 a[132:135], v230 offset:25600
    v_mfma_f32_16x16x32_bf16 v[156:159], a[140:143], a[28:31], v[156:159]
    v_mfma_f32_16x16x32_bf16 v[152:155], a[140:143], a[20:23], v[152:155]
    v_mfma_f32_16x16x32_bf16 v[152:155], a[136:139], a[16:19], v[152:155]
    v_mfma_f32_16x16x32_bf16 v[148:151], a[136:139], a[8:11], v[148:151]
    v_mfma_f32_16x16x32_bf16 v[148:151], a[140:143], a[12:15], v[148:151]
    buffer_load_dwordx4 a[116:119], v226, s[44:47], s25 offen offset:1024 sc1
    v_mfma_f32_16x16x32_bf16 v[144:147], a[140:143], a[4:7], v[144:147]
    v_mfma_f32_16x16x32_bf16 v[144:147], a[136:139], a[0:3], v[144:147]
    ds_read_b128 a[136:139], v230 offset:26624
    s_waitcnt lgkmcnt(5)
    v_mfma_f32_16x16x32_bf16 v[160:163], a[144:147], a[0:3], v[160:163]
    ds_read_b128 a[140:143], v230 offset:27648
    v_mfma_f32_16x16x32_bf16 v[160:163], a[148:151], a[4:7], v[160:163]
    v_mfma_f32_16x16x32_bf16 v[164:167], a[148:151], a[12:15], v[164:167]
    v_mfma_f32_16x16x32_bf16 v[164:167], a[144:147], a[8:11], v[164:167]
    v_mfma_f32_16x16x32_bf16 v[168:171], a[144:147], a[16:19], v[168:171]
    v_mfma_f32_16x16x32_bf16 v[168:171], a[148:151], a[20:23], v[168:171]
    v_mfma_f32_16x16x32_bf16 v[172:175], a[148:151], a[28:31], v[172:175]
    s_waitcnt vmcnt(25)
    s_barrier
    v_mfma_f32_16x16x32_bf16 v[172:175], a[144:147], a[24:27], v[172:175]
    ds_read_b128 a[144:147], v230 offset:28672
    s_waitcnt lgkmcnt(5)
    v_mfma_f32_16x16x32_bf16 v[188:191], a[152:155], a[24:27], v[188:191]
    s_add_u32 m0, s26, 86016
    s_add_u32 s24, s24, 28672
    buffer_load_dwordx4 v228, s[44:47], s24 offen offset:0 sc1 lds
    v_mfma_f32_16x16x32_bf16 v[188:191], a[156:159], a[28:31], v[188:191]
    ds_read_b128 a[148:151], v230 offset:29696
    v_mfma_f32_16x16x32_bf16 v[184:187], a[156:159], a[20:23], v[184:187]
    v_mfma_f32_16x16x32_bf16 v[184:187], a[152:155], a[16:19], v[184:187]
    buffer_load_dwordx4 a[120:123], v227, s[44:47], s25 offen offset:0 sc1
    v_mfma_f32_16x16x32_bf16 v[180:183], a[152:155], a[8:11], v[180:183]
    v_mfma_f32_16x16x32_bf16 v[180:183], a[156:159], a[12:15], v[180:183]
    v_mfma_f32_16x16x32_bf16 v[176:179], a[156:159], a[4:7], v[176:179]
    s_add_u32 m0, s26, 86016
    s_nop 0
    buffer_load_dwordx4 v228, s[44:47], s24 offen offset:1024 sc1 lds
    v_mfma_f32_16x16x32_bf16 v[176:179], a[152:155], a[0:3], v[176:179]
    ds_read_b128 a[152:155], v230 offset:30720
    s_waitcnt lgkmcnt(5)
    v_mfma_f32_16x16x32_bf16 v[192:195], a[128:131], a[0:3], v[192:195]
    ds_read_b128 a[156:159], v230 offset:31744
    v_mfma_f32_16x16x32_bf16 v[192:195], a[132:135], a[4:7], v[192:195]
    v_mfma_f32_16x16x32_bf16 v[196:199], a[132:135], a[12:15], v[196:199]
    v_mfma_f32_16x16x32_bf16 v[196:199], a[128:131], a[8:11], v[196:199]
    v_mfma_f32_16x16x32_bf16 v[200:203], a[128:131], a[16:19], v[200:203]
    s_add_u32 m0, s26, 86016
    s_nop 0
    buffer_load_dwordx4 v228, s[44:47], s24 offen offset:2048 sc1 lds
    v_mfma_f32_16x16x32_bf16 v[200:203], a[132:135], a[20:23], v[200:203]
    v_mfma_f32_16x16x32_bf16 v[204:207], a[132:135], a[28:31], v[204:207]
    v_mfma_f32_16x16x32_bf16 v[204:207], a[128:131], a[24:27], v[204:207]
    ds_read_b128 a[128:131], v230 offset:32768
    s_waitcnt lgkmcnt(5)
    v_mfma_f32_16x16x32_bf16 v[220:223], a[136:139], a[24:27], v[220:223]
    ds_read_b128 a[132:135], v230 offset:33792
    v_mfma_f32_16x16x32_bf16 v[220:223], a[140:143], a[28:31], v[220:223]
    buffer_load_dwordx4 a[124:127], v227, s[44:47], s25 offen offset:1024 sc1
    v_mfma_f32_16x16x32_bf16 v[216:219], a[140:143], a[20:23], v[216:219]
    s_add_u32 m0, s26, 86016
    s_nop 0
    buffer_load_dwordx4 v228, s[44:47], s24 offen offset:3072 sc1 lds
    v_mfma_f32_16x16x32_bf16 v[216:219], a[136:139], a[16:19], v[216:219]
    v_mfma_f32_16x16x32_bf16 v[212:215], a[136:139], a[8:11], v[212:215]
    v_mfma_f32_16x16x32_bf16 v[212:215], a[140:143], a[12:15], v[212:215]
    v_mfma_f32_16x16x32_bf16 v[208:211], a[140:143], a[4:7], v[208:211]
    v_mfma_f32_16x16x32_bf16 v[208:211], a[136:139], a[0:3], v[208:211]
    ds_read_b128 a[136:139], v230 offset:34816
    ds_read_b128 a[140:143], v230 offset:35840
    s_waitcnt lgkmcnt(6)
    v_mfma_f32_16x16x32_bf16 v[0:3], a[144:147], a[32:35], v[0:3]
    v_mfma_f32_16x16x32_bf16 v[0:3], a[148:151], a[36:39], v[0:3]
    s_add_u32 m0, s26, 90112
    s_nop 0
    buffer_load_dwordx4 v229, s[44:47], s24 offen offset:0 sc1 lds
    v_mfma_f32_16x16x32_bf16 v[4:7], a[148:151], a[44:47], v[4:7]
    v_mfma_f32_16x16x32_bf16 v[4:7], a[144:147], a[40:43], v[4:7]
    v_mfma_f32_16x16x32_bf16 v[8:11], a[144:147], a[48:51], v[8:11]
    v_mfma_f32_16x16x32_bf16 v[8:11], a[148:151], a[52:55], v[8:11]
    v_mfma_f32_16x16x32_bf16 v[12:15], a[148:151], a[60:63], v[12:15]
    v_mfma_f32_16x16x32_bf16 v[12:15], a[144:147], a[56:59], v[12:15]
    ds_read_b128 a[144:147], v230 offset:36864
    s_waitcnt lgkmcnt(5)
    v_mfma_f32_16x16x32_bf16 v[28:31], a[152:155], a[56:59], v[28:31]
    s_add_u32 m0, s26, 90112
    s_nop 0
    buffer_load_dwordx4 v229, s[44:47], s24 offen offset:1024 sc1 lds
    v_mfma_f32_16x16x32_bf16 v[28:31], a[156:159], a[60:63], v[28:31]
    ds_read_b128 a[148:151], v230 offset:37888
    v_mfma_f32_16x16x32_bf16 v[24:27], a[156:159], a[52:55], v[24:27]
    v_mfma_f32_16x16x32_bf16 v[24:27], a[152:155], a[48:51], v[24:27]
    v_mfma_f32_16x16x32_bf16 v[20:23], a[152:155], a[40:43], v[20:23]
    v_mfma_f32_16x16x32_bf16 v[20:23], a[156:159], a[44:47], v[20:23]
    s_add_u32 m0, s26, 90112
    s_nop 0
    buffer_load_dwordx4 v229, s[44:47], s24 offen offset:2048 sc1 lds
    v_mfma_f32_16x16x32_bf16 v[16:19], a[156:159], a[36:39], v[16:19]
    v_mfma_f32_16x16x32_bf16 v[16:19], a[152:155], a[32:35], v[16:19]
    ds_read_b128 a[152:155], v230 offset:38912
    s_waitcnt lgkmcnt(5)
    v_mfma_f32_16x16x32_bf16 v[32:35], a[128:131], a[32:35], v[32:35]
    ds_read_b128 a[156:159], v230 offset:39936
    v_mfma_f32_16x16x32_bf16 v[32:35], a[132:135], a[36:39], v[32:35]
    v_mfma_f32_16x16x32_bf16 v[36:39], a[132:135], a[44:47], v[36:39]
    v_mfma_f32_16x16x32_bf16 v[36:39], a[128:131], a[40:43], v[36:39]
    v_mfma_f32_16x16x32_bf16 v[40:43], a[128:131], a[48:51], v[40:43]
    v_mfma_f32_16x16x32_bf16 v[40:43], a[132:135], a[52:55], v[40:43]
    v_mfma_f32_16x16x32_bf16 v[44:47], a[132:135], a[60:63], v[44:47]
    v_mfma_f32_16x16x32_bf16 v[44:47], a[128:131], a[56:59], v[44:47]
    ds_read_b128 a[128:131], v230 offset:40960
    s_waitcnt lgkmcnt(5)
    v_mfma_f32_16x16x32_bf16 v[60:63], a[136:139], a[56:59], v[60:63]
    ds_read_b128 a[132:135], v230 offset:41984
    v_mfma_f32_16x16x32_bf16 v[60:63], a[140:143], a[60:63], v[60:63]
    v_mfma_f32_16x16x32_bf16 v[56:59], a[140:143], a[52:55], v[56:59]
    v_mfma_f32_16x16x32_bf16 v[56:59], a[136:139], a[48:51], v[56:59]
    v_mfma_f32_16x16x32_bf16 v[52:55], a[136:139], a[40:43], v[52:55]
    v_mfma_f32_16x16x32_bf16 v[52:55], a[140:143], a[44:47], v[52:55]
    v_mfma_f32_16x16x32_bf16 v[48:51], a[140:143], a[36:39], v[48:51]
    v_mfma_f32_16x16x32_bf16 v[48:51], a[136:139], a[32:35], v[48:51]
    ds_read_b128 a[136:139], v230 offset:43008
    s_waitcnt lgkmcnt(5)
    v_mfma_f32_16x16x32_bf16 v[64:67], a[144:147], a[32:35], v[64:67]
    ds_read_b128 a[140:143], v230 offset:44032
    v_mfma_f32_16x16x32_bf16 v[64:67], a[148:151], a[36:39], v[64:67]
    v_mfma_f32_16x16x32_bf16 v[68:71], a[148:151], a[44:47], v[68:71]
    v_mfma_f32_16x16x32_bf16 v[68:71], a[144:147], a[40:43], v[68:71]
    v_mfma_f32_16x16x32_bf16 v[72:75], a[144:147], a[48:51], v[72:75]
    v_mfma_f32_16x16x32_bf16 v[72:75], a[148:151], a[52:55], v[72:75]
    v_mfma_f32_16x16x32_bf16 v[76:79], a[148:151], a[60:63], v[76:79]
    v_mfma_f32_16x16x32_bf16 v[76:79], a[144:147], a[56:59], v[76:79]
    ds_read_b128 a[144:147], v230 offset:45056
    s_waitcnt lgkmcnt(5)
    v_mfma_f32_16x16x32_bf16 v[92:95], a[152:155], a[56:59], v[92:95]
    ds_read_b128 a[148:151], v230 offset:46080
    v_mfma_f32_16x16x32_bf16 v[92:95], a[156:159], a[60:63], v[92:95]
    v_mfma_f32_16x16x32_bf16 v[88:91], a[156:159], a[52:55], v[88:91]
    v_mfma_f32_16x16x32_bf16 v[88:91], a[152:155], a[48:51], v[88:91]
    v_mfma_f32_16x16x32_bf16 v[84:87], a[152:155], a[40:43], v[84:87]
    v_mfma_f32_16x16x32_bf16 v[84:87], a[156:159], a[44:47], v[84:87]
    v_mfma_f32_16x16x32_bf16 v[80:83], a[156:159], a[36:39], v[80:83]
    v_mfma_f32_16x16x32_bf16 v[80:83], a[152:155], a[32:35], v[80:83]
    ds_read_b128 a[152:155], v230 offset:47104
    s_waitcnt lgkmcnt(5)
    v_mfma_f32_16x16x32_bf16 v[96:99], a[128:131], a[32:35], v[96:99]
    ds_read_b128 a[156:159], v230 offset:48128
    v_mfma_f32_16x16x32_bf16 v[96:99], a[132:135], a[36:39], v[96:99]
    v_mfma_f32_16x16x32_bf16 v[100:103], a[132:135], a[44:47], v[100:103]
    v_mfma_f32_16x16x32_bf16 v[100:103], a[128:131], a[40:43], v[100:103]
    v_mfma_f32_16x16x32_bf16 v[104:107], a[128:131], a[48:51], v[104:107]
    v_mfma_f32_16x16x32_bf16 v[104:107], a[132:135], a[52:55], v[104:107]
    v_mfma_f32_16x16x32_bf16 v[108:111], a[132:135], a[60:63], v[108:111]
    v_mfma_f32_16x16x32_bf16 v[108:111], a[128:131], a[56:59], v[108:111]
    ds_read_b128 a[128:131], v230 offset:49152
    s_waitcnt lgkmcnt(5)
    v_mfma_f32_16x16x32_bf16 v[124:127], a[136:139], a[56:59], v[124:127]
    ds_read_b128 a[132:135], v230 offset:50176
    v_mfma_f32_16x16x32_bf16 v[124:127], a[140:143], a[60:63], v[124:127]
    v_mfma_f32_16x16x32_bf16 v[120:123], a[140:143], a[52:55], v[120:123]
    v_mfma_f32_16x16x32_bf16 v[120:123], a[136:139], a[48:51], v[120:123]
    v_mfma_f32_16x16x32_bf16 v[116:119], a[136:139], a[40:43], v[116:119]
    s_lshr_b32 s12, s2, 3
    v_mfma_f32_16x16x32_bf16 v[116:119], a[140:143], a[44:47], v[116:119]
    s_and_b32 s12, s12, 31
    v_mfma_f32_16x16x32_bf16 v[112:115], a[140:143], a[36:39], v[112:115]
    s_lshl_b32 s12, s12, 10
    v_mfma_f32_16x16x32_bf16 v[112:115], a[136:139], a[32:35], v[112:115]
    v_and_b32 v233, 7, v232
    s_waitcnt lgkmcnt(4)
    v_mfma_f32_16x16x32_bf16 v[128:131], a[144:147], a[32:35], v[128:131]
    v_lshlrev_b32 v233, 7, v233
    v_mfma_f32_16x16x32_bf16 v[128:131], a[148:151], a[36:39], v[128:131]
    v_add_u32 v233, s12, v233
    v_mfma_f32_16x16x32_bf16 v[132:135], a[148:151], a[44:47], v[132:135]
    s_getpc_b64 s[10:11]
    s_add_u32 s10, s10, PH_d0@rel32@lo+4
    s_addc_u32 s11, s11, PH_d0@rel32@hi+12
    v_min_u32 v234, END_PH_d0-PH_d0-4, v233
    global_load_dword v234, v234, s[10:11]
    v_mfma_f32_16x16x32_bf16 v[132:135], a[144:147], a[40:43], v[132:135]
    ds_read_b128 a[136:139], v230 offset:51200
    v_mfma_f32_16x16x32_bf16 v[136:139], a[144:147], a[48:51], v[136:139]
    ds_read_b128 a[140:143], v230 offset:52224
    v_mfma_f32_16x16x32_bf16 v[136:139], a[148:151], a[52:55], v[136:139]
    v_mfma_f32_16x16x32_bf16 v[140:143], a[148:151], a[60:63], v[140:143]
    v_mfma_f32_16x16x32_bf16 v[140:143], a[144:147], a[56:59], v[140:143]
    ds_read_b128 a[144:147], v230 offset:53248
    s_waitcnt lgkmcnt(5)
    v_mfma_f32_16x16x32_bf16 v[156:159], a[152:155], a[56:59], v[156:159]
    ds_read_b128 a[148:151], v230 offset:54272
    v_mfma_f32_16x16x32_bf16 v[156:159], a[156:159], a[60:63], v[156:159]
    v_mfma_f32_16x16x32_bf16 v[152:155], a[156:159], a[52:55], v[152:155]
    v_mfma_f32_16x16x32_bf16 v[152:155], a[152:155], a[48:51], v[152:155]
    v_mfma_f32_16x16x32_bf16 v[148:151], a[152:155], a[40:43], v[148:151]
    v_mfma_f32_16x16x32_bf16 v[148:151], a[156:159], a[44:47], v[148:151]
    v_mfma_f32_16x16x32_bf16 v[144:147], a[156:159], a[36:39], v[144:147]
    v_mfma_f32_16x16x32_bf16 v[144:147], a[152:155], a[32:35], v[144:147]
    ds_read_b128 a[152:155], v230 offset:55296
    s_waitcnt lgkmcnt(5)
    v_mfma_f32_16x16x32_bf16 v[160:163], a[128:131], a[32:35], v[160:163]
    ds_read_b128 a[156:159], v230 offset:56320
    v_mfma_f32_16x16x32_bf16 v[160:163], a[132:135], a[36:39], v[160:163]
    v_mfma_f32_16x16x32_bf16 v[164:167], a[132:135], a[44:47], v[164:167]
    v_mfma_f32_16x16x32_bf16 v[164:167], a[128:131], a[40:43], v[164:167]
    v_mfma_f32_16x16x32_bf16 v[168:171], a[128:131], a[48:51], v[168:171]
    v_mfma_f32_16x16x32_bf16 v[168:171], a[132:135], a[52:55], v[168:171]
    v_mfma_f32_16x16x32_bf16 v[172:175], a[132:135], a[60:63], v[172:175]
    s_waitcnt vmcnt(1)
    s_barrier
    v_mfma_f32_16x16x32_bf16 v[172:175], a[128:131], a[56:59], v[172:175]
    ds_read_b128 a[128:131], v231 offset:0
    s_waitcnt lgkmcnt(5)
    v_mfma_f32_16x16x32_bf16 v[188:191], a[136:139], a[56:59], v[188:191]
    ds_read_b128 a[132:135], v231 offset:1024
    v_mfma_f32_16x16x32_bf16 v[188:191], a[140:143], a[60:63], v[188:191]
    v_mfma_f32_16x16x32_bf16 v[184:187], a[140:143], a[52:55], v[184:187]
    v_mfma_f32_16x16x32_bf16 v[184:187], a[136:139], a[48:51], v[184:187]
    v_mfma_f32_16x16x32_bf16 v[180:183], a[136:139], a[40:43], v[180:183]
    v_mfma_f32_16x16x32_bf16 v[180:183], a[140:143], a[44:47], v[180:183]
    v_mfma_f32_16x16x32_bf16 v[176:179], a[140:143], a[36:39], v[176:179]
    v_mfma_f32_16x16x32_bf16 v[176:179], a[136:139], a[32:35], v[176:179]
    ds_read_b128 a[136:139], v231 offset:28672
    s_waitcnt lgkmcnt(5)
    v_mfma_f32_16x16x32_bf16 v[192:195], a[144:147], a[32:35], v[192:195]
    ds_read_b128 a[140:143], v231 offset:29696
    v_mfma_f32_16x16x32_bf16 v[192:195], a[148:151], a[36:39], v[192:195]
    v_mfma_f32_16x16x32_bf16 v[196:199], a[148:151], a[44:47], v[196:199]
    v_mfma_f32_16x16x32_bf16 v[196:199], a[144:147], a[40:43], v[196:199]
    v_mfma_f32_16x16x32_bf16 v[200:203], a[144:147], a[48:51], v[200:203]
    v_mfma_f32_16x16x32_bf16 v[200:203], a[148:151], a[52:55], v[200:203]
    v_mfma_f32_16x16x32_bf16 v[204:207], a[148:151], a[60:63], v[204:207]
    v_mfma_f32_16x16x32_bf16 v[204:207], a[144:147], a[56:59], v[204:207]
    ds_read_b128 a[144:147], v231 offset:2048
    s_waitcnt lgkmcnt(5)
    v_mfma_f32_16x16x32_bf16 v[220:223], a[152:155], a[56:59], v[220:223]
    ds_read_b128 a[148:151], v231 offset:3072
    v_mfma_f32_16x16x32_bf16 v[220:223], a[156:159], a[60:63], v[220:223]
    v_mfma_f32_16x16x32_bf16 v[216:219], a[156:159], a[52:55], v[216:219]
    v_mfma_f32_16x16x32_bf16 v[216:219], a[152:155], a[48:51], v[216:219]
    v_mfma_f32_16x16x32_bf16 v[212:215], a[152:155], a[40:43], v[212:215]
    v_mfma_f32_16x16x32_bf16 v[212:215], a[156:159], a[44:47], v[212:215]
    v_mfma_f32_16x16x32_bf16 v[208:211], a[156:159], a[36:39], v[208:211]
    v_mfma_f32_16x16x32_bf16 v[208:211], a[152:155], a[32:35], v[208:211]
    ds_read_b128 a[152:155], v231 offset:30720
    ds_read_b128 a[156:159], v231 offset:31744
    s_waitcnt lgkmcnt(6)
    v_mfma_f32_16x16x32_bf16 v[0:3], a[128:131], a[64:67], v[0:3]
    v_mfma_f32_16x16x32_bf16 v[0:3], a[132:135], a[68:71], v[0:3]
    v_mfma_f32_16x16x32_bf16 v[4:7], a[132:135], a[76:79], v[4:7]
    v_mfma_f32_16x16x32_bf16 v[4:7], a[128:131], a[72:75], v[4:7]
    v_mfma_f32_16x16x32_bf16 v[8:11], a[128:131], a[80:83], v[8:11]
    s_waitcnt vmcnt(0)
    s_barrier
    v_mfma_f32_16x16x32_bf16 v[8:11], a[132:135], a[84:87], v[8:11]
    buffer_atomic_add v243, v242, s[44:47], s13 offen sc1
    v_mfma_f32_16x16x32_bf16 v[12:15], a[132:135], a[92:95], v[12:15]
    v_mfma_f32_16x16x32_bf16 v[12:15], a[128:131], a[88:91], v[12:15]
    ds_read_b128 a[128:131], v231 offset:4096
    s_waitcnt lgkmcnt(5)
    v_mfma_f32_16x16x32_bf16 v[12:15], a[136:139], a[120:123], v[12:15]
    ds_read_b128 a[132:135], v231 offset:5120
    v_mfma_f32_16x16x32_bf16 v[12:15], a[140:143], a[124:127], v[12:15]
    v_mfma_f32_16x16x32_bf16 v[8:11], a[140:143], a[116:119], v[8:11]
    v_mfma_f32_16x16x32_bf16 v[8:11], a[136:139], a[112:115], v[8:11]
    v_mfma_f32_16x16x32_bf16 v[4:7], a[136:139], a[104:107], v[4:7]
    v_mfma_f32_16x16x32_bf16 v[4:7], a[140:143], a[108:111], v[4:7]
    v_mfma_f32_16x16x32_bf16 v[0:3], a[140:143], a[100:103], v[0:3]
    v_mfma_f32_16x16x32_bf16 v[0:3], a[136:139], a[96:99], v[0:3]
    ds_read_b128 a[136:139], v231 offset:32768
    s_waitcnt lgkmcnt(5)
    v_mfma_f32_16x16x32_bf16 v[16:19], a[144:147], a[64:67], v[16:19]
    ds_read_b128 a[140:143], v231 offset:33792
    v_mfma_f32_16x16x32_bf16 v[16:19], a[148:151], a[68:71], v[16:19]
    v_mfma_f32_16x16x32_bf16 v[20:23], a[148:151], a[76:79], v[20:23]
    v_mfma_f32_16x16x32_bf16 v[20:23], a[144:147], a[72:75], v[20:23]
    v_mfma_f32_16x16x32_bf16 v[24:27], a[144:147], a[80:83], v[24:27]
    v_mfma_f32_16x16x32_bf16 v[24:27], a[148:151], a[84:87], v[24:27]
    v_mfma_f32_16x16x32_bf16 v[28:31], a[148:151], a[92:95], v[28:31]
    v_mfma_f32_16x16x32_bf16 v[28:31], a[144:147], a[88:91], v[28:31]
    ds_read_b128 a[144:147], v231 offset:6144
    s_waitcnt lgkmcnt(5)
    v_mfma_f32_16x16x32_bf16 v[28:31], a[152:155], a[120:123], v[28:31]
    ds_read_b128 a[148:151], v231 offset:7168
    v_mfma_f32_16x16x32_bf16 v[28:31], a[156:159], a[124:127], v[28:31]
    v_mfma_f32_16x16x32_bf16 v[24:27], a[156:159], a[116:119], v[24:27]
    v_mfma_f32_16x16x32_bf16 v[24:27], a[152:155], a[112:115], v[24:27]
    v_mfma_f32_16x16x32_bf16 v[20:23], a[152:155], a[104:107], v[20:23]
    v_mfma_f32_16x16x32_bf16 v[20:23], a[156:159], a[108:111], v[20:23]
    v_mfma_f32_16x16x32_bf16 v[16:19], a[156:159], a[100:103], v[16:19]
    v_mfma_f32_16x16x32_bf16 v[16:19], a[152:155], a[96:99], v[16:19]
    ds_read_b128 a[152:155], v231 offset:34816
    s_waitcnt lgkmcnt(5)
    v_mfma_f32_16x16x32_bf16 v[32:35], a[128:131], a[64:67], v[32:35]
    ds_read_b128 a[156:159], v231 offset:35840
    v_mfma_f32_16x16x32_bf16 v[32:35], a[132:135], a[68:71], v[32:35]
    v_mfma_f32_16x16x32_bf16 v[36:39], a[132:135], a[76:79], v[36:39]
    v_mfma_f32_16x16x32_bf16 v[36:39], a[128:131], a[72:75], v[36:39]
    v_mfma_f32_16x16x32_bf16 v[40:43], a[128:131], a[80:83], v[40:43]
    v_mfma_f32_16x16x32_bf16 v[40:43], a[132:135], a[84:87], v[40:43]
    v_mfma_f32_16x16x32_bf16 v[44:47], a[132:135], a[92:95], v[44:47]
    v_mfma_f32_16x16x32_bf16 v[44:47], a[128:131], a[88:91], v[44:47]
    ds_read_b128 a[128:131], v231 offset:8192
    s_waitcnt lgkmcnt(5)
    v_mfma_f32_16x16x32_bf16 v[44:47], a[136:139], a[120:123], v[44:47]
    ds_read_b128 a[132:135], v231 offset:9216
    v_mfma_f32_16x16x32_bf16 v[44:47], a[140:143], a[124:127], v[44:47]
    v_mfma_f32_16x16x32_bf16 v[40:43], a[140:143], a[116:119], v[40:43]
    v_mfma_f32_16x16x32_bf16 v[40:43], a[136:139], a[112:115], v[40:43]
    v_mfma_f32_16x16x32_bf16 v[36:39], a[136:139], a[104:107], v[36:39]
    v_mfma_f32_16x16x32_bf16 v[36:39], a[140:143], a[108:111], v[36:39]
    v_mfma_f32_16x16x32_bf16 v[32:35], a[140:143], a[100:103], v[32:35]
    v_mfma_f32_16x16x32_bf16 v[32:35], a[136:139], a[96:99], v[32:35]
    ds_read_b128 a[136:139], v231 offset:36864
    s_waitcnt lgkmcnt(5)
    v_mfma_f32_16x16x32_bf16 v[48:51], a[144:147], a[64:67], v[48:51]
    ds_read_b128 a[140:143], v231 offset:37888
    v_mfma_f32_16x16x32_bf16 v[48:51], a[148:151], a[68:71], v[48:51]
    v_mfma_f32_16x16x32_bf16 v[52:55], a[148:151], a[76:79], v[52:55]
    v_mfma_f32_16x16x32_bf16 v[52:55], a[144:147], a[72:75], v[52:55]
    v_mfma_f32_16x16x32_bf16 v[56:59], a[144:147], a[80:83], v[56:59]
    v_mfma_f32_16x16x32_bf16 v[56:59], a[148:151], a[84:87], v[56:59]
    v_mfma_f32_16x16x32_bf16 v[60:63], a[148:151], a[92:95], v[60:63]
    v_mfma_f32_16x16x32_bf16 v[60:63], a[144:147], a[88:91], v[60:63]
    ds_read_b128 a[144:147], v231 offset:10240
    s_waitcnt lgkmcnt(5)
    v_mfma_f32_16x16x32_bf16 v[60:63], a[152:155], a[120:123], v[60:63]
    ds_read_b128 a[148:151], v231 offset:11264
    v_mfma_f32_16x16x32_bf16 v[60:63], a[156:159], a[124:127], v[60:63]
    v_mfma_f32_16x16x32_bf16 v[56:59], a[156:159], a[116:119], v[56:59]
    v_mfma_f32_16x16x32_bf16 v[56:59], a[152:155], a[112:115], v[56:59]
    v_mfma_f32_16x16x32_bf16 v[52:55], a[152:155], a[104:107], v[52:55]
    v_mfma_f32_16x16x32_bf16 v[52:55], a[156:159], a[108:111], v[52:55]
    v_mfma_f32_16x16x32_bf16 v[48:51], a[156:159], a[100:103], v[48:51]
    v_mfma_f32_16x16x32_bf16 v[48:51], a[152:155], a[96:99], v[48:51]
    ds_read_b128 a[152:155], v231 offset:38912
    s_waitcnt lgkmcnt(5)
    v_mfma_f32_16x16x32_bf16 v[64:67], a[128:131], a[64:67], v[64:67]
    ds_read_b128 a[156:159], v231 offset:39936
    v_mfma_f32_16x16x32_bf16 v[64:67], a[132:135], a[68:71], v[64:67]
    v_mfma_f32_16x16x32_bf16 v[68:71], a[132:135], a[76:79], v[68:71]
    v_mul_f32 v28, v12, v28
    v_mfma_f32_16x16x32_bf16 v[68:71], a[128:131], a[72:75], v[68:71]
    v_mul_f32 v29, v13, v29
    v_mfma_f32_16x16x32_bf16 v[72:75], a[128:131], a[80:83], v[72:75]
    v_mul_f32 v30, v14, v30
    v_mfma_f32_16x16x32_bf16 v[72:75], a[132:135], a[84:87], v[72:75]
    v_mul_f32 v31, v15, v31
    v_mfma_f32_16x16x32_bf16 v[76:79], a[132:135], a[92:95], v[76:79]
    v_mul_f32 v60, v44, v60
    v_mfma_f32_16x16x32_bf16 v[76:79], a[128:131], a[88:91], v[76:79]
    v_mul_f32 v61, v45, v61
    s_waitcnt lgkmcnt(4)
    v_mfma_f32_16x16x32_bf16 v[76:79], a[136:139], a[120:123], v[76:79]
    v_mul_f32 v62, v46, v62
    v_mfma_f32_16x16x32_bf16 v[76:79], a[140:143], a[124:127], v[76:79]
    v_mul_f32 v63, v47, v63
    v_mfma_f32_16x16x32_bf16 v[72:75], a[140:143], a[116:119], v[72:75]
    v_cvt_pk_bf16_f32 v12, v28, v29
    v_mfma_f32_16x16x32_bf16 v[72:75], a[136:139], a[112:115], v[72:75]
    v_cvt_pk_bf16_f32 v13, v30, v31
    v_mfma_f32_16x16x32_bf16 v[68:71], a[136:139], a[104:107], v[68:71]
    v_cvt_pk_bf16_f32 v14, v60, v61
    ds_read_b128 a[128:131], v231 offset:12288
    ds_read_b128 a[132:135], v231 offset:13312
    v_mfma_f32_16x16x32_bf16 v[68:71], a[140:143], a[108:111], v[68:71]
    v_cvt_pk_bf16_f32 v15, v62, v63
    v_mfma_f32_16x16x32_bf16 v[64:67], a[140:143], a[100:103], v[64:67]
    buffer_store_dwordx4 v[12:15], v224, s[44:47], s60 offen offset:0 sc1
    v_mfma_f32_16x16x32_bf16 v[64:67], a[136:139], a[96:99], v[64:67]
    v_mul_f32 v24, v8, v24
    s_waitcnt lgkmcnt(4)
    v_mfma_f32_16x16x32_bf16 v[80:83], a[144:147], a[64:67], v[80:83]
    v_mul_f32 v25, v9, v25
    v_mfma_f32_16x16x32_bf16 v[80:83], a[148:151], a[68:71], v[80:83]
    v_mul_f32 v26, v10, v26
    v_mfma_f32_16x16x32_bf16 v[84:87], a[148:151], a[76:79], v[84:87]
    v_mul_f32 v27, v11, v27
    v_mfma_f32_16x16x32_bf16 v[84:87], a[144:147], a[72:75], v[84:87]
    v_mul_f32 v56, v40, v56
    v_mfma_f32_16x16x32_bf16 v[88:91], a[144:147], a[80:83], v[88:91]
    v_mul_f32 v57, v41, v57
    ds_read_b128 a[136:139], v231 offset:40960
    ds_read_b128 a[140:143], v231 offset:41984
    v_mfma_f32_16x16x32_bf16 v[88:91], a[148:151], a[84:87], v[88:91]
    v_mul_f32 v58, v42, v58
    v_mfma_f32_16x16x32_bf16 v[92:95], a[148:151], a[92:95], v[92:95]
    v_mul_f32 v59, v43, v59
    v_mfma_f32_16x16x32_bf16 v[92:95], a[144:147], a[88:91], v[92:95]
    v_cvt_pk_bf16_f32 v8, v24, v25
    s_waitcnt lgkmcnt(4)
    v_mfma_f32_16x16x32_bf16 v[92:95], a[152:155], a[120:123], v[92:95]
    v_cvt_pk_bf16_f32 v9, v26, v27
    v_mfma_f32_16x16x32_bf16 v[92:95], a[156:159], a[124:127], v[92:95]
    v_cvt_pk_bf16_f32 v10, v56, v57
    v_mfma_f32_16x16x32_bf16 v[88:91], a[156:159], a[116:119], v[88:91]
    v_cvt_pk_bf16_f32 v11, v58, v59
    v_mfma_f32_16x16x32_bf16 v[88:91], a[152:155], a[112:115], v[88:91]
    buffer_store_dwordx4 v[8:11], v224, s[44:47], s58 offen offset:0 sc1
    v_mfma_f32_16x16x32_bf16 v[84:87], a[152:155], a[104:107], v[84:87]
    v_mul_f32 v20, v4, v20
    ds_read_b128 a[144:147], v231 offset:14336
    ds_read_b128 a[148:151], v231 offset:15360
    v_mfma_f32_16x16x32_bf16 v[84:87], a[156:159], a[108:111], v[84:87]
    v_mul_f32 v21, v5, v21
    v_mfma_f32_16x16x32_bf16 v[80:83], a[156:159], a[100:103], v[80:83]
    v_mul_f32 v22, v6, v22
    v_mfma_f32_16x16x32_bf16 v[80:83], a[152:155], a[96:99], v[80:83]
    v_mul_f32 v23, v7, v23
    s_waitcnt lgkmcnt(4)
    v_mfma_f32_16x16x32_bf16 v[96:99], a[128:131], a[64:67], v[96:99]
    v_mul_f32 v52, v36, v52
    v_mfma_f32_16x16x32_bf16 v[96:99], a[132:135], a[68:71], v[96:99]
    v_mul_f32 v53, v37, v53
    v_mfma_f32_16x16x32_bf16 v[100:103], a[132:135], a[76:79], v[100:103]
    v_mul_f32 v54, v38, v54
    v_mfma_f32_16x16x32_bf16 v[100:103], a[128:131], a[72:75], v[100:103]
    v_mul_f32 v55, v39, v55
    v_mfma_f32_16x16x32_bf16 v[104:107], a[128:131], a[80:83], v[104:107]
    v_cvt_pk_bf16_f32 v4, v20, v21
    ds_read_b128 a[152:155], v231 offset:43008
    ds_read_b128 a[156:159], v231 offset:44032
    v_mfma_f32_16x16x32_bf16 v[104:107], a[132:135], a[84:87], v[104:107]
    v_cvt_pk_bf16_f32 v5, v22, v23
    v_mfma_f32_16x16x32_bf16 v[108:111], a[132:135], a[92:95], v[108:111]
    v_cvt_pk_bf16_f32 v6, v52, v53
    v_mfma_f32_16x16x32_bf16 v[108:111], a[128:131], a[88:91], v[108:111]
    v_cvt_pk_bf16_f32 v7, v54, v55
    s_waitcnt lgkmcnt(4)
    v_mfma_f32_16x16x32_bf16 v[108:111], a[136:139], a[120:123], v[108:111]
    buffer_store_dwordx4 v[4:7], v224, s[44:47], s56 offen offset:0 sc1
    v_mfma_f32_16x16x32_bf16 v[108:111], a[140:143], a[124:127], v[108:111]
    v_mul_f32 v16, v0, v16
    v_mfma_f32_16x16x32_bf16 v[104:107], a[140:143], a[116:119], v[104:107]
    v_mul_f32 v17, v1, v17
    v_mfma_f32_16x16x32_bf16 v[104:107], a[136:139], a[112:115], v[104:107]
    v_mul_f32 v18, v2, v18
    v_mfma_f32_16x16x32_bf16 v[100:103], a[136:139], a[104:107], v[100:103]
    v_mul_f32 v19, v3, v19
    ds_read_b128 a[128:131], v231 offset:16384
    ds_read_b128 a[132:135], v231 offset:17408
    v_mfma_f32_16x16x32_bf16 v[100:103], a[140:143], a[108:111], v[100:103]
    v_mul_f32 v48, v32, v48
    v_mfma_f32_16x16x32_bf16 v[96:99], a[140:143], a[100:103], v[96:99]
    v_mul_f32 v49, v33, v49
    v_mfma_f32_16x16x32_bf16 v[96:99], a[136:139], a[96:99], v[96:99]
    v_mul_f32 v50, v34, v50
    ds_read_b128 a[136:139], v231 offset:45056
    ds_read_b128 a[140:143], v231 offset:46080
    s_waitcnt lgkmcnt(6)
    v_mfma_f32_16x16x32_bf16 v[112:115], a[144:147], a[64:67], v[112:115]
    v_mul_f32 v51, v35, v51
    v_mfma_f32_16x16x32_bf16 v[112:115], a[148:151], a[68:71], v[112:115]
    v_cvt_pk_bf16_f32 v0, v16, v17
    v_mfma_f32_16x16x32_bf16 v[116:119], a[148:151], a[76:79], v[116:119]
    v_cvt_pk_bf16_f32 v1, v18, v19
    v_mfma_f32_16x16x32_bf16 v[116:119], a[144:147], a[72:75], v[116:119]
    v_cvt_pk_bf16_f32 v2, v48, v49
    v_mfma_f32_16x16x32_bf16 v[120:123], a[144:147], a[80:83], v[120:123]
    v_cvt_pk_bf16_f32 v3, v50, v51
    v_mfma_f32_16x16x32_bf16 v[120:123], a[148:151], a[84:87], v[120:123]
    buffer_store_dwordx4 v[0:3], v224, s[44:47], s51 offen offset:0 sc1
    v_mfma_f32_16x16x32_bf16 v[124:127], a[148:151], a[92:95], v[124:127]
    v_mfma_f32_16x16x32_bf16 v[124:127], a[144:147], a[88:91], v[124:127]
    ds_read_b128 a[144:147], v231 offset:18432
    s_waitcnt lgkmcnt(5)
    v_mfma_f32_16x16x32_bf16 v[124:127], a[152:155], a[120:123], v[124:127]
    ds_read_b128 a[148:151], v231 offset:19456
    v_mfma_f32_16x16x32_bf16 v[124:127], a[156:159], a[124:127], v[124:127]
    v_mfma_f32_16x16x32_bf16 v[120:123], a[156:159], a[116:119], v[120:123]
    v_mfma_f32_16x16x32_bf16 v[120:123], a[152:155], a[112:115], v[120:123]
    v_mfma_f32_16x16x32_bf16 v[116:119], a[152:155], a[104:107], v[116:119]
    v_mfma_f32_16x16x32_bf16 v[116:119], a[156:159], a[108:111], v[116:119]
    v_mfma_f32_16x16x32_bf16 v[112:115], a[156:159], a[100:103], v[112:115]
    v_mfma_f32_16x16x32_bf16 v[112:115], a[152:155], a[96:99], v[112:115]
    ds_read_b128 a[152:155], v231 offset:47104
    s_waitcnt lgkmcnt(5)
    v_mfma_f32_16x16x32_bf16 v[128:131], a[128:131], a[64:67], v[128:131]
    ds_read_b128 a[156:159], v231 offset:48128
    v_mfma_f32_16x16x32_bf16 v[128:131], a[132:135], a[68:71], v[128:131]
    v_mfma_f32_16x16x32_bf16 v[132:135], a[132:135], a[76:79], v[132:135]
    v_mul_f32 v92, v76, v92
    v_mfma_f32_16x16x32_bf16 v[132:135], a[128:131], a[72:75], v[132:135]
    v_mul_f32 v93, v77, v93
    v_mfma_f32_16x16x32_bf16 v[136:139], a[128:131], a[80:83], v[136:139]
    v_mul_f32 v94, v78, v94
    v_mfma_f32_16x16x32_bf16 v[136:139], a[132:135], a[84:87], v[136:139]
    v_mul_f32 v95, v79, v95
    v_mfma_f32_16x16x32_bf16 v[140:143], a[132:135], a[92:95], v[140:143]
    v_mul_f32 v124, v108, v124
    v_mfma_f32_16x16x32_bf16 v[140:143], a[128:131], a[88:91], v[140:143]
    v_mul_f32 v125, v109, v125
    s_waitcnt lgkmcnt(4)
    v_mfma_f32_16x16x32_bf16 v[140:143], a[136:139], a[120:123], v[140:143]
    v_mul_f32 v126, v110, v126
    v_mfma_f32_16x16x32_bf16 v[140:143], a[140:143], a[124:127], v[140:143]
    v_mul_f32 v127, v111, v127
    v_mfma_f32_16x16x32_bf16 v[136:139], a[140:143], a[116:119], v[136:139]
    v_cvt_pk_bf16_f32 v76, v92, v93
    v_mfma_f32_16x16x32_bf16 v[136:139], a[136:139], a[112:115], v[136:139]
    v_cvt_pk_bf16_f32 v77, v94, v95
    v_mfma_f32_16x16x32_bf16 v[132:135], a[136:139], a[104:107], v[132:135]
    v_cvt_pk_bf16_f32 v78, v124, v125
    ds_read_b128 a[128:131], v231 offset:20480
    ds_read_b128 a[132:135], v231 offset:21504
    v_mfma_f32_16x16x32_bf16 v[132:135], a[140:143], a[108:111], v[132:135]
    v_cvt_pk_bf16_f32 v79, v126, v127
    v_mfma_f32_16x16x32_bf16 v[128:131], a[140:143], a[100:103], v[128:131]
    buffer_store_dwordx4 v[76:79], v224, s[44:47], s60 offen offset:1024 sc1
    v_mfma_f32_16x16x32_bf16 v[128:131], a[136:139], a[96:99], v[128:131]
    v_mul_f32 v88, v72, v88
    s_waitcnt lgkmcnt(4)
    v_mfma_f32_16x16x32_bf16 v[144:147], a[144:147], a[64:67], v[144:147]
    v_mul_f32 v89, v73, v89
    v_mfma_f32_16x16x32_bf16 v[144:147], a[148:151], a[68:71], v[144:147]
    v_mul_f32 v90, v74, v90
    v_mfma_f32_16x16x32_bf16 v[148:151], a[148:151], a[76:79], v[148:151]
    v_mul_f32 v91, v75, v91
    v_mfma_f32_16x16x32_bf16 v[148:151], a[144:147], a[72:75], v[148:151]
    v_mul_f32 v120, v104, v120
    v_mfma_f32_16x16x32_bf16 v[152:155], a[144:147], a[80:83], v[152:155]
    v_mul_f32 v121, v105, v121
    ds_read_b128 a[136:139], v231 offset:49152
    ds_read_b128 a[140:143], v231 offset:50176
    v_mfma_f32_16x16x32_bf16 v[152:155], a[148:151], a[84:87], v[152:155]
    v_mul_f32 v122, v106, v122
    v_mfma_f32_16x16x32_bf16 v[156:159], a[148:151], a[92:95], v[156:159]
    v_mul_f32 v123, v107, v123
    v_mfma_f32_16x16x32_bf16 v[156:159], a[144:147], a[88:91], v[156:159]
    v_cvt_pk_bf16_f32 v72, v88, v89
    s_waitcnt lgkmcnt(4)
    v_mfma_f32_16x16x32_bf16 v[156:159], a[152:155], a[120:123], v[156:159]
    v_cvt_pk_bf16_f32 v73, v90, v91
    v_mfma_f32_16x16x32_bf16 v[156:159], a[156:159], a[124:127], v[156:159]
    v_cvt_pk_bf16_f32 v74, v120, v121
    v_mfma_f32_16x16x32_bf16 v[152:155], a[156:159], a[116:119], v[152:155]
    v_cvt_pk_bf16_f32 v75, v122, v123
    v_mfma_f32_16x16x32_bf16 v[152:155], a[152:155], a[112:115], v[152:155]
    buffer_store_dwordx4 v[72:75], v224, s[44:47], s58 offen offset:1024 sc1
    v_mfma_f32_16x16x32_bf16 v[148:151], a[152:155], a[104:107], v[148:151]
    v_mul_f32 v84, v68, v84
    ds_read_b128 a[144:147], v231 offset:22528
    ds_read_b128 a[148:151], v231 offset:23552
    v_mfma_f32_16x16x32_bf16 v[148:151], a[156:159], a[108:111], v[148:151]
    v_mul_f32 v85, v69, v85
    v_mfma_f32_16x16x32_bf16 v[144:147], a[156:159], a[100:103], v[144:147]
    v_mul_f32 v86, v70, v86
    v_mfma_f32_16x16x32_bf16 v[144:147], a[152:155], a[96:99], v[144:147]
    v_mul_f32 v87, v71, v87
    s_waitcnt lgkmcnt(4)
    v_mfma_f32_16x16x32_bf16 v[160:163], a[128:131], a[64:67], v[160:163]
    v_mul_f32 v116, v100, v116
    v_mfma_f32_16x16x32_bf16 v[160:163], a[132:135], a[68:71], v[160:163]
    v_mul_f32 v117, v101, v117
    v_mfma_f32_16x16x32_bf16 v[164:167], a[132:135], a[76:79], v[164:167]
    v_mul_f32 v118, v102, v118
    v_mfma_f32_16x16x32_bf16 v[164:167], a[128:131], a[72:75], v[164:167]
    v_mul_f32 v119, v103, v119
    v_mfma_f32_16x16x32_bf16 v[168:171], a[128:131], a[80:83], v[168:171]
    v_cvt_pk_bf16_f32 v68, v84, v85
    ds_read_b128 a[152:155], v231 offset:51200
    ds_read_b128 a[156:159], v231 offset:52224
    v_mfma_f32_16x16x32_bf16 v[168:171], a[132:135], a[84:87], v[168:171]
    v_cvt_pk_bf16_f32 v69, v86, v87
    v_mfma_f32_16x16x32_bf16 v[172:175], a[132:135], a[92:95], v[172:175]
    v_cvt_pk_bf16_f32 v70, v116, v117
    v_mfma_f32_16x16x32_bf16 v[172:175], a[128:131], a[88:91], v[172:175]
    v_cvt_pk_bf16_f32 v71, v118, v119
    s_waitcnt lgkmcnt(4)
    v_mfma_f32_16x16x32_bf16 v[172:175], a[136:139], a[120:123], v[172:175]
    buffer_store_dwordx4 v[68:71], v224, s[44:47], s56 offen offset:1024 sc1
    v_mfma_f32_16x16x32_bf16 v[172:175], a[140:143], a[124:127], v[172:175]
    v_mul_f32 v80, v64, v80
    v_mfma_f32_16x16x32_bf16 v[168:171], a[140:143], a[116:119], v[168:171]
    v_mul_f32 v81, v65, v81
    v_mfma_f32_16x16x32_bf16 v[168:171], a[136:139], a[112:115], v[168:171]
    v_mul_f32 v82, v66, v82
    v_mfma_f32_16x16x32_bf16 v[164:167], a[136:139], a[104:107], v[164:167]
    v_mul_f32 v83, v67, v83
    ds_read_b128 a[128:131], v231 offset:24576
    ds_read_b128 a[132:135], v231 offset:25600
    v_mfma_f32_16x16x32_bf16 v[164:167], a[140:143], a[108:111], v[164:167]
    v_mul_f32 v112, v96, v112
    v_mfma_f32_16x16x32_bf16 v[160:163], a[140:143], a[100:103], v[160:163]
    v_mul_f32 v113, v97, v113
    v_mfma_f32_16x16x32_bf16 v[160:163], a[136:139], a[96:99], v[160:163]
    v_mul_f32 v114, v98, v114
    s_waitcnt lgkmcnt(4)
    v_mfma_f32_16x16x32_bf16 v[176:179], a[144:147], a[64:67], v[176:179]
    v_mul_f32 v115, v99, v115
    v_mfma_f32_16x16x32_bf16 v[176:179], a[148:151], a[68:71], v[176:179]
    v_cvt_pk_bf16_f32 v64, v80, v81
    v_mfma_f32_16x16x32_bf16 v[180:183], a[148:151], a[76:79], v[180:183]
    v_cvt_pk_bf16_f32 v65, v82, v83
    v_mfma_f32_16x16x32_bf16 v[180:183], a[144:147], a[72:75], v[180:183]
    v_cvt_pk_bf16_f32 v66, v112, v113
    v_mfma_f32_16x16x32_bf16 v[184:187], a[144:147], a[80:83], v[184:187]
    v_cvt_pk_bf16_f32 v67, v114, v115
    ds_read_b128 a[136:139], v231 offset:53248
    ds_read_b128 a[140:143], v231 offset:54272
    v_mfma_f32_16x16x32_bf16 v[184:187], a[148:151], a[84:87], v[184:187]
    buffer_store_dwordx4 v[64:67], v224, s[44:47], s51 offen offset:1024 sc1
    v_mfma_f32_16x16x32_bf16 v[188:191], a[148:151], a[92:95], v[188:191]
    v_mfma_f32_16x16x32_bf16 v[188:191], a[144:147], a[88:91], v[188:191]
    ds_read_b128 a[144:147], v231 offset:26624
    s_waitcnt lgkmcnt(5)
    v_mfma_f32_16x16x32_bf16 v[188:191], a[152:155], a[120:123], v[188:191]
    ds_read_b128 a[148:151], v231 offset:27648
    v_mfma_f32_16x16x32_bf16 v[188:191], a[156:159], a[124:127], v[188:191]
    v_mfma_f32_16x16x32_bf16 v[184:187], a[156:159], a[116:119], v[184:187]
    v_mfma_f32_16x16x32_bf16 v[184:187], a[152:155], a[112:115], v[184:187]
    v_mfma_f32_16x16x32_bf16 v[180:183], a[152:155], a[104:107], v[180:183]
    v_mfma_f32_16x16x32_bf16 v[180:183], a[156:159], a[108:111], v[180:183]
    v_mfma_f32_16x16x32_bf16 v[176:179], a[156:159], a[100:103], v[176:179]
    v_mfma_f32_16x16x32_bf16 v[176:179], a[152:155], a[96:99], v[176:179]
    ds_read_b128 a[152:155], v231 offset:55296
    s_waitcnt lgkmcnt(5)
    v_mfma_f32_16x16x32_bf16 v[192:195], a[128:131], a[64:67], v[192:195]
    ds_read_b128 a[156:159], v231 offset:56320
    v_mfma_f32_16x16x32_bf16 v[192:195], a[132:135], a[68:71], v[192:195]
    v_mfma_f32_16x16x32_bf16 v[196:199], a[132:135], a[76:79], v[196:199]
    v_mul_f32 v156, v140, v156
    v_mul_f32 v157, v141, v157
    v_mfma_f32_16x16x32_bf16 v[196:199], a[128:131], a[72:75], v[196:199]
    v_mul_f32 v158, v142, v158
    v_mul_f32 v159, v143, v159
    v_mfma_f32_16x16x32_bf16 v[200:203], a[128:131], a[80:83], v[200:203]
    v_mul_f32 v188, v172, v188
    v_mul_f32 v189, v173, v189
    v_mfma_f32_16x16x32_bf16 v[200:203], a[132:135], a[84:87], v[200:203]
    v_mul_f32 v190, v174, v190
    v_mul_f32 v191, v175, v191
    v_mfma_f32_16x16x32_bf16 v[204:207], a[132:135], a[92:95], v[204:207]
    v_cvt_pk_bf16_f32 v140, v156, v157
    v_cvt_pk_bf16_f32 v141, v158, v159
    v_mfma_f32_16x16x32_bf16 v[204:207], a[128:131], a[88:91], v[204:207]
    v_cvt_pk_bf16_f32 v142, v188, v189
    v_cvt_pk_bf16_f32 v143, v190, v191
    s_waitcnt lgkmcnt(4)
    v_mfma_f32_16x16x32_bf16 v[204:207], a[136:139], a[120:123], v[204:207]
    buffer_store_dwordx4 v[140:143], v224, s[44:47], s60 offen offset:2048 sc1
    v_mfma_f32_16x16x32_bf16 v[204:207], a[140:143], a[124:127], v[204:207]
    v_mul_f32 v152, v136, v152
    v_mul_f32 v153, v137, v153
    v_mfma_f32_16x16x32_bf16 v[200:203], a[140:143], a[116:119], v[200:203]
    v_mul_f32 v154, v138, v154
    v_mul_f32 v155, v139, v155
    v_mfma_f32_16x16x32_bf16 v[200:203], a[136:139], a[112:115], v[200:203]
    v_mul_f32 v184, v168, v184
    v_mul_f32 v185, v169, v185
    v_mfma_f32_16x16x32_bf16 v[196:199], a[136:139], a[104:107], v[196:199]
    v_mul_f32 v186, v170, v186
    v_mul_f32 v187, v171, v187
    v_mfma_f32_16x16x32_bf16 v[196:199], a[140:143], a[108:111], v[196:199]
    v_cvt_pk_bf16_f32 v136, v152, v153
    v_cvt_pk_bf16_f32 v137, v154, v155
    v_mfma_f32_16x16x32_bf16 v[192:195], a[140:143], a[100:103], v[192:195]
    v_cvt_pk_bf16_f32 v138, v184, v185
    v_cvt_pk_bf16_f32 v139, v186, v187
    v_mfma_f32_16x16x32_bf16 v[192:195], a[136:139], a[96:99], v[192:195]
    buffer_store_dwordx4 v[136:139], v224, s[44:47], s58 offen offset:2048 sc1
    s_waitcnt lgkmcnt(2)
    v_mfma_f32_16x16x32_bf16 v[208:211], a[144:147], a[64:67], v[208:211]
    v_mul_f32 v148, v132, v148
    v_mul_f32 v149, v133, v149
    v_mfma_f32_16x16x32_bf16 v[208:211], a[148:151], a[68:71], v[208:211]
    v_mul_f32 v150, v134, v150
    v_mul_f32 v151, v135, v151
    v_mfma_f32_16x16x32_bf16 v[212:215], a[148:151], a[76:79], v[212:215]
    v_mul_f32 v180, v164, v180
    v_mul_f32 v181, v165, v181
    v_mfma_f32_16x16x32_bf16 v[212:215], a[144:147], a[72:75], v[212:215]
    v_mul_f32 v182, v166, v182
    v_mul_f32 v183, v167, v183
    v_mfma_f32_16x16x32_bf16 v[216:219], a[144:147], a[80:83], v[216:219]
    v_cvt_pk_bf16_f32 v132, v148, v149
    v_cvt_pk_bf16_f32 v133, v150, v151
    v_mfma_f32_16x16x32_bf16 v[216:219], a[148:151], a[84:87], v[216:219]
    v_cvt_pk_bf16_f32 v134, v180, v181
    v_cvt_pk_bf16_f32 v135, v182, v183
    v_mfma_f32_16x16x32_bf16 v[220:223], a[148:151], a[92:95], v[220:223]
    buffer_store_dwordx4 v[132:135], v224, s[44:47], s56 offen offset:2048 sc1
    v_mfma_f32_16x16x32_bf16 v[220:223], a[144:147], a[88:91], v[220:223]
    v_mul_f32 v144, v128, v144
    v_mul_f32 v145, v129, v145
    s_waitcnt lgkmcnt(0)
    v_mfma_f32_16x16x32_bf16 v[220:223], a[152:155], a[120:123], v[220:223]
    v_mul_f32 v146, v130, v146
    v_mul_f32 v147, v131, v147
    v_mfma_f32_16x16x32_bf16 v[220:223], a[156:159], a[124:127], v[220:223]
    v_mul_f32 v176, v160, v176
    v_mul_f32 v177, v161, v177
    v_mfma_f32_16x16x32_bf16 v[216:219], a[156:159], a[116:119], v[216:219]
    v_mul_f32 v178, v162, v178
    v_mul_f32 v179, v163, v179
    v_mfma_f32_16x16x32_bf16 v[216:219], a[152:155], a[112:115], v[216:219]
    v_cvt_pk_bf16_f32 v128, v144, v145
    v_cvt_pk_bf16_f32 v129, v146, v147
    v_mfma_f32_16x16x32_bf16 v[212:215], a[152:155], a[104:107], v[212:215]
    v_cvt_pk_bf16_f32 v130, v176, v177
    v_cvt_pk_bf16_f32 v131, v178, v179
    v_mfma_f32_16x16x32_bf16 v[212:215], a[156:159], a[108:111], v[212:215]
    buffer_store_dwordx4 v[128:131], v224, s[44:47], s51 offen offset:2048 sc1
    v_mfma_f32_16x16x32_bf16 v[208:211], a[156:159], a[100:103], v[208:211]
    v_mfma_f32_16x16x32_bf16 v[208:211], a[152:155], a[96:99], v[208:211]
    s_nop 7
    v_mul_f32 v220, v204, v220
    v_mul_f32 v221, v205, v221
    v_mul_f32 v222, v206, v222
    v_mul_f32 v223, v207, v223
    v_cvt_pk_bf16_f32 v204, v220, v221
    v_cvt_pk_bf16_f32 v205, v222, v223
    buffer_store_dwordx2 v[204:205], v224, s[44:47], s61 offen sc1
    v_mul_f32 v216, v200, v216
    v_mul_f32 v217, v201, v217
    v_mul_f32 v218, v202, v218
    v_mul_f32 v219, v203, v219
    v_cvt_pk_bf16_f32 v200, v216, v217
    v_cvt_pk_bf16_f32 v201, v218, v219
    buffer_store_dwordx2 v[200:201], v224, s[44:47], s59 offen sc1
    v_mul_f32 v212, v196, v212
    v_mul_f32 v213, v197, v213
    v_mul_f32 v214, v198, v214
    v_mul_f32 v215, v199, v215
    v_cvt_pk_bf16_f32 v196, v212, v213
    v_cvt_pk_bf16_f32 v197, v214, v215
    buffer_store_dwordx2 v[196:197], v224, s[44:47], s57 offen sc1
    v_mul_f32 v208, v192, v208
    v_mul_f32 v209, v193, v209
    v_mul_f32 v210, v194, v210
    v_mul_f32 v211, v195, v211
    v_cvt_pk_bf16_f32 v192, v208, v209
    v_cvt_pk_bf16_f32 v193, v210, v211
    buffer_store_dwordx2 v[192:193], v224, s[44:47], s52 offen sc1
    s_lshl_b32 s19, s37, 7
    s_add_u32 s19, s19, 54343680
    v_min_u32 v233, 1, v232
    v_lshlrev_b32 v233, 26, v233
    v_mov_b32 v234, 1
    s_cmp_eq_u32 s34, 0
    s_cselect_b32 s18, s19, 0x7ff00000
    s_waitcnt vmcnt(0)
    s_barrier
    buffer_atomic_add v234, v233, s[44:47], s18 offen sc1
END_PH_u0:
PH_d0:
    v_mbcnt_lo_u32_b32 v40, -1, 0
    v_mbcnt_hi_u32_b32 v40, -1, v40
    s_and_b32 s35, s2, 7
    s_lshr_b32 s36, s2, 3
    s_lshr_b32 s37, s35, 1
    s_lshl_b32 s37, s37, 2
    s_lshr_b32 s38, s36, 3
    s_add_u32 s37, s37, s38
    s_and_b32 s38, s35, 1
    s_lshl_b32 s38, s38, 3
    s_and_b32 s39, s36, 7
    s_add_u32 s38, s38, s39
    v_lshlrev_b32 v32, 4, v40
    v_add_u32 v33, 114688, v32
    s_mul_i32 s26, s34, 2048
    v_add_u32 v34, s26, v32
    s_lshl_b32 s42, s37, 3
    s_lshl_b32 s43, s34, 1
    s_add_u32 s42, s42, s43
    s_mul_i32 s25, s42, 114688
    s_add_u32 s25, s25, 8388608
    s_mul_i32 s24, s38, 458752
    s_add_u32 s24, s24, 46137344
    s_lshr_b32 s19, s38, 2
    s_lshl_b32 s19, s19, 7
    s_add_u32 s19, s19, 54347776
    v_mov_b32 v41, 0
    s_mov_b32 s17, 0
Pd0w:
    buffer_load_dword v42, v41, s[44:47], s19 offen sc1
    s_waitcnt vmcnt(0)
    v_readfirstlane_b32 s16, v42
    s_cmp_ge_u32 s16, 64
    s_cbranch_scc1 PEd0w
    s_sleep 1
    s_add_u32 s17, s17, 1
    s_cmp_lt_u32 s17, 0x40000
    s_cbranch_scc1 Pd0w
PEd0w:
    s_add_u32 m0, s26, 0
    s_nop 0
    buffer_load_dwordx4 v34, s[44:47], s24 offen offset:0 sc1 lds
    buffer_load_dwordx4 v34, s[44:47], s24 offen offset:1024 sc1 lds
    s_add_u32 m0, s26, 8192
    s_add_u32 s24, s24, 8192
    buffer_load_dwordx4 v34, s[44:47], s24 offen offset:0 sc1 lds
    buffer_load_dwordx4 v34, s[44:47], s24 offen offset:1024 sc1 lds
    s_add_u32 m0, s26, 16384
    s_add_u32 s24, s24, 8192
    buffer_load_dwordx4 v34, s[44:47], s24 offen offset:0 sc1 lds
    buffer_load_dwordx4 v34, s[44:47], s24 offen offset:1024 sc1 lds
    s_add_u32 m0, s26, 24576
    s_add_u32 s24, s24, 8192
    buffer_load_dwordx4 v34, s[44:47], s24 offen offset:0 sc1 lds
    buffer_load_dwordx4 v34, s[44:47], s24 offen offset:1024 sc1 lds
    s_add_u32 m0, s26, 32768
    s_add_u32 s24, s24, 8192
    buffer_load_dwordx4 v34, s[44:47], s24 offen offset:0 sc1 lds
    buffer_load_dwordx4 v34, s[44:47], s24 offen offset:1024 sc1 lds
    s_add_u32 m0, s26, 40960
    s_add_u32 s24, s24, 8192
    buffer_load_dwordx4 v34, s[44:47], s24 offen offset:0 sc1 lds
    buffer_load_dwordx4 v34, s[44:47], s24 offen offset:1024 sc1 lds
    s_add_u32 m0, s26, 49152
    s_add_u32 s24, s24, 8192
    buffer_load_dwordx4 v34, s[44:47], s24 offen offset:0 sc1 lds
    buffer_load_dwordx4 v34, s[44:47], s24 offen offset:1024 sc1 lds
    v_mov_b32 v36, v32
    v_and_b32 v44, 31, v40
    v_and_b32 v41, 15, v40
    v_lshrrev_b32 v42, 4, v40
    v_lshlrev_b32 v45, 4, v41
    v_lshl_add_u32 v45, v42, 2, v45
    v_mov_b32 v35, 0x3f803f80
    s_lshl_b32 s54, s42, 15
    s_lshl_b32 s55, s38, 11
    s_add_u32 s48, s54, s55
    s_add_u32 s49, s48, 32768
    s_lshl_b32 s54, s42, 11
    s_lshl_b32 s55, s38, 8
    s_add_u32 s52, s54, s55
    s_add_u32 s52, s52, 53477376
    s_add_u32 s53, s54, 53739520
    s_lshr_b32 s19, s37, 1
    s_lshl_b32 s19, s19, 7
    s_add_u32 s19, s19, 54343680
    s_cmp_lg_u32 s34, 0
    s_cbranch_scc1 PEd0g
    v_mov_b32 v41, 0
    s_mov_b32 s17, 0
Pd0g:
    buffer_load_dword v42, v41, s[44:47], s19 offen sc1
    s_waitcnt vmcnt(0)
    v_readfirstlane_b32 s16, v42
    s_cmp_ge_u32 s16, 32
    s_cbranch_scc1 PEd0g
    s_sleep 4
    s_add_u32 s17, s17, 1
    s_cmp_lt_u32 s17, 0x40000
    s_cbranch_scc1 Pd0g
PEd0g:
    s_waitcnt vmcnt(0)
    s_barrier
    buffer_load_dwordx4 a[0:3], v32, s[44:47], s25 offen offset:0 sc1
    buffer_load_dwordx4 a[4:7], v32, s[44:47], s25 offen offset:1024 sc1
    buffer_load_dwordx4 a[8:11], v33, s[44:47], s25 offen offset:0 sc1
    buffer_load_dwordx4 a[12:15], v33, s[44:47], s25 offen offset:1024 sc1
    s_add_u32 s25, s25, 2048
    buffer_load_dwordx4 a[16:19], v32, s[44:47], s25 offen offset:0 sc1
    buffer_load_dwordx4 a[20:23], v32, s[44:47], s25 offen offset:1024 sc1
    buffer_load_dwordx4 a[24:27], v33, s[44:47], s25 offen offset:0 sc1
    buffer_load_dwordx4 a[28:31], v33, s[44:47], s25 offen offset:1024 sc1
    s_waitcnt vmcnt(20)
    s_barrier
    ds_read_b128 a[64:67], v36 offset:0
    ds_read_b128 a[68:71], v36 offset:1024
    ds_read_b128 a[72:75], v36 offset:2048
    ds_read_b128 a[76:79], v36 offset:3072
    s_waitcnt vmcnt(6) lgkmcnt(2)
    v_mfma_f32_16x16x32_bf16 v[0:3], a[64:67], a[0:3], 0
    s_add_u32 s25, s25, 2048
    buffer_load_dwordx4 a[32:35], v32, s[44:47], s25 offen offset:0 sc1
    v_mfma_f32_16x16x32_bf16 v[0:3], a[68:71], a[4:7], v[0:3]
    buffer_load_dwordx4 a[36:39], v32, s[44:47], s25 offen offset:1024 sc1
    s_waitcnt vmcnt(6)
    v_mfma_f32_16x16x32_bf16 v[4:7], a[68:71], a[12:15], 0
    buffer_load_dwordx4 a[40:43], v33, s[44:47], s25 offen offset:0 sc1
    v_mfma_f32_16x16x32_bf16 v[4:7], a[64:67], a[8:11], v[4:7]
    buffer_load_dwordx4 a[44:47], v33, s[44:47], s25 offen offset:1024 sc1
    s_waitcnt lgkmcnt(0)
    v_mfma_f32_16x16x32_bf16 v[12:15], a[72:75], a[8:11], 0
    s_add_u32 s25, s25, 2048
    buffer_load_dwordx4 a[48:51], v32, s[44:47], s25 offen offset:0 sc1
    v_mfma_f32_16x16x32_bf16 v[12:15], a[76:79], a[12:15], v[12:15]
    ds_read_b128 a[64:67], v36 offset:4096
    ds_read_b128 a[68:71], v36 offset:5120
    v_mfma_f32_16x16x32_bf16 v[8:11], a[76:79], a[4:7], 0
    buffer_load_dwordx4 a[52:55], v32, s[44:47], s25 offen offset:1024 sc1
    v_mfma_f32_16x16x32_bf16 v[8:11], a[72:75], a[0:3], v[8:11]
    ds_read_b128 a[72:75], v36 offset:6144
    s_waitcnt lgkmcnt(1)
    v_mfma_f32_16x16x32_bf16 v[16:19], a[64:67], a[0:3], 0
    ds_read_b128 a[76:79], v36 offset:7168
    v_mfma_f32_16x16x32_bf16 v[16:19], a[68:71], a[4:7], v[16:19]
    v_mfma_f32_16x16x32_bf16 v[20:23], a[68:71], a[12:15], 0
    buffer_load_dwordx4 a[56:59], v33, s[44:47], s25 offen offset:0 sc1
    s_barrier
    v_mfma_f32_16x16x32_bf16 v[20:23], a[64:67], a[8:11], v[20:23]
    ds_read_b128 a[64:67], v36 offset:8192
    s_waitcnt lgkmcnt(1)
    v_mfma_f32_16x16x32_bf16 v[28:31], a[72:75], a[8:11], 0
    s_add_u32 m0, s26, 57344
    s_add_u32 s24, s24, 8192
    buffer_load_dwordx4 v34, s[44:47], s24 offen offset:0 sc1 lds
    v_mfma_f32_16x16x32_bf16 v[28:31], a[76:79], a[12:15], v[28:31]
    ds_read_b128 a[68:71], v36 offset:9216
    v_mfma_f32_16x16x32_bf16 v[24:27], a[76:79], a[4:7], 0
    buffer_load_dwordx4 a[60:63], v33, s[44:47], s25 offen offset:1024 sc1
    v_mfma_f32_16x16x32_bf16 v[24:27], a[72:75], a[0:3], v[24:27]
    ds_read_b128 a[72:75], v36 offset:10240
    ds_read_b128 a[76:79], v36 offset:11264
    s_waitcnt vmcnt(11) lgkmcnt(2)
    v_mfma_f32_16x16x32_bf16 v[0:3], a[64:67], a[16:19], v[0:3]
    v_mfma_f32_16x16x32_bf16 v[0:3], a[68:71], a[20:23], v[0:3]
    s_waitcnt vmcnt(9)
    v_mfma_f32_16x16x32_bf16 v[4:7], a[68:71], a[28:31], v[4:7]
    s_add_u32 s25, s25, 2048
    buffer_load_dwordx4 a[0:3], v32, s[44:47], s25 offen offset:0 sc1
    v_mfma_f32_16x16x32_bf16 v[4:7], a[64:67], a[24:27], v[4:7]
    buffer_load_dwordx4 v[48:51], v32, s[44:47], s53 offen offset:0 sc1
    buffer_load_dwordx4 v34, s[44:47], s24 offen offset:1024 sc1 lds
    s_waitcnt lgkmcnt(0)
    v_mfma_f32_16x16x32_bf16 v[12:15], a[72:75], a[24:27], v[12:15]
    ds_read_b128 a[64:67], v36 offset:12288
    v_mfma_f32_16x16x32_bf16 v[12:15], a[76:79], a[28:31], v[12:15]
    ds_read_b128 a[68:71], v36 offset:13312
    v_mfma_f32_16x16x32_bf16 v[8:11], a[76:79], a[20:23], v[8:11]
    buffer_load_dwordx4 v[64:67], v32, s[44:47], s48 offen offset:0 sc1
    buffer_load_dwordx4 a[4:7], v32, s[44:47], s25 offen offset:1024 sc1
    v_mfma_f32_16x16x32_bf16 v[8:11], a[72:75], a[16:19], v[8:11]
    ds_read_b128 a[72:75], v36 offset:14336
    s_waitcnt lgkmcnt(1)
    v_mfma_f32_16x16x32_bf16 v[16:19], a[64:67], a[16:19], v[16:19]
    ds_read_b128 a[76:79], v36 offset:15360
    v_mfma_f32_16x16x32_bf16 v[16:19], a[68:71], a[20:23], v[16:19]
    v_mfma_f32_16x16x32_bf16 v[20:23], a[68:71], a[28:31], v[20:23]
    buffer_load_dwordx4 a[8:11], v33, s[44:47], s25 offen offset:0 sc1
    s_barrier
    v_mfma_f32_16x16x32_bf16 v[20:23], a[64:67], a[24:27], v[20:23]
    buffer_load_dwordx4 v[52:55], v32, s[44:47], s53 offen offset:1024 sc1
    s_waitcnt lgkmcnt(0)
    v_mfma_f32_16x16x32_bf16 v[28:31], a[72:75], a[24:27], v[28:31]
    s_add_u32 m0, s26, 0
    s_add_u32 s24, s24, 8192
    buffer_load_dwordx4 v34, s[44:47], s24 offen offset:0 sc1 lds
    v_mfma_f32_16x16x32_bf16 v[28:31], a[76:79], a[28:31], v[28:31]
    ds_read_b128 a[64:67], v36 offset:16384
    ds_read_b128 a[68:71], v36 offset:17408
    v_mfma_f32_16x16x32_bf16 v[24:27], a[76:79], a[20:23], v[24:27]
    buffer_load_dwordx4 v[68:71], v32, s[44:47], s48 offen offset:1024 sc1
    buffer_load_dwordx4 a[12:15], v33, s[44:47], s25 offen offset:1024 sc1
    v_mfma_f32_16x16x32_bf16 v[24:27], a[72:75], a[16:19], v[24:27]
    ds_read_b128 a[72:75], v36 offset:18432
    ds_read_b128 a[76:79], v36 offset:19456
    s_waitcnt vmcnt(15) lgkmcnt(2)
    v_mfma_f32_16x16x32_bf16 v[0:3], a[64:67], a[32:35], v[0:3]
    v_mfma_f32_16x16x32_bf16 v[0:3], a[68:71], a[36:39], v[0:3]
    v_mfma_f32_16x16x32_bf16 v[4:7], a[68:71], a[44:47], v[4:7]
    s_add_u32 s25, s25, 2048
    buffer_load_dwordx4 a[16:19], v32, s[44:47], s25 offen offset:0 sc1
    v_mfma_f32_16x16x32_bf16 v[4:7], a[64:67], a[40:43], v[4:7]
    buffer_load_dwordx4 v[56:59], v32, s[44:47], s53 offen offset:2048 sc1
    buffer_load_dwordx4 v34, s[44:47], s24 offen offset:1024 sc1 lds
    s_waitcnt lgkmcnt(0)
    v_mfma_f32_16x16x32_bf16 v[12:15], a[72:75], a[40:43], v[12:15]
    ds_read_b128 a[64:67], v36 offset:20480
    v_mfma_f32_16x16x32_bf16 v[12:15], a[76:79], a[44:47], v[12:15]
    ds_read_b128 a[68:71], v36 offset:21504
    v_mfma_f32_16x16x32_bf16 v[8:11], a[76:79], a[36:39], v[8:11]
    buffer_load_dwordx4 v[72:75], v32, s[44:47], s49 offen offset:0 sc1
    buffer_load_dwordx4 a[20:23], v32, s[44:47], s25 offen offset:1024 sc1
    v_mfma_f32_16x16x32_bf16 v[8:11], a[72:75], a[32:35], v[8:11]
    ds_read_b128 a[72:75], v36 offset:22528
    s_waitcnt lgkmcnt(1)
    v_mfma_f32_16x16x32_bf16 v[16:19], a[64:67], a[32:35], v[16:19]
    ds_read_b128 a[76:79], v36 offset:23552
    v_mfma_f32_16x16x32_bf16 v[16:19], a[68:71], a[36:39], v[16:19]
    v_mfma_f32_16x16x32_bf16 v[20:23], a[68:71], a[44:47], v[20:23]
    buffer_load_dwordx4 a[24:27], v33, s[44:47], s25 offen offset:0 sc1
    s_barrier
    v_mfma_f32_16x16x32_bf16 v[20:23], a[64:67], a[40:43], v[20:23]
    buffer_load_dwordx4 v[60:63], v32, s[44:47], s53 offen offset:3072 sc1
    s_waitcnt lgkmcnt(0)
    v_mfma_f32_16x16x32_bf16 v[28:31], a[72:75], a[40:43], v[28:31]
    s_add_u32 m0, s26, 8192
    s_add_u32 s24, s24, 8192
    buffer_load_dwordx4 v34, s[44:47], s24 offen offset:0 sc1 lds
    v_mfma_f32_16x16x32_bf16 v[28:31], a[76:79], a[44:47], v[28:31]
    ds_read_b128 a[64:67], v36 offset:24576
    ds_read_b128 a[68:71], v36 offset:25600
    v_mfma_f32_16x16x32_bf16 v[24:27], a[76:79], a[36:39], v[24:27]
    buffer_load_dwordx4 v[76:79], v32, s[44:47], s49 offen offset:1024 sc1
    buffer_load_dwordx4 a[28:31], v33, s[44:47], s25 offen offset:1024 sc1
    v_mfma_f32_16x16x32_bf16 v[24:27], a[72:75], a[32:35], v[24:27]
    ds_read_b128 a[72:75], v36 offset:26624
    ds_read_b128 a[76:79], v36 offset:27648
    s_waitcnt vmcnt(20) lgkmcnt(2)
    v_mfma_f32_16x16x32_bf16 v[0:3], a[64:67], a[48:51], v[0:3]
    v_mfma_f32_16x16x32_bf16 v[0:3], a[68:71], a[52:55], v[0:3]
    v_mfma_f32_16x16x32_bf16 v[4:7], a[68:71], a[60:63], v[4:7]
    s_add_u32 s25, s25, 2048
    buffer_load_dwordx4 a[32:35], v32, s[44:47], s25 offen offset:0 sc1
    v_mfma_f32_16x16x32_bf16 v[4:7], a[64:67], a[56:59], v[4:7]
    buffer_load_dwordx4 v34, s[44:47], s24 offen offset:1024 sc1 lds
    s_waitcnt lgkmcnt(0)
    v_mfma_f32_16x16x32_bf16 v[12:15], a[72:75], a[56:59], v[12:15]
    ds_read_b128 a[64:67], v36 offset:28672
    v_mfma_f32_16x16x32_bf16 v[12:15], a[76:79], a[60:63], v[12:15]
    ds_read_b128 a[68:71], v36 offset:29696
    v_mfma_f32_16x16x32_bf16 v[8:11], a[76:79], a[52:55], v[8:11]
    buffer_load_dwordx4 a[36:39], v32, s[44:47], s25 offen offset:1024 sc1
    v_mfma_f32_16x16x32_bf16 v[8:11], a[72:75], a[48:51], v[8:11]
    ds_read_b128 a[72:75], v36 offset:30720
    s_waitcnt lgkmcnt(1)
    v_mfma_f32_16x16x32_bf16 v[16:19], a[64:67], a[48:51], v[16:19]
    ds_read_b128 a[76:79], v36 offset:31744
    v_mfma_f32_16x16x32_bf16 v[16:19], a[68:71], a[52:55], v[16:19]
    v_mfma_f32_16x16x32_bf16 v[20:23], a[68:71], a[60:63], v[20:23]
    buffer_load_dwordx4 a[40:43], v33, s[44:47], s25 offen offset:0 sc1
    s_barrier
    v_mfma_f32_16x16x32_bf16 v[20:23], a[64:67], a[56:59], v[20:23]
    ds_read_b128 a[64:67], v36 offset:32768
    s_waitcnt lgkmcnt(1)
    v_mfma_f32_16x16x32_bf16 v[28:31], a[72:75], a[56:59], v[28:31]
    s_add_u32 m0, s26, 16384
    s_add_u32 s24, s24, 8192
    buffer_load_dwordx4 v34, s[44:47], s24 offen offset:0 sc1 lds
    v_mfma_f32_16x16x32_bf16 v[28:31], a[76:79], a[60:63], v[28:31]
    ds_read_b128 a[68:71], v36 offset:33792
    v_mfma_f32_16x16x32_bf16 v[24:27], a[76:79], a[52:55], v[24:27]
    buffer_load_dwordx4 a[44:47], v33, s[44:47], s25 offen offset:1024 sc1
    v_mfma_f32_16x16x32_bf16 v[24:27], a[72:75], a[48:51], v[24:27]
    ds_read_b128 a[72:75], v36 offset:34816
    ds_read_b128 a[76:79], v36 offset:35840
    s_waitcnt vmcnt(16) lgkmcnt(2)
    v_mfma_f32_16x16x32_bf16 v[0:3], a[64:67], a[0:3], v[0:3]
    v_mfma_f32_16x16x32_bf16 v[0:3], a[68:71], a[4:7], v[0:3]
    v_mfma_f32_16x16x32_bf16 v[4:7], a[68:71], a[12:15], v[4:7]
    s_add_u32 s25, s25, 2048
    buffer_load_dwordx4 a[48:51], v32, s[44:47], s25 offen offset:0 sc1
    v_mfma_f32_16x16x32_bf16 v[4:7], a[64:67], a[8:11], v[4:7]
    buffer_load_dwordx4 v34, s[44:47], s24 offen offset:1024 sc1 lds
    s_waitcnt lgkmcnt(0)
    v_mfma_f32_16x16x32_bf16 v[12:15], a[72:75], a[8:11], v[12:15]
    ds_read_b128 a[64:67], v36 offset:36864
    v_mfma_f32_16x16x32_bf16 v[12:15], a[76:79], a[12:15], v[12:15]
    ds_read_b128 a[68:71], v36 offset:37888
    v_mfma_f32_16x16x32_bf16 v[8:11], a[76:79], a[4:7], v[8:11]
    buffer_load_dwordx4 a[52:55], v32, s[44:47], s25 offen offset:1024 sc1
    v_mfma_f32_16x16x32_bf16 v[8:11], a[72:75], a[0:3], v[8:11]
    ds_read_b128 a[72:75], v36 offset:38912
    s_waitcnt lgkmcnt(1)
    v_mfma_f32_16x16x32_bf16 v[16:19], a[64:67], a[0:3], v[16:19]
    s_waitcnt vmcnt(10)
    v_add_f32 v48, v48, v52
    v_add_f32 v49, v49, v53
    v_add_f32 v50, v50, v54
    v_mfma_f32_16x16x32_bf16 v[16:19], a[68:71], a[4:7], v[16:19]
    v_add_f32 v51, v51, v55
    v_add_f32 v56, v56, v60
    v_add_f32 v57, v57, v61
    ds_read_b128 a[76:79], v36 offset:39936
    v_mfma_f32_16x16x32_bf16 v[20:23], a[68:71], a[12:15], v[20:23]
    v_add_f32 v58, v58, v62
    v_add_f32 v59, v59, v63
    v_add_f32 v52, v49, v57
    buffer_load_dwordx4 a[56:59], v33, s[44:47], s25 offen offset:0 sc1
    s_barrier
    v_mfma_f32_16x16x32_bf16 v[20:23], a[64:67], a[8:11], v[20:23]
    v_add_f32 v60, v51, v59
    v_add_f32 v48, v48, v56
    v_add_f32 v56, v50, v58
    s_waitcnt lgkmcnt(0)
    v_mfma_f32_16x16x32_bf16 v[28:31], a[72:75], a[8:11], v[28:31]
    v_mov_b32 v49, v48
    v_mov_b32 v57, v56
    s_nop 1
    s_add_u32 m0, s26, 24576
    s_add_u32 s24, s24, 8192
    buffer_load_dwordx4 v34, s[44:47], s24 offen offset:0 sc1 lds
    v_mfma_f32_16x16x32_bf16 v[28:31], a[76:79], a[12:15], v[28:31]
    s_nop 1
    v_permlane32_swap_b32 v48, v49
    v_permlane32_swap_b32 v56, v57
    ds_read_b128 a[64:67], v36 offset:40960
    ds_read_b128 a[68:71], v36 offset:41984
    v_mfma_f32_16x16x32_bf16 v[24:27], a[76:79], a[4:7], v[24:27]
    v_add_f32 v48, v48, v49
    v_add_f32 v56, v56, v57
    v_mov_b32 v49, v48
    buffer_load_dwordx4 a[60:63], v33, s[44:47], s25 offen offset:1024 sc1
    v_mfma_f32_16x16x32_bf16 v[24:27], a[72:75], a[0:3], v[24:27]
    v_mov_b32 v57, v56
    s_nop 1
    s_nop 1
    ds_read_b128 a[72:75], v36 offset:43008
    ds_read_b128 a[76:79], v36 offset:44032
    s_waitcnt vmcnt(12) lgkmcnt(2)
    v_mfma_f32_16x16x32_bf16 v[0:3], a[64:67], a[16:19], v[0:3]
    v_permlane16_swap_b32 v48, v49
    v_permlane16_swap_b32 v56, v57
    v_add_f32 v48, v48, v49
    v_mfma_f32_16x16x32_bf16 v[0:3], a[68:71], a[20:23], v[0:3]
    v_add_f32 v56, v56, v57
    v_mul_f32 v48, 0xba800000, v48
    v_mul_f32 v56, 0xba800000, v56
    v_mfma_f32_16x16x32_bf16 v[4:7], a[68:71], a[28:31], v[4:7]
    v_mov_b32 v53, v52
    v_mov_b32 v61, v60
    s_nop 1
    s_add_u32 s25, s25, 2048
    buffer_load_dwordx4 a[0:3], v32, s[44:47], s25 offen offset:0 sc1
    v_mfma_f32_16x16x32_bf16 v[4:7], a[64:67], a[24:27], v[4:7]
    s_nop 1
    v_permlane32_swap_b32 v52, v53
    v_permlane32_swap_b32 v60, v61
    buffer_load_dwordx4 v34, s[44:47], s24 offen offset:1024 sc1 lds
    s_waitcnt lgkmcnt(0)
    v_mfma_f32_16x16x32_bf16 v[12:15], a[72:75], a[24:27], v[12:15]
    v_add_f32 v52, v52, v53
    v_add_f32 v60, v60, v61
    v_mov_b32 v53, v52
    v_mfma_f32_16x16x32_bf16 v[12:15], a[76:79], a[28:31], v[12:15]
    v_mov_b32 v61, v60
    s_nop 1
    s_nop 1
    ds_read_b128 a[64:67], v36 offset:45056
    ds_read_b128 a[68:71], v36 offset:46080
    v_mfma_f32_16x16x32_bf16 v[8:11], a[76:79], a[20:23], v[8:11]
    v_permlane16_swap_b32 v52, v53
    v_permlane16_swap_b32 v60, v61
    v_add_f32 v52, v52, v53
    buffer_load_dwordx4 a[4:7], v32, s[44:47], s25 offen offset:1024 sc1
    v_mfma_f32_16x16x32_bf16 v[8:11], a[72:75], a[16:19], v[8:11]
    v_add_f32 v60, v60, v61
    v_mul_f32 v52, 0x3a800000, v52
    v_mul_f32 v60, 0x3a800000, v60
    s_waitcnt lgkmcnt(0)
    v_mfma_f32_16x16x32_bf16 v[16:19], a[64:67], a[16:19], v[16:19]
    v_fma_f32 v52, -v48, v48, v52
    v_fma_f32 v60, -v56, v56, v60
    v_max_f32 v52, 0, v52
    v_mfma_f32_16x16x32_bf16 v[16:19], a[68:71], a[20:23], v[16:19]
    v_max_f32 v60, 0, v60
    v_cvt_pk_bf16_f32 v52, v52, v52
    v_cvt_pk_bf16_f32 v60, v60, v60
    ds_read_b128 a[72:75], v36 offset:47104
    ds_read_b128 a[76:79], v36 offset:48128
    v_mfma_f32_16x16x32_bf16 v[20:23], a[68:71], a[28:31], v[20:23]
    v_and_b32 v52, 0xffff0000, v52
    v_and_b32 v60, 0xffff0000, v60
    v_add_f32 v52, 0x3727c5ac, v52
    buffer_load_dwordx4 a[8:11], v33, s[44:47], s25 offen offset:0 sc1
    s_barrier
    v_mfma_f32_16x16x32_bf16 v[20:23], a[64:67], a[24:27], v[20:23]
    v_add_f32 v60, 0x3727c5ac, v60
    v_cvt_pk_bf16_f32 v52, v52, v52
    v_cvt_pk_bf16_f32 v60, v60, v60
    s_waitcnt lgkmcnt(0)
    v_mfma_f32_16x16x32_bf16 v[28:31], a[72:75], a[24:27], v[28:31]
    v_and_b32 v52, 0xffff0000, v52
    v_and_b32 v60, 0xffff0000, v60
    v_sqrt_f32 v52, v52
    s_add_u32 m0, s26, 32768
    s_add_u32 s24, s24, 8192
    buffer_load_dwordx4 v34, s[44:47], s24 offen offset:0 sc1 lds
    v_mfma_f32_16x16x32_bf16 v[28:31], a[76:79], a[28:31], v[28:31]
    v_sqrt_f32 v60, v60
    s_nop 0
    s_nop 0
    ds_read_b128 a[64:67], v36 offset:49152
    ds_read_b128 a[68:71], v36 offset:50176
    v_mfma_f32_16x16x32_bf16 v[24:27], a[76:79], a[20:23], v[24:27]
    v_cvt_pk_bf16_f32 v52, v52, v52
    v_cvt_pk_bf16_f32 v60, v60, v60
    v_and_b32 v52, 0xffff0000, v52
    buffer_load_dwordx4 a[12:15], v33, s[44:47], s25 offen offset:1024 sc1
    v_mfma_f32_16x16x32_bf16 v[24:27], a[72:75], a[16:19], v[24:27]
    v_and_b32 v60, 0xffff0000, v60
    v_mul_f32 v50, v52, v52
    v_mul_f32 v58, v60, v60
    ds_read_b128 a[72:75], v36 offset:51200
    ds_read_b128 a[76:79], v36 offset:52224
    s_waitcnt vmcnt(12) lgkmcnt(2)
    v_mfma_f32_16x16x32_bf16 v[0:3], a[64:67], a[32:35], v[0:3]
    v_rcp_f32 v52, v52
    v_rcp_f32 v60, v60
    s_nop 0
    v_mfma_f32_16x16x32_bf16 v[0:3], a[68:71], a[36:39], v[0:3]
    s_nop 0
    v_mul_f32 v52, v52, v52
    v_mul_f32 v60, v60, v60
    v_mfma_f32_16x16x32_bf16 v[4:7], a[68:71], a[44:47], v[4:7]
    s_add_u32 s25, s25, 2048
    buffer_load_dwordx4 a[16:19], v32, s[44:47], s25 offen offset:0 sc1
    v_mfma_f32_16x16x32_bf16 v[4:7], a[64:67], a[40:43], v[4:7]
    buffer_load_dwordx4 v34, s[44:47], s24 offen offset:1024 sc1 lds
    s_waitcnt lgkmcnt(0)
    v_mfma_f32_16x16x32_bf16 v[12:15], a[72:75], a[40:43], v[12:15]
    ds_read_b128 a[64:67], v36 offset:53248
    v_mfma_f32_16x16x32_bf16 v[12:15], a[76:79], a[44:47], v[12:15]
    ds_read_b128 a[68:71], v36 offset:54272
    v_mfma_f32_16x16x32_bf16 v[8:11], a[76:79], a[36:39], v[8:11]
    buffer_load_dwordx4 a[20:23], v32, s[44:47], s25 offen offset:1024 sc1
    v_mfma_f32_16x16x32_bf16 v[8:11], a[72:75], a[32:35], v[8:11]
    ds_read_b128 a[72:75], v36 offset:55296
    s_waitcnt lgkmcnt(1)
    v_mfma_f32_16x16x32_bf16 v[16:19], a[64:67], a[32:35], v[16:19]
    v_lshlrev_b32 v80, 16, v64
    v_and_b32 v81, 0xffff0000, v64
    v_lshlrev_b32 v82, 16, v65
    v_and_b32 v83, 0xffff0000, v65
    v_mfma_f32_16x16x32_bf16 v[16:19], a[68:71], a[36:39], v[16:19]
    v_fmac_f32 v0, v80, v50
    v_fmac_f32 v1, v81, v50
    v_fmac_f32 v2, v82, v50
    v_fmac_f32 v3, v83, v50
    ds_read_b128 a[76:79], v36 offset:56320
    v_mfma_f32_16x16x32_bf16 v[20:23], a[68:71], a[44:47], v[20:23]
    v_lshlrev_b32 v84, 16, v72
    v_and_b32 v85, 0xffff0000, v72
    v_lshlrev_b32 v86, 16, v73
    v_and_b32 v87, 0xffff0000, v73
    buffer_load_dwordx4 a[24:27], v33, s[44:47], s25 offen offset:0 sc1
    s_barrier
    v_mfma_f32_16x16x32_bf16 v[20:23], a[64:67], a[40:43], v[20:23]
    v_fmac_f32 v4, v84, v58
    v_fmac_f32 v5, v85, v58
    v_fmac_f32 v6, v86, v58
    v_fmac_f32 v7, v87, v58
    s_waitcnt lgkmcnt(0)
    v_mfma_f32_16x16x32_bf16 v[28:31], a[72:75], a[40:43], v[28:31]
    v_lshlrev_b32 v84, 16, v74
    v_and_b32 v85, 0xffff0000, v74
    v_lshlrev_b32 v86, 16, v75
    v_and_b32 v87, 0xffff0000, v75
    s_add_u32 m0, s26, 40960
    s_add_u32 s24, s24, 8192
    buffer_load_dwordx4 v34, s[44:47], s24 offen offset:0 sc1 lds
    v_mfma_f32_16x16x32_bf16 v[28:31], a[76:79], a[44:47], v[28:31]
    v_fmac_f32 v12, v84, v58
    v_fmac_f32 v13, v85, v58
    v_fmac_f32 v14, v86, v58
    v_fmac_f32 v15, v87, v58
    ds_read_b128 a[64:67], v36 offset:57344
    ds_read_b128 a[68:71], v36 offset:58368
    v_mfma_f32_16x16x32_bf16 v[24:27], a[76:79], a[36:39], v[24:27]
    v_lshlrev_b32 v80, 16, v66
    v_and_b32 v81, 0xffff0000, v66
    v_lshlrev_b32 v82, 16, v67
    v_and_b32 v83, 0xffff0000, v67
    buffer_load_dwordx4 a[28:31], v33, s[44:47], s25 offen offset:1024 sc1
    v_mfma_f32_16x16x32_bf16 v[24:27], a[72:75], a[32:35], v[24:27]
    v_fmac_f32 v8, v80, v50
    v_fmac_f32 v9, v81, v50
    v_fmac_f32 v10, v82, v50
    v_fmac_f32 v11, v83, v50
    ds_read_b128 a[72:75], v36 offset:59392
    ds_read_b128 a[76:79], v36 offset:60416
    s_waitcnt vmcnt(12) lgkmcnt(2)
    v_mfma_f32_16x16x32_bf16 v[0:3], a[64:67], a[48:51], v[0:3]
    v_lshlrev_b32 v80, 16, v68
    v_and_b32 v81, 0xffff0000, v68
    v_lshlrev_b32 v82, 16, v69
    v_and_b32 v83, 0xffff0000, v69
    v_mfma_f32_16x16x32_bf16 v[0:3], a[68:71], a[52:55], v[0:3]
    v_fmac_f32 v16, v80, v50
    v_fmac_f32 v17, v81, v50
    v_fmac_f32 v18, v82, v50
    v_fmac_f32 v19, v83, v50
    v_mfma_f32_16x16x32_bf16 v[4:7], a[68:71], a[60:63], v[4:7]
    v_lshlrev_b32 v84, 16, v76
    v_and_b32 v85, 0xffff0000, v76
    v_lshlrev_b32 v86, 16, v77
    v_and_b32 v87, 0xffff0000, v77
    s_add_u32 s25, s25, 2048
    buffer_load_dwordx4 a[32:35], v32, s[44:47], s25 offen offset:0 sc1
    v_mfma_f32_16x16x32_bf16 v[4:7], a[64:67], a[56:59], v[4:7]
    v_fmac_f32 v20, v84, v58
    v_fmac_f32 v21, v85, v58
    v_fmac_f32 v22, v86, v58
    v_fmac_f32 v23, v87, v58
    buffer_load_dwordx4 v34, s[44:47], s24 offen offset:1024 sc1 lds
    s_waitcnt lgkmcnt(0)
    v_mfma_f32_16x16x32_bf16 v[12:15], a[72:75], a[56:59], v[12:15]
    v_lshlrev_b32 v84, 16, v78
    v_and_b32 v85, 0xffff0000, v78
    v_lshlrev_b32 v86, 16, v79
    v_and_b32 v87, 0xffff0000, v79
    v_mfma_f32_16x16x32_bf16 v[12:15], a[76:79], a[60:63], v[12:15]
    v_fmac_f32 v28, v84, v58
    v_fmac_f32 v29, v85, v58
    v_fmac_f32 v30, v86, v58
    v_fmac_f32 v31, v87, v58
    ds_read_b128 a[64:67], v36 offset:61440
    ds_read_b128 a[68:71], v36 offset:62464
    v_mfma_f32_16x16x32_bf16 v[8:11], a[76:79], a[52:55], v[8:11]
    v_lshlrev_b32 v80, 16, v70
    v_and_b32 v81, 0xffff0000, v70
    v_lshlrev_b32 v82, 16, v71
    v_and_b32 v83, 0xffff0000, v71
    buffer_load_dwordx4 a[36:39], v32, s[44:47], s25 offen offset:1024 sc1
    v_mfma_f32_16x16x32_bf16 v[8:11], a[72:75], a[48:51], v[8:11]
    v_fmac_f32 v24, v80, v50
    v_fmac_f32 v25, v81, v50
    v_fmac_f32 v26, v82, v50
    v_fmac_f32 v27, v83, v50
    s_waitcnt lgkmcnt(0)
    v_mfma_f32_16x16x32_bf16 v[16:19], a[64:67], a[48:51], v[16:19]
    ds_read_b128 a[72:75], v36 offset:63488
    v_mfma_f32_16x16x32_bf16 v[16:19], a[68:71], a[52:55], v[16:19]
    ds_read_b128 a[76:79], v36 offset:64512
    v_mfma_f32_16x16x32_bf16 v[20:23], a[68:71], a[60:63], v[20:23]
    buffer_load_dwordx4 a[40:43], v33, s[44:47], s25 offen offset:0 sc1
    s_barrier
    v_mfma_f32_16x16x32_bf16 v[20:23], a[64:67], a[56:59], v[20:23]
    ds_read_b128 a[64:67], v36 offset:0
    s_waitcnt lgkmcnt(1)
    v_mfma_f32_16x16x32_bf16 v[28:31], a[72:75], a[56:59], v[28:31]
    s_add_u32 m0, s26, 49152
    s_add_u32 s24, s24, 8192
    buffer_load_dwordx4 v34, s[44:47], s24 offen offset:0 sc1 lds
    v_mfma_f32_16x16x32_bf16 v[28:31], a[76:79], a[60:63], v[28:31]
    ds_read_b128 a[68:71], v36 offset:1024
    v_mfma_f32_16x16x32_bf16 v[24:27], a[76:79], a[52:55], v[24:27]
    buffer_load_dwordx4 a[44:47], v33, s[44:47], s25 offen offset:1024 sc1
    v_mfma_f32_16x16x32_bf16 v[24:27], a[72:75], a[48:51], v[24:27]
    ds_read_b128 a[72:75], v36 offset:2048
    ds_read_b128 a[76:79], v36 offset:3072
    s_mov_b32 s27, 5
L_d0:
    s_waitcnt vmcnt(12) lgkmcnt(2)
    v_mfma_f32_16x16x32_bf16 v[0:3], a[64:67], a[0:3], v[0:3]
    v_mfma_f32_16x16x32_bf16 v[0:3], a[68:71], a[4:7], v[0:3]
    v_mfma_f32_16x16x32_bf16 v[4:7], a[68:71], a[12:15], v[4:7]
    s_add_u32 s25, s25, 2048
    buffer_load_dwordx4 a[48:51], v32, s[44:47], s25 offen offset:0 sc1
    v_mfma_f32_16x16x32_bf16 v[4:7], a[64:67], a[8:11], v[4:7]
    buffer_load_dwordx4 v34, s[44:47], s24 offen offset:1024 sc1 lds
    s_waitcnt lgkmcnt(0)
    v_mfma_f32_16x16x32_bf16 v[12:15], a[72:75], a[8:11], v[12:15]
    ds_read_b128 a[64:67], v36 offset:4096
    v_mfma_f32_16x16x32_bf16 v[12:15], a[76:79], a[12:15], v[12:15]
    ds_read_b128 a[68:71], v36 offset:5120
    v_mfma_f32_16x16x32_bf16 v[8:11], a[76:79], a[4:7], v[8:11]
    buffer_load_dwordx4 a[52:55], v32, s[44:47], s25 offen offset:1024 sc1
    v_mfma_f32_16x16x32_bf16 v[8:11], a[72:75], a[0:3], v[8:11]
    ds_read_b128 a[72:75], v36 offset:6144
    s_waitcnt lgkmcnt(1)
    v_mfma_f32_16x16x32_bf16 v[16:19], a[64:67], a[0:3], v[16:19]
    ds_read_b128 a[76:79], v36 offset:7168
    v_mfma_f32_16x16x32_bf16 v[16:19], a[68:71], a[4:7], v[16:19]
    v_mfma_f32_16x16x32_bf16 v[20:23], a[68:71], a[12:15], v[20:23]
    buffer_load_dwordx4 a[56:59], v33, s[44:47], s25 offen offset:0 sc1
    s_barrier
    v_mfma_f32_16x16x32_bf16 v[20:23], a[64:67], a[8:11], v[20:23]
    ds_read_b128 a[64:67], v36 offset:8192
    s_waitcnt lgkmcnt(1)
    v_mfma_f32_16x16x32_bf16 v[28:31], a[72:75], a[8:11], v[28:31]
    s_add_u32 m0, s26, 57344
    s_add_u32 s24, s24, 8192
    buffer_load_dwordx4 v34, s[44:47], s24 offen offset:0 sc1 lds
    v_mfma_f32_16x16x32_bf16 v[28:31], a[76:79], a[12:15], v[28:31]
    ds_read_b128 a[68:71], v36 offset:9216
    v_mfma_f32_16x16x32_bf16 v[24:27], a[76:79], a[4:7], v[24:27]
    buffer_load_dwordx4 a[60:63], v33, s[44:47], s25 offen offset:1024 sc1
    v_mfma_f32_16x16x32_bf16 v[24:27], a[72:75], a[0:3], v[24:27]
    ds_read_b128 a[72:75], v36 offset:10240
    ds_read_b128 a[76:79], v36 offset:11264
    s_waitcnt vmcnt(12) lgkmcnt(2)
    v_mfma_f32_16x16x32_bf16 v[0:3], a[64:67], a[16:19], v[0:3]
    v_mfma_f32_16x16x32_bf16 v[0:3], a[68:71], a[20:23], v[0:3]
    v_mfma_f32_16x16x32_bf16 v[4:7], a[68:71], a[28:31], v[4:7]
    s_add_u32 s25, s25, 2048
    buffer_load_dwordx4 a[0:3], v32, s[44:47], s25 offen offset:0 sc1
    v_mfma_f32_16x16x32_bf16 v[4:7], a[64:67], a[24:27], v[4:7]
    buffer_load_dwordx4 v34, s[44:47], s24 offen offset:1024 sc1 lds
    s_waitcnt lgkmcnt(0)
    v_mfma_f32_16x16x32_bf16 v[12:15], a[72:75], a[24:27], v[12:15]
    ds_read_b128 a[64:67], v36 offset:12288
    v_mfma_f32_16x16x32_bf16 v[12:15], a[76:79], a[28:31], v[12:15]
    ds_read_b128 a[68:71], v36 offset:13312
    v_mfma_f32_16x16x32_bf16 v[8:11], a[76:79], a[20:23], v[8:11]
    buffer_load_dwordx4 a[4:7], v32, s[44:47], s25 offen offset:1024 sc1
    v_mfma_f32_16x16x32_bf16 v[8:11], a[72:75], a[16:19], v[8:11]
    ds_read_b128 a[72:75], v36 offset:14336
    s_waitcnt lgkmcnt(1)
    v_mfma_f32_16x16x32_bf16 v[16:19], a[64:67], a[16:19], v[16:19]
    ds_read_b128 a[76:79], v36 offset:15360
    v_mfma_f32_16x16x32_bf16 v[16:19], a[68:71], a[20:23], v[16:19]
    v_mfma_f32_16x16x32_bf16 v[20:23], a[68:71], a[28:31], v[20:23]
    buffer_load_dwordx4 a[8:11], v33, s[44:47], s25 offen offset:0 sc1
    s_barrier
    v_mfma_f32_16x16x32_bf16 v[20:23], a[64:67], a[24:27], v[20:23]
    ds_read_b128 a[64:67], v36 offset:16384
    s_waitcnt lgkmcnt(1)
    v_mfma_f32_16x16x32_bf16 v[28:31], a[72:75], a[24:27], v[28:31]
    s_add_u32 m0, s26, 0
    s_add_u32 s24, s24, 8192
    buffer_load_dwordx4 v34, s[44:47], s24 offen offset:0 sc1 lds
    v_mfma_f32_16x16x32_bf16 v[28:31], a[76:79], a[28:31], v[28:31]
    ds_read_b128 a[68:71], v36 offset:17408
    v_mfma_f32_16x16x32_bf16 v[24:27], a[76:79], a[20:23], v[24:27]
    buffer_load_dwordx4 a[12:15], v33, s[44:47], s25 offen offset:1024 sc1
    v_mfma_f32_16x16x32_bf16 v[24:27], a[72:75], a[16:19], v[24:27]
    ds_read_b128 a[72:75], v36 offset:18432
    ds_read_b128 a[76:79], v36 offset:19456
    s_waitcnt vmcnt(12) lgkmcnt(2)
    v_mfma_f32_16x16x32_bf16 v[0:3], a[64:67], a[32:35], v[0:3]
    v_mfma_f32_16x16x32_bf16 v[0:3], a[68:71], a[36:39], v[0:3]
    v_mfma_f32_16x16x32_bf16 v[4:7], a[68:71], a[44:47], v[4:7]
    s_add_u32 s25, s25, 2048
    buffer_load_dwordx4 a[16:19], v32, s[44:47], s25 offen offset:0 sc1
    v_mfma_f32_16x16x32_bf16 v[4:7], a[64:67], a[40:43], v[4:7]
    buffer_load_dwordx4 v34, s[44:47], s24 offen offset:1024 sc1 lds
    s_waitcnt lgkmcnt(0)
    v_mfma_f32_16x16x32_bf16 v[12:15], a[72:75], a[40:43], v[12:15]
    ds_read_b128 a[64:67], v36 offset:20480
    v_mfma_f32_16x16x32_bf16 v[12:15], a[76:79], a[44:47], v[12:15]
    ds_read_b128 a[68:71], v36 offset:21504
    v_mfma_f32_16x16x32_bf16 v[8:11], a[76:79], a[36:39], v[8:11]
    buffer_load_dwordx4 a[20:23], v32, s[44:47], s25 offen offset:1024 sc1
    v_mfma_f32_16x16x32_bf16 v[8:11], a[72:75], a[32:35], v[8:11]
    ds_read_b128 a[72:75], v36 offset:22528
    s_waitcnt lgkmcnt(1)
    v_mfma_f32_16x16x32_bf16 v[16:19], a[64:67], a[32:35], v[16:19]
    ds_read_b128 a[76:79], v36 offset:23552
    v_mfma_f32_16x16x32_bf16 v[16:19], a[68:71], a[36:39], v[16:19]
    v_mfma_f32_16x16x32_bf16 v[20:23], a[68:71], a[44:47], v[20:23]
    buffer_load_dwordx4 a[24:27], v33, s[44:47], s25 offen offset:0 sc1
    s_barrier
    v_mfma_f32_16x16x32_bf16 v[20:23], a[64:67], a[40:43], v[20:23]
    ds_read_b128 a[64:67], v36 offset:24576
    s_waitcnt lgkmcnt(1)
    v_mfma_f32_16x16x32_bf16 v[28:31], a[72:75], a[40:43], v[28:31]
    s_add_u32 m0, s26, 8192
    s_add_u32 s24, s24, 8192
    buffer_load_dwordx4 v34, s[44:47], s24 offen offset:0 sc1 lds
    v_mfma_f32_16x16x32_bf16 v[28:31], a[76:79], a[44:47], v[28:31]
    ds_read_b128 a[68:71], v36 offset:25600
    v_mfma_f32_16x16x32_bf16 v[24:27], a[76:79], a[36:39], v[24:27]
    buffer_load_dwordx4 a[28:31], v33, s[44:47], s25 offen offset:1024 sc1
    v_mfma_f32_16x16x32_bf16 v[24:27], a[72:75], a[32:35], v[24:27]
    ds_read_b128 a[72:75], v36 offset:26624
    ds_read_b128 a[76:79], v36 offset:27648
    s_waitcnt vmcnt(12) lgkmcnt(2)
    v_mfma_f32_16x16x32_bf16 v[0:3], a[64:67], a[48:51], v[0:3]
    v_mfma_f32_16x16x32_bf16 v[0:3], a[68:71], a[52:55], v[0:3]
    v_mfma_f32_16x16x32_bf16 v[4:7], a[68:71], a[60:63], v[4:7]
    s_add_u32 s25, s25, 2048
    buffer_load_dwordx4 a[32:35], v32, s[44:47], s25 offen offset:0 sc1
    v_mfma_f32_16x16x32_bf16 v[4:7], a[64:67], a[56:59], v[4:7]
    buffer_load_dwordx4 v34, s[44:47], s24 offen offset:1024 sc1 lds
    s_waitcnt lgkmcnt(0)
    v_mfma_f32_16x16x32_bf16 v[12:15], a[72:75], a[56:59], v[12:15]
    ds_read_b128 a[64:67], v36 offset:28672
    v_mfma_f32_16x16x32_bf16 v[12:15], a[76:79], a[60:63], v[12:15]
    ds_read_b128 a[68:71], v36 offset:29696
    v_mfma_f32_16x16x32_bf16 v[8:11], a[76:79], a[52:55], v[8:11]
    buffer_load_dwordx4 a[36:39], v32, s[44:47], s25 offen offset:1024 sc1
    v_mfma_f32_16x16x32_bf16 v[8:11], a[72:75], a[48:51], v[8:11]
    ds_read_b128 a[72:75], v36 offset:30720
    s_waitcnt lgkmcnt(1)
    v_mfma_f32_16x16x32_bf16 v[16:19], a[64:67], a[48:51], v[16:19]
    ds_read_b128 a[76:79], v36 offset:31744
    v_mfma_f32_16x16x32_bf16 v[16:19], a[68:71], a[52:55], v[16:19]
    v_mfma_f32_16x16x32_bf16 v[20:23], a[68:71], a[60:63], v[20:23]
    buffer_load_dwordx4 a[40:43], v33, s[44:47], s25 offen offset:0 sc1
    s_barrier
    v_mfma_f32_16x16x32_bf16 v[20:23], a[64:67], a[56:59], v[20:23]
    ds_read_b128 a[64:67], v36 offset:32768
    s_waitcnt lgkmcnt(1)
    v_mfma_f32_16x16x32_bf16 v[28:31], a[72:75], a[56:59], v[28:31]
    s_add_u32 m0, s26, 16384
    s_add_u32 s24, s24, 8192
    buffer_load_dwordx4 v34, s[44:47], s24 offen offset:0 sc1 lds
    v_mfma_f32_16x16x32_bf16 v[28:31], a[76:79], a[60:63], v[28:31]
    ds_read_b128 a[68:71], v36 offset:33792
    v_mfma_f32_16x16x32_bf16 v[24:27], a[76:79], a[52:55], v[24:27]
    buffer_load_dwordx4 a[44:47], v33, s[44:47], s25 offen offset:1024 sc1
    v_mfma_f32_16x16x32_bf16 v[24:27], a[72:75], a[48:51], v[24:27]
    ds_read_b128 a[72:75], v36 offset:34816
    ds_read_b128 a[76:79], v36 offset:35840
    s_waitcnt vmcnt(12) lgkmcnt(2)
    v_mfma_f32_16x16x32_bf16 v[0:3], a[64:67], a[0:3], v[0:3]
    v_mfma_f32_16x16x32_bf16 v[0:3], a[68:71], a[4:7], v[0:3]
    v_mfma_f32_16x16x32_bf16 v[4:7], a[68:71], a[12:15], v[4:7]
    s_add_u32 s25, s25, 2048
    buffer_load_dwordx4 a[48:51], v32, s[44:47], s25 offen offset:0 sc1
    v_mfma_f32_16x16x32_bf16 v[4:7], a[64:67], a[8:11], v[4:7]
    buffer_load_dwordx4 v34, s[44:47], s24 offen offset:1024 sc1 lds
    s_waitcnt lgkmcnt(0)
    v_mfma_f32_16x16x32_bf16 v[12:15], a[72:75], a[8:11], v[12:15]
    ds_read_b128 a[64:67], v36 offset:36864
    v_mfma_f32_16x16x32_bf16 v[12:15], a[76:79], a[12:15], v[12:15]
    ds_read_b128 a[68:71], v36 offset:37888
    v_mfma_f32_16x16x32_bf16 v[8:11], a[76:79], a[4:7], v[8:11]
    buffer_load_dwordx4 a[52:55], v32, s[44:47], s25 offen offset:1024 sc1
    v_mfma_f32_16x16x32_bf16 v[8:11], a[72:75], a[0:3], v[8:11]
    ds_read_b128 a[72:75], v36 offset:38912
    s_waitcnt lgkmcnt(1)
    v_mfma_f32_16x16x32_bf16 v[16:19], a[64:67], a[0:3], v[16:19]
    ds_read_b128 a[76:79], v36 offset:39936
    v_mfma_f32_16x16x32_bf16 v[16:19], a[68:71], a[4:7], v[16:19]
    v_mfma_f32_16x16x32_bf16 v[20:23], a[68:71], a[12:15], v[20:23]
    buffer_load_dwordx4 a[56:59], v33, s[44:47], s25 offen offset:0 sc1
    s_barrier
    v_mfma_f32_16x16x32_bf16 v[20:23], a[64:67], a[8:11], v[20:23]
    ds_read_b128 a[64:67], v36 offset:40960
    s_waitcnt lgkmcnt(1)
    v_mfma_f32_16x16x32_bf16 v[28:31], a[72:75], a[8:11], v[28:31]
    s_add_u32 m0, s26, 24576
    s_add_u32 s24, s24, 8192
    buffer_load_dwordx4 v34, s[44:47], s24 offen offset:0 sc1 lds
    v_mfma_f32_16x16x32_bf16 v[28:31], a[76:79], a[12:15], v[28:31]
    ds_read_b128 a[68:71], v36 offset:41984
    v_mfma_f32_16x16x32_bf16 v[24:27], a[76:79], a[4:7], v[24:27]
    buffer_load_dwordx4 a[60:63], v33, s[44:47], s25 offen offset:1024 sc1
    v_mfma_f32_16x16x32_bf16 v[24:27], a[72:75], a[0:3], v[24:27]
    ds_read_b128 a[72:75], v36 offset:43008
    ds_read_b128 a[76:79], v36 offset:44032
    s_waitcnt vmcnt(12) lgkmcnt(2)
    v_mfma_f32_16x16x32_bf16 v[0:3], a[64:67], a[16:19], v[0:3]
    v_mfma_f32_16x16x32_bf16 v[0:3], a[68:71], a[20:23], v[0:3]
    v_mfma_f32_16x16x32_bf16 v[4:7], a[68:71], a[28:31], v[4:7]
    s_add_u32 s25, s25, 2048
    buffer_load_dwordx4 a[0:3], v32, s[44:47], s25 offen offset:0 sc1
    v_mfma_f32_16x16x32_bf16 v[4:7], a[64:67], a[24:27], v[4:7]
    buffer_load_dwordx4 v34, s[44:47], s24 offen offset:1024 sc1 lds
    s_waitcnt lgkmcnt(0)
    v_mfma_f32_16x16x32_bf16 v[12:15], a[72:75], a[24:27], v[12:15]
    ds_read_b128 a[64:67], v36 offset:45056
    v_mfma_f32_16x16x32_bf16 v[12:15], a[76:79], a[28:31], v[12:15]
    ds_read_b128 a[68:71], v36 offset:46080
    v_mfma_f32_16x16x32_bf16 v[8:11], a[76:79], a[20:23], v[8:11]
    buffer_load_dwordx4 a[4:7], v32, s[44:47], s25 offen offset:1024 sc1
    v_mfma_f32_16x16x32_bf16 v[8:11], a[72:75], a[16:19], v[8:11]
    ds_read_b128 a[72:75], v36 offset:47104
    s_waitcnt lgkmcnt(1)
    v_mfma_f32_16x16x32_bf16 v[16:19], a[64:67], a[16:19], v[16:19]
    ds_read_b128 a[76:79], v36 offset:48128
    v_mfma_f32_16x16x32_bf16 v[16:19], a[68:71], a[20:23], v[16:19]
    v_mfma_f32_16x16x32_bf16 v[20:23], a[68:71], a[28:31], v[20:23]
    buffer_load_dwordx4 a[8:11], v33, s[44:47], s25 offen offset:0 sc1
    s_barrier
    v_mfma_f32_16x16x32_bf16 v[20:23], a[64:67], a[24:27], v[20:23]
    ds_read_b128 a[64:67], v36 offset:49152
    s_waitcnt lgkmcnt(1)
    v_mfma_f32_16x16x32_bf16 v[28:31], a[72:75], a[24:27], v[28:31]
    s_add_u32 m0, s26, 32768
    s_add_u32 s24, s24, 8192
    buffer_load_dwordx4 v34, s[44:47], s24 offen offset:0 sc1 lds
    v_mfma_f32_16x16x32_bf16 v[28:31], a[76:79], a[28:31], v[28:31]
    ds_read_b128 a[68:71], v36 offset:50176
    v_mfma_f32_16x16x32_bf16 v[24:27], a[76:79], a[20:23], v[24:27]
    buffer_load_dwordx4 a[12:15], v33, s[44:47], s25 offen offset:1024 sc1
    v_mfma_f32_16x16x32_bf16 v[24:27], a[72:75], a[16:19], v[24:27]
    ds_read_b128 a[72:75], v36 offset:51200
    ds_read_b128 a[76:79], v36 offset:52224
    s_waitcnt vmcnt(12) lgkmcnt(2)
    v_mfma_f32_16x16x32_bf16 v[0:3], a[64:67], a[32:35], v[0:3]
    v_mfma_f32_16x16x32_bf16 v[0:3], a[68:71], a[36:39], v[0:3]
    v_mfma_f32_16x16x32_bf16 v[4:7], a[68:71], a[44:47], v[4:7]
    s_add_u32 s25, s25, 2048
    buffer_load_dwordx4 a[16:19], v32, s[44:47], s25 offen offset:0 sc1
    v_mfma_f32_16x16x32_bf16 v[4:7], a[64:67], a[40:43], v[4:7]
    buffer_load_dwordx4 v34, s[44:47], s24 offen offset:1024 sc1 lds
    s_waitcnt lgkmcnt(0)
    v_mfma_f32_16x16x32_bf16 v[12:15], a[72:75], a[40:43], v[12:15]
    ds_read_b128 a[64:67], v36 offset:53248
    v_mfma_f32_16x16x32_bf16 v[12:15], a[76:79], a[44:47], v[12:15]
    ds_read_b128 a[68:71], v36 offset:54272
    v_mfma_f32_16x16x32_bf16 v[8:11], a[76:79], a[36:39], v[8:11]
    buffer_load_dwordx4 a[20:23], v32, s[44:47], s25 offen offset:1024 sc1
    v_mfma_f32_16x16x32_bf16 v[8:11], a[72:75], a[32:35], v[8:11]
    ds_read_b128 a[72:75], v36 offset:55296
    s_waitcnt lgkmcnt(1)
    v_mfma_f32_16x16x32_bf16 v[16:19], a[64:67], a[32:35], v[16:19]
    ds_read_b128 a[76:79], v36 offset:56320
    v_mfma_f32_16x16x32_bf16 v[16:19], a[68:71], a[36:39], v[16:19]
    v_mfma_f32_16x16x32_bf16 v[20:23], a[68:71], a[44:47], v[20:23]
    buffer_load_dwordx4 a[24:27], v33, s[44:47], s25 offen offset:0 sc1
    s_barrier
    v_mfma_f32_16x16x32_bf16 v[20:23], a[64:67], a[40:43], v[20:23]
    ds_read_b128 a[64:67], v36 offset:57344
    s_waitcnt lgkmcnt(1)
    v_mfma_f32_16x16x32_bf16 v[28:31], a[72:75], a[40:43], v[28:31]
    s_add_u32 m0, s26, 40960
    s_add_u32 s24, s24, 8192
    buffer_load_dwordx4 v34, s[44:47], s24 offen offset:0 sc1 lds
    v_mfma_f32_16x16x32_bf16 v[28:31], a[76:79], a[44:47], v[28:31]
    ds_read_b128 a[68:71], v36 offset:58368
    v_mfma_f32_16x16x32_bf16 v[24:27], a[76:79], a[36:39], v[24:27]
    buffer_load_dwordx4 a[28:31], v33, s[44:47], s25 offen offset:1024 sc1
    v_mfma_f32_16x16x32_bf16 v[24:27], a[72:75], a[32:35], v[24:27]
    ds_read_b128 a[72:75], v36 offset:59392
    ds_read_b128 a[76:79], v36 offset:60416
    s_waitcnt vmcnt(12) lgkmcnt(2)
    v_mfma_f32_16x16x32_bf16 v[0:3], a[64:67], a[48:51], v[0:3]
    v_mfma_f32_16x16x32_bf16 v[0:3], a[68:71], a[52:55], v[0:3]
    v_mfma_f32_16x16x32_bf16 v[4:7], a[68:71], a[60:63], v[4:7]
    s_add_u32 s25, s25, 2048
    buffer_load_dwordx4 a[32:35], v32, s[44:47], s25 offen offset:0 sc1
    v_mfma_f32_16x16x32_bf16 v[4:7], a[64:67], a[56:59], v[4:7]
    buffer_load_dwordx4 v34, s[44:47], s24 offen offset:1024 sc1 lds
    s_waitcnt lgkmcnt(0)
    v_mfma_f32_16x16x32_bf16 v[12:15], a[72:75], a[56:59], v[12:15]
    ds_read_b128 a[64:67], v36 offset:61440
    v_mfma_f32_16x16x32_bf16 v[12:15], a[76:79], a[60:63], v[12:15]
    ds_read_b128 a[68:71], v36 offset:62464
    v_mfma_f32_16x16x32_bf16 v[8:11], a[76:79], a[52:55], v[8:11]
    buffer_load_dwordx4 a[36:39], v32, s[44:47], s25 offen offset:1024 sc1
    v_mfma_f32_16x16x32_bf16 v[8:11], a[72:75], a[48:51], v[8:11]
    ds_read_b128 a[72:75], v36 offset:63488
    s_waitcnt lgkmcnt(1)
    v_mfma_f32_16x16x32_bf16 v[16:19], a[64:67], a[48:51], v[16:19]
    ds_read_b128 a[76:79], v36 offset:64512
    v_mfma_f32_16x16x32_bf16 v[16:19], a[68:71], a[52:55], v[16:19]
    v_mfma_f32_16x16x32_bf16 v[20:23], a[68:71], a[60:63], v[20:23]
    buffer_load_dwordx4 a[40:43], v33, s[44:47], s25 offen offset:0 sc1
    s_barrier
    v_mfma_f32_16x16x32_bf16 v[20:23], a[64:67], a[56:59], v[20:23]
    ds_read_b128 a[64:67], v36 offset:0
    s_waitcnt lgkmcnt(1)
    v_mfma_f32_16x16x32_bf16 v[28:31], a[72:75], a[56:59], v[28:31]
    s_add_u32 m0, s26, 49152
    s_add_u32 s24, s24, 8192
    buffer_load_dwordx4 v34, s[44:47], s24 offen offset:0 sc1 lds
    v_mfma_f32_16x16x32_bf16 v[28:31], a[76:79], a[60:63], v[28:31]
    ds_read_b128 a[68:71], v36 offset:1024
    v_mfma_f32_16x16x32_bf16 v[24:27], a[76:79], a[52:55], v[24:27]
    buffer_load_dwordx4 a[44:47], v33, s[44:47], s25 offen offset:1024 sc1
    v_mfma_f32_16x16x32_bf16 v[24:27], a[72:75], a[48:51], v[24:27]
    ds_read_b128 a[72:75], v36 offset:2048
    ds_read_b128 a[76:79], v36 offset:3072
    s_sub_u32 s27, s27, 1
    s_cmp_lg_u32 s27, 0
    s_cbranch_scc1 L_d0
    s_waitcnt vmcnt(12) lgkmcnt(2)
    v_mfma_f32_16x16x32_bf16 v[0:3], a[64:67], a[0:3], v[0:3]
    v_mfma_f32_16x16x32_bf16 v[0:3], a[68:71], a[4:7], v[0:3]
    v_mfma_f32_16x16x32_bf16 v[4:7], a[68:71], a[12:15], v[4:7]
    s_add_u32 s25, s25, 2048
    buffer_load_dwordx4 a[48:51], v32, s[44:47], s25 offen offset:0 sc1
    v_mfma_f32_16x16x32_bf16 v[4:7], a[64:67], a[8:11], v[4:7]
    buffer_load_dwordx4 v34, s[44:47], s24 offen offset:1024 sc1 lds
    s_waitcnt lgkmcnt(0)
    v_mfma_f32_16x16x32_bf16 v[12:15], a[72:75], a[8:11], v[12:15]
    ds_read_b128 a[64:67], v36 offset:4096
    v_mfma_f32_16x16x32_bf16 v[12:15], a[76:79], a[12:15], v[12:15]
    ds_read_b128 a[68:71], v36 offset:5120
    v_mfma_f32_16x16x32_bf16 v[8:11], a[76:79], a[4:7], v[8:11]
    buffer_load_dwordx4 a[52:55], v32, s[44:47], s25 offen offset:1024 sc1
    v_mfma_f32_16x16x32_bf16 v[8:11], a[72:75], a[0:3], v[8:11]
    ds_read_b128 a[72:75], v36 offset:6144
    s_waitcnt lgkmcnt(1)
    v_mfma_f32_16x16x32_bf16 v[16:19], a[64:67], a[0:3], v[16:19]
    ds_read_b128 a[76:79], v36 offset:7168
    v_mfma_f32_16x16x32_bf16 v[16:19], a[68:71], a[4:7], v[16:19]
    v_mfma_f32_16x16x32_bf16 v[20:23], a[68:71], a[12:15], v[20:23]
    buffer_load_dwordx4 a[56:59], v33, s[44:47], s25 offen offset:0 sc1
    s_barrier
    v_mfma_f32_16x16x32_bf16 v[20:23], a[64:67], a[8:11], v[20:23]
    ds_read_b128 a[64:67], v36 offset:8192
    s_waitcnt lgkmcnt(1)
    v_mfma_f32_16x16x32_bf16 v[28:31], a[72:75], a[8:11], v[28:31]
    s_add_u32 m0, s26, 57344
    s_add_u32 s24, s24, 8192
    buffer_load_dwordx4 v34, s[44:47], s24 offen offset:0 sc1 lds
    v_mfma_f32_16x16x32_bf16 v[28:31], a[76:79], a[12:15], v[28:31]
    ds_read_b128 a[68:71], v36 offset:9216
    v_mfma_f32_16x16x32_bf16 v[24:27], a[76:79], a[4:7], v[24:27]
    buffer_load_dwordx4 a[60:63], v33, s[44:47], s25 offen offset:1024 sc1
    v_mfma_f32_16x16x32_bf16 v[24:27], a[72:75], a[0:3], v[24:27]
    ds_read_b128 a[72:75], v36 offset:10240
    ds_read_b128 a[76:79], v36 offset:11264
    s_waitcnt vmcnt(12) lgkmcnt(2)
    v_mfma_f32_16x16x32_bf16 v[0:3], a[64:67], a[16:19], v[0:3]
    v_mfma_f32_16x16x32_bf16 v[0:3], a[68:71], a[20:23], v[0:3]
    v_mfma_f32_16x16x32_bf16 v[4:7], a[68:71], a[28:31], v[4:7]
    s_add_u32 s25, s25, 2048
    buffer_load_dwordx4 a[0:3], v32, s[44:47], s25 offen offset:0 sc1
    v_mfma_f32_16x16x32_bf16 v[4:7], a[64:67], a[24:27], v[4:7]
    buffer_load_dwordx4 v34, s[44:47], s24 offen offset:1024 sc1 lds
    s_waitcnt lgkmcnt(0)
    v_mfma_f32_16x16x32_bf16 v[12:15], a[72:75], a[24:27], v[12:15]
    ds_read_b128 a[64:67], v36 offset:12288
    v_mfma_f32_16x16x32_bf16 v[12:15], a[76:79], a[28:31], v[12:15]
    ds_read_b128 a[68:71], v36 offset:13312
    v_mfma_f32_16x16x32_bf16 v[8:11], a[76:79], a[20:23], v[8:11]
    buffer_load_dwordx4 a[4:7], v32, s[44:47], s25 offen offset:1024 sc1
    v_mfma_f32_16x16x32_bf16 v[8:11], a[72:75], a[16:19], v[8:11]
    ds_read_b128 a[72:75], v36 offset:14336
    s_waitcnt lgkmcnt(1)
    v_mfma_f32_16x16x32_bf16 v[16:19], a[64:67], a[16:19], v[16:19]
    ds_read_b128 a[76:79], v36 offset:15360
    v_mfma_f32_16x16x32_bf16 v[16:19], a[68:71], a[20:23], v[16:19]
    v_mfma_f32_16x16x32_bf16 v[20:23], a[68:71], a[28:31], v[20:23]
    buffer_load_dwordx4 a[8:11], v33, s[44:47], s25 offen offset:0 sc1
    s_barrier
    v_mfma_f32_16x16x32_bf16 v[20:23], a[64:67], a[24:27], v[20:23]
    ds_read_b128 a[64:67], v36 offset:16384
    s_waitcnt lgkmcnt(1)
    v_mfma_f32_16x16x32_bf16 v[28:31], a[72:75], a[24:27], v[28:31]
    ds_read_b128 a[68:71], v36 offset:17408
    v_mfma_f32_16x16x32_bf16 v[28:31], a[76:79], a[28:31], v[28:31]
    v_mfma_f32_16x16x32_bf16 v[24:27], a[76:79], a[20:23], v[24:27]
    buffer_load_dwordx4 a[12:15], v33, s[44:47], s25 offen offset:1024 sc1
    v_mfma_f32_16x16x32_bf16 v[24:27], a[72:75], a[16:19], v[24:27]
    ds_read_b128 a[72:75], v36 offset:18432
    ds_read_b128 a[76:79], v36 offset:19456
    s_waitcnt vmcnt(11) lgkmcnt(2)
    v_mfma_f32_16x16x32_bf16 v[0:3], a[64:67], a[32:35], v[0:3]
    v_mfma_f32_16x16x32_bf16 v[0:3], a[68:71], a[36:39], v[0:3]
    v_mfma_f32_16x16x32_bf16 v[4:7], a[68:71], a[44:47], v[4:7]
    s_add_u32 s25, s25, 2048
    buffer_load_dwordx4 a[16:19], v32, s[44:47], s25 offen offset:0 sc1
    v_mfma_f32_16x16x32_bf16 v[4:7], a[64:67], a[40:43], v[4:7]
    ds_read_b128 a[64:67], v36 offset:20480
    s_waitcnt lgkmcnt(1)
    v_mfma_f32_16x16x32_bf16 v[12:15], a[72:75], a[40:43], v[12:15]
    ds_read_b128 a[68:71], v36 offset:21504
    v_mfma_f32_16x16x32_bf16 v[12:15], a[76:79], a[44:47], v[12:15]
    v_mfma_f32_16x16x32_bf16 v[8:11], a[76:79], a[36:39], v[8:11]
    buffer_load_dwordx4 a[20:23], v32, s[44:47], s25 offen offset:1024 sc1
    v_mfma_f32_16x16x32_bf16 v[8:11], a[72:75], a[32:35], v[8:11]
    ds_read_b128 a[72:75], v36 offset:22528
    s_waitcnt lgkmcnt(1)
    v_mfma_f32_16x16x32_bf16 v[16:19], a[64:67], a[32:35], v[16:19]
    ds_read_b128 a[76:79], v36 offset:23552
    v_mfma_f32_16x16x32_bf16 v[16:19], a[68:71], a[36:39], v[16:19]
    v_mfma_f32_16x16x32_bf16 v[20:23], a[68:71], a[44:47], v[20:23]
    buffer_load_dwordx4 a[24:27], v33, s[44:47], s25 offen offset:0 sc1
    s_barrier
    v_mfma_f32_16x16x32_bf16 v[20:23], a[64:67], a[40:43], v[20:23]
    ds_read_b128 a[64:67], v36 offset:24576
    s_waitcnt lgkmcnt(1)
    v_mfma_f32_16x16x32_bf16 v[28:31], a[72:75], a[40:43], v[28:31]
    ds_read_b128 a[68:71], v36 offset:25600
    v_mfma_f32_16x16x32_bf16 v[28:31], a[76:79], a[44:47], v[28:31]
    v_mfma_f32_16x16x32_bf16 v[24:27], a[76:79], a[36:39], v[24:27]
    buffer_load_dwordx4 a[28:31], v33, s[44:47], s25 offen offset:1024 sc1
    v_mfma_f32_16x16x32_bf16 v[24:27], a[72:75], a[32:35], v[24:27]
    ds_read_b128 a[72:75], v36 offset:26624
    ds_read_b128 a[76:79], v36 offset:27648
    s_waitcnt vmcnt(9) lgkmcnt(2)
    v_mfma_f32_16x16x32_bf16 v[0:3], a[64:67], a[48:51], v[0:3]
    v_mfma_f32_16x16x32_bf16 v[0:3], a[68:71], a[52:55], v[0:3]
    v_mfma_f32_16x16x32_bf16 v[4:7], a[68:71], a[60:63], v[4:7]
    s_lshr_b32 s12, s2, 3
    s_and_b32 s12, s12, 31
    s_lshl_b32 s12, s12, 10
    v_and_b32 v41, 7, v40
    v_lshlrev_b32 v41, 7, v41
    v_add_u32 v41, s12, v41
    s_getpc_b64 s[10:11]
    s_add_u32 s10, s10, PH_a1@rel32@lo+4
    s_addc_u32 s11, s11, PH_a1@rel32@hi+12
    v_min_u32 v42, END_PH_a1-PH_a1-4, v41
    global_load_dword v42, v42, s[10:11]
    s_add_u32 s25, s25, 2048
    buffer_load_dwordx4 a[32:35], v32, s[44:47], s25 offen offset:0 sc1
    v_mfma_f32_16x16x32_bf16 v[4:7], a[64:67], a[56:59], v[4:7]
    ds_read_b128 a[64:67], v36 offset:28672
    s_waitcnt lgkmcnt(1)
    v_mfma_f32_16x16x32_bf16 v[12:15], a[72:75], a[56:59], v[12:15]
    ds_read_b128 a[68:71], v36 offset:29696
    v_mfma_f32_16x16x32_bf16 v[12:15], a[76:79], a[60:63], v[12:15]
    v_mfma_f32_16x16x32_bf16 v[8:11], a[76:79], a[52:55], v[8:11]
    buffer_load_dwordx4 a[36:39], v32, s[44:47], s25 offen offset:1024 sc1
    v_mfma_f32_16x16x32_bf16 v[8:11], a[72:75], a[48:51], v[8:11]
    ds_read_b128 a[72:75], v36 offset:30720
    s_waitcnt lgkmcnt(1)
    v_mfma_f32_16x16x32_bf16 v[16:19], a[64:67], a[48:51], v[16:19]
    ds_read_b128 a[76:79], v36 offset:31744
    v_mfma_f32_16x16x32_bf16 v[16:19], a[68:71], a[52:55], v[16:19]
    v_mfma_f32_16x16x32_bf16 v[20:23], a[68:71], a[60:63], v[20:23]
    buffer_load_dwordx4 a[40:43], v33, s[44:47], s25 offen offset:0 sc1
    s_barrier
    v_mfma_f32_16x16x32_bf16 v[20:23], a[64:67], a[56:59], v[20:23]
    ds_read_b128 a[64:67], v36 offset:32768
    s_waitcnt lgkmcnt(1)
    v_mfma_f32_16x16x32_bf16 v[28:31], a[72:75], a[56:59], v[28:31]
    ds_read_b128 a[68:71], v36 offset:33792
    v_mfma_f32_16x16x32_bf16 v[28:31], a[76:79], a[60:63], v[28:31]
    v_mfma_f32_16x16x32_bf16 v[24:27], a[76:79], a[52:55], v[24:27]
    buffer_load_dwordx4 a[44:47], v33, s[44:47], s25 offen offset:1024 sc1
    v_mfma_f32_16x16x32_bf16 v[24:27], a[72:75], a[48:51], v[24:27]
    ds_read_b128 a[72:75], v36 offset:34816
    ds_read_b128 a[76:79], v36 offset:35840
    s_waitcnt vmcnt(9) lgkmcnt(2)
    v_mfma_f32_16x16x32_bf16 v[0:3], a[64:67], a[0:3], v[0:3]
    v_mfma_f32_16x16x32_bf16 v[0:3], a[68:71], a[4:7], v[0:3]
    v_mfma_f32_16x16x32_bf16 v[4:7], a[68:71], a[12:15], v[4:7]
    s_add_u32 s25, s25, 2048
    buffer_load_dwordx4 a[48:51], v32, s[44:47], s25 offen offset:0 sc1
    v_mfma_f32_16x16x32_bf16 v[4:7], a[64:67], a[8:11], v[4:7]
    ds_read_b128 a[64:67], v36 offset:36864
    s_waitcnt lgkmcnt(1)
    v_mfma_f32_16x16x32_bf16 v[12:15], a[72:75], a[8:11], v[12:15]
    ds_read_b128 a[68:71], v36 offset:37888
    v_mfma_f32_16x16x32_bf16 v[12:15], a[76:79], a[12:15], v[12:15]
    v_mfma_f32_16x16x32_bf16 v[8:11], a[76:79], a[4:7], v[8:11]
    buffer_load_dwordx4 a[52:55], v32, s[44:47], s25 offen offset:1024 sc1
    v_mfma_f32_16x16x32_bf16 v[8:11], a[72:75], a[0:3], v[8:11]
    ds_read_b128 a[72:75], v36 offset:38912
    s_waitcnt lgkmcnt(1)
    v_mfma_f32_16x16x32_bf16 v[16:19], a[64:67], a[0:3], v[16:19]
    ds_read_b128 a[76:79], v36 offset:39936
    v_mfma_f32_16x16x32_bf16 v[16:19], a[68:71], a[4:7], v[16:19]
    v_mfma_f32_16x16x32_bf16 v[20:23], a[68:71], a[12:15], v[20:23]
    buffer_load_dwordx4 a[56:59], v33, s[44:47], s25 offen offset:0 sc1
    s_barrier
    v_mfma_f32_16x16x32_bf16 v[20:23], a[64:67], a[8:11], v[20:23]
    ds_read_b128 a[64:67], v36 offset:40960
    s_waitcnt lgkmcnt(1)
    v_mfma_f32_16x16x32_bf16 v[28:31], a[72:75], a[8:11], v[28:31]
    ds_read_b128 a[68:71], v36 offset:41984
    v_mfma_f32_16x16x32_bf16 v[28:31], a[76:79], a[12:15], v[28:31]
    v_mfma_f32_16x16x32_bf16 v[24:27], a[76:79], a[4:7], v[24:27]
    buffer_load_dwordx4 a[60:63], v33, s[44:47], s25 offen offset:1024 sc1
    v_mfma_f32_16x16x32_bf16 v[24:27], a[72:75], a[0:3], v[24:27]
    ds_read_b128 a[72:75], v36 offset:43008
    ds_read_b128 a[76:79], v36 offset:44032
    s_waitcnt vmcnt(9) lgkmcnt(2)
    v_mfma_f32_16x16x32_bf16 v[0:3], a[64:67], a[16:19], v[0:3]
    v_mfma_f32_16x16x32_bf16 v[0:3], a[68:71], a[20:23], v[0:3]
    v_mfma_f32_16x16x32_bf16 v[4:7], a[68:71], a[28:31], v[4:7]
    v_mfma_f32_16x16x32_bf16 v[4:7], a[64:67], a[24:27], v[4:7]
    ds_read_b128 a[64:67], v36 offset:45056
    s_waitcnt lgkmcnt(1)
    v_mfma_f32_16x16x32_bf16 v[12:15], a[72:75], a[24:27], v[12:15]
    ds_read_b128 a[68:71], v36 offset:46080
    v_mfma_f32_16x16x32_bf16 v[12:15], a[76:79], a[28:31], v[12:15]
    v_mfma_f32_16x16x32_bf16 v[8:11], a[76:79], a[20:23], v[8:11]
    v_mfma_f32_16x16x32_bf16 v[8:11], a[72:75], a[16:19], v[8:11]
    ds_read_b128 a[72:75], v36 offset:47104
    s_waitcnt lgkmcnt(1)
    v_mfma_f32_16x16x32_bf16 v[16:19], a[64:67], a[16:19], v[16:19]
    ds_read_b128 a[76:79], v36 offset:48128
    v_mfma_f32_16x16x32_bf16 v[16:19], a[68:71], a[20:23], v[16:19]
    v_mfma_f32_16x16x32_bf16 v[20:23], a[68:71], a[28:31], v[20:23]
    s_barrier
    v_mfma_f32_16x16x32_bf16 v[20:23], a[64:67], a[24:27], v[20:23]
    ds_read_b128 a[64:67], v36 offset:49152
    s_waitcnt lgkmcnt(1)
    v_mfma_f32_16x16x32_bf16 v[28:31], a[72:75], a[24:27], v[28:31]
    ds_read_b128 a[68:71], v36 offset:50176
    v_mfma_f32_16x16x32_bf16 v[28:31], a[76:79], a[28:31], v[28:31]
    v_mfma_f32_16x16x32_bf16 v[24:27], a[76:79], a[20:23], v[24:27]
    v_mfma_f32_16x16x32_bf16 v[24:27], a[72:75], a[16:19], v[24:27]
    ds_read_b128 a[72:75], v36 offset:51200
    ds_read_b128 a[76:79], v36 offset:52224
    s_waitcnt vmcnt(4) lgkmcnt(2)
    v_mfma_f32_16x16x32_bf16 v[0:3], a[64:67], a[32:35], v[0:3]
    v_mfma_f32_16x16x32_bf16 v[0:3], a[68:71], a[36:39], v[0:3]
    v_mfma_f32_16x16x32_bf16 v[4:7], a[68:71], a[44:47], v[4:7]
    v_mfma_f32_16x16x32_bf16 v[4:7], a[64:67], a[40:43], v[4:7]
    ds_read_b128 a[64:67], v36 offset:53248
    s_waitcnt lgkmcnt(1)
    v_mfma_f32_16x16x32_bf16 v[12:15], a[72:75], a[40:43], v[12:15]
    ds_read_b128 a[68:71], v36 offset:54272
    v_mfma_f32_16x16x32_bf16 v[12:15], a[76:79], a[44:47], v[12:15]
    v_mfma_f32_16x16x32_bf16 v[8:11], a[76:79], a[36:39], v[8:11]
    v_mfma_f32_16x16x32_bf16 v[8:11], a[72:75], a[32:35], v[8:11]
    ds_read_b128 a[72:75], v36 offset:55296
    s_waitcnt lgkmcnt(1)
    v_mfma_f32_16x16x32_bf16 v[16:19], a[64:67], a[32:35], v[16:19]
    ds_read_b128 a[76:79], v36 offset:56320
    v_mfma_f32_16x16x32_bf16 v[16:19], a[68:71], a[36:39], v[16:19]
    v_mfma_f32_16x16x32_bf16 v[20:23], a[68:71], a[44:47], v[20:23]
    s_barrier
    v_mfma_f32_16x16x32_bf16 v[20:23], a[64:67], a[40:43], v[20:23]
    ds_read_b128 a[64:67], v36 offset:57344
    s_waitcnt lgkmcnt(1)
    v_mfma_f32_16x16x32_bf16 v[28:31], a[72:75], a[40:43], v[28:31]
    ds_read_b128 a[68:71], v36 offset:58368
    v_mfma_f32_16x16x32_bf16 v[28:31], a[76:79], a[44:47], v[28:31]
    v_mfma_f32_16x16x32_bf16 v[24:27], a[76:79], a[36:39], v[24:27]
    v_mfma_f32_16x16x32_bf16 v[24:27], a[72:75], a[32:35], v[24:27]
    ds_read_b128 a[72:75], v36 offset:59392
    ds_read_b128 a[76:79], v36 offset:60416
    s_waitcnt vmcnt(0) lgkmcnt(2)
    v_mfma_f32_16x16x32_bf16 v[0:3], a[64:67], a[48:51], v[0:3]
    v_mfma_f32_16x16x32_bf16 v[0:3], a[68:71], a[52:55], v[0:3]
    v_mfma_f32_16x16x32_bf16 v[4:7], a[68:71], a[60:63], v[4:7]
    v_mfma_f32_16x16x32_bf16 v[4:7], a[64:67], a[56:59], v[4:7]
    ds_read_b128 a[64:67], v36 offset:61440
    s_waitcnt lgkmcnt(1)
    v_mfma_f32_16x16x32_bf16 v[12:15], a[72:75], a[56:59], v[12:15]
    ds_read_b128 a[68:71], v36 offset:62464
    v_mfma_f32_16x16x32_bf16 v[12:15], a[76:79], a[60:63], v[12:15]
    v_mfma_f32_16x16x32_bf16 v[8:11], a[76:79], a[52:55], v[8:11]
    v_mfma_f32_16x16x32_bf16 v[8:11], a[72:75], a[48:51], v[8:11]
    ds_read_b128 a[72:75], v36 offset:63488
    s_waitcnt lgkmcnt(1)
    v_mfma_f32_16x16x32_bf16 v[16:19], a[64:67], a[48:51], v[16:19]
    ds_read_b128 a[76:79], v36 offset:64512
    v_mfma_f32_16x16x32_bf16 v[16:19], a[68:71], a[52:55], v[16:19]
    v_mfma_f32_16x16x32_bf16 v[20:23], a[68:71], a[60:63], v[20:23]
    v_mfma_f32_16x16x32_bf16 v[20:23], a[64:67], a[56:59], v[20:23]
    s_waitcnt lgkmcnt(0)
    v_mfma_f32_16x16x32_bf16 v[28:31], a[72:75], a[56:59], v[28:31]
    v_mfma_f32_16x16x32_bf16 v[28:31], a[76:79], a[60:63], v[28:31]
    v_mfma_f32_16x16x32_bf16 v[24:27], a[76:79], a[52:55], v[24:27]
    v_mfma_f32_16x16x32_bf16 v[24:27], a[72:75], a[48:51], v[24:27]
    s_nop 7
    v_mov_b32 v88, 0
    v_mov_b32 v89, 0
    v_mul_f32 v0, v0, v52
    v_mul_f32 v1, v1, v52
    v_mul_f32 v2, v2, v52
    v_mul_f32 v3, v3, v52
    v_mul_f32 v8, v8, v52
    v_mul_f32 v9, v9, v52
    v_mul_f32 v10, v10, v52
    v_mul_f32 v11, v11, v52
    v_cvt_pk_bf16_f32 v64, v0, v1
    v_cvt_pk_bf16_f32 v65, v2, v3
    v_cvt_pk_bf16_f32 v66, v8, v9
    v_cvt_pk_bf16_f32 v67, v10, v11
    buffer_store_dwordx4 v[64:67], v32, s[44:47], s48 offen offset:0 sc1
    v_dot2_f32_bf16 v88, v64, v35, v88
    v_dot2_f32_bf16 v88, v65, v35, v88
    v_dot2_f32_bf16 v88, v66, v35, v88
    v_dot2_f32_bf16 v88, v67, v35, v88
    v_dot2_f32_bf16 v89, v64, v64, v89
    v_dot2_f32_bf16 v89, v65, v65, v89
    v_dot2_f32_bf16 v89, v66, v66, v89
    v_dot2_f32_bf16 v89, v67, v67, v89
    v_mul_f32 v16, v16, v52
    v_mul_f32 v17, v17, v52
    v_mul_f32 v18, v18, v52
    v_mul_f32 v19, v19, v52
    v_mul_f32 v24, v24, v52
    v_mul_f32 v25, v25, v52
    v_mul_f32 v26, v26, v52
    v_mul_f32 v27, v27, v52
    v_cvt_pk_bf16_f32 v68, v16, v17
    v_cvt_pk_bf16_f32 v69, v18, v19
    v_cvt_pk_bf16_f32 v70, v24, v25
    v_cvt_pk_bf16_f32 v71, v26, v27
    buffer_store_dwordx4 v[68:71], v32, s[44:47], s48 offen offset:1024 sc1
    v_dot2_f32_bf16 v88, v68, v35, v88
    v_dot2_f32_bf16 v88, v69, v35, v88
    v_dot2_f32_bf16 v88, v70, v35, v88
    v_dot2_f32_bf16 v88, v71, v35, v88
    v_dot2_f32_bf16 v89, v68, v68, v89
    v_dot2_f32_bf16 v89, v69, v69, v89
    v_dot2_f32_bf16 v89, v70, v70, v89
    v_dot2_f32_bf16 v89, v71, v71, v89
    v_mov_b32 v90, 0
    v_mov_b32 v91, 0
    v_mul_f32 v4, v4, v60
    v_mul_f32 v5, v5, v60
    v_mul_f32 v6, v6, v60
    v_mul_f32 v7, v7, v60
    v_mul_f32 v12, v12, v60
    v_mul_f32 v13, v13, v60
    v_mul_f32 v14, v14, v60
    v_mul_f32 v15, v15, v60
    v_cvt_pk_bf16_f32 v72, v4, v5
    v_cvt_pk_bf16_f32 v73, v6, v7
    v_cvt_pk_bf16_f32 v74, v12, v13
    v_cvt_pk_bf16_f32 v75, v14, v15
    buffer_store_dwordx4 v[72:75], v32, s[44:47], s49 offen offset:0 sc1
    v_dot2_f32_bf16 v90, v72, v35, v90
    v_dot2_f32_bf16 v90, v73, v35, v90
    v_dot2_f32_bf16 v90, v74, v35, v90
    v_dot2_f32_bf16 v90, v75, v35, v90
    v_dot2_f32_bf16 v91, v72, v72, v91
    v_dot2_f32_bf16 v91, v73, v73, v91
    v_dot2_f32_bf16 v91, v74, v74, v91
    v_dot2_f32_bf16 v91, v75, v75, v91
    v_mul_f32 v20, v20, v60
    v_mul_f32 v21, v21, v60
    v_mul_f32 v22, v22, v60
    v_mul_f32 v23, v23, v60
    v_mul_f32 v28, v28, v60
    v_mul_f32 v29, v29, v60
    v_mul_f32 v30, v30, v60
    v_mul_f32 v31, v31, v60
    v_cvt_pk_bf16_f32 v76, v20, v21
    v_cvt_pk_bf16_f32 v77, v22, v23
    v_cvt_pk_bf16_f32 v78, v28, v29
    v_cvt_pk_bf16_f32 v79, v30, v31
    buffer_store_dwordx4 v[76:79], v32, s[44:47], s49 offen offset:1024 sc1
    v_dot2_f32_bf16 v90, v76, v35, v90
    v_dot2_f32_bf16 v90, v77, v35, v90
    v_dot2_f32_bf16 v90, v78, v35, v90
    v_dot2_f32_bf16 v90, v79, v35, v90
    v_dot2_f32_bf16 v91, v76, v76, v91
    v_dot2_f32_bf16 v91, v77, v77, v91
    v_dot2_f32_bf16 v91, v78, v78, v91
    v_dot2_f32_bf16 v91, v79, v79, v91
    s_nop 2
    v_mov_b32 v80, v88
    v_mov_b32 v81, v89
    v_mov_b32 v82, v90
    v_mov_b32 v83, v91
    s_nop 1
    s_nop 1
    s_nop 1
    s_nop 1
    v_permlane32_swap_b32 v88, v80
    v_permlane32_swap_b32 v89, v81
    v_permlane32_swap_b32 v90, v82
    v_permlane32_swap_b32 v91, v83
    v_add_f32 v88, v88, v80
    v_add_f32 v89, v89, v81
    v_add_f32 v90, v90, v82
    v_add_f32 v91, v91, v83
    v_mov_b32 v80, v88
    v_mov_b32 v81, v89
    v_mov_b32 v82, v90
    v_mov_b32 v83, v91
    s_nop 1
    s_nop 1
    s_nop 1
    s_nop 1
    v_permlane16_swap_b32 v88, v80
    v_permlane16_swap_b32 v89, v81
    v_permlane16_swap_b32 v90, v82
    v_permlane16_swap_b32 v91, v83
    v_add_f32 v88, v88, v80
    v_add_f32 v89, v89, v81
    v_add_f32 v90, v90, v82
    v_add_f32 v91, v91, v83
    v_cmp_gt_u32 vcc, 16, v44
    s_nop 1
    v_cndmask_b32 v80, v89, v88, vcc
    v_cndmask_b32 v81, v91, v90, vcc
    v_cmp_gt_u32 vcc, 512, v32
    s_nop 1
    v_cndmask_b32 v80, v81, v80, vcc
    buffer_store_dword v80, v45, s[44:47], s52 offen sc1
    s_lshl_b32 s19, s37, 7
    s_add_u32 s19, s19, 54345728
    v_min_u32 v41, 1, v40
    v_lshlrev_b32 v41, 26, v41
    v_mov_b32 v42, 1
    s_cmp_eq_u32 s34, 0
    s_cselect_b32 s18, s19, 0x7ff00000
    s_waitcnt vmcnt(0)
    s_barrier
    buffer_atomic_add v42, v41, s[44:47], s18 offen sc1
END_PH_d0:
PH_a1:
    v_mbcnt_lo_u32_b32 v133, -1, 0
    v_mbcnt_hi_u32_b32 v133, -1, v133
    s_and_b32 s35, s2, 7
    s_lshr_b32 s36, s2, 3
    s_lshr_b32 s37, s35, 2
    s_lshl_b32 s37, s37, 3
    s_lshr_b32 s38, s36, 2
    s_add_u32 s37, s37, s38
    s_and_b32 s38, s35, 3
    s_lshl_b32 s38, s38, 2
    s_and_b32 s39, s36, 3
    s_add_u32 s38, s38, s39
    v_lshlrev_b32 v128, 4, v133
    v_add_u32 v129, 32768, v128
    s_mul_i32 s26, s34, 4096
    v_add_u32 v130, s26, v128
    s_lshl_b32 s42, s37, 3
    s_lshl_b32 s43, s34, 1
    s_add_u32 s42, s42, s43
    s_lshl_b32 s25, s42, 15
    s_mul_i32 s24, s38, 393216
    s_add_u32 s24, s24, 23068672
    v_lshlrev_b32 v184, 2, v133
    s_lshl_b32 s50, s38, 8
    s_lshl_b32 s51, s34, 12
    s_add_u32 s50, s50, s51
    s_add_u32 s50, s50, 54853632
    buffer_load_dword v174, v184, s[44:47], s50 offen sc1
    s_add_u32 s50, s50, 12288
    buffer_load_dword v175, v184, s[44:47], s50 offen sc1
    s_add_u32 s50, s50, 12288
    buffer_load_dword v176, v184, s[44:47], s50 offen sc1
    s_add_u32 s50, s50, 12288
    buffer_load_dword v177, v184, s[44:47], s50 offen sc1
    v_and_b32 v134, 15, v133
    v_lshrrev_b32 v135, 4, v133
    s_lshl_b32 s48, s42, 11
    s_add_u32 s48, s48, 53477376
    s_add_u32 m0, s26, 0
    s_nop 0
    buffer_load_dwordx4 v130, s[44:47], s24 offen offset:0 sc1 lds
    buffer_load_dwordx4 v130, s[44:47], s24 offen offset:1024 sc1 lds
    buffer_load_dwordx4 v130, s[44:47], s24 offen offset:2048 sc1 lds
    buffer_load_dwordx4 v130, s[44:47], s24 offen offset:3072 sc1 lds
    s_add_u32 m0, s26, 16384
    s_add_u32 s24, s24, 16384
    buffer_load_dwordx4 v130, s[44:47], s24 offen offset:0 sc1 lds
    buffer_load_dwordx4 v130, s[44:47], s24 offen offset:1024 sc1 lds
    buffer_load_dwordx4 v130, s[44:47], s24 offen offset:2048 sc1 lds
    buffer_load_dwordx4 v130, s[44:47], s24 offen offset:3072 sc1 lds
    s_add_u32 m0, s26, 32768
    s_add_u32 s24, s24, 16384
    buffer_load_dwordx4 v130, s[44:47], s24 offen offset:0 sc1 lds
    buffer_load_dwordx4 v130, s[44:47], s24 offen offset:1024 sc1 lds
    buffer_load_dwordx4 v130, s[44:47], s24 offen offset:2048 sc1 lds
    buffer_load_dwordx4 v130, s[44:47], s24 offen offset:3072 sc1 lds
    s_add_u32 m0, s26, 49152
    s_add_u32 s24, s24, 16384
    buffer_load_dwordx4 v130, s[44:47], s24 offen offset:0 sc1 lds
    buffer_load_dwordx4 v130, s[44:47], s24 offen offset:1024 sc1 lds
    buffer_load_dwordx4 v130, s[44:47], s24 offen offset:2048 sc1 lds
    buffer_load_dwordx4 v130, s[44:47], s24 offen offset:3072 sc1 lds
    s_add_u32 m0, s26, 65536
    s_add_u32 s24, s24, 16384
    buffer_load_dwordx4 v130, s[44:47], s24 offen offset:0 sc1 lds
    buffer_load_dwordx4 v130, s[44:47], s24 offen offset:1024 sc1 lds
    buffer_load_dwordx4 v130, s[44:47], s24 offen offset:2048 sc1 lds
    buffer_load_dwordx4 v130, s[44:47], s24 offen offset:3072 sc1 lds
    s_lshl_b32 s51, s34, 8
    v_add_u32 v137, s51, v184
    s_add_u32 s51, s51, 99328
    v_lshl_add_u32 v185, v134, 2, s51
    v_lshl_add_u32 v186, v135, 4, s51
    v_add_u32 v187, 98304, v137
    v_lshlrev_b32 v188, 2, v134
    v_add_u32 v188, 98304, v188
    v_lshlrev_b32 v189, 4, v135
    v_add_u32 v189, 98304, v189
    v_mov_b32 v131, v128
    v_add_u32 v132, 65536, v128
    s_waitcnt vmcnt(20)
    v_add_f32 v174, v174, v175
    v_add_f32 v176, v176, v177
    v_add_f32 v174, v174, v176
    ds_write_b32 v187, v174
    s_waitcnt lgkmcnt(0)
    s_barrier
    ds_read_b32 v174, v188 offset:256
    ds_read_b32 v175, v188 offset:320
    ds_read_b32 v176, v188 offset:384
    ds_read_b32 v177, v188 offset:448
    ds_read_b32 v178, v188 offset:512
    ds_read_b32 v179, v188 offset:576
    ds_read_b32 v180, v188 offset:640
    ds_read_b32 v181, v188 offset:704
    ds_read_b128 v[64:67], v189 offset:0
    ds_read_b128 v[72:75], v189 offset:64
    ds_read_b128 v[80:83], v189 offset:128
    ds_read_b128 v[88:91], v189 offset:192
    s_lshl_b32 s19, s37, 7
    s_add_u32 s19, s19, 54345728
    s_cmp_lg_u32 s34, 0
    s_cbranch_scc1 PEa1g
    v_mov_b32 v136, 0
    s_mov_b32 s17, 0
Pa1g:
    buffer_load_dword v138, v136, s[44:47], s19 offen sc1
    s_waitcnt vmcnt(0)
    v_readfirstlane_b32 s16, v138
    s_cmp_ge_u32 s16, 16
    s_cbranch_scc1 PEa1g
    s_sleep 4
    s_add_u32 s17, s17, 1
    s_cmp_lt_u32 s17, 0x40000
    s_cbranch_scc1 Pa1g
PEa1g:
    s_waitcnt vmcnt(0)
    s_barrier
    buffer_load_dwordx4 v[142:145], v128, s[44:47], s48 offen offset:0 sc1
    buffer_load_dwordx4 v[146:149], v128, s[44:47], s48 offen offset:1024 sc1
    buffer_load_dwordx4 v[150:153], v128, s[44:47], s48 offen offset:2048 sc1
    buffer_load_dwordx4 v[154:157], v128, s[44:47], s48 offen offset:3072 sc1
    buffer_load_dwordx4 a[0:3], v128, s[44:47], s25 offen offset:0 sc1
    buffer_load_dwordx4 a[4:7], v128, s[44:47], s25 offen offset:1024 sc1
    buffer_load_dwordx4 a[8:11], v129, s[44:47], s25 offen offset:0 sc1
    buffer_load_dwordx4 a[12:15], v129, s[44:47], s25 offen offset:1024 sc1
    s_add_u32 s25, s25, 2048
    buffer_load_dwordx4 a[16:19], v128, s[44:47], s25 offen offset:0 sc1
    buffer_load_dwordx4 a[20:23], v128, s[44:47], s25 offen offset:1024 sc1
    buffer_load_dwordx4 a[24:27], v129, s[44:47], s25 offen offset:0 sc1
    buffer_load_dwordx4 a[28:31], v129, s[44:47], s25 offen offset:1024 sc1
    s_waitcnt vmcnt(8)
    v_add_f32 v142, v142, v146
    v_add_f32 v143, v143, v147
    v_add_f32 v144, v144, v148
    v_add_f32 v145, v145, v149
    v_add_f32 v150, v150, v154
    v_add_f32 v151, v151, v155
    v_add_f32 v152, v152, v156
    v_add_f32 v153, v153, v157
    v_add_f32 v146, v143, v151
    v_add_f32 v154, v145, v153
    v_add_f32 v142, v142, v150
    v_add_f32 v150, v144, v152
    v_mov_b32 v143, v142
    v_mov_b32 v151, v150
    s_nop 1
    s_nop 1
    v_permlane32_swap_b32 v142, v143
    v_permlane32_swap_b32 v150, v151
    v_add_f32 v142, v142, v143
    v_add_f32 v150, v150, v151
    v_mov_b32 v143, v142
    v_mov_b32 v151, v150
    s_nop 1
    s_nop 1
    v_permlane16_swap_b32 v142, v143
    v_permlane16_swap_b32 v150, v151
    v_add_f32 v142, v142, v143
    v_add_f32 v150, v150, v151
    v_mul_f32 v142, 0xba800000, v142
    v_mul_f32 v150, 0xba800000, v150
    v_mov_b32 v147, v146
    v_mov_b32 v155, v154
    s_nop 1
    s_nop 1
    v_permlane32_swap_b32 v146, v147
    v_permlane32_swap_b32 v154, v155
    v_add_f32 v146, v146, v147
    v_add_f32 v154, v154, v155
    v_mov_b32 v147, v146
    v_mov_b32 v155, v154
    s_nop 1
    s_nop 1
    v_permlane16_swap_b32 v146, v147
    v_permlane16_swap_b32 v154, v155
    v_add_f32 v146, v146, v147
    v_add_f32 v154, v154, v155
    v_mul_f32 v146, 0x3a800000, v146
    v_mul_f32 v154, 0x3a800000, v154
    v_fma_f32 v146, -v142, v142, v146
    v_fma_f32 v154, -v150, v150, v154
    v_max_f32 v146, 0, v146
    v_max_f32 v154, 0, v154
    v_cvt_pk_bf16_f32 v146, v146, v146
    v_cvt_pk_bf16_f32 v154, v154, v154
    v_and_b32 v146, 0xffff0000, v146
    v_and_b32 v154, 0xffff0000, v154
    v_add_f32 v146, 0x3727c5ac, v146
    v_add_f32 v154, 0x3727c5ac, v154
    v_cvt_pk_bf16_f32 v146, v146, v146
    v_cvt_pk_bf16_f32 v154, v154, v154
    v_and_b32 v146, 0xffff0000, v146
    v_and_b32 v154, 0xffff0000, v154
    v_sqrt_f32 v146, v146
    v_sqrt_f32 v154, v154
    s_nop 0
    s_nop 0
    v_cvt_pk_bf16_f32 v146, v146, v146
    v_cvt_pk_bf16_f32 v154, v154, v154
    v_and_b32 v146, 0xffff0000, v146
    v_and_b32 v154, 0xffff0000, v154
    v_rcp_f32 v146, v146
    v_rcp_f32 v154, v154
    s_nop 0
    s_nop 0
    v_cvt_pk_bf16_f32 v142, v142, v142
    v_cvt_pk_bf16_f32 v150, v150, v150
    v_and_b32 v142, 0xffff0000, v142
    v_and_b32 v150, 0xffff0000, v150
    ds_write_b32 v185, v142 offset:0
    ds_write_b32 v185, v150 offset:128
    ds_write_b32 v185, v146 offset:64
    ds_write_b32 v185, v154 offset:192
    ds_read_b128 v[158:161], v186 offset:0
    ds_read_b128 v[166:169], v186 offset:128
    ds_read_b128 v[162:165], v186 offset:64
    ds_read_b128 v[170:173], v186 offset:192
    s_waitcnt lgkmcnt(0)
    v_pk_mul_f32 v[0:1], v[158:159], v[174:175] op_sel_hi:[1,0]
    v_pk_mul_f32 v[2:3], v[160:161], v[174:175] op_sel_hi:[1,0]
    v_pk_mul_f32 v[4:5], v[166:167], v[174:175] op_sel_hi:[1,0]
    v_pk_mul_f32 v[6:7], v[168:169], v[174:175] op_sel_hi:[1,0]
    v_pk_mul_f32 v[8:9], v[158:159], v[174:175] op_sel:[0,1] op_sel_hi:[1,1]
    v_pk_mul_f32 v[10:11], v[160:161], v[174:175] op_sel:[0,1] op_sel_hi:[1,1]
    v_pk_mul_f32 v[12:13], v[166:167], v[174:175] op_sel:[0,1] op_sel_hi:[1,1]
    v_pk_mul_f32 v[14:15], v[168:169], v[174:175] op_sel:[0,1] op_sel_hi:[1,1]
    v_pk_mul_f32 v[16:17], v[158:159], v[176:177] op_sel_hi:[1,0]
    v_pk_mul_f32 v[18:19], v[160:161], v[176:177] op_sel_hi:[1,0]
    v_pk_mul_f32 v[20:21], v[166:167], v[176:177] op_sel_hi:[1,0]
    v_pk_mul_f32 v[22:23], v[168:169], v[176:177] op_sel_hi:[1,0]
    v_pk_mul_f32 v[24:25], v[158:159], v[176:177] op_sel:[0,1] op_sel_hi:[1,1]
    v_pk_mul_f32 v[26:27], v[160:161], v[176:177] op_sel:[0,1] op_sel_hi:[1,1]
    v_pk_mul_f32 v[28:29], v[166:167], v[176:177] op_sel:[0,1] op_sel_hi:[1,1]
    v_pk_mul_f32 v[30:31], v[168:169], v[176:177] op_sel:[0,1] op_sel_hi:[1,1]
    v_pk_mul_f32 v[32:33], v[158:159], v[178:179] op_sel_hi:[1,0]
    v_pk_mul_f32 v[34:35], v[160:161], v[178:179] op_sel_hi:[1,0]
    v_pk_mul_f32 v[36:37], v[166:167], v[178:179] op_sel_hi:[1,0]
    v_pk_mul_f32 v[38:39], v[168:169], v[178:179] op_sel_hi:[1,0]
    v_pk_mul_f32 v[40:41], v[158:159], v[178:179] op_sel:[0,1] op_sel_hi:[1,1]
    v_pk_mul_f32 v[42:43], v[160:161], v[178:179] op_sel:[0,1] op_sel_hi:[1,1]
    v_pk_mul_f32 v[44:45], v[166:167], v[178:179] op_sel:[0,1] op_sel_hi:[1,1]
    v_pk_mul_f32 v[46:47], v[168:169], v[178:179] op_sel:[0,1] op_sel_hi:[1,1]
    v_pk_mul_f32 v[48:49], v[158:159], v[180:181] op_sel_hi:[1,0]
    v_pk_mul_f32 v[50:51], v[160:161], v[180:181] op_sel_hi:[1,0]
    v_pk_mul_f32 v[52:53], v[166:167], v[180:181] op_sel_hi:[1,0]
    v_pk_mul_f32 v[54:55], v[168:169], v[180:181] op_sel_hi:[1,0]
    v_pk_mul_f32 v[56:57], v[158:159], v[180:181] op_sel:[0,1] op_sel_hi:[1,1]
    v_pk_mul_f32 v[58:59], v[160:161], v[180:181] op_sel:[0,1] op_sel_hi:[1,1]
    v_pk_mul_f32 v[60:61], v[166:167], v[180:181] op_sel:[0,1] op_sel_hi:[1,1]
    v_pk_mul_f32 v[62:63], v[168:169], v[180:181] op_sel:[0,1] op_sel_hi:[1,1]
    s_waitcnt vmcnt(24)
    s_barrier
    ds_read_b128 v[96:99], v131 offset:0
    ds_read_b128 v[100:103], v131 offset:1024
    ds_read_b128 v[104:107], v131 offset:2048
    ds_read_b128 v[108:111], v131 offset:3072
    ds_read_b128 v[112:115], v131 offset:4096
    ds_read_b128 v[116:119], v131 offset:5120
    ds_read_b128 v[120:123], v131 offset:6144
    ds_read_b128 v[124:127], v131 offset:7168
    s_waitcnt vmcnt(6) lgkmcnt(6)
    v_mfma_f32_16x16x32_bf16 v[0:3], a[0:3], v[96:99], v[0:3]
    s_add_u32 s25, s25, 2048
    buffer_load_dwordx4 a[32:35], v128, s[44:47], s25 offen offset:0 sc1
    v_mfma_f32_16x16x32_bf16 v[0:3], a[4:7], v[100:103], v[0:3]
    s_waitcnt vmcnt(5)
    v_mfma_f32_16x16x32_bf16 v[4:7], a[12:15], v[100:103], v[4:7]
    v_mfma_f32_16x16x32_bf16 v[4:7], a[8:11], v[96:99], v[4:7]
    ds_read_b128 v[96:99], v131 offset:8192
    s_waitcnt lgkmcnt(5)
    v_mfma_f32_16x16x32_bf16 v[12:15], a[8:11], v[104:107], v[12:15]
    buffer_load_dwordx4 a[36:39], v128, s[44:47], s25 offen offset:1024 sc1
    ds_read_b128 v[100:103], v131 offset:9216
    v_mfma_f32_16x16x32_bf16 v[12:15], a[12:15], v[108:111], v[12:15]
    v_mfma_f32_16x16x32_bf16 v[8:11], a[4:7], v[108:111], v[8:11]
    v_mfma_f32_16x16x32_bf16 v[8:11], a[0:3], v[104:107], v[8:11]
    ds_read_b128 v[104:107], v131 offset:10240
    s_waitcnt lgkmcnt(5)
    v_mfma_f32_16x16x32_bf16 v[16:19], a[0:3], v[112:115], v[16:19]
    buffer_load_dwordx4 a[40:43], v129, s[44:47], s25 offen offset:0 sc1
    ds_read_b128 v[108:111], v131 offset:11264
    v_mfma_f32_16x16x32_bf16 v[16:19], a[4:7], v[116:119], v[16:19]
    v_mfma_f32_16x16x32_bf16 v[20:23], a[12:15], v[116:119], v[20:23]
    v_mfma_f32_16x16x32_bf16 v[20:23], a[8:11], v[112:115], v[20:23]
    ds_read_b128 v[112:115], v131 offset:12288
    s_waitcnt lgkmcnt(5)
    v_mfma_f32_16x16x32_bf16 v[28:31], a[8:11], v[120:123], v[28:31]
    buffer_load_dwordx4 a[44:47], v129, s[44:47], s25 offen offset:1024 sc1
    ds_read_b128 v[116:119], v131 offset:13312
    v_mfma_f32_16x16x32_bf16 v[28:31], a[12:15], v[124:127], v[28:31]
    v_mfma_f32_16x16x32_bf16 v[24:27], a[4:7], v[124:127], v[24:27]
    v_mfma_f32_16x16x32_bf16 v[24:27], a[0:3], v[120:123], v[24:27]
    ds_read_b128 v[120:123], v131 offset:14336
    s_waitcnt lgkmcnt(5)
    v_mfma_f32_16x16x32_bf16 v[32:35], a[0:3], v[96:99], v[32:35]
    s_add_u32 s25, s25, 2048
    buffer_load_dwordx4 a[48:51], v128, s[44:47], s25 offen offset:0 sc1
    ds_read_b128 v[124:127], v131 offset:15360
    v_mfma_f32_16x16x32_bf16 v[32:35], a[4:7], v[100:103], v[32:35]
    v_mfma_f32_16x16x32_bf16 v[36:39], a[12:15], v[100:103], v[36:39]
    s_barrier
    v_mfma_f32_16x16x32_bf16 v[36:39], a[8:11], v[96:99], v[36:39]
    ds_read_b128 v[96:99], v131 offset:16384
    s_waitcnt lgkmcnt(5)
    v_mfma_f32_16x16x32_bf16 v[44:47], a[8:11], v[104:107], v[44:47]
    buffer_load_dwordx4 a[52:55], v128, s[44:47], s25 offen offset:1024 sc1
    ds_read_b128 v[100:103], v131 offset:17408
    v_mfma_f32_16x16x32_bf16 v[44:47], a[12:15], v[108:111], v[44:47]
    v_mfma_f32_16x16x32_bf16 v[40:43], a[4:7], v[108:111], v[40:43]
    v_mfma_f32_16x16x32_bf16 v[40:43], a[0:3], v[104:107], v[40:43]
    ds_read_b128 v[104:107], v131 offset:18432
    s_waitcnt lgkmcnt(5)
    v_mfma_f32_16x16x32_bf16 v[48:51], a[0:3], v[112:115], v[48:51]
    buffer_load_dwordx4 a[56:59], v129, s[44:47], s25 offen offset:0 sc1
    ds_read_b128 v[108:111], v131 offset:19456
    v_mfma_f32_16x16x32_bf16 v[48:51], a[4:7], v[116:119], v[48:51]
    v_mfma_f32_16x16x32_bf16 v[52:55], a[12:15], v[116:119], v[52:55]
    v_mfma_f32_16x16x32_bf16 v[52:55], a[8:11], v[112:115], v[52:55]
    ds_read_b128 v[112:115], v131 offset:20480
    s_waitcnt lgkmcnt(5)
    v_mfma_f32_16x16x32_bf16 v[60:63], a[8:11], v[120:123], v[60:63]
    buffer_load_dwordx4 a[60:63], v129, s[44:47], s25 offen offset:1024 sc1
    ds_read_b128 v[116:119], v131 offset:21504
    v_mfma_f32_16x16x32_bf16 v[60:63], a[12:15], v[124:127], v[60:63]
    v_mfma_f32_16x16x32_bf16 v[56:59], a[4:7], v[124:127], v[56:59]
    v_mfma_f32_16x16x32_bf16 v[56:59], a[0:3], v[120:123], v[56:59]
    s_add_u32 m0, s26, 81920
    s_add_u32 s24, s24, 16384
    buffer_load_dwordx4 v130, s[44:47], s24 offen offset:0 sc1 lds
    ds_read_b128 v[120:123], v131 offset:22528
    ds_read_b128 v[124:127], v131 offset:23552
    s_waitcnt vmcnt(11) lgkmcnt(6)
    v_mfma_f32_16x16x32_bf16 v[0:3], a[16:19], v[96:99], v[0:3]
    v_mfma_f32_16x16x32_bf16 v[0:3], a[20:23], v[100:103], v[0:3]
    s_waitcnt vmcnt(9)
    v_mfma_f32_16x16x32_bf16 v[4:7], a[28:31], v[100:103], v[4:7]
    buffer_load_dwordx4 v130, s[44:47], s24 offen offset:1024 sc1 lds
    v_mfma_f32_16x16x32_bf16 v[4:7], a[24:27], v[96:99], v[4:7]
    ds_read_b128 v[96:99], v131 offset:24576
    s_waitcnt lgkmcnt(5)
    v_mfma_f32_16x16x32_bf16 v[12:15], a[24:27], v[104:107], v[12:15]
    ds_read_b128 v[100:103], v131 offset:25600
    v_mfma_f32_16x16x32_bf16 v[12:15], a[28:31], v[108:111], v[12:15]
    s_add_u32 s25, s25, 2048
    buffer_load_dwordx4 a[64:67], v128, s[44:47], s25 offen offset:0 sc1
    v_mfma_f32_16x16x32_bf16 v[8:11], a[20:23], v[108:111], v[8:11]
    v_mfma_f32_16x16x32_bf16 v[8:11], a[16:19], v[104:107], v[8:11]
    ds_read_b128 v[104:107], v131 offset:26624
    s_waitcnt lgkmcnt(5)
    v_mfma_f32_16x16x32_bf16 v[16:19], a[16:19], v[112:115], v[16:19]
    buffer_load_dwordx4 v130, s[44:47], s24 offen offset:2048 sc1 lds
    ds_read_b128 v[108:111], v131 offset:27648
    v_mfma_f32_16x16x32_bf16 v[16:19], a[20:23], v[116:119], v[16:19]
    v_mfma_f32_16x16x32_bf16 v[20:23], a[28:31], v[116:119], v[20:23]
    v_mfma_f32_16x16x32_bf16 v[20:23], a[24:27], v[112:115], v[20:23]
    ds_read_b128 v[112:115], v131 offset:28672
    s_waitcnt lgkmcnt(5)
    v_mfma_f32_16x16x32_bf16 v[28:31], a[24:27], v[120:123], v[28:31]
    buffer_load_dwordx4 a[68:71], v128, s[44:47], s25 offen offset:1024 sc1
    ds_read_b128 v[116:119], v131 offset:29696
    v_mfma_f32_16x16x32_bf16 v[28:31], a[28:31], v[124:127], v[28:31]
    v_mfma_f32_16x16x32_bf16 v[24:27], a[20:23], v[124:127], v[24:27]
    v_mfma_f32_16x16x32_bf16 v[24:27], a[16:19], v[120:123], v[24:27]
    ds_read_b128 v[120:123], v131 offset:30720
    s_waitcnt lgkmcnt(5)
    v_mfma_f32_16x16x32_bf16 v[32:35], a[16:19], v[96:99], v[32:35]
    buffer_load_dwordx4 v130, s[44:47], s24 offen offset:3072 sc1 lds
    ds_read_b128 v[124:127], v131 offset:31744
    v_mfma_f32_16x16x32_bf16 v[32:35], a[20:23], v[100:103], v[32:35]
    v_mfma_f32_16x16x32_bf16 v[36:39], a[28:31], v[100:103], v[36:39]
    s_barrier
    v_mfma_f32_16x16x32_bf16 v[36:39], a[24:27], v[96:99], v[36:39]
    ds_read_b128 v[96:99], v131 offset:32768
    s_waitcnt lgkmcnt(5)
    v_mfma_f32_16x16x32_bf16 v[44:47], a[24:27], v[104:107], v[44:47]
    buffer_load_dwordx4 a[72:75], v129, s[44:47], s25 offen offset:0 sc1
    ds_read_b128 v[100:103], v131 offset:33792
    v_mfma_f32_16x16x32_bf16 v[44:47], a[28:31], v[108:111], v[44:47]
    v_mfma_f32_16x16x32_bf16 v[40:43], a[20:23], v[108:111], v[40:43]
    v_mfma_f32_16x16x32_bf16 v[40:43], a[16:19], v[104:107], v[40:43]
    ds_read_b128 v[104:107], v131 offset:34816
    s_waitcnt lgkmcnt(5)
    v_mfma_f32_16x16x32_bf16 v[48:51], a[16:19], v[112:115], v[48:51]
    s_add_u32 m0, s26, 0
    s_add_u32 s24, s24, 16384
    buffer_load_dwordx4 v130, s[44:47], s24 offen offset:0 sc1 lds
    ds_read_b128 v[108:111], v131 offset:35840
    v_mfma_f32_16x16x32_bf16 v[48:51], a[20:23], v[116:119], v[48:51]
    v_mfma_f32_16x16x32_bf16 v[52:55], a[28:31], v[116:119], v[52:55]
    v_mfma_f32_16x16x32_bf16 v[52:55], a[24:27], v[112:115], v[52:55]
    ds_read_b128 v[112:115], v131 offset:36864
    s_waitcnt lgkmcnt(5)
    v_mfma_f32_16x16x32_bf16 v[60:63], a[24:27], v[120:123], v[60:63]
    buffer_load_dwordx4 a[76:79], v129, s[44:47], s25 offen offset:1024 sc1
    ds_read_b128 v[116:119], v131 offset:37888
    v_mfma_f32_16x16x32_bf16 v[60:63], a[28:31], v[124:127], v[60:63]
    v_mfma_f32_16x16x32_bf16 v[56:59], a[20:23], v[124:127], v[56:59]
    v_mfma_f32_16x16x32_bf16 v[56:59], a[16:19], v[120:123], v[56:59]
    buffer_load_dwordx4 v130, s[44:47], s24 offen offset:1024 sc1 lds
    ds_read_b128 v[120:123], v131 offset:38912
    ds_read_b128 v[124:127], v131 offset:39936
    s_waitcnt vmcnt(14) lgkmcnt(6)
    v_mfma_f32_16x16x32_bf16 v[0:3], a[32:35], v[96:99], v[0:3]
    v_mfma_f32_16x16x32_bf16 v[0:3], a[36:39], v[100:103], v[0:3]
    v_mfma_f32_16x16x32_bf16 v[4:7], a[44:47], v[100:103], v[4:7]
    buffer_load_dwordx4 v130, s[44:47], s24 offen offset:2048 sc1 lds
    v_mfma_f32_16x16x32_bf16 v[4:7], a[40:43], v[96:99], v[4:7]
    ds_read_b128 v[96:99], v131 offset:40960
    s_waitcnt lgkmcnt(5)
    v_mfma_f32_16x16x32_bf16 v[12:15], a[40:43], v[104:107], v[12:15]
    ds_read_b128 v[100:103], v131 offset:41984
    v_mfma_f32_16x16x32_bf16 v[12:15], a[44:47], v[108:111], v[12:15]
    s_add_u32 s25, s25, 2048
    buffer_load_dwordx4 a[80:83], v128, s[44:47], s25 offen offset:0 sc1
    v_mfma_f32_16x16x32_bf16 v[8:11], a[36:39], v[108:111], v[8:11]
    v_mfma_f32_16x16x32_bf16 v[8:11], a[32:35], v[104:107], v[8:11]
    ds_read_b128 v[104:107], v131 offset:43008
    s_waitcnt lgkmcnt(5)
    v_mfma_f32_16x16x32_bf16 v[16:19], a[32:35], v[112:115], v[16:19]
    ds_read_b128 v[108:111], v131 offset:44032
    v_mfma_f32_16x16x32_bf16 v[16:19], a[36:39], v[116:119], v[16:19]
    buffer_load_dwordx4 v130, s[44:47], s24 offen offset:3072 sc1 lds
    v_mfma_f32_16x16x32_bf16 v[20:23], a[44:47], v[116:119], v[20:23]
    v_mfma_f32_16x16x32_bf16 v[20:23], a[40:43], v[112:115], v[20:23]
    ds_read_b128 v[112:115], v131 offset:45056
    s_waitcnt lgkmcnt(5)
    v_mfma_f32_16x16x32_bf16 v[28:31], a[40:43], v[120:123], v[28:31]
    buffer_load_dwordx4 a[84:87], v128, s[44:47], s25 offen offset:1024 sc1
    ds_read_b128 v[116:119], v131 offset:46080
    v_mfma_f32_16x16x32_bf16 v[28:31], a[44:47], v[124:127], v[28:31]
    v_mfma_f32_16x16x32_bf16 v[24:27], a[36:39], v[124:127], v[24:27]
    v_mfma_f32_16x16x32_bf16 v[24:27], a[32:35], v[120:123], v[24:27]
    ds_read_b128 v[120:123], v131 offset:47104
    s_waitcnt lgkmcnt(5)
    v_mfma_f32_16x16x32_bf16 v[32:35], a[32:35], v[96:99], v[32:35]
    ds_read_b128 v[124:127], v131 offset:48128
    v_mfma_f32_16x16x32_bf16 v[32:35], a[36:39], v[100:103], v[32:35]
    v_mfma_f32_16x16x32_bf16 v[36:39], a[44:47], v[100:103], v[36:39]
    s_barrier
    v_mfma_f32_16x16x32_bf16 v[36:39], a[40:43], v[96:99], v[36:39]
    ds_read_b128 v[96:99], v131 offset:49152
    s_waitcnt lgkmcnt(5)
    v_mfma_f32_16x16x32_bf16 v[44:47], a[40:43], v[104:107], v[44:47]
    buffer_load_dwordx4 a[88:91], v129, s[44:47], s25 offen offset:0 sc1
    ds_read_b128 v[100:103], v131 offset:50176
    v_mfma_f32_16x16x32_bf16 v[44:47], a[44:47], v[108:111], v[44:47]
    v_mfma_f32_16x16x32_bf16 v[40:43], a[36:39], v[108:111], v[40:43]
    v_mfma_f32_16x16x32_bf16 v[40:43], a[32:35], v[104:107], v[40:43]
    ds_read_b128 v[104:107], v131 offset:51200
    s_waitcnt lgkmcnt(5)
    v_mfma_f32_16x16x32_bf16 v[48:51], a[32:35], v[112:115], v[48:51]
    s_add_u32 m0, s26, 16384
    s_add_u32 s24, s24, 16384
    buffer_load_dwordx4 v130, s[44:47], s24 offen offset:0 sc1 lds
    ds_read_b128 v[108:111], v131 offset:52224
    v_mfma_f32_16x16x32_bf16 v[48:51], a[36:39], v[116:119], v[48:51]
    v_mfma_f32_16x16x32_bf16 v[52:55], a[44:47], v[116:119], v[52:55]
    v_mfma_f32_16x16x32_bf16 v[52:55], a[40:43], v[112:115], v[52:55]
    ds_read_b128 v[112:115], v131 offset:53248
    s_waitcnt lgkmcnt(5)
    v_mfma_f32_16x16x32_bf16 v[60:63], a[40:43], v[120:123], v[60:63]
    buffer_load_dwordx4 a[92:95], v129, s[44:47], s25 offen offset:1024 sc1
    ds_read_b128 v[116:119], v131 offset:54272
    v_mfma_f32_16x16x32_bf16 v[60:63], a[44:47], v[124:127], v[60:63]
    v_mfma_f32_16x16x32_bf16 v[56:59], a[36:39], v[124:127], v[56:59]
    v_mfma_f32_16x16x32_bf16 v[56:59], a[32:35], v[120:123], v[56:59]
    buffer_load_dwordx4 v130, s[44:47], s24 offen offset:1024 sc1 lds
    ds_read_b128 v[120:123], v131 offset:55296
    ds_read_b128 v[124:127], v131 offset:56320
    s_waitcnt vmcnt(18) lgkmcnt(6)
    v_mfma_f32_16x16x32_bf16 v[0:3], a[48:51], v[96:99], v[0:3]
    v_mfma_f32_16x16x32_bf16 v[0:3], a[52:55], v[100:103], v[0:3]
    v_mfma_f32_16x16x32_bf16 v[4:7], a[60:63], v[100:103], v[4:7]
    buffer_load_dwordx4 v130, s[44:47], s24 offen offset:2048 sc1 lds
    v_mfma_f32_16x16x32_bf16 v[4:7], a[56:59], v[96:99], v[4:7]
    ds_read_b128 v[96:99], v131 offset:57344
    s_waitcnt lgkmcnt(5)
    v_mfma_f32_16x16x32_bf16 v[12:15], a[56:59], v[104:107], v[12:15]
    ds_read_b128 v[100:103], v131 offset:58368
    v_mfma_f32_16x16x32_bf16 v[12:15], a[60:63], v[108:111], v[12:15]
    s_add_u32 s25, s25, 2048
    buffer_load_dwordx4 a[96:99], v128, s[44:47], s25 offen offset:0 sc1
    v_mfma_f32_16x16x32_bf16 v[8:11], a[52:55], v[108:111], v[8:11]
    v_mfma_f32_16x16x32_bf16 v[8:11], a[48:51], v[104:107], v[8:11]
    ds_read_b128 v[104:107], v131 offset:59392
    s_waitcnt lgkmcnt(5)
    v_mfma_f32_16x16x32_bf16 v[16:19], a[48:51], v[112:115], v[16:19]
    ds_read_b128 v[108:111], v131 offset:60416
    v_mfma_f32_16x16x32_bf16 v[16:19], a[52:55], v[116:119], v[16:19]
    buffer_load_dwordx4 v130, s[44:47], s24 offen offset:3072 sc1 lds
    v_mfma_f32_16x16x32_bf16 v[20:23], a[60:63], v[116:119], v[20:23]
    v_mfma_f32_16x16x32_bf16 v[20:23], a[56:59], v[112:115], v[20:23]
    ds_read_b128 v[112:115], v131 offset:61440
    s_waitcnt lgkmcnt(5)
    v_mfma_f32_16x16x32_bf16 v[28:31], a[56:59], v[120:123], v[28:31]
    buffer_load_dwordx4 a[100:103], v128, s[44:47], s25 offen offset:1024 sc1
    ds_read_b128 v[116:119], v131 offset:62464
    v_mfma_f32_16x16x32_bf16 v[28:31], a[60:63], v[124:127], v[28:31]
    v_mfma_f32_16x16x32_bf16 v[24:27], a[52:55], v[124:127], v[24:27]
    v_mfma_f32_16x16x32_bf16 v[24:27], a[48:51], v[120:123], v[24:27]
    ds_read_b128 v[120:123], v131 offset:63488
    s_waitcnt lgkmcnt(5)
    v_mfma_f32_16x16x32_bf16 v[32:35], a[48:51], v[96:99], v[32:35]
    ds_read_b128 v[124:127], v131 offset:64512
    v_mfma_f32_16x16x32_bf16 v[32:35], a[52:55], v[100:103], v[32:35]
    v_mfma_f32_16x16x32_bf16 v[36:39], a[60:63], v[100:103], v[36:39]
    s_barrier
    v_mfma_f32_16x16x32_bf16 v[36:39], a[56:59], v[96:99], v[36:39]
    ds_read_b128 v[96:99], v132 offset:0
    s_waitcnt lgkmcnt(5)
    v_mfma_f32_16x16x32_bf16 v[44:47], a[56:59], v[104:107], v[44:47]
    buffer_load_dwordx4 a[104:107], v129, s[44:47], s25 offen offset:0 sc1
    ds_read_b128 v[100:103], v132 offset:1024
    v_mfma_f32_16x16x32_bf16 v[44:47], a[60:63], v[108:111], v[44:47]
    v_mfma_f32_16x16x32_bf16 v[40:43], a[52:55], v[108:111], v[40:43]
    v_mfma_f32_16x16x32_bf16 v[40:43], a[48:51], v[104:107], v[40:43]
    ds_read_b128 v[104:107], v132 offset:2048
    s_waitcnt lgkmcnt(5)
    v_mfma_f32_16x16x32_bf16 v[48:51], a[48:51], v[112:115], v[48:51]
    s_add_u32 m0, s26, 32768
    s_add_u32 s24, s24, 16384
    buffer_load_dwordx4 v130, s[44:47], s24 offen offset:0 sc1 lds
    ds_read_b128 v[108:111], v132 offset:3072
    v_mfma_f32_16x16x32_bf16 v[48:51], a[52:55], v[116:119], v[48:51]
    v_mfma_f32_16x16x32_bf16 v[52:55], a[60:63], v[116:119], v[52:55]
    v_mfma_f32_16x16x32_bf16 v[52:55], a[56:59], v[112:115], v[52:55]
    ds_read_b128 v[112:115], v132 offset:4096
    s_waitcnt lgkmcnt(5)
    v_mfma_f32_16x16x32_bf16 v[60:63], a[56:59], v[120:123], v[60:63]
    buffer_load_dwordx4 a[108:111], v129, s[44:47], s25 offen offset:1024 sc1
    ds_read_b128 v[116:119], v132 offset:5120
    v_mfma_f32_16x16x32_bf16 v[60:63], a[60:63], v[124:127], v[60:63]
    v_mfma_f32_16x16x32_bf16 v[56:59], a[52:55], v[124:127], v[56:59]
    v_mfma_f32_16x16x32_bf16 v[56:59], a[48:51], v[120:123], v[56:59]
    buffer_load_dwordx4 v130, s[44:47], s24 offen offset:1024 sc1 lds
    ds_read_b128 v[120:123], v132 offset:6144
    ds_read_b128 v[124:127], v132 offset:7168
    s_waitcnt vmcnt(17) lgkmcnt(6)
    v_mfma_f32_16x16x32_bf16 v[0:3], a[64:67], v[96:99], v[0:3]
    v_mfma_f32_16x16x32_bf16 v[0:3], a[68:71], v[100:103], v[0:3]
    v_mfma_f32_16x16x32_bf16 v[4:7], a[76:79], v[100:103], v[4:7]
    buffer_load_dwordx4 v130, s[44:47], s24 offen offset:2048 sc1 lds
    v_mfma_f32_16x16x32_bf16 v[4:7], a[72:75], v[96:99], v[4:7]
    ds_read_b128 v[96:99], v132 offset:8192
    s_waitcnt lgkmcnt(5)
    v_mfma_f32_16x16x32_bf16 v[12:15], a[72:75], v[104:107], v[12:15]
    ds_read_b128 v[100:103], v132 offset:9216
    v_mfma_f32_16x16x32_bf16 v[12:15], a[76:79], v[108:111], v[12:15]
    s_add_u32 s25, s25, 2048
    buffer_load_dwordx4 a[112:115], v128, s[44:47], s25 offen offset:0 sc1
    v_mfma_f32_16x16x32_bf16 v[8:11], a[68:71], v[108:111], v[8:11]
    v_mfma_f32_16x16x32_bf16 v[8:11], a[64:67], v[104:107], v[8:11]
    ds_read_b128 v[104:107], v132 offset:10240
    s_waitcnt lgkmcnt(5)
    v_mfma_f32_16x16x32_bf16 v[16:19], a[64:67], v[112:115], v[16:19]
    ds_read_b128 v[108:111], v132 offset:11264
    v_mfma_f32_16x16x32_bf16 v[16:19], a[68:71], v[116:119], v[16:19]
    buffer_load_dwordx4 v130, s[44:47], s24 offen offset:3072 sc1 lds
    v_mfma_f32_16x16x32_bf16 v[20:23], a[76:79], v[116:119], v[20:23]
    v_mfma_f32_16x16x32_bf16 v[20:23], a[72:75], v[112:115], v[20:23]
    ds_read_b128 v[112:115], v132 offset:12288
    s_waitcnt lgkmcnt(5)
    v_mfma_f32_16x16x32_bf16 v[28:31], a[72:75], v[120:123], v[28:31]
    buffer_load_dwordx4 a[116:119], v128, s[44:47], s25 offen offset:1024 sc1
    ds_read_b128 v[116:119], v132 offset:13312
    v_mfma_f32_16x16x32_bf16 v[28:31], a[76:79], v[124:127], v[28:31]
    v_mfma_f32_16x16x32_bf16 v[24:27], a[68:71], v[124:127], v[24:27]
    v_mfma_f32_16x16x32_bf16 v[24:27], a[64:67], v[120:123], v[24:27]
    ds_read_b128 v[120:123], v132 offset:14336
    s_waitcnt lgkmcnt(5)
    v_mfma_f32_16x16x32_bf16 v[32:35], a[64:67], v[96:99], v[32:35]
    ds_read_b128 v[124:127], v132 offset:15360
    v_mfma_f32_16x16x32_bf16 v[32:35], a[68:71], v[100:103], v[32:35]
    v_mfma_f32_16x16x32_bf16 v[36:39], a[76:79], v[100:103], v[36:39]
    s_barrier
    v_mfma_f32_16x16x32_bf16 v[36:39], a[72:75], v[96:99], v[36:39]
    ds_read_b128 v[96:99], v132 offset:16384
    s_waitcnt lgkmcnt(5)
    v_mfma_f32_16x16x32_bf16 v[44:47], a[72:75], v[104:107], v[44:47]
    buffer_load_dwordx4 a[120:123], v129, s[44:47], s25 offen offset:0 sc1
    ds_read_b128 v[100:103], v132 offset:17408
    v_mfma_f32_16x16x32_bf16 v[44:47], a[76:79], v[108:111], v[44:47]
    v_mfma_f32_16x16x32_bf16 v[40:43], a[68:71], v[108:111], v[40:43]
    v_mfma_f32_16x16x32_bf16 v[40:43], a[64:67], v[104:107], v[40:43]
    ds_read_b128 v[104:107], v132 offset:18432
    s_waitcnt lgkmcnt(5)
    v_mfma_f32_16x16x32_bf16 v[48:51], a[64:67], v[112:115], v[48:51]
    s_add_u32 m0, s26, 49152
    s_add_u32 s24, s24, 16384
    buffer_load_dwordx4 v130, s[44:47], s24 offen offset:0 sc1 lds
    ds_read_b128 v[108:111], v132 offset:19456
    v_mfma_f32_16x16x32_bf16 v[48:51], a[68:71], v[116:119], v[48:51]
    v_mfma_f32_16x16x32_bf16 v[52:55], a[76:79], v[116:119], v[52:55]
    v_mfma_f32_16x16x32_bf16 v[52:55], a[72:75], v[112:115], v[52:55]
    ds_read_b128 v[112:115], v132 offset:20480
    s_waitcnt lgkmcnt(5)
    v_mfma_f32_16x16x32_bf16 v[60:63], a[72:75], v[120:123], v[60:63]
    buffer_load_dwordx4 a[124:127], v129, s[44:47], s25 offen offset:1024 sc1
    ds_read_b128 v[116:119], v132 offset:21504
    v_mfma_f32_16x16x32_bf16 v[60:63], a[76:79], v[124:127], v[60:63]
    v_mfma_f32_16x16x32_bf16 v[56:59], a[68:71], v[124:127], v[56:59]
    v_mfma_f32_16x16x32_bf16 v[56:59], a[64:67], v[120:123], v[56:59]
    buffer_load_dwordx4 v130, s[44:47], s24 offen offset:1024 sc1 lds
    ds_read_b128 v[120:123], v132 offset:22528
    ds_read_b128 v[124:127], v132 offset:23552
    s_waitcnt vmcnt(17) lgkmcnt(6)
    v_mfma_f32_16x16x32_bf16 v[0:3], a[80:83], v[96:99], v[0:3]
    v_mfma_f32_16x16x32_bf16 v[0:3], a[84:87], v[100:103], v[0:3]
    v_mul_f32 v68, v64, v150
    v_mfma_f32_16x16x32_bf16 v[4:7], a[92:95], v[100:103], v[4:7]
    v_mul_f32 v69, v65, v150
    v_mfma_f32_16x16x32_bf16 v[4:7], a[88:91], v[96:99], v[4:7]
    v_mul_f32 v70, v66, v150
    s_waitcnt lgkmcnt(4)
    v_mfma_f32_16x16x32_bf16 v[12:15], a[88:91], v[104:107], v[12:15]
    v_mul_f32 v71, v67, v150
    s_add_u32 s25, s25, 2048
    buffer_load_dwordx4 a[128:131], v128, s[44:47], s25 offen offset:0 sc1
    ds_read_b128 v[96:99], v132 offset:24576
    ds_read_b128 v[100:103], v132 offset:25600
    v_mfma_f32_16x16x32_bf16 v[12:15], a[92:95], v[108:111], v[12:15]
    v_mul_f32 v64, v64, v142
    v_mfma_f32_16x16x32_bf16 v[8:11], a[84:87], v[108:111], v[8:11]
    v_mul_f32 v65, v65, v142
    v_mfma_f32_16x16x32_bf16 v[8:11], a[80:83], v[104:107], v[8:11]
    v_mul_f32 v66, v66, v142
    s_waitcnt lgkmcnt(4)
    v_mfma_f32_16x16x32_bf16 v[16:19], a[80:83], v[112:115], v[16:19]
    v_mul_f32 v67, v67, v142
    ds_read_b128 v[104:107], v132 offset:26624
    ds_read_b128 v[108:111], v132 offset:27648
    v_mfma_f32_16x16x32_bf16 v[16:19], a[84:87], v[116:119], v[16:19]
    v_mul_f32 v76, v72, v150
    buffer_load_dwordx4 v130, s[44:47], s24 offen offset:2048 sc1 lds
    v_mfma_f32_16x16x32_bf16 v[20:23], a[92:95], v[116:119], v[20:23]
    v_mul_f32 v77, v73, v150
    v_mfma_f32_16x16x32_bf16 v[20:23], a[88:91], v[112:115], v[20:23]
    v_mul_f32 v78, v74, v150
    s_waitcnt lgkmcnt(4)
    v_mfma_f32_16x16x32_bf16 v[28:31], a[88:91], v[120:123], v[28:31]
    v_mul_f32 v79, v75, v150
    ds_read_b128 v[112:115], v132 offset:28672
    ds_read_b128 v[116:119], v132 offset:29696
    v_mfma_f32_16x16x32_bf16 v[28:31], a[92:95], v[124:127], v[28:31]
    v_mul_f32 v72, v72, v142
    v_mfma_f32_16x16x32_bf16 v[24:27], a[84:87], v[124:127], v[24:27]
    v_mul_f32 v73, v73, v142
    buffer_load_dwordx4 a[132:135], v128, s[44:47], s25 offen offset:1024 sc1
    v_mfma_f32_16x16x32_bf16 v[24:27], a[80:83], v[120:123], v[24:27]
    v_mul_f32 v74, v74, v142
    s_waitcnt lgkmcnt(4)
    v_mfma_f32_16x16x32_bf16 v[32:35], a[80:83], v[96:99], v[32:35]
    v_mul_f32 v75, v75, v142
    ds_read_b128 v[120:123], v132 offset:30720
    ds_read_b128 v[124:127], v132 offset:31744
    v_mfma_f32_16x16x32_bf16 v[32:35], a[84:87], v[100:103], v[32:35]
    v_mul_f32 v84, v80, v150
    v_mfma_f32_16x16x32_bf16 v[36:39], a[92:95], v[100:103], v[36:39]
    v_mul_f32 v85, v81, v150
    s_barrier
    v_mfma_f32_16x16x32_bf16 v[36:39], a[88:91], v[96:99], v[36:39]
    v_mul_f32 v86, v82, v150
    buffer_load_dwordx4 v130, s[44:47], s24 offen offset:3072 sc1 lds
    s_waitcnt lgkmcnt(4)
    v_mfma_f32_16x16x32_bf16 v[44:47], a[88:91], v[104:107], v[44:47]
    v_mul_f32 v87, v83, v150
    ds_read_b128 v[96:99], v131 offset:0
    ds_read_b128 v[100:103], v131 offset:1024
    v_mfma_f32_16x16x32_bf16 v[44:47], a[92:95], v[108:111], v[44:47]
    v_mul_f32 v80, v80, v142
    v_mfma_f32_16x16x32_bf16 v[40:43], a[84:87], v[108:111], v[40:43]
    v_mul_f32 v81, v81, v142
    v_mfma_f32_16x16x32_bf16 v[40:43], a[80:83], v[104:107], v[40:43]
    v_mul_f32 v82, v82, v142
    s_waitcnt lgkmcnt(4)
    v_mfma_f32_16x16x32_bf16 v[48:51], a[80:83], v[112:115], v[48:51]
    v_mul_f32 v83, v83, v142
    buffer_load_dwordx4 a[136:139], v129, s[44:47], s25 offen offset:0 sc1
    ds_read_b128 v[104:107], v131 offset:2048
    ds_read_b128 v[108:111], v131 offset:3072
    v_mfma_f32_16x16x32_bf16 v[48:51], a[84:87], v[116:119], v[48:51]
    v_mul_f32 v92, v88, v150
    v_mfma_f32_16x16x32_bf16 v[52:55], a[92:95], v[116:119], v[52:55]
    v_mul_f32 v93, v89, v150
    v_mfma_f32_16x16x32_bf16 v[52:55], a[88:91], v[112:115], v[52:55]
    v_mul_f32 v94, v90, v150
    s_waitcnt lgkmcnt(4)
    v_mfma_f32_16x16x32_bf16 v[60:63], a[88:91], v[120:123], v[60:63]
    v_mul_f32 v95, v91, v150
    ds_read_b128 v[112:115], v131 offset:4096
    ds_read_b128 v[116:119], v131 offset:5120
    v_mfma_f32_16x16x32_bf16 v[60:63], a[92:95], v[124:127], v[60:63]
    v_mul_f32 v88, v88, v142
    buffer_load_dwordx4 a[140:143], v129, s[44:47], s25 offen offset:1024 sc1
    v_mfma_f32_16x16x32_bf16 v[56:59], a[84:87], v[124:127], v[56:59]
    v_mul_f32 v89, v89, v142
    v_mfma_f32_16x16x32_bf16 v[56:59], a[80:83], v[120:123], v[56:59]
    v_mul_f32 v90, v90, v142
    ds_read_b128 v[120:123], v131 offset:6144
    ds_read_b128 v[124:127], v131 offset:7168
    s_waitcnt vmcnt(15) lgkmcnt(6)
    v_mfma_f32_16x16x32_bf16 v[0:3], a[96:99], v[96:99], v[0:3]
    v_mul_f32 v91, v91, v142
    v_mfma_f32_16x16x32_bf16 v[0:3], a[100:103], v[100:103], v[0:3]
    s_mov_b32 s52, 0x358637bd
    v_mfma_f32_16x16x32_bf16 v[4:7], a[108:111], v[100:103], v[4:7]
    s_mov_b32 s53, 0x358637bd
    s_add_u32 m0, s26, 65536
    s_add_u32 s24, s24, 16384
    buffer_load_dwordx4 v130, s[44:47], s24 offen offset:0 sc1 lds
    v_mfma_f32_16x16x32_bf16 v[4:7], a[104:107], v[96:99], v[4:7]
    s_mov_b32 s54, 0x3fb8aa3b
    s_waitcnt lgkmcnt(4)
    v_mfma_f32_16x16x32_bf16 v[12:15], a[104:107], v[104:107], v[12:15]
    v_mul_f32 v158, s54, v162
    ds_read_b128 v[96:99], v131 offset:8192
    ds_read_b128 v[100:103], v131 offset:9216
    v_mfma_f32_16x16x32_bf16 v[12:15], a[108:111], v[108:111], v[12:15]
    v_mul_f32 v159, s54, v163
    v_mfma_f32_16x16x32_bf16 v[8:11], a[100:103], v[108:111], v[8:11]
    v_mul_f32 v160, s54, v164
    v_mfma_f32_16x16x32_bf16 v[8:11], a[96:99], v[104:107], v[8:11]
    v_mul_f32 v161, s54, v165
    s_add_u32 s25, s25, 2048
    buffer_load_dwordx4 a[144:147], v128, s[44:47], s25 offen offset:0 sc1
    s_waitcnt lgkmcnt(4)
    v_mfma_f32_16x16x32_bf16 v[16:19], a[96:99], v[112:115], v[16:19]
    v_mul_f32 v142, s54, v146
    ds_read_b128 v[104:107], v131 offset:10240
    ds_read_b128 v[108:111], v131 offset:11264
    v_mfma_f32_16x16x32_bf16 v[16:19], a[100:103], v[116:119], v[16:19]
    v_mul_f32 v166, s54, v170
    v_mfma_f32_16x16x32_bf16 v[20:23], a[108:111], v[116:119], v[20:23]
    v_mul_f32 v167, s54, v171
    v_mfma_f32_16x16x32_bf16 v[20:23], a[104:107], v[112:115], v[20:23]
    v_mul_f32 v168, s54, v172
    s_waitcnt lgkmcnt(4)
    v_mfma_f32_16x16x32_bf16 v[28:31], a[104:107], v[120:123], v[28:31]
    v_mul_f32 v169, s54, v173
    buffer_load_dwordx4 a[148:151], v128, s[44:47], s25 offen offset:1024 sc1
    ds_read_b128 v[112:115], v131 offset:12288
    ds_read_b128 v[116:119], v131 offset:13312
    v_mfma_f32_16x16x32_bf16 v[28:31], a[108:111], v[124:127], v[28:31]
    v_mul_f32 v150, s54, v154
    v_mfma_f32_16x16x32_bf16 v[24:27], a[100:103], v[124:127], v[24:27]
    v_mov_b32 v140, 1.0
    v_mfma_f32_16x16x32_bf16 v[24:27], a[96:99], v[120:123], v[24:27]
    v_mov_b32 v141, 1.0
    s_waitcnt lgkmcnt(4)
    v_mfma_f32_16x16x32_bf16 v[32:35], a[96:99], v[96:99], v[32:35]
    v_mov_b32 v246, 0x3f803f80
    ds_read_b128 v[120:123], v131 offset:14336
    ds_read_b128 v[124:127], v131 offset:15360
    v_mfma_f32_16x16x32_bf16 v[32:35], a[100:103], v[100:103], v[32:35]
    v_mov_b32 v247, 0x3f803f80
    buffer_load_dwordx4 v130, s[44:47], s24 offen offset:1024 sc1 lds
    v_mfma_f32_16x16x32_bf16 v[36:39], a[108:111], v[100:103], v[36:39]
    v_mov_b32 v248, 0x3f803f80
    s_barrier
    v_mfma_f32_16x16x32_bf16 v[36:39], a[104:107], v[96:99], v[36:39]
    v_mov_b32 v249, 0x3f803f80
    s_waitcnt lgkmcnt(4)
    v_mfma_f32_16x16x32_bf16 v[44:47], a[104:107], v[104:107], v[44:47]
    v_mov_b32 v250, 0x358637bd
    ds_read_b128 v[96:99], v131 offset:16384
    ds_read_b128 v[100:103], v131 offset:17408
    v_mfma_f32_16x16x32_bf16 v[44:47], a[108:111], v[108:111], v[44:47]
    v_mov_b32 v251, 0x358637bd
    v_mfma_f32_16x16x32_bf16 v[40:43], a[100:103], v[108:111], v[40:43]
    v_mov_b32 v252, 0x358637bd
    buffer_load_dwordx4 a[152:155], v129, s[44:47], s25 offen offset:0 sc1
    v_mfma_f32_16x16x32_bf16 v[40:43], a[96:99], v[104:107], v[40:43]
    v_mov_b32 v253, 0x358637bd
    s_waitcnt lgkmcnt(4)
    v_mfma_f32_16x16x32_bf16 v[48:51], a[96:99], v[112:115], v[48:51]
    s_mul_i32 s55, s34, 8448
    ds_read_b128 v[104:107], v131 offset:18432
    ds_read_b128 v[108:111], v131 offset:19456
    v_mfma_f32_16x16x32_bf16 v[48:51], a[100:103], v[116:119], v[48:51]
    s_add_u32 s55, s55, 100352
    v_mfma_f32_16x16x32_bf16 v[52:55], a[108:111], v[116:119], v[52:55]
    v_add_u32 v254, s55, v128
    v_mfma_f32_16x16x32_bf16 v[52:55], a[104:107], v[112:115], v[52:55]
    v_lshl_add_u32 v255, v135, 4, s55
    buffer_load_dwordx4 v130, s[44:47], s24 offen offset:2048 sc1 lds
    s_waitcnt lgkmcnt(4)
    v_mfma_f32_16x16x32_bf16 v[60:63], a[104:107], v[120:123], v[60:63]
    v_add_u32 v138, 100352, v137
    ds_read_b128 v[112:115], v131 offset:20480
    ds_read_b128 v[116:119], v131 offset:21504
    v_mfma_f32_16x16x32_bf16 v[60:63], a[108:111], v[124:127], v[60:63]
    s_lshl_b32 s56, s38, 13
    v_mfma_f32_16x16x32_bf16 v[56:59], a[100:103], v[124:127], v[56:59]
    s_add_u32 s56, s56, 54202368
    v_mfma_f32_16x16x32_bf16 v[56:59], a[96:99], v[120:123], v[56:59]
    s_add_u32 s57, s56, 4096
    buffer_load_dwordx4 a[156:159], v129, s[44:47], s25 offen offset:1024 sc1
    ds_read_b128 v[120:123], v131 offset:22528
    ds_read_b128 v[124:127], v131 offset:23552
    s_waitcnt vmcnt(14) lgkmcnt(6)
    v_mfma_f32_16x16x32_bf16 v[0:3], a[112:115], v[96:99], v[0:3]
    s_lshl_b32 s59, s38, 7
    v_mfma_f32_16x16x32_bf16 v[0:3], a[116:119], v[100:103], v[0:3]
    s_add_u32 s59, s59, 54349824
    v_mfma_f32_16x16x32_bf16 v[4:7], a[124:127], v[100:103], v[4:7]
    s_lshl_b32 s58, s38, 8
    v_mfma_f32_16x16x32_bf16 v[4:7], a[120:123], v[96:99], v[4:7]
    s_add_u32 s58, s58, 54333440
    s_waitcnt lgkmcnt(4)
    v_mfma_f32_16x16x32_bf16 v[12:15], a[120:123], v[104:107], v[12:15]
    s_lshl_b32 s60, s42, 15
    buffer_load_dwordx4 v130, s[44:47], s24 offen offset:3072 sc1 lds
    ds_read_b128 v[96:99], v131 offset:24576
    ds_read_b128 v[100:103], v131 offset:25600
    v_mfma_f32_16x16x32_bf16 v[12:15], a[124:127], v[108:111], v[12:15]
    s_lshl_b32 s61, s38, 11
    v_mfma_f32_16x16x32_bf16 v[8:11], a[116:119], v[108:111], v[8:11]
    s_add_u32 s60, s60, s61
    v_mfma_f32_16x16x32_bf16 v[8:11], a[112:115], v[104:107], v[8:11]
    s_add_u32 s60, s60, 4194304
    s_waitcnt lgkmcnt(4)
    v_mfma_f32_16x16x32_bf16 v[16:19], a[112:115], v[112:115], v[16:19]
    s_add_u32 s61, s60, 32768
    ds_read_b128 v[104:107], v131 offset:26624
    ds_read_b128 v[108:111], v131 offset:27648
    v_mfma_f32_16x16x32_bf16 v[16:19], a[116:119], v[116:119], v[16:19]
    v_min_u32 v184, 1, v133
    s_add_u32 s25, s25, 2048
    buffer_load_dwordx4 a[160:163], v128, s[44:47], s25 offen offset:0 sc1
    v_mfma_f32_16x16x32_bf16 v[20:23], a[124:127], v[116:119], v[20:23]
    v_lshlrev_b32 v184, 26, v184
    v_mfma_f32_16x16x32_bf16 v[20:23], a[120:123], v[112:115], v[20:23]
    v_mov_b32 v185, 1
    s_waitcnt lgkmcnt(4)
    v_mfma_f32_16x16x32_bf16 v[28:31], a[120:123], v[120:123], v[28:31]
    v_mov_b32 v134, 0
    ds_read_b128 v[112:115], v131 offset:28672
    ds_read_b128 v[116:119], v131 offset:29696
    v_mfma_f32_16x16x32_bf16 v[28:31], a[124:127], v[124:127], v[28:31]
    s_lshl_b32 s40, s34, 11
    v_mfma_f32_16x16x32_bf16 v[24:27], a[116:119], v[124:127], v[24:27]
    s_add_u32 s40, s40, s56
    buffer_load_dwordx4 a[164:167], v128, s[44:47], s25 offen offset:1024 sc1
    v_mfma_f32_16x16x32_bf16 v[24:27], a[112:115], v[120:123], v[24:27]
    s_lshl_b32 s41, s34, 10
    s_waitcnt lgkmcnt(4)
    v_mfma_f32_16x16x32_bf16 v[32:35], a[112:115], v[96:99], v[32:35]
    s_add_u32 s41, s41, 155648
    ds_read_b128 v[120:123], v131 offset:30720
    ds_read_b128 v[124:127], v131 offset:31744
    v_mfma_f32_16x16x32_bf16 v[32:35], a[116:119], v[100:103], v[32:35]
    v_add_u32 v139, s41, v128
    v_mfma_f32_16x16x32_bf16 v[36:39], a[124:127], v[100:103], v[36:39]
    v_add_u32 v186, 155648, v128
    s_barrier
    v_mfma_f32_16x16x32_bf16 v[36:39], a[120:123], v[96:99], v[36:39]
    v_lshlrev_b32 v135, 4, v135
    s_add_u32 m0, s26, 81920
    s_add_u32 s24, s24, 16384
    buffer_load_dwordx4 v130, s[44:47], s24 offen offset:0 sc1 lds
    s_waitcnt lgkmcnt(4)
    v_mfma_f32_16x16x32_bf16 v[44:47], a[120:123], v[104:107], v[44:47]
    s_lshl_b32 s18, s37, 7
    ds_read_b128 v[96:99], v131 offset:32768
    ds_read_b128 v[100:103], v131 offset:33792
    v_mfma_f32_16x16x32_bf16 v[44:47], a[124:127], v[108:111], v[44:47]
    s_add_u32 s18, s18, 54351872
    v_mfma_f32_16x16x32_bf16 v[40:43], a[116:119], v[108:111], v[40:43]
    s_and_b32 s35, s2, 7
    v_mfma_f32_16x16x32_bf16 v[40:43], a[112:115], v[104:107], v[40:43]
    s_lshr_b32 s36, s2, 3
    s_waitcnt lgkmcnt(4)
    v_mfma_f32_16x16x32_bf16 v[48:51], a[112:115], v[112:115], v[48:51]
    s_lshr_b32 s37, s35, 1
    buffer_load_dwordx4 a[168:171], v129, s[44:47], s25 offen offset:0 sc1
    ds_read_b128 v[104:107], v131 offset:34816
    ds_read_b128 v[108:111], v131 offset:35840
    v_mfma_f32_16x16x32_bf16 v[48:51], a[116:119], v[116:119], v[48:51]
    s_lshl_b32 s37, s37, 2
    v_mfma_f32_16x16x32_bf16 v[52:55], a[124:127], v[116:119], v[52:55]
    s_lshr_b32 s38, s36, 3
    v_mfma_f32_16x16x32_bf16 v[52:55], a[120:123], v[112:115], v[52:55]
    s_add_u32 s37, s37, s38
    s_waitcnt lgkmcnt(4)
    v_mfma_f32_16x16x32_bf16 v[60:63], a[120:123], v[120:123], v[60:63]
    s_and_b32 s38, s35, 1
    ds_read_b128 v[112:115], v131 offset:36864
    ds_read_b128 v[116:119], v131 offset:37888
    v_mfma_f32_16x16x32_bf16 v[60:63], a[124:127], v[124:127], v[60:63]
    s_lshl_b32 s38, s38, 3
    buffer_load_dwordx4 a[172:175], v129, s[44:47], s25 offen offset:1024 sc1
    v_mfma_f32_16x16x32_bf16 v[56:59], a[116:119], v[124:127], v[56:59]
    s_and_b32 s39, s36, 7
    v_mfma_f32_16x16x32_bf16 v[56:59], a[112:115], v[120:123], v[56:59]
    s_add_u32 s38, s38, s39
    ds_read_b128 v[120:123], v131 offset:38912
    ds_read_b128 v[124:127], v131 offset:39936
    s_waitcnt vmcnt(13) lgkmcnt(6)
    v_mfma_f32_16x16x32_bf16 v[0:3], a[128:131], v[96:99], v[0:3]
    s_lshl_b32 s42, s37, 3
    v_mfma_f32_16x16x32_bf16 v[0:3], a[132:135], v[100:103], v[0:3]
    s_lshl_b32 s43, s34, 1
    v_mfma_f32_16x16x32_bf16 v[4:7], a[140:143], v[100:103], v[4:7]
    s_add_u32 s42, s42, s43
    buffer_load_dwordx4 v130, s[44:47], s24 offen offset:1024 sc1 lds
    v_mfma_f32_16x16x32_bf16 v[4:7], a[136:139], v[96:99], v[4:7]
    s_lshl_b32 s20, s38, 17
    s_waitcnt lgkmcnt(4)
    v_mfma_f32_16x16x32_bf16 v[12:15], a[136:139], v[104:107], v[12:15]
    s_add_u32 s20, s20, 29360128
    ds_read_b128 v[96:99], v131 offset:40960
    ds_read_b128 v[100:103], v131 offset:41984
    v_mfma_f32_16x16x32_bf16 v[12:15], a[140:143], v[108:111], v[12:15]
    s_lshl_b32 s21, s34, 11
    v_mfma_f32_16x16x32_bf16 v[8:11], a[132:135], v[108:111], v[8:11]
    v_add_u32 v187, s21, v128
    v_mfma_f32_16x16x32_bf16 v[8:11], a[128:131], v[104:107], v[8:11]
    s_lshl_b32 s22, s37, 7
    buffer_load_dwordx4 v130, s[44:47], s24 offen offset:2048 sc1 lds
    s_waitcnt lgkmcnt(4)
    v_mfma_f32_16x16x32_bf16 v[16:19], a[128:131], v[112:115], v[16:19]
    s_add_u32 s22, s22, 54351872
    ds_read_b128 v[104:107], v131 offset:43008
    ds_read_b128 v[108:111], v131 offset:44032
    v_mfma_f32_16x16x32_bf16 v[16:19], a[132:135], v[116:119], v[16:19]
    s_lshl_b32 s23, s42, 15
    v_mfma_f32_16x16x32_bf16 v[20:23], a[140:143], v[116:119], v[20:23]
    s_add_u32 s23, s23, 4194304
    v_mfma_f32_16x16x32_bf16 v[20:23], a[136:139], v[112:115], v[20:23]
    v_add_u32 v188, 65536, v128
    s_waitcnt lgkmcnt(4)
    v_mfma_f32_16x16x32_bf16 v[28:31], a[136:139], v[120:123], v[28:31]
    v_add_u32 v189, 131072, v128
    buffer_load_dwordx4 v130, s[44:47], s24 offen offset:3072 sc1 lds
    ds_read_b128 v[112:115], v131 offset:45056
    ds_read_b128 v[116:119], v131 offset:46080
    v_mfma_f32_16x16x32_bf16 v[28:31], a[140:143], v[124:127], v[28:31]
    v_mfma_f32_16x16x32_bf16 v[24:27], a[132:135], v[124:127], v[24:27]
    v_mfma_f32_16x16x32_bf16 v[24:27], a[128:131], v[120:123], v[24:27]
    ds_read_b128 v[120:123], v131 offset:47104
    s_waitcnt lgkmcnt(5)
    v_mfma_f32_16x16x32_bf16 v[32:35], a[128:131], v[96:99], v[32:35]
    s_add_u32 s25, s25, 2048
    buffer_load_dwordx4 a[176:179], v128, s[44:47], s25 offen offset:0 sc1
    ds_read_b128 v[124:127], v131 offset:48128
    v_mfma_f32_16x16x32_bf16 v[32:35], a[132:135], v[100:103], v[32:35]
    v_mfma_f32_16x16x32_bf16 v[36:39], a[140:143], v[100:103], v[36:39]
    s_barrier
    v_mfma_f32_16x16x32_bf16 v[36:39], a[136:139], v[96:99], v[36:39]
    ds_read_b128 v[96:99], v131 offset:49152
    s_waitcnt lgkmcnt(5)
    v_mfma_f32_16x16x32_bf16 v[44:47], a[136:139], v[104:107], v[44:47]
    buffer_load_dwordx4 a[180:183], v128, s[44:47], s25 offen offset:1024 sc1
    ds_read_b128 v[100:103], v131 offset:50176
    v_mfma_f32_16x16x32_bf16 v[44:47], a[140:143], v[108:111], v[44:47]
    v_mfma_f32_16x16x32_bf16 v[40:43], a[132:135], v[108:111], v[40:43]
    v_mfma_f32_16x16x32_bf16 v[40:43], a[128:131], v[104:107], v[40:43]
    ds_read_b128 v[104:107], v131 offset:51200
    s_waitcnt lgkmcnt(5)
    v_mfma_f32_16x16x32_bf16 v[48:51], a[128:131], v[112:115], v[48:51]
    buffer_load_dwordx4 a[184:187], v129, s[44:47], s25 offen offset:0 sc1
    ds_read_b128 v[108:111], v131 offset:52224
    v_mfma_f32_16x16x32_bf16 v[48:51], a[132:135], v[116:119], v[48:51]
    v_mfma_f32_16x16x32_bf16 v[52:55], a[140:143], v[116:119], v[52:55]
    v_mfma_f32_16x16x32_bf16 v[52:55], a[136:139], v[112:115], v[52:55]
    ds_read_b128 v[112:115], v131 offset:53248
    s_waitcnt lgkmcnt(5)
    v_mfma_f32_16x16x32_bf16 v[60:63], a[136:139], v[120:123], v[60:63]
    buffer_load_dwordx4 a[188:191], v129, s[44:47], s25 offen offset:1024 sc1
    ds_read_b128 v[116:119], v131 offset:54272
    v_mfma_f32_16x16x32_bf16 v[60:63], a[140:143], v[124:127], v[60:63]
    v_mfma_f32_16x16x32_bf16 v[56:59], a[132:135], v[124:127], v[56:59]
    v_mfma_f32_16x16x32_bf16 v[56:59], a[128:131], v[120:123], v[56:59]
    s_add_u32 m0, s26, 0
    s_add_u32 s24, s24, 16384
    buffer_load_dwordx4 v130, s[44:47], s24 offen offset:0 sc1 lds
    ds_read_b128 v[120:123], v131 offset:55296
    ds_read_b128 v[124:127], v131 offset:56320
    s_waitcnt vmcnt(14) lgkmcnt(6)
    v_mfma_f32_16x16x32_bf16 v[0:3], a[144:147], v[96:99], v[0:3]
    v_mfma_f32_16x16x32_bf16 v[0:3], a[148:151], v[100:103], v[0:3]
    v_mfma_f32_16x16x32_bf16 v[4:7], a[156:159], v[100:103], v[4:7]
    buffer_load_dwordx4 v130, s[44:47], s24 offen offset:1024 sc1 lds
    v_mfma_f32_16x16x32_bf16 v[4:7], a[152:155], v[96:99], v[4:7]
    ds_read_b128 v[96:99], v131 offset:57344
    s_waitcnt lgkmcnt(5)
    v_mfma_f32_16x16x32_bf16 v[12:15], a[152:155], v[104:107], v[12:15]
    ds_read_b128 v[100:103], v131 offset:58368
    v_mfma_f32_16x16x32_bf16 v[12:15], a[156:159], v[108:111], v[12:15]
    buffer_load_dwordx4 v130, s[44:47], s24 offen offset:2048 sc1 lds
    v_mfma_f32_16x16x32_bf16 v[8:11], a[148:151], v[108:111], v[8:11]
    v_mfma_f32_16x16x32_bf16 v[8:11], a[144:147], v[104:107], v[8:11]
    ds_read_b128 v[104:107], v131 offset:59392
    s_waitcnt lgkmcnt(5)
    v_mfma_f32_16x16x32_bf16 v[16:19], a[144:147], v[112:115], v[16:19]
    buffer_load_dwordx4 v130, s[44:47], s24 offen offset:3072 sc1 lds
    ds_read_b128 v[108:111], v131 offset:60416
    v_mfma_f32_16x16x32_bf16 v[16:19], a[148:151], v[116:119], v[16:19]
    v_mfma_f32_16x16x32_bf16 v[20:23], a[156:159], v[116:119], v[20:23]
    v_mfma_f32_16x16x32_bf16 v[20:23], a[152:155], v[112:115], v[20:23]
    ds_read_b128 v[112:115], v131 offset:61440
    s_waitcnt lgkmcnt(5)
    v_mfma_f32_16x16x32_bf16 v[28:31], a[152:155], v[120:123], v[28:31]
    s_add_u32 s25, s25, 2048
    buffer_load_dwordx4 a[192:195], v128, s[44:47], s25 offen offset:0 sc1
    ds_read_b128 v[116:119], v131 offset:62464
    v_mfma_f32_16x16x32_bf16 v[28:31], a[156:159], v[124:127], v[28:31]
    v_mfma_f32_16x16x32_bf16 v[24:27], a[148:151], v[124:127], v[24:27]
    v_mfma_f32_16x16x32_bf16 v[24:27], a[144:147], v[120:123], v[24:27]
    ds_read_b128 v[120:123], v131 offset:63488
    s_waitcnt lgkmcnt(5)
    v_mfma_f32_16x16x32_bf16 v[32:35], a[144:147], v[96:99], v[32:35]
    buffer_load_dwordx4 a[196:199], v128, s[44:47], s25 offen offset:1024 sc1
    ds_read_b128 v[124:127], v131 offset:64512
    v_mfma_f32_16x16x32_bf16 v[32:35], a[148:151], v[100:103], v[32:35]
    v_mfma_f32_16x16x32_bf16 v[36:39], a[156:159], v[100:103], v[36:39]
    s_waitcnt vmcnt(18)
    s_barrier
    v_mfma_f32_16x16x32_bf16 v[36:39], a[152:155], v[96:99], v[36:39]
    ds_read_b128 v[96:99], v132 offset:0
    s_waitcnt lgkmcnt(5)
    v_mfma_f32_16x16x32_bf16 v[44:47], a[152:155], v[104:107], v[44:47]
    buffer_load_dwordx4 a[200:203], v129, s[44:47], s25 offen offset:0 sc1
    ds_read_b128 v[100:103], v132 offset:1024
    v_mfma_f32_16x16x32_bf16 v[44:47], a[156:159], v[108:111], v[44:47]
    v_mfma_f32_16x16x32_bf16 v[40:43], a[148:151], v[108:111], v[40:43]
    v_mfma_f32_16x16x32_bf16 v[40:43], a[144:147], v[104:107], v[40:43]
    ds_read_b128 v[104:107], v132 offset:2048
    s_waitcnt lgkmcnt(5)
    v_mfma_f32_16x16x32_bf16 v[48:51], a[144:147], v[112:115], v[48:51]
    s_add_u32 m0, s26, 16384
    s_add_u32 s24, s24, 16384
    buffer_load_dwordx4 v130, s[44:47], s24 offen offset:0 sc1 lds
    ds_read_b128 v[108:111], v132 offset:3072
    v_mfma_f32_16x16x32_bf16 v[48:51], a[148:151], v[116:119], v[48:51]
    v_mfma_f32_16x16x32_bf16 v[52:55], a[156:159], v[116:119], v[52:55]
    v_mfma_f32_16x16x32_bf16 v[52:55], a[152:155], v[112:115], v[52:55]
    ds_read_b128 v[112:115], v132 offset:4096
    s_waitcnt lgkmcnt(5)
    v_mfma_f32_16x16x32_bf16 v[60:63], a[152:155], v[120:123], v[60:63]
    buffer_load_dwordx4 a[204:207], v129, s[44:47], s25 offen offset:1024 sc1
    ds_read_b128 v[116:119], v132 offset:5120
    v_mfma_f32_16x16x32_bf16 v[60:63], a[156:159], v[124:127], v[60:63]
    v_mfma_f32_16x16x32_bf16 v[56:59], a[148:151], v[124:127], v[56:59]
    v_mfma_f32_16x16x32_bf16 v[56:59], a[144:147], v[120:123], v[56:59]
    buffer_load_dwordx4 v130, s[44:47], s24 offen offset:1024 sc1 lds
    ds_read_b128 v[120:123], v132 offset:6144
    ds_read_b128 v[124:127], v132 offset:7168
    s_waitcnt vmcnt(17) lgkmcnt(6)
    v_mfma_f32_16x16x32_bf16 v[0:3], a[160:163], v[96:99], v[0:3]
    v_mfma_f32_16x16x32_bf16 v[0:3], a[164:167], v[100:103], v[0:3]
    v_mfma_f32_16x16x32_bf16 v[4:7], a[172:175], v[100:103], v[4:7]
    buffer_load_dwordx4 v130, s[44:47], s24 offen offset:2048 sc1 lds
    v_mfma_f32_16x16x32_bf16 v[4:7], a[168:171], v[96:99], v[4:7]
    ds_read_b128 v[96:99], v132 offset:8192
    s_waitcnt lgkmcnt(5)
    v_mfma_f32_16x16x32_bf16 v[12:15], a[168:171], v[104:107], v[12:15]
    ds_read_b128 v[100:103], v132 offset:9216
    v_mfma_f32_16x16x32_bf16 v[12:15], a[172:175], v[108:111], v[12:15]
    buffer_load_dwordx4 v130, s[44:47], s24 offen offset:3072 sc1 lds
    v_mfma_f32_16x16x32_bf16 v[8:11], a[164:167], v[108:111], v[8:11]
    v_mfma_f32_16x16x32_bf16 v[8:11], a[160:163], v[104:107], v[8:11]
    ds_read_b128 v[104:107], v132 offset:10240
    s_waitcnt lgkmcnt(5)
    v_mfma_f32_16x16x32_bf16 v[16:19], a[160:163], v[112:115], v[16:19]
    s_add_u32 s25, s25, 2048
    buffer_load_dwordx4 a[208:211], v128, s[44:47], s25 offen offset:0 sc1
    ds_read_b128 v[108:111], v132 offset:11264
    v_mfma_f32_16x16x32_bf16 v[16:19], a[164:167], v[116:119], v[16:19]
    v_mfma_f32_16x16x32_bf16 v[20:23], a[172:175], v[116:119], v[20:23]
    v_mfma_f32_16x16x32_bf16 v[20:23], a[168:171], v[112:115], v[20:23]
    ds_read_b128 v[112:115], v132 offset:12288
    s_waitcnt lgkmcnt(5)
    v_mfma_f32_16x16x32_bf16 v[28:31], a[168:171], v[120:123], v[28:31]
    buffer_load_dwordx4 a[212:215], v128, s[44:47], s25 offen offset:1024 sc1
    ds_read_b128 v[116:119], v132 offset:13312
    v_mfma_f32_16x16x32_bf16 v[28:31], a[172:175], v[124:127], v[28:31]
    v_mfma_f32_16x16x32_bf16 v[24:27], a[164:167], v[124:127], v[24:27]
    v_mfma_f32_16x16x32_bf16 v[24:27], a[160:163], v[120:123], v[24:27]
    ds_read_b128 v[120:123], v132 offset:14336
    s_waitcnt lgkmcnt(5)
    v_mfma_f32_16x16x32_bf16 v[32:35], a[160:163], v[96:99], v[32:35]
    s_add_u32 m0, s26, 32768
    s_add_u32 s24, s24, 16384
    buffer_load_dwordx4 v130, s[44:47], s24 offen offset:0 sc1 lds
    ds_read_b128 v[124:127], v132 offset:15360
    v_mfma_f32_16x16x32_bf16 v[32:35], a[164:167], v[100:103], v[32:35]
    v_mfma_f32_16x16x32_bf16 v[36:39], a[172:175], v[100:103], v[36:39]
    s_waitcnt vmcnt(19)
    s_barrier
    v_mfma_f32_16x16x32_bf16 v[36:39], a[168:171], v[96:99], v[36:39]
    ds_read_b128 v[96:99], v132 offset:16384
    s_waitcnt lgkmcnt(5)
    v_mfma_f32_16x16x32_bf16 v[44:47], a[168:171], v[104:107], v[44:47]
    buffer_load_dwordx4 a[216:219], v129, s[44:47], s25 offen offset:0 sc1
    ds_read_b128 v[100:103], v132 offset:17408
    v_mfma_f32_16x16x32_bf16 v[44:47], a[172:175], v[108:111], v[44:47]
    v_mfma_f32_16x16x32_bf16 v[40:43], a[164:167], v[108:111], v[40:43]
    v_mfma_f32_16x16x32_bf16 v[40:43], a[160:163], v[104:107], v[40:43]
    ds_read_b128 v[104:107], v132 offset:18432
    s_waitcnt lgkmcnt(5)
    v_mfma_f32_16x16x32_bf16 v[48:51], a[160:163], v[112:115], v[48:51]
    buffer_load_dwordx4 v130, s[44:47], s24 offen offset:1024 sc1 lds
    ds_read_b128 v[108:111], v132 offset:19456
    v_mfma_f32_16x16x32_bf16 v[48:51], a[164:167], v[116:119], v[48:51]
    v_mfma_f32_16x16x32_bf16 v[52:55], a[172:175], v[116:119], v[52:55]
    v_mfma_f32_16x16x32_bf16 v[52:55], a[168:171], v[112:115], v[52:55]
    ds_read_b128 v[112:115], v132 offset:20480
    s_waitcnt lgkmcnt(5)
    v_mfma_f32_16x16x32_bf16 v[60:63], a[168:171], v[120:123], v[60:63]
    buffer_load_dwordx4 a[220:223], v129, s[44:47], s25 offen offset:1024 sc1
    ds_read_b128 v[116:119], v132 offset:21504
    v_mfma_f32_16x16x32_bf16 v[60:63], a[172:175], v[124:127], v[60:63]
    v_mfma_f32_16x16x32_bf16 v[56:59], a[164:167], v[124:127], v[56:59]
    v_mfma_f32_16x16x32_bf16 v[56:59], a[160:163], v[120:123], v[56:59]
    buffer_load_dwordx4 v130, s[44:47], s24 offen offset:2048 sc1 lds
    ds_read_b128 v[120:123], v132 offset:22528
    ds_read_b128 v[124:127], v132 offset:23552
    s_waitcnt vmcnt(19) lgkmcnt(6)
    v_mfma_f32_16x16x32_bf16 v[0:3], a[176:179], v[96:99], v[0:3]
    v_mfma_f32_16x16x32_bf16 v[0:3], a[180:183], v[100:103], v[0:3]
    s_cmp_eq_u32 s34, 0
    s_cselect_b32 s62, s58, 0x7ff00000
    s_cselect_b32 s63, s59, 0x7ff00000
    s_cselect_b32 s19, s18, 0x7ff00000
    v_mfma_f32_16x16x32_bf16 v[4:7], a[188:191], v[100:103], v[4:7]
    buffer_load_dwordx4 v130, s[44:47], s24 offen offset:3072 sc1 lds
    v_mfma_f32_16x16x32_bf16 v[4:7], a[184:187], v[96:99], v[4:7]
    ds_read_b128 v[96:99], v132 offset:24576
    s_waitcnt lgkmcnt(5)
    v_mfma_f32_16x16x32_bf16 v[12:15], a[184:187], v[104:107], v[12:15]
    ds_read_b128 v[100:103], v132 offset:25600
    v_mfma_f32_16x16x32_bf16 v[12:15], a[188:191], v[108:111], v[12:15]
    s_add_u32 s25, s25, 2048
    buffer_load_dwordx4 a[224:227], v128, s[44:47], s25 offen offset:0 sc1
    v_mfma_f32_16x16x32_bf16 v[8:11], a[180:183], v[108:111], v[8:11]
    v_mfma_f32_16x16x32_bf16 v[8:11], a[176:179], v[104:107], v[8:11]
    ds_read_b128 v[104:107], v132 offset:26624
    s_waitcnt lgkmcnt(5)
    v_mfma_f32_16x16x32_bf16 v[16:19], a[176:179], v[112:115], v[16:19]
    s_add_u32 m0, s26, 49152
    s_add_u32 s24, s24, 16384
    buffer_load_dwordx4 v130, s[44:47], s24 offen offset:0 sc1 lds
    ds_read_b128 v[108:111], v132 offset:27648
    v_mfma_f32_16x16x32_bf16 v[16:19], a[180:183], v[116:119], v[16:19]
    v_mfma_f32_16x16x32_bf16 v[20:23], a[188:191], v[116:119], v[20:23]
    v_mfma_f32_16x16x32_bf16 v[20:23], a[184:187], v[112:115], v[20:23]
    ds_read_b128 v[112:115], v132 offset:28672
    s_waitcnt lgkmcnt(5)
    v_mfma_f32_16x16x32_bf16 v[28:31], a[184:187], v[120:123], v[28:31]
    buffer_load_dwordx4 a[228:231], v128, s[44:47], s25 offen offset:1024 sc1
    ds_read_b128 v[116:119], v132 offset:29696
    v_mfma_f32_16x16x32_bf16 v[28:31], a[188:191], v[124:127], v[28:31]
    v_mfma_f32_16x16x32_bf16 v[24:27], a[180:183], v[124:127], v[24:27]
    v_mfma_f32_16x16x32_bf16 v[24:27], a[176:179], v[120:123], v[24:27]
    ds_read_b128 v[120:123], v132 offset:30720
    s_waitcnt lgkmcnt(5)
    v_mfma_f32_16x16x32_bf16 v[32:35], a[176:179], v[96:99], v[32:35]
    buffer_load_dwordx4 v130, s[44:47], s24 offen offset:1024 sc1 lds
    ds_read_b128 v[124:127], v132 offset:31744
    v_mfma_f32_16x16x32_bf16 v[32:35], a[180:183], v[100:103], v[32:35]
    v_mfma_f32_16x16x32_bf16 v[36:39], a[188:191], v[100:103], v[36:39]
    s_waitcnt vmcnt(20)
    s_barrier
    v_mfma_f32_16x16x32_bf16 v[36:39], a[184:187], v[96:99], v[36:39]
    ds_read_b128 v[96:99], v131 offset:0
    s_waitcnt lgkmcnt(5)
    v_mfma_f32_16x16x32_bf16 v[44:47], a[184:187], v[104:107], v[44:47]
    buffer_load_dwordx4 a[232:235], v129, s[44:47], s25 offen offset:0 sc1
    ds_read_b128 v[100:103], v131 offset:1024
    v_mfma_f32_16x16x32_bf16 v[44:47], a[188:191], v[108:111], v[44:47]
    v_mfma_f32_16x16x32_bf16 v[40:43], a[180:183], v[108:111], v[40:43]
    v_mfma_f32_16x16x32_bf16 v[40:43], a[176:179], v[104:107], v[40:43]
    ds_read_b128 v[104:107], v131 offset:2048
    s_waitcnt lgkmcnt(5)
    v_mfma_f32_16x16x32_bf16 v[48:51], a[176:179], v[112:115], v[48:51]
    buffer_load_dwordx4 v130, s[44:47], s24 offen offset:2048 sc1 lds
    ds_read_b128 v[108:111], v131 offset:3072
    v_mfma_f32_16x16x32_bf16 v[48:51], a[180:183], v[116:119], v[48:51]
    v_mfma_f32_16x16x32_bf16 v[52:55], a[188:191], v[116:119], v[52:55]
    v_mfma_f32_16x16x32_bf16 v[52:55], a[184:187], v[112:115], v[52:55]
    ds_read_b128 v[112:115], v131 offset:4096
    s_waitcnt lgkmcnt(5)
    v_mfma_f32_16x16x32_bf16 v[60:63], a[184:187], v[120:123], v[60:63]
    buffer_load_dwordx4 a[236:239], v129, s[44:47], s25 offen offset:1024 sc1
    ds_read_b128 v[116:119], v131 offset:5120
    v_mfma_f32_16x16x32_bf16 v[60:63], a[188:191], v[124:127], v[60:63]
    v_mfma_f32_16x16x32_bf16 v[56:59], a[180:183], v[124:127], v[56:59]
    v_mfma_f32_16x16x32_bf16 v[56:59], a[176:179], v[120:123], v[56:59]
    buffer_load_dwordx4 v130, s[44:47], s24 offen offset:3072 sc1 lds
    ds_read_b128 v[120:123], v131 offset:6144
    ds_read_b128 v[124:127], v131 offset:7168
    s_waitcnt vmcnt(19) lgkmcnt(6)
    v_mfma_f32_16x16x32_bf16 v[0:3], a[192:195], v[96:99], v[0:3]
    s_add_u32 m0, s26, 65536
    s_add_u32 s24, s24, 16384
    buffer_load_dwordx4 v130, s[44:47], s24 offen offset:0 sc1 lds
    v_mfma_f32_16x16x32_bf16 v[0:3], a[196:199], v[100:103], v[0:3]
    s_add_u32 m0, s26, 65536
    s_nop 0
    buffer_load_dwordx4 v130, s[44:47], s24 offen offset:1024 sc1 lds
    v_mfma_f32_16x16x32_bf16 v[4:7], a[204:207], v[100:103], v[4:7]
    s_add_u32 m0, s26, 65536
    s_nop 0
    buffer_load_dwordx4 v130, s[44:47], s24 offen offset:2048 sc1 lds
    v_mfma_f32_16x16x32_bf16 v[4:7], a[200:203], v[96:99], v[4:7]
    ds_read_b128 v[96:99], v131 offset:8192
    s_waitcnt lgkmcnt(5)
    v_mfma_f32_16x16x32_bf16 v[12:15], a[200:203], v[104:107], v[12:15]
    s_add_u32 s25, s25, 2048
    buffer_load_dwordx4 a[240:243], v128, s[44:47], s25 offen offset:0 sc1
    ds_read_b128 v[100:103], v131 offset:9216
    v_mfma_f32_16x16x32_bf16 v[12:15], a[204:207], v[108:111], v[12:15]
    v_mfma_f32_16x16x32_bf16 v[8:11], a[196:199], v[108:111], v[8:11]
    v_mfma_f32_16x16x32_bf16 v[8:11], a[192:195], v[104:107], v[8:11]
    ds_read_b128 v[104:107], v131 offset:10240
    s_waitcnt lgkmcnt(5)
    v_mfma_f32_16x16x32_bf16 v[16:19], a[192:195], v[112:115], v[16:19]
    ds_read_b128 v[108:111], v131 offset:11264
    v_mfma_f32_16x16x32_bf16 v[16:19], a[196:199], v[116:119], v[16:19]
    s_add_u32 m0, s26, 65536
    s_nop 0
    buffer_load_dwordx4 v130, s[44:47], s24 offen offset:3072 sc1 lds
    v_mfma_f32_16x16x32_bf16 v[20:23], a[204:207], v[116:119], v[20:23]
    v_mfma_f32_16x16x32_bf16 v[20:23], a[200:203], v[112:115], v[20:23]
    ds_read_b128 v[112:115], v131 offset:12288
    s_waitcnt lgkmcnt(5)
    v_mfma_f32_16x16x32_bf16 v[28:31], a[200:203], v[120:123], v[28:31]
    buffer_load_dwordx4 a[244:247], v128, s[44:47], s25 offen offset:1024 sc1
    ds_read_b128 v[116:119], v131 offset:13312
    v_mfma_f32_16x16x32_bf16 v[28:31], a[204:207], v[124:127], v[28:31]
    v_mfma_f32_16x16x32_bf16 v[24:27], a[196:199], v[124:127], v[24:27]
    v_mfma_f32_16x16x32_bf16 v[24:27], a[192:195], v[120:123], v[24:27]
    ds_read_b128 v[120:123], v131 offset:14336
    s_waitcnt lgkmcnt(5)
    v_mfma_f32_16x16x32_bf16 v[32:35], a[192:195], v[96:99], v[32:35]
    ds_read_b128 v[124:127], v131 offset:15360
    v_mfma_f32_16x16x32_bf16 v[32:35], a[196:199], v[100:103], v[32:35]
    v_mfma_f32_16x16x32_bf16 v[36:39], a[204:207], v[100:103], v[36:39]
    s_waitcnt vmcnt(22)
    s_barrier
    v_mfma_f32_16x16x32_bf16 v[36:39], a[200:203], v[96:99], v[36:39]
    ds_read_b128 v[96:99], v131 offset:16384
    s_waitcnt lgkmcnt(5)
    v_mfma_f32_16x16x32_bf16 v[44:47], a[200:203], v[104:107], v[44:47]
    buffer_load_dwordx4 a[248:251], v129, s[44:47], s25 offen offset:0 sc1
    ds_read_b128 v[100:103], v131 offset:17408
    v_mfma_f32_16x16x32_bf16 v[44:47], a[204:207], v[108:111], v[44:47]
    s_add_u32 m0, s26, 81920
    s_add_u32 s24, s24, 16384
    buffer_load_dwordx4 v130, s[44:47], s24 offen offset:0 sc1 lds
    v_mfma_f32_16x16x32_bf16 v[40:43], a[196:199], v[108:111], v[40:43]
    v_mfma_f32_16x16x32_bf16 v[40:43], a[192:195], v[104:107], v[40:43]
    ds_read_b128 v[104:107], v131 offset:18432
    s_waitcnt lgkmcnt(5)
    v_mfma_f32_16x16x32_bf16 v[48:51], a[192:195], v[112:115], v[48:51]
    ds_read_b128 v[108:111], v131 offset:19456
    v_mfma_f32_16x16x32_bf16 v[48:51], a[196:199], v[116:119], v[48:51]
    v_mfma_f32_16x16x32_bf16 v[52:55], a[204:207], v[116:119], v[52:55]
    v_mfma_f32_16x16x32_bf16 v[52:55], a[200:203], v[112:115], v[52:55]
    ds_read_b128 v[112:115], v131 offset:20480
    s_waitcnt lgkmcnt(5)
    v_mfma_f32_16x16x32_bf16 v[60:63], a[200:203], v[120:123], v[60:63]
    buffer_load_dwordx4 a[252:255], v129, s[44:47], s25 offen offset:1024 sc1
    ds_read_b128 v[116:119], v131 offset:21504
    v_mfma_f32_16x16x32_bf16 v[60:63], a[204:207], v[124:127], v[60:63]
    s_add_u32 m0, s26, 81920
    s_nop 0
    buffer_load_dwordx4 v130, s[44:47], s24 offen offset:1024 sc1 lds
    v_mfma_f32_16x16x32_bf16 v[56:59], a[196:199], v[124:127], v[56:59]
    v_mfma_f32_16x16x32_bf16 v[56:59], a[192:195], v[120:123], v[56:59]
    ds_read_b128 v[120:123], v131 offset:22528
    ds_read_b128 v[124:127], v131 offset:23552
    s_waitcnt vmcnt(20) lgkmcnt(6)
    v_mfma_f32_16x16x32_bf16 v[0:3], a[208:211], v[96:99], v[0:3]
    v_mfma_f32_16x16x32_bf16 v[0:3], a[212:215], v[100:103], v[0:3]
    v_mfma_f32_16x16x32_bf16 v[4:7], a[220:223], v[100:103], v[4:7]
    s_add_u32 m0, s26, 81920
    s_nop 0
    buffer_load_dwordx4 v130, s[44:47], s24 offen offset:2048 sc1 lds
    v_mfma_f32_16x16x32_bf16 v[4:7], a[216:219], v[96:99], v[4:7]
    ds_read_b128 v[96:99], v131 offset:24576
    s_waitcnt lgkmcnt(5)
    v_mfma_f32_16x16x32_bf16 v[12:15], a[216:219], v[104:107], v[12:15]
    ds_read_b128 v[100:103], v131 offset:25600
    v_mfma_f32_16x16x32_bf16 v[12:15], a[220:223], v[108:111], v[12:15]
    v_mfma_f32_16x16x32_bf16 v[8:11], a[212:215], v[108:111], v[8:11]
    v_mfma_f32_16x16x32_bf16 v[8:11], a[208:211], v[104:107], v[8:11]
    ds_read_b128 v[104:107], v131 offset:26624
    s_waitcnt lgkmcnt(5)
    v_mfma_f32_16x16x32_bf16 v[16:19], a[208:211], v[112:115], v[16:19]
    ds_read_b128 v[108:111], v131 offset:27648
    v_mfma_f32_16x16x32_bf16 v[16:19], a[212:215], v[116:119], v[16:19]
    s_add_u32 m0, s26, 81920
    s_nop 0
    buffer_load_dwordx4 v130, s[44:47], s24 offen offset:3072 sc1 lds
    v_mfma_f32_16x16x32_bf16 v[20:23], a[220:223], v[116:119], v[20:23]
    v_mfma_f32_16x16x32_bf16 v[20:23], a[216:219], v[112:115], v[20:23]
    ds_read_b128 v[112:115], v131 offset:28672
    s_waitcnt lgkmcnt(5)
    v_mfma_f32_16x16x32_bf16 v[28:31], a[216:219], v[120:123], v[28:31]
    ds_read_b128 v[116:119], v131 offset:29696
    v_mfma_f32_16x16x32_bf16 v[28:31], a[220:223], v[124:127], v[28:31]
    v_mfma_f32_16x16x32_bf16 v[24:27], a[212:215], v[124:127], v[24:27]
    v_mfma_f32_16x16x32_bf16 v[24:27], a[208:211], v[120:123], v[24:27]
    ds_read_b128 v[120:123], v131 offset:30720
    s_waitcnt lgkmcnt(5)
    v_mfma_f32_16x16x32_bf16 v[32:35], a[208:211], v[96:99], v[32:35]
    ds_read_b128 v[124:127], v131 offset:31744
    v_mfma_f32_16x16x32_bf16 v[32:35], a[212:215], v[100:103], v[32:35]
    v_mfma_f32_16x16x32_bf16 v[36:39], a[220:223], v[100:103], v[36:39]
    s_waitcnt vmcnt(20)
    s_barrier
    v_mfma_f32_16x16x32_bf16 v[36:39], a[216:219], v[96:99], v[36:39]
    ds_read_b128 v[96:99], v131 offset:32768
    s_waitcnt lgkmcnt(5)
    v_mfma_f32_16x16x32_bf16 v[44:47], a[216:219], v[104:107], v[44:47]
    s_add_u32 m0, s26, 0
    s_add_u32 s24, s24, 16384
    buffer_load_dwordx4 v130, s[44:47], s24 offen offset:0 sc1 lds
    ds_read_b128 v[100:103], v131 offset:33792
    v_mfma_f32_16x16x32_bf16 v[44:47], a[220:223], v[108:111], v[44:47]
    v_mfma_f32_16x16x32_bf16 v[40:43], a[212:215], v[108:111], v[40:43]
    v_mfma_f32_16x16x32_bf16 v[40:43], a[208:211], v[104:107], v[40:43]
    ds_read_b128 v[104:107], v131 offset:34816
    s_waitcnt lgkmcnt(5)
    v_mfma_f32_16x16x32_bf16 v[48:51], a[208:211], v[112:115], v[48:51]
    ds_read_b128 v[108:111], v131 offset:35840
    v_mfma_f32_16x16x32_bf16 v[48:51], a[212:215], v[116:119], v[48:51]
    v_mfma_f32_16x16x32_bf16 v[52:55], a[220:223], v[116:119], v[52:55]
    v_mfma_f32_16x16x32_bf16 v[52:55], a[216:219], v[112:115], v[52:55]
    ds_read_b128 v[112:115], v131 offset:36864
    s_waitcnt lgkmcnt(5)
    v_mfma_f32_16x16x32_bf16 v[60:63], a[216:219], v[120:123], v[60:63]
    s_add_u32 m0, s26, 0
    s_nop 0
    buffer_load_dwordx4 v130, s[44:47], s24 offen offset:1024 sc1 lds
    ds_read_b128 v[116:119], v131 offset:37888
    v_mfma_f32_16x16x32_bf16 v[60:63], a[220:223], v[124:127], v[60:63]
    v_mfma_f32_16x16x32_bf16 v[56:59], a[212:215], v[124:127], v[56:59]
    v_mfma_f32_16x16x32_bf16 v[56:59], a[208:211], v[120:123], v[56:59]
    ds_read_b128 v[120:123], v131 offset:38912
    ds_read_b128 v[124:127], v131 offset:39936
    s_waitcnt vmcnt(15) lgkmcnt(6)
    v_mfma_f32_16x16x32_bf16 v[0:3], a[224:227], v[96:99], v[0:3]
    v_mfma_f32_16x16x32_bf16 v[0:3], a[228:231], v[100:103], v[0:3]
    v_mfma_f32_16x16x32_bf16 v[4:7], a[236:239], v[100:103], v[4:7]
    s_add_u32 m0, s26, 0
    s_nop 0
    buffer_load_dwordx4 v130, s[44:47], s24 offen offset:2048 sc1 lds
    v_mfma_f32_16x16x32_bf16 v[4:7], a[232:235], v[96:99], v[4:7]
    ds_read_b128 v[96:99], v131 offset:40960
    s_waitcnt lgkmcnt(5)
    v_mfma_f32_16x16x32_bf16 v[12:15], a[232:235], v[104:107], v[12:15]
    ds_read_b128 v[100:103], v131 offset:41984
    v_mfma_f32_16x16x32_bf16 v[12:15], a[236:239], v[108:111], v[12:15]
    v_mfma_f32_16x16x32_bf16 v[8:11], a[228:231], v[108:111], v[8:11]
    v_mfma_f32_16x16x32_bf16 v[8:11], a[224:227], v[104:107], v[8:11]
    ds_read_b128 v[104:107], v131 offset:43008
    s_waitcnt lgkmcnt(5)
    v_mfma_f32_16x16x32_bf16 v[16:19], a[224:227], v[112:115], v[16:19]
    ds_read_b128 v[108:111], v131 offset:44032
    v_mfma_f32_16x16x32_bf16 v[16:19], a[228:231], v[116:119], v[16:19]
    s_add_u32 m0, s26, 0
    s_nop 0
    buffer_load_dwordx4 v130, s[44:47], s24 offen offset:3072 sc1 lds
    v_mfma_f32_16x16x32_bf16 v[20:23], a[236:239], v[116:119], v[20:23]
    v_mfma_f32_16x16x32_bf16 v[20:23], a[232:235], v[112:115], v[20:23]
    ds_read_b128 v[112:115], v131 offset:45056
    s_waitcnt lgkmcnt(5)
    v_mfma_f32_16x16x32_bf16 v[28:31], a[232:235], v[120:123], v[28:31]
    ds_read_b128 v[116:119], v131 offset:46080
    v_mfma_f32_16x16x32_bf16 v[28:31], a[236:239], v[124:127], v[28:31]
    v_mfma_f32_16x16x32_bf16 v[24:27], a[228:231], v[124:127], v[24:27]
    v_mfma_f32_16x16x32_bf16 v[24:27], a[224:227], v[120:123], v[24:27]
    ds_read_b128 v[120:123], v131 offset:47104
    s_waitcnt lgkmcnt(5)
    v_mfma_f32_16x16x32_bf16 v[32:35], a[224:227], v[96:99], v[32:35]
    ds_read_b128 v[124:127], v131 offset:48128
    v_mfma_f32_16x16x32_bf16 v[32:35], a[228:231], v[100:103], v[32:35]
    v_mfma_f32_16x16x32_bf16 v[36:39], a[236:239], v[100:103], v[36:39]
    s_waitcnt vmcnt(16)
    s_barrier
    v_mfma_f32_16x16x32_bf16 v[36:39], a[232:235], v[96:99], v[36:39]
    ds_read_b128 v[96:99], v131 offset:49152
    s_waitcnt lgkmcnt(5)
    v_mfma_f32_16x16x32_bf16 v[44:47], a[232:235], v[104:107], v[44:47]
    s_add_u32 m0, s26, 16384
    s_add_u32 s24, s24, 16384
    buffer_load_dwordx4 v130, s[44:47], s24 offen offset:0 sc1 lds
    ds_read_b128 v[100:103], v131 offset:50176
    v_mfma_f32_16x16x32_bf16 v[44:47], a[236:239], v[108:111], v[44:47]
    v_mfma_f32_16x16x32_bf16 v[40:43], a[228:231], v[108:111], v[40:43]
    v_mfma_f32_16x16x32_bf16 v[40:43], a[224:227], v[104:107], v[40:43]
    ds_read_b128 v[104:107], v131 offset:51200
    s_waitcnt lgkmcnt(5)
    v_mfma_f32_16x16x32_bf16 v[48:51], a[224:227], v[112:115], v[48:51]
    ds_read_b128 v[108:111], v131 offset:52224
    v_mfma_f32_16x16x32_bf16 v[48:51], a[228:231], v[116:119], v[48:51]
    v_mfma_f32_16x16x32_bf16 v[52:55], a[236:239], v[116:119], v[52:55]
    v_mfma_f32_16x16x32_bf16 v[52:55], a[232:235], v[112:115], v[52:55]
    ds_read_b128 v[112:115], v131 offset:53248
    s_waitcnt lgkmcnt(5)
    v_mfma_f32_16x16x32_bf16 v[60:63], a[232:235], v[120:123], v[60:63]
    s_add_u32 m0, s26, 16384
    s_nop 0
    buffer_load_dwordx4 v130, s[44:47], s24 offen offset:1024 sc1 lds
    ds_read_b128 v[116:119], v131 offset:54272
    v_mfma_f32_16x16x32_bf16 v[60:63], a[236:239], v[124:127], v[60:63]
    v_mfma_f32_16x16x32_bf16 v[56:59], a[228:231], v[124:127], v[56:59]
    v_mfma_f32_16x16x32_bf16 v[56:59], a[224:227], v[120:123], v[56:59]
    ds_read_b128 v[120:123], v131 offset:55296
    ds_read_b128 v[124:127], v131 offset:56320
    s_waitcnt vmcnt(9) lgkmcnt(6)
    v_mfma_f32_16x16x32_bf16 v[0:3], a[240:243], v[96:99], v[0:3]
    v_mfma_f32_16x16x32_bf16 v[0:3], a[244:247], v[100:103], v[0:3]
    v_mfma_f32_16x16x32_bf16 v[4:7], a[252:255], v[100:103], v[4:7]
    s_add_u32 m0, s26, 16384
    s_nop 0
    buffer_load_dwordx4 v130, s[44:47], s24 offen offset:2048 sc1 lds
    v_mfma_f32_16x16x32_bf16 v[4:7], a[248:251], v[96:99], v[4:7]
    ds_read_b128 v[96:99], v131 offset:57344
    s_waitcnt lgkmcnt(5)
    v_mfma_f32_16x16x32_bf16 v[12:15], a[248:251], v[104:107], v[12:15]
    ds_read_b128 v[100:103], v131 offset:58368
    v_mfma_f32_16x16x32_bf16 v[12:15], a[252:255], v[108:111], v[12:15]
    v_mfma_f32_16x16x32_bf16 v[8:11], a[244:247], v[108:111], v[8:11]
    v_mfma_f32_16x16x32_bf16 v[8:11], a[240:243], v[104:107], v[8:11]
    ds_read_b128 v[104:107], v131 offset:59392
    s_waitcnt lgkmcnt(5)
    v_mfma_f32_16x16x32_bf16 v[16:19], a[240:243], v[112:115], v[16:19]
    ds_read_b128 v[108:111], v131 offset:60416
    v_mfma_f32_16x16x32_bf16 v[16:19], a[244:247], v[116:119], v[16:19]
    s_add_u32 m0, s26, 16384
    s_nop 0
    buffer_load_dwordx4 v130, s[44:47], s24 offen offset:3072 sc1 lds
    v_mfma_f32_16x16x32_bf16 v[20:23], a[252:255], v[116:119], v[20:23]
    v_mfma_f32_16x16x32_bf16 v[20:23], a[248:251], v[112:115], v[20:23]
    ds_read_b128 v[112:115], v131 offset:61440
    s_waitcnt lgkmcnt(5)
    v_mfma_f32_16x16x32_bf16 v[28:31], a[248:251], v[120:123], v[28:31]
    ds_read_b128 v[116:119], v131 offset:62464
    v_mfma_f32_16x16x32_bf16 v[28:31], a[252:255], v[124:127], v[28:31]
    v_mfma_f32_16x16x32_bf16 v[24:27], a[244:247], v[124:127], v[24:27]
    v_mfma_f32_16x16x32_bf16 v[24:27], a[240:243], v[120:123], v[24:27]
    ds_read_b128 v[120:123], v131 offset:63488
    s_waitcnt lgkmcnt(5)
    v_mfma_f32_16x16x32_bf16 v[32:35], a[240:243], v[96:99], v[32:35]
    ds_read_b128 v[124:127], v131 offset:64512
    v_mfma_f32_16x16x32_bf16 v[32:35], a[244:247], v[100:103], v[32:35]
    v_mfma_f32_16x16x32_bf16 v[36:39], a[252:255], v[100:103], v[36:39]
    s_barrier
    v_mfma_f32_16x16x32_bf16 v[36:39], a[248:251], v[96:99], v[36:39]
    v_pk_mul_f32 v[238:239], v[0:1], v[158:159]
    v_pk_mul_f32 v[240:241], v[2:3], v[160:161]
    v_exp_f32_e64 v238, v238 clamp
    v_exp_f32_e64 v239, v239 clamp
    v_exp_f32_e64 v240, v240 clamp
    v_exp_f32_e64 v241, v241 clamp
    v_pk_fma_f32 v[0:1], v[0:1], v[162:163], v[140:141]
    v_pk_fma_f32 v[2:3], v[2:3], v[164:165], v[140:141]
    s_waitcnt lgkmcnt(4)
    v_mfma_f32_16x16x32_bf16 v[44:47], a[248:251], v[104:107], v[44:47]
    v_max_f32 v0, v0, v238
    v_max_f32 v1, v1, v239
    v_max_f32 v2, v2, v240
    v_max_f32 v3, v3, v241
    v_pk_add_f32 v[0:1], v[0:1], s[52:53]
    v_pk_add_f32 v[2:3], v[2:3], s[52:53]
    v_cvt_pk_bf16_f32 v0, v0, v1
    v_cvt_pk_bf16_f32 v1, v2, v3
    ds_read_b128 v[96:99], v132 offset:0
    ds_read_b128 v[100:103], v132 offset:1024
    v_mfma_f32_16x16x32_bf16 v[44:47], a[252:255], v[108:111], v[44:47]
    v_pk_mul_f32 v[242:243], v[4:5], v[166:167]
    v_pk_mul_f32 v[244:245], v[6:7], v[168:169]
    v_exp_f32_e64 v242, v242 clamp
    v_exp_f32_e64 v243, v243 clamp
    v_exp_f32_e64 v244, v244 clamp
    v_exp_f32_e64 v245, v245 clamp
    v_pk_fma_f32 v[4:5], v[4:5], v[170:171], v[140:141]
    v_pk_fma_f32 v[6:7], v[6:7], v[172:173], v[140:141]
    v_mfma_f32_16x16x32_bf16 v[40:43], a[244:247], v[108:111], v[40:43]
    v_max_f32 v4, v4, v242
    v_max_f32 v5, v5, v243
    v_max_f32 v6, v6, v244
    v_max_f32 v7, v7, v245
    v_pk_add_f32 v[4:5], v[4:5], s[52:53]
    v_pk_add_f32 v[6:7], v[6:7], s[52:53]
    v_cvt_pk_bf16_f32 v2, v4, v5
    v_cvt_pk_bf16_f32 v3, v6, v7
    s_add_u32 m0, s26, 32768
    s_add_u32 s24, s24, 16384
    buffer_load_dwordx4 v130, s[44:47], s24 offen offset:0 sc1 lds
    v_mfma_f32_16x16x32_bf16 v[40:43], a[240:243], v[104:107], v[40:43]
    v_pk_mul_f32 v[238:239], v[8:9], v[158:159]
    v_pk_mul_f32 v[240:241], v[10:11], v[160:161]
    v_exp_f32_e64 v238, v238 clamp
    v_exp_f32_e64 v239, v239 clamp
    v_exp_f32_e64 v240, v240 clamp
    v_exp_f32_e64 v241, v241 clamp
    v_pk_fma_f32 v[8:9], v[8:9], v[162:163], v[140:141]
    v_pk_fma_f32 v[10:11], v[10:11], v[164:165], v[140:141]
    s_waitcnt lgkmcnt(4)
    v_mfma_f32_16x16x32_bf16 v[48:51], a[240:243], v[112:115], v[48:51]
    v_max_f32 v8, v8, v238
    v_max_f32 v9, v9, v239
    v_max_f32 v10, v10, v240
    v_max_f32 v11, v11, v241
    v_pk_add_f32 v[8:9], v[8:9], s[52:53]
    v_pk_add_f32 v[10:11], v[10:11], s[52:53]
    v_cvt_pk_bf16_f32 v8, v8, v9
    v_cvt_pk_bf16_f32 v9, v10, v11
    ds_read_b128 v[104:107], v132 offset:2048
    ds_read_b128 v[108:111], v132 offset:3072
    v_mfma_f32_16x16x32_bf16 v[48:51], a[244:247], v[116:119], v[48:51]
    v_pk_mul_f32 v[242:243], v[12:13], v[166:167]
    v_pk_mul_f32 v[244:245], v[14:15], v[168:169]
    v_exp_f32_e64 v242, v242 clamp
    v_exp_f32_e64 v243, v243 clamp
    v_exp_f32_e64 v244, v244 clamp
    v_exp_f32_e64 v245, v245 clamp
    v_pk_fma_f32 v[12:13], v[12:13], v[170:171], v[140:141]
    v_pk_fma_f32 v[14:15], v[14:15], v[172:173], v[140:141]
    v_mfma_f32_16x16x32_bf16 v[52:55], a[252:255], v[116:119], v[52:55]
    v_max_f32 v12, v12, v242
    v_max_f32 v13, v13, v243
    v_max_f32 v14, v14, v244
    v_max_f32 v15, v15, v245
    v_pk_add_f32 v[12:13], v[12:13], s[52:53]
    v_pk_add_f32 v[14:15], v[14:15], s[52:53]
    v_cvt_pk_bf16_f32 v10, v12, v13
    v_cvt_pk_bf16_f32 v11, v14, v15
    v_mfma_f32_16x16x32_bf16 v[52:55], a[248:251], v[112:115], v[52:55]
    v_pk_mul_f32 v[238:239], v[16:17], v[158:159]
    v_pk_mul_f32 v[240:241], v[18:19], v[160:161]
    v_exp_f32_e64 v238, v238 clamp
    v_exp_f32_e64 v239, v239 clamp
    v_exp_f32_e64 v240, v240 clamp
    v_exp_f32_e64 v241, v241 clamp
    v_pk_fma_f32 v[16:17], v[16:17], v[162:163], v[140:141]
    v_pk_fma_f32 v[18:19], v[18:19], v[164:165], v[140:141]
    s_waitcnt lgkmcnt(4)
    v_mfma_f32_16x16x32_bf16 v[60:63], a[248:251], v[120:123], v[60:63]
    v_max_f32 v16, v16, v238
    v_max_f32 v17, v17, v239
    v_max_f32 v18, v18, v240
    v_max_f32 v19, v19, v241
    v_pk_add_f32 v[16:17], v[16:17], s[52:53]
    v_pk_add_f32 v[18:19], v[18:19], s[52:53]
    v_cvt_pk_bf16_f32 v16, v16, v17
    v_cvt_pk_bf16_f32 v17, v18, v19
    ds_read_b128 v[112:115], v132 offset:4096
    ds_read_b128 v[116:119], v132 offset:5120
    v_mfma_f32_16x16x32_bf16 v[60:63], a[252:255], v[124:127], v[60:63]
    v_pk_mul_f32 v[242:243], v[20:21], v[166:167]
    v_pk_mul_f32 v[244:245], v[22:23], v[168:169]
    v_exp_f32_e64 v242, v242 clamp
    v_exp_f32_e64 v243, v243 clamp
    v_exp_f32_e64 v244, v244 clamp
    v_exp_f32_e64 v245, v245 clamp
    v_pk_fma_f32 v[20:21], v[20:21], v[170:171], v[140:141]
    v_pk_fma_f32 v[22:23], v[22:23], v[172:173], v[140:141]
    s_add_u32 m0, s26, 32768
    s_nop 0
    buffer_load_dwordx4 v130, s[44:47], s24 offen offset:1024 sc1 lds
    v_mfma_f32_16x16x32_bf16 v[56:59], a[244:247], v[124:127], v[56:59]
    v_max_f32 v20, v20, v242
    v_max_f32 v21, v21, v243
    v_max_f32 v22, v22, v244
    v_max_f32 v23, v23, v245
    v_pk_add_f32 v[20:21], v[20:21], s[52:53]
    v_pk_add_f32 v[22:23], v[22:23], s[52:53]
    v_cvt_pk_bf16_f32 v18, v20, v21
    v_cvt_pk_bf16_f32 v19, v22, v23
    v_mfma_f32_16x16x32_bf16 v[56:59], a[240:243], v[120:123], v[56:59]
    v_pk_mul_f32 v[238:239], v[24:25], v[158:159]
    v_pk_mul_f32 v[240:241], v[26:27], v[160:161]
    v_exp_f32_e64 v238, v238 clamp
    v_exp_f32_e64 v239, v239 clamp
    v_exp_f32_e64 v240, v240 clamp
    v_exp_f32_e64 v241, v241 clamp
    v_pk_fma_f32 v[24:25], v[24:25], v[162:163], v[140:141]
    v_pk_fma_f32 v[26:27], v[26:27], v[164:165], v[140:141]
    ds_read_b128 v[120:123], v132 offset:6144
    ds_read_b128 v[124:127], v132 offset:7168
    s_waitcnt lgkmcnt(6)
    v_mfma_f32_16x16x32_bf16 v[64:67], v[96:99], a[0:3], v[64:67]
    v_max_f32 v24, v24, v238
    v_max_f32 v25, v25, v239
    v_max_f32 v26, v26, v240
    v_max_f32 v27, v27, v241
    v_pk_add_f32 v[24:25], v[24:25], s[52:53]
    v_pk_add_f32 v[26:27], v[26:27], s[52:53]
    v_cvt_pk_bf16_f32 v24, v24, v25
    v_cvt_pk_bf16_f32 v25, v26, v27
    v_mfma_f32_16x16x32_bf16 v[64:67], v[100:103], a[4:7], v[64:67]
    v_pk_mul_f32 v[242:243], v[28:29], v[166:167]
    v_pk_mul_f32 v[244:245], v[30:31], v[168:169]
    v_exp_f32_e64 v242, v242 clamp
    v_exp_f32_e64 v243, v243 clamp
    v_exp_f32_e64 v244, v244 clamp
    v_exp_f32_e64 v245, v245 clamp
    v_pk_fma_f32 v[28:29], v[28:29], v[170:171], v[140:141]
    v_pk_fma_f32 v[30:31], v[30:31], v[172:173], v[140:141]
    v_mfma_f32_16x16x32_bf16 v[68:71], v[100:103], a[12:15], v[68:71]
    v_max_f32 v28, v28, v242
    v_max_f32 v29, v29, v243
    v_max_f32 v30, v30, v244
    v_max_f32 v31, v31, v245
    v_pk_add_f32 v[28:29], v[28:29], s[52:53]
    v_pk_add_f32 v[30:31], v[30:31], s[52:53]
    v_cvt_pk_bf16_f32 v26, v28, v29
    v_cvt_pk_bf16_f32 v27, v30, v31
    v_mfma_f32_16x16x32_bf16 v[68:71], v[96:99], a[8:11], v[68:71]
    v_pk_mul_f32 v[32:33], v[32:33], v[162:163]
    v_pk_mul_f32 v[34:35], v[34:35], v[164:165]
    v_cvt_pk_bf16_f32 v32, v32, v33
    v_cvt_pk_bf16_f32 v33, v34, v35
    v_pk_mul_f32 v[36:37], v[36:37], v[170:171]
    v_pk_mul_f32 v[38:39], v[38:39], v[172:173]
    v_cvt_pk_bf16_f32 v34, v36, v37
    v_cvt_pk_bf16_f32 v35, v38, v39
    s_waitcnt lgkmcnt(4)
    v_mfma_f32_16x16x32_bf16 v[68:71], v[104:107], a[24:27], v[68:71]
    v_pk_mul_f32 v[40:41], v[40:41], v[162:163]
    v_pk_mul_f32 v[42:43], v[42:43], v[164:165]
    v_cvt_pk_bf16_f32 v40, v40, v41
    v_cvt_pk_bf16_f32 v41, v42, v43
    v_pk_mul_f32 v[44:45], v[44:45], v[170:171]
    v_pk_mul_f32 v[46:47], v[46:47], v[172:173]
    v_cvt_pk_bf16_f32 v42, v44, v45
    v_cvt_pk_bf16_f32 v43, v46, v47
    s_add_u32 m0, s26, 32768
    s_nop 0
    buffer_load_dwordx4 v130, s[44:47], s24 offen offset:2048 sc1 lds
    ds_read_b128 v[96:99], v132 offset:8192
    ds_read_b128 v[100:103], v132 offset:9216
    v_mfma_f32_16x16x32_bf16 v[68:71], v[108:111], a[28:31], v[68:71]
    v_pk_mul_f32 v[48:49], v[48:49], v[162:163]
    v_pk_mul_f32 v[50:51], v[50:51], v[164:165]
    v_cvt_pk_bf16_f32 v48, v48, v49
    v_cvt_pk_bf16_f32 v49, v50, v51
    v_pk_mul_f32 v[52:53], v[52:53], v[170:171]
    v_pk_mul_f32 v[54:55], v[54:55], v[172:173]
    v_cvt_pk_bf16_f32 v50, v52, v53
    v_cvt_pk_bf16_f32 v51, v54, v55
    v_mfma_f32_16x16x32_bf16 v[64:67], v[108:111], a[20:23], v[64:67]
    v_pk_mul_f32 v[56:57], v[56:57], v[162:163]
    v_pk_mul_f32 v[58:59], v[58:59], v[164:165]
    v_cvt_pk_bf16_f32 v56, v56, v57
    v_cvt_pk_bf16_f32 v57, v58, v59
    v_pk_mul_f32 v[60:61], v[60:61], v[170:171]
    v_pk_mul_f32 v[62:63], v[62:63], v[172:173]
    v_cvt_pk_bf16_f32 v58, v60, v61
    v_cvt_pk_bf16_f32 v59, v62, v63
    v_mfma_f32_16x16x32_bf16 v[64:67], v[104:107], a[16:19], v[64:67]
    ds_read_b128 v[104:107], v132 offset:10240
    s_waitcnt lgkmcnt(5)
    v_mfma_f32_16x16x32_bf16 v[64:67], v[112:115], a[32:35], v[64:67]
    v_mfma_f32_16x16x32_bf16 v[190:193], v[0:3], v[32:35], 0
    ds_read_b128 v[108:111], v132 offset:11264
    v_mfma_f32_16x16x32_bf16 v[64:67], v[116:119], a[36:39], v[64:67]
    v_mfma_f32_16x16x32_bf16 v[194:197], v[8:11], v[32:35], 0
    s_add_u32 m0, s26, 32768
    s_nop 0
    buffer_load_dwordx4 v130, s[44:47], s24 offen offset:3072 sc1 lds
    v_mfma_f32_16x16x32_bf16 v[68:71], v[116:119], a[44:47], v[68:71]
    v_mfma_f32_16x16x32_bf16 v[198:201], v[0:3], v[40:43], 0
    v_mfma_f32_16x16x32_bf16 v[68:71], v[112:115], a[40:43], v[68:71]
    v_mfma_f32_16x16x32_bf16 v[202:205], v[8:11], v[40:43], 0
    ds_read_b128 v[112:115], v132 offset:12288
    s_waitcnt lgkmcnt(5)
    v_mfma_f32_16x16x32_bf16 v[68:71], v[120:123], a[56:59], v[68:71]
    v_mfma_f32_16x16x32_bf16 v[222:225], v[0:3], v[246:249], 0
    ds_read_b128 v[116:119], v132 offset:13312
    v_mfma_f32_16x16x32_bf16 v[68:71], v[124:127], a[60:63], v[68:71]
    v_mfma_f32_16x16x32_bf16 v[226:229], v[8:11], v[246:249], 0
    v_mfma_f32_16x16x32_bf16 v[64:67], v[124:127], a[52:55], v[64:67]
    v_mfma_f32_16x16x32_bf16 v[206:209], v[16:19], v[48:51], 0
    ds_write_b128 v254, v[190:193] offset:0
    v_mfma_f32_16x16x32_bf16 v[64:67], v[120:123], a[48:51], v[64:67]
    v_mfma_f32_16x16x32_bf16 v[210:213], v[24:27], v[48:51], 0
    ds_write_b128 v254, v[194:197] offset:1024
    s_waitcnt lgkmcnt(6)
    v_mfma_f32_16x16x32_bf16 v[64:67], v[96:99], a[64:67], v[64:67]
    v_mfma_f32_16x16x32_bf16 v[214:217], v[16:19], v[56:59], 0
    ds_write_b128 v254, v[198:201] offset:2048
    ds_read_b128 v[120:123], v132 offset:14336
    ds_read_b128 v[124:127], v132 offset:15360
    v_mfma_f32_16x16x32_bf16 v[64:67], v[100:103], a[68:71], v[64:67]
    v_mfma_f32_16x16x32_bf16 v[218:221], v[24:27], v[56:59], 0
    ds_write_b128 v254, v[202:205] offset:3072
    v_mfma_f32_16x16x32_bf16 v[68:71], v[100:103], a[76:79], v[68:71]
    v_mfma_f32_16x16x32_bf16 v[230:233], v[16:19], v[246:249], 0
    ds_write_b128 v254, v[206:209] offset:4096
    s_waitcnt vmcnt(12)
    s_barrier
    v_mfma_f32_16x16x32_bf16 v[68:71], v[96:99], a[72:75], v[68:71]
    v_mfma_f32_16x16x32_bf16 v[234:237], v[24:27], v[246:249], 0
    ds_write_b128 v254, v[210:213] offset:5120
    s_waitcnt lgkmcnt(8)
    v_mfma_f32_16x16x32_bf16 v[68:71], v[104:107], a[88:91], v[68:71]
    ds_write_b128 v254, v[214:217] offset:6144
    ds_read_b128 v[96:99], v132 offset:16384
    ds_read_b128 v[100:103], v132 offset:17408
    v_mfma_f32_16x16x32_bf16 v[68:71], v[108:111], a[92:95], v[68:71]
    ds_write_b128 v254, v[218:221] offset:7168
    v_mfma_f32_16x16x32_bf16 v[64:67], v[108:111], a[84:87], v[64:67]
    s_add_u32 m0, s26, 49152
    s_add_u32 s24, s24, 16384
    buffer_load_dwordx4 v130, s[44:47], s24 offen offset:0 sc1 lds
    v_mfma_f32_16x16x32_bf16 v[64:67], v[104:107], a[80:83], v[64:67]
    ds_read_b128 v[104:107], v132 offset:18432
    v_mfma_f32_16x16x32_bf16 v[64:67], v[112:115], a[96:99], v[64:67]
    ds_write_b128 v255, v[222:225] offset:8192
    ds_read_b128 v[108:111], v132 offset:19456
    v_mfma_f32_16x16x32_bf16 v[64:67], v[116:119], a[100:103], v[64:67]
    ds_write_b128 v255, v[226:229] offset:8256
    v_mfma_f32_16x16x32_bf16 v[68:71], v[116:119], a[108:111], v[68:71]
    ds_write_b128 v255, v[230:233] offset:8320
    v_mfma_f32_16x16x32_bf16 v[68:71], v[112:115], a[104:107], v[68:71]
    ds_write_b128 v255, v[234:237] offset:8384
    s_waitcnt lgkmcnt(8)
    v_mfma_f32_16x16x32_bf16 v[68:71], v[120:123], a[120:123], v[68:71]
    s_add_u32 m0, s26, 49152
    s_nop 0
    buffer_load_dwordx4 v130, s[44:47], s24 offen offset:1024 sc1 lds
    ds_read_b128 v[112:115], v132 offset:20480
    ds_read_b128 v[116:119], v132 offset:21504
    v_mfma_f32_16x16x32_bf16 v[68:71], v[124:127], a[124:127], v[68:71]
    v_mfma_f32_16x16x32_bf16 v[64:67], v[124:127], a[116:119], v[64:67]
    v_mfma_f32_16x16x32_bf16 v[64:67], v[120:123], a[112:115], v[64:67]
    ds_read_b128 v[120:123], v132 offset:22528
    ds_read_b128 v[124:127], v132 offset:23552
    s_waitcnt lgkmcnt(8)
    v_mfma_f32_16x16x32_bf16 v[64:67], v[96:99], a[128:131], v[64:67]
    s_waitcnt lgkmcnt(4)
    s_barrier
    v_mfma_f32_16x16x32_bf16 v[64:67], v[100:103], a[132:135], v[64:67]
    ds_read2st64_b32 v[190:191], v138 offset0:0 offset1:33
    ds_read2st64_b32 v[192:193], v138 offset0:66 offset1:99
    v_mfma_f32_16x16x32_bf16 v[68:71], v[100:103], a[140:143], v[68:71]
    ds_read2st64_b32 v[194:195], v138 offset0:4 offset1:37
    ds_read2st64_b32 v[196:197], v138 offset0:70 offset1:103
    v_mfma_f32_16x16x32_bf16 v[68:71], v[96:99], a[136:139], v[68:71]
    ds_read2st64_b32 v[198:199], v138 offset0:8 offset1:41
    ds_read2st64_b32 v[200:201], v138 offset0:74 offset1:107
    v_mfma_f32_16x16x32_bf16 v[68:71], v[104:107], a[152:155], v[68:71]
    ds_read2st64_b32 v[202:203], v138 offset0:12 offset1:45
    ds_read2st64_b32 v[204:205], v138 offset0:78 offset1:111
    s_add_u32 m0, s26, 49152
    s_nop 0
    buffer_load_dwordx4 v130, s[44:47], s24 offen offset:2048 sc1 lds
    ds_read_b128 v[96:99], v132 offset:24576
    ds_read_b128 v[100:103], v132 offset:25600
    v_mfma_f32_16x16x32_bf16 v[68:71], v[108:111], a[156:159], v[68:71]
    ds_read2st64_b32 v[206:207], v138 offset0:16 offset1:49
    ds_read2st64_b32 v[208:209], v138 offset0:82 offset1:115
    v_mfma_f32_16x16x32_bf16 v[64:67], v[108:111], a[148:151], v[64:67]
    ds_read2st64_b32 v[210:211], v138 offset0:20 offset1:53
    ds_read2st64_b32 v[212:213], v138 offset0:86 offset1:119
    v_mfma_f32_16x16x32_bf16 v[64:67], v[104:107], a[144:147], v[64:67]
    ds_read2st64_b32 v[214:215], v138 offset0:24 offset1:57
    ds_read2st64_b32 v[216:217], v138 offset0:90 offset1:123
    s_waitcnt lgkmcnt(8)
    v_mfma_f32_16x16x32_bf16 v[64:67], v[112:115], a[160:163], v[64:67]
    ds_read2st64_b32 v[218:219], v138 offset0:28 offset1:61
    ds_read2st64_b32 v[220:221], v138 offset0:94 offset1:127
    ds_read_b128 v[104:107], v132 offset:26624
    ds_read_b128 v[108:111], v132 offset:27648
    v_mfma_f32_16x16x32_bf16 v[64:67], v[116:119], a[164:167], v[64:67]
    ds_read2st64_b32 v[222:223], v138 offset0:32 offset1:65
    ds_read2st64_b32 v[224:225], v138 offset0:98 offset1:131
    v_mfma_f32_16x16x32_bf16 v[68:71], v[116:119], a[172:175], v[68:71]
    v_add_f32 v190, v190, v191
    v_add_f32 v192, v192, v193
    v_add_f32 v190, v190, v192
    v_mfma_f32_16x16x32_bf16 v[68:71], v[112:115], a[168:171], v[68:71]
    buffer_atomic_add_f32 v190, v137, s[44:47], s56 offen offset:0
    s_add_u32 m0, s26, 49152
    s_nop 0
    buffer_load_dwordx4 v130, s[44:47], s24 offen offset:3072 sc1 lds
    v_mfma_f32_16x16x32_bf16 v[68:71], v[120:123], a[184:187], v[68:71]
    v_add_f32 v194, v194, v195
    v_add_f32 v196, v196, v197
    v_add_f32 v194, v194, v196
    ds_read_b128 v[112:115], v132 offset:28672
    ds_read_b128 v[116:119], v132 offset:29696
    v_mfma_f32_16x16x32_bf16 v[68:71], v[124:127], a[188:191], v[68:71]
    buffer_atomic_add_f32 v194, v137, s[44:47], s56 offen offset:1024
    v_mfma_f32_16x16x32_bf16 v[64:67], v[124:127], a[180:183], v[64:67]
    v_add_f32 v198, v198, v199
    v_add_f32 v200, v200, v201
    v_add_f32 v198, v198, v200
    v_mfma_f32_16x16x32_bf16 v[64:67], v[120:123], a[176:179], v[64:67]
    buffer_atomic_add_f32 v198, v137, s[44:47], s56 offen offset:2048
    s_waitcnt lgkmcnt(8)
    v_mfma_f32_16x16x32_bf16 v[64:67], v[96:99], a[192:195], v[64:67]
    v_add_f32 v202, v202, v203
    v_add_f32 v204, v204, v205
    v_add_f32 v202, v202, v204
    ds_read_b128 v[120:123], v132 offset:30720
    ds_read_b128 v[124:127], v132 offset:31744
    v_mfma_f32_16x16x32_bf16 v[64:67], v[100:103], a[196:199], v[64:67]
    buffer_atomic_add_f32 v202, v137, s[44:47], s56 offen offset:3072
    v_mfma_f32_16x16x32_bf16 v[68:71], v[100:103], a[204:207], v[68:71]
    v_add_f32 v206, v206, v207
    v_add_f32 v208, v208, v209
    v_add_f32 v206, v206, v208
    s_waitcnt vmcnt(16)
    s_barrier
    v_mfma_f32_16x16x32_bf16 v[68:71], v[96:99], a[200:203], v[68:71]
    buffer_atomic_add_f32 v206, v137, s[44:47], s57 offen offset:0
    s_waitcnt lgkmcnt(6)
    v_mfma_f32_16x16x32_bf16 v[68:71], v[104:107], a[216:219], v[68:71]
    v_add_f32 v210, v210, v211
    v_add_f32 v212, v212, v213
    v_add_f32 v210, v210, v212
    ds_read_b128 v[96:99], v131 offset:0
    ds_read_b128 v[100:103], v131 offset:1024
    v_mfma_f32_16x16x32_bf16 v[68:71], v[108:111], a[220:223], v[68:71]
    buffer_atomic_add_f32 v210, v137, s[44:47], s57 offen offset:1024
    v_mfma_f32_16x16x32_bf16 v[64:67], v[108:111], a[212:215], v[64:67]
    v_add_f32 v214, v214, v215
    v_add_f32 v216, v216, v217
    v_add_f32 v214, v214, v216
    s_add_u32 m0, s26, 65536
    s_add_u32 s24, s24, 16384
    buffer_load_dwordx4 v130, s[44:47], s24 offen offset:0 sc1 lds
    v_mfma_f32_16x16x32_bf16 v[64:67], v[104:107], a[208:211], v[64:67]
    buffer_atomic_add_f32 v214, v137, s[44:47], s57 offen offset:2048
    s_waitcnt lgkmcnt(4)
    v_mfma_f32_16x16x32_bf16 v[64:67], v[112:115], a[224:227], v[64:67]
    v_add_f32 v218, v218, v219
    v_add_f32 v220, v220, v221
    v_add_f32 v218, v218, v220
    ds_read_b128 v[104:107], v131 offset:2048
    ds_read_b128 v[108:111], v131 offset:3072
    v_mfma_f32_16x16x32_bf16 v[64:67], v[116:119], a[228:231], v[64:67]
    buffer_atomic_add_f32 v218, v137, s[44:47], s57 offen offset:3072
    v_mfma_f32_16x16x32_bf16 v[68:71], v[116:119], a[236:239], v[68:71]
    v_add_f32 v222, v222, v223
    v_add_f32 v224, v224, v225
    v_add_f32 v222, v222, v224
    v_mfma_f32_16x16x32_bf16 v[68:71], v[112:115], a[232:235], v[68:71]
    buffer_atomic_add_f32 v222, v137, s[44:47], s62 offen
    s_waitcnt lgkmcnt(4)
    v_mfma_f32_16x16x32_bf16 v[68:71], v[120:123], a[248:251], v[68:71]
    s_add_u32 m0, s26, 65536
    s_nop 0
    buffer_load_dwordx4 v130, s[44:47], s24 offen offset:1024 sc1 lds
    ds_read_b128 v[112:115], v131 offset:4096
    ds_read_b128 v[116:119], v131 offset:5120
    v_mfma_f32_16x16x32_bf16 v[68:71], v[124:127], a[252:255], v[68:71]
    v_mfma_f32_16x16x32_bf16 v[64:67], v[124:127], a[244:247], v[64:67]
    v_mfma_f32_16x16x32_bf16 v[64:67], v[120:123], a[240:243], v[64:67]
    ds_read_b128 v[120:123], v131 offset:6144
    ds_read_b128 v[124:127], v131 offset:7168
    s_waitcnt lgkmcnt(6)
    v_mfma_f32_16x16x32_bf16 v[72:75], v[96:99], a[0:3], v[72:75]
    v_mfma_f32_16x16x32_bf16 v[72:75], v[100:103], a[4:7], v[72:75]
    v_mfma_f32_16x16x32_bf16 v[76:79], v[100:103], a[12:15], v[76:79]
    s_add_u32 m0, s26, 65536
    s_nop 0
    buffer_load_dwordx4 v130, s[44:47], s24 offen offset:2048 sc1 lds
    v_mfma_f32_16x16x32_bf16 v[76:79], v[96:99], a[8:11], v[76:79]
    ds_read_b128 v[96:99], v131 offset:8192
    s_waitcnt lgkmcnt(5)
    v_mfma_f32_16x16x32_bf16 v[76:79], v[104:107], a[24:27], v[76:79]
    ds_read_b128 v[100:103], v131 offset:9216
    v_mfma_f32_16x16x32_bf16 v[76:79], v[108:111], a[28:31], v[76:79]
    v_mul_f32 v242, v68, v150
    v_mfma_f32_16x16x32_bf16 v[72:75], v[108:111], a[20:23], v[72:75]
    v_mul_f32 v243, v69, v150
    v_mfma_f32_16x16x32_bf16 v[72:75], v[104:107], a[16:19], v[72:75]
    v_mul_f32 v244, v70, v150
    s_waitcnt lgkmcnt(4)
    v_mfma_f32_16x16x32_bf16 v[72:75], v[112:115], a[32:35], v[72:75]
    v_mul_f32 v245, v71, v150
    ds_read_b128 v[104:107], v131 offset:10240
    ds_read_b128 v[108:111], v131 offset:11264
    v_mfma_f32_16x16x32_bf16 v[72:75], v[116:119], a[36:39], v[72:75]
    v_exp_f32_e64 v242, v242 clamp
    v_mfma_f32_16x16x32_bf16 v[76:79], v[116:119], a[44:47], v[76:79]
    v_exp_f32_e64 v243, v243 clamp
    v_mfma_f32_16x16x32_bf16 v[76:79], v[112:115], a[40:43], v[76:79]
    v_exp_f32_e64 v244, v244 clamp
    s_add_u32 m0, s26, 65536
    s_nop 0
    buffer_load_dwordx4 v130, s[44:47], s24 offen offset:3072 sc1 lds
    s_waitcnt lgkmcnt(4)
    v_mfma_f32_16x16x32_bf16 v[76:79], v[120:123], a[56:59], v[76:79]
    v_exp_f32_e64 v245, v245 clamp
    ds_read_b128 v[112:115], v131 offset:12288
    ds_read_b128 v[116:119], v131 offset:13312
    v_mfma_f32_16x16x32_bf16 v[76:79], v[124:127], a[60:63], v[76:79]
    v_fma_f32 v68, v68, v154, 1.0
    v_mfma_f32_16x16x32_bf16 v[72:75], v[124:127], a[52:55], v[72:75]
    v_fma_f32 v69, v69, v154, 1.0
    v_mfma_f32_16x16x32_bf16 v[72:75], v[120:123], a[48:51], v[72:75]
    v_fma_f32 v70, v70, v154, 1.0
    s_waitcnt lgkmcnt(4)
    v_mfma_f32_16x16x32_bf16 v[72:75], v[96:99], a[64:67], v[72:75]
    v_fma_f32 v71, v71, v154, 1.0
    ds_read_b128 v[120:123], v131 offset:14336
    ds_read_b128 v[124:127], v131 offset:15360
    v_mfma_f32_16x16x32_bf16 v[72:75], v[100:103], a[68:71], v[72:75]
    v_max_f32 v68, v68, v242
    v_mfma_f32_16x16x32_bf16 v[76:79], v[100:103], a[76:79], v[76:79]
    v_max_f32 v69, v69, v243
    s_waitcnt vmcnt(21)
    s_barrier
    v_mfma_f32_16x16x32_bf16 v[76:79], v[96:99], a[72:75], v[76:79]
    v_max_f32 v70, v70, v244
    s_waitcnt lgkmcnt(4)
    v_mfma_f32_16x16x32_bf16 v[76:79], v[104:107], a[88:91], v[76:79]
    v_max_f32 v71, v71, v245
    ds_read_b128 v[96:99], v131 offset:16384
    ds_read_b128 v[100:103], v131 offset:17408
    v_mfma_f32_16x16x32_bf16 v[76:79], v[108:111], a[92:95], v[76:79]
    v_add_f32 v68, s52, v68
    v_mfma_f32_16x16x32_bf16 v[72:75], v[108:111], a[84:87], v[72:75]
    v_add_f32 v69, s52, v69
    s_add_u32 m0, s26, 81920
    s_add_u32 s24, s24, 16384
    buffer_load_dwordx4 v130, s[44:47], s24 offen offset:0 sc1 lds
    v_mfma_f32_16x16x32_bf16 v[72:75], v[104:107], a[80:83], v[72:75]
    v_add_f32 v70, s52, v70
    s_waitcnt lgkmcnt(4)
    v_mfma_f32_16x16x32_bf16 v[72:75], v[112:115], a[96:99], v[72:75]
    v_add_f32 v71, s52, v71
    ds_read_b128 v[104:107], v131 offset:18432
    ds_read_b128 v[108:111], v131 offset:19456
    v_mfma_f32_16x16x32_bf16 v[72:75], v[116:119], a[100:103], v[72:75]
    v_cvt_pk_bf16_f32 v68, v68, v69
    v_mfma_f32_16x16x32_bf16 v[76:79], v[116:119], a[108:111], v[76:79]
    v_cvt_pk_bf16_f32 v69, v70, v71
    v_mfma_f32_16x16x32_bf16 v[76:79], v[112:115], a[104:107], v[76:79]
    v_mul_f32 v238, v64, v142
    s_waitcnt lgkmcnt(4)
    v_mfma_f32_16x16x32_bf16 v[76:79], v[120:123], a[120:123], v[76:79]
    v_mul_f32 v239, v65, v142
    ds_read_b128 v[112:115], v131 offset:20480
    ds_read_b128 v[116:119], v131 offset:21504
    v_mfma_f32_16x16x32_bf16 v[76:79], v[124:127], a[124:127], v[76:79]
    v_mul_f32 v240, v66, v142
    s_add_u32 m0, s26, 81920
    s_nop 0
    buffer_load_dwordx4 v130, s[44:47], s24 offen offset:1024 sc1 lds
    v_mfma_f32_16x16x32_bf16 v[72:75], v[124:127], a[116:119], v[72:75]
    v_mul_f32 v241, v67, v142
    v_mfma_f32_16x16x32_bf16 v[72:75], v[120:123], a[112:115], v[72:75]
    v_exp_f32_e64 v238, v238 clamp
    ds_read_b128 v[120:123], v131 offset:22528
    ds_read_b128 v[124:127], v131 offset:23552
    s_waitcnt lgkmcnt(6)
    v_mfma_f32_16x16x32_bf16 v[72:75], v[96:99], a[128:131], v[72:75]
    v_exp_f32_e64 v239, v239 clamp
    v_mfma_f32_16x16x32_bf16 v[72:75], v[100:103], a[132:135], v[72:75]
    v_exp_f32_e64 v240, v240 clamp
    v_mfma_f32_16x16x32_bf16 v[76:79], v[100:103], a[140:143], v[76:79]
    v_exp_f32_e64 v241, v241 clamp
    v_mfma_f32_16x16x32_bf16 v[76:79], v[96:99], a[136:139], v[76:79]
    v_fma_f32 v64, v64, v146, 1.0
    s_waitcnt lgkmcnt(4)
    v_mfma_f32_16x16x32_bf16 v[76:79], v[104:107], a[152:155], v[76:79]
    v_fma_f32 v65, v65, v146, 1.0
    s_add_u32 m0, s26, 81920
    s_nop 0
    buffer_load_dwordx4 v130, s[44:47], s24 offen offset:2048 sc1 lds
    ds_read_b128 v[96:99], v131 offset:24576
    ds_read_b128 v[100:103], v131 offset:25600
    v_mfma_f32_16x16x32_bf16 v[76:79], v[108:111], a[156:159], v[76:79]
    v_fma_f32 v66, v66, v146, 1.0
    v_mfma_f32_16x16x32_bf16 v[72:75], v[108:111], a[148:151], v[72:75]
    v_fma_f32 v67, v67, v146, 1.0
    v_mfma_f32_16x16x32_bf16 v[72:75], v[104:107], a[144:147], v[72:75]
    v_max_f32 v64, v64, v238
    s_waitcnt lgkmcnt(4)
    v_mfma_f32_16x16x32_bf16 v[72:75], v[112:115], a[160:163], v[72:75]
    v_max_f32 v65, v65, v239
    ds_read_b128 v[104:107], v131 offset:26624
    ds_read_b128 v[108:111], v131 offset:27648
    v_mfma_f32_16x16x32_bf16 v[72:75], v[116:119], a[164:167], v[72:75]
    v_max_f32 v66, v66, v240
    v_mfma_f32_16x16x32_bf16 v[76:79], v[116:119], a[172:175], v[76:79]
    v_max_f32 v67, v67, v241
    v_mfma_f32_16x16x32_bf16 v[76:79], v[112:115], a[168:171], v[76:79]
    v_add_f32 v64, s52, v64
    s_add_u32 m0, s26, 81920
    s_nop 0
    buffer_load_dwordx4 v130, s[44:47], s24 offen offset:3072 sc1 lds
    s_waitcnt lgkmcnt(4)
    v_mfma_f32_16x16x32_bf16 v[76:79], v[120:123], a[184:187], v[76:79]
    v_add_f32 v65, s52, v65
    ds_read_b128 v[112:115], v131 offset:28672
    ds_read_b128 v[116:119], v131 offset:29696
    v_mfma_f32_16x16x32_bf16 v[76:79], v[124:127], a[188:191], v[76:79]
    v_add_f32 v66, s52, v66
    v_mfma_f32_16x16x32_bf16 v[72:75], v[124:127], a[180:183], v[72:75]
    v_add_f32 v67, s52, v67
    v_mfma_f32_16x16x32_bf16 v[72:75], v[120:123], a[176:179], v[72:75]
    v_cvt_pk_bf16_f32 v64, v64, v65
    s_waitcnt lgkmcnt(4)
    v_mfma_f32_16x16x32_bf16 v[72:75], v[96:99], a[192:195], v[72:75]
    v_cvt_pk_bf16_f32 v65, v66, v67
    ds_read_b128 v[120:123], v131 offset:30720
    ds_read_b128 v[124:127], v131 offset:31744
    v_mfma_f32_16x16x32_bf16 v[72:75], v[100:103], a[196:199], v[72:75]
    v_mfma_f32_16x16x32_bf16 v[76:79], v[100:103], a[204:207], v[76:79]
    s_waitcnt vmcnt(21)
    s_barrier
    v_mfma_f32_16x16x32_bf16 v[76:79], v[96:99], a[200:203], v[76:79]
    ds_read_b128 v[96:99], v131 offset:32768
    s_waitcnt lgkmcnt(5)
    v_mfma_f32_16x16x32_bf16 v[76:79], v[104:107], a[216:219], v[76:79]
    ds_read_b128 v[100:103], v131 offset:33792
    v_mfma_f32_16x16x32_bf16 v[76:79], v[108:111], a[220:223], v[76:79]
    v_mfma_f32_16x16x32_bf16 v[72:75], v[108:111], a[212:215], v[72:75]
    v_mfma_f32_16x16x32_bf16 v[72:75], v[104:107], a[208:211], v[72:75]
    ds_read_b128 v[104:107], v131 offset:34816
    s_waitcnt lgkmcnt(5)
    v_mfma_f32_16x16x32_bf16 v[72:75], v[112:115], a[224:227], v[72:75]
    ds_read_b128 v[108:111], v131 offset:35840
    v_mfma_f32_16x16x32_bf16 v[72:75], v[116:119], a[228:231], v[72:75]
    v_mfma_f32_16x16x32_bf16 v[76:79], v[116:119], a[236:239], v[76:79]
    v_mfma_f32_16x16x32_bf16 v[76:79], v[112:115], a[232:235], v[76:79]
    ds_read_b128 v[112:115], v131 offset:36864
    s_waitcnt lgkmcnt(5)
    v_mfma_f32_16x16x32_bf16 v[76:79], v[120:123], a[248:251], v[76:79]
    ds_read_b128 v[116:119], v131 offset:37888
    v_mfma_f32_16x16x32_bf16 v[76:79], v[124:127], a[252:255], v[76:79]
    v_mfma_f32_16x16x32_bf16 v[72:75], v[124:127], a[244:247], v[72:75]
    v_mfma_f32_16x16x32_bf16 v[72:75], v[120:123], a[240:243], v[72:75]
    ds_read_b128 v[120:123], v131 offset:38912
    ds_read_b128 v[124:127], v131 offset:39936
    s_waitcnt lgkmcnt(6)
    v_mfma_f32_16x16x32_bf16 v[80:83], v[96:99], a[0:3], v[80:83]
    v_mfma_f32_16x16x32_bf16 v[80:83], v[100:103], a[4:7], v[80:83]
    v_mfma_f32_16x16x32_bf16 v[84:87], v[100:103], a[12:15], v[84:87]
    v_mfma_f32_16x16x32_bf16 v[84:87], v[96:99], a[8:11], v[84:87]
    ds_read_b128 v[96:99], v131 offset:40960
    s_waitcnt lgkmcnt(5)
    v_mfma_f32_16x16x32_bf16 v[84:87], v[104:107], a[24:27], v[84:87]
    ds_read_b128 v[100:103], v131 offset:41984
    v_mfma_f32_16x16x32_bf16 v[84:87], v[108:111], a[28:31], v[84:87]
    v_mul_f32 v242, v76, v150
    v_mfma_f32_16x16x32_bf16 v[80:83], v[108:111], a[20:23], v[80:83]
    v_mul_f32 v243, v77, v150
    v_mfma_f32_16x16x32_bf16 v[80:83], v[104:107], a[16:19], v[80:83]
    v_mul_f32 v244, v78, v150
    s_waitcnt lgkmcnt(4)
    v_mfma_f32_16x16x32_bf16 v[80:83], v[112:115], a[32:35], v[80:83]
    v_mul_f32 v245, v79, v150
    ds_read_b128 v[104:107], v131 offset:43008
    ds_read_b128 v[108:111], v131 offset:44032
    v_mfma_f32_16x16x32_bf16 v[80:83], v[116:119], a[36:39], v[80:83]
    v_exp_f32_e64 v242, v242 clamp
    v_mfma_f32_16x16x32_bf16 v[84:87], v[116:119], a[44:47], v[84:87]
    v_exp_f32_e64 v243, v243 clamp
    v_mfma_f32_16x16x32_bf16 v[84:87], v[112:115], a[40:43], v[84:87]
    v_exp_f32_e64 v244, v244 clamp
    s_waitcnt lgkmcnt(4)
    v_mfma_f32_16x16x32_bf16 v[84:87], v[120:123], a[56:59], v[84:87]
    v_exp_f32_e64 v245, v245 clamp
    ds_read_b128 v[112:115], v131 offset:45056
    ds_read_b128 v[116:119], v131 offset:46080
    v_mfma_f32_16x16x32_bf16 v[84:87], v[124:127], a[60:63], v[84:87]
    v_fma_f32 v76, v76, v154, 1.0
    v_mfma_f32_16x16x32_bf16 v[80:83], v[124:127], a[52:55], v[80:83]
    v_fma_f32 v77, v77, v154, 1.0
    v_mfma_f32_16x16x32_bf16 v[80:83], v[120:123], a[48:51], v[80:83]
    v_fma_f32 v78, v78, v154, 1.0
    s_waitcnt lgkmcnt(4)
    v_mfma_f32_16x16x32_bf16 v[80:83], v[96:99], a[64:67], v[80:83]
    v_fma_f32 v79, v79, v154, 1.0
    ds_read_b128 v[120:123], v131 offset:47104
    ds_read_b128 v[124:127], v131 offset:48128
    v_mfma_f32_16x16x32_bf16 v[80:83], v[100:103], a[68:71], v[80:83]
    v_max_f32 v76, v76, v242
    v_mfma_f32_16x16x32_bf16 v[84:87], v[100:103], a[76:79], v[84:87]
    v_max_f32 v77, v77, v243
    s_waitcnt vmcnt(16)
    s_barrier
    v_mfma_f32_16x16x32_bf16 v[84:87], v[96:99], a[72:75], v[84:87]
    v_max_f32 v78, v78, v244
    s_waitcnt lgkmcnt(4)
    v_mfma_f32_16x16x32_bf16 v[84:87], v[104:107], a[88:91], v[84:87]
    v_max_f32 v79, v79, v245
    ds_read_b128 v[96:99], v131 offset:49152
    ds_read_b128 v[100:103], v131 offset:50176
    v_mfma_f32_16x16x32_bf16 v[84:87], v[108:111], a[92:95], v[84:87]
    v_add_f32 v76, s52, v76
    v_mfma_f32_16x16x32_bf16 v[80:83], v[108:111], a[84:87], v[80:83]
    v_add_f32 v77, s52, v77
    v_mfma_f32_16x16x32_bf16 v[80:83], v[104:107], a[80:83], v[80:83]
    v_add_f32 v78, s52, v78
    s_waitcnt lgkmcnt(4)
    v_mfma_f32_16x16x32_bf16 v[80:83], v[112:115], a[96:99], v[80:83]
    v_add_f32 v79, s52, v79
    ds_read_b128 v[104:107], v131 offset:51200
    ds_read_b128 v[108:111], v131 offset:52224
    v_mfma_f32_16x16x32_bf16 v[80:83], v[116:119], a[100:103], v[80:83]
    v_cvt_pk_bf16_f32 v70, v76, v77
    v_mfma_f32_16x16x32_bf16 v[84:87], v[116:119], a[108:111], v[84:87]
    v_cvt_pk_bf16_f32 v71, v78, v79
    v_mfma_f32_16x16x32_bf16 v[84:87], v[112:115], a[104:107], v[84:87]
    v_mul_f32 v238, v72, v142
    s_waitcnt lgkmcnt(4)
    v_mfma_f32_16x16x32_bf16 v[84:87], v[120:123], a[120:123], v[84:87]
    v_mul_f32 v239, v73, v142
    ds_read_b128 v[112:115], v131 offset:53248
    ds_read_b128 v[116:119], v131 offset:54272
    v_mfma_f32_16x16x32_bf16 v[84:87], v[124:127], a[124:127], v[84:87]
    v_mul_f32 v240, v74, v142
    v_mfma_f32_16x16x32_bf16 v[80:83], v[124:127], a[116:119], v[80:83]
    v_mul_f32 v241, v75, v142
    v_mfma_f32_16x16x32_bf16 v[80:83], v[120:123], a[112:115], v[80:83]
    v_exp_f32_e64 v238, v238 clamp
    ds_read_b128 v[120:123], v131 offset:55296
    ds_read_b128 v[124:127], v131 offset:56320
    s_waitcnt lgkmcnt(6)
    v_mfma_f32_16x16x32_bf16 v[80:83], v[96:99], a[128:131], v[80:83]
    v_exp_f32_e64 v239, v239 clamp
    v_mfma_f32_16x16x32_bf16 v[80:83], v[100:103], a[132:135], v[80:83]
    v_exp_f32_e64 v240, v240 clamp
    v_mfma_f32_16x16x32_bf16 v[84:87], v[100:103], a[140:143], v[84:87]
    v_exp_f32_e64 v241, v241 clamp
    v_mfma_f32_16x16x32_bf16 v[84:87], v[96:99], a[136:139], v[84:87]
    v_fma_f32 v72, v72, v146, 1.0
    s_waitcnt lgkmcnt(4)
    v_mfma_f32_16x16x32_bf16 v[84:87], v[104:107], a[152:155], v[84:87]
    v_fma_f32 v73, v73, v146, 1.0
    ds_read_b128 v[96:99], v131 offset:57344
    ds_read_b128 v[100:103], v131 offset:58368
    v_mfma_f32_16x16x32_bf16 v[84:87], v[108:111], a[156:159], v[84:87]
    v_fma_f32 v74, v74, v146, 1.0
    v_mfma_f32_16x16x32_bf16 v[80:83], v[108:111], a[148:151], v[80:83]
    v_fma_f32 v75, v75, v146, 1.0
    v_mfma_f32_16x16x32_bf16 v[80:83], v[104:107], a[144:147], v[80:83]
    v_max_f32 v72, v72, v238
    s_waitcnt lgkmcnt(4)
    v_mfma_f32_16x16x32_bf16 v[80:83], v[112:115], a[160:163], v[80:83]
    v_max_f32 v73, v73, v239
    ds_read_b128 v[104:107], v131 offset:59392
    ds_read_b128 v[108:111], v131 offset:60416
    v_mfma_f32_16x16x32_bf16 v[80:83], v[116:119], a[164:167], v[80:83]
    v_max_f32 v74, v74, v240
    v_mfma_f32_16x16x32_bf16 v[84:87], v[116:119], a[172:175], v[84:87]
    v_max_f32 v75, v75, v241
    v_mfma_f32_16x16x32_bf16 v[84:87], v[112:115], a[168:171], v[84:87]
    v_add_f32 v72, s52, v72
    s_waitcnt lgkmcnt(4)
    v_mfma_f32_16x16x32_bf16 v[84:87], v[120:123], a[184:187], v[84:87]
    v_add_f32 v73, s52, v73
    ds_read_b128 v[112:115], v131 offset:61440
    ds_read_b128 v[116:119], v131 offset:62464
    v_mfma_f32_16x16x32_bf16 v[84:87], v[124:127], a[188:191], v[84:87]
    v_add_f32 v74, s52, v74
    v_mfma_f32_16x16x32_bf16 v[80:83], v[124:127], a[180:183], v[80:83]
    v_add_f32 v75, s52, v75
    v_mfma_f32_16x16x32_bf16 v[80:83], v[120:123], a[176:179], v[80:83]
    v_cvt_pk_bf16_f32 v66, v72, v73
    s_waitcnt vmcnt(0)
    s_barrier
    s_waitcnt lgkmcnt(4)
    v_mfma_f32_16x16x32_bf16 v[80:83], v[96:99], a[192:195], v[80:83]
    v_cvt_pk_bf16_f32 v67, v74, v75
    buffer_atomic_add v185, v184, s[44:47], s63 offen sc1
    ds_read_b128 v[120:123], v131 offset:63488
    ds_read_b128 v[124:127], v131 offset:64512
    v_mfma_f32_16x16x32_bf16 v[80:83], v[100:103], a[196:199], v[80:83]
    v_mfma_f32_16x16x32_bf16 v[84:87], v[100:103], a[204:207], v[84:87]
    s_add_u32 m0, s21, 98304
    s_nop 0
    buffer_load_dwordx4 v187, s[44:47], s20 offen offset:0 sc1 lds
    s_waitcnt vmcnt(6)
    s_barrier
    v_mfma_f32_16x16x32_bf16 v[84:87], v[96:99], a[200:203], v[84:87]
    ds_read_b128 v[96:99], v132 offset:0
    s_waitcnt lgkmcnt(5)
    v_mfma_f32_16x16x32_bf16 v[84:87], v[104:107], a[216:219], v[84:87]
    ds_read_b128 v[100:103], v132 offset:1024
    v_mfma_f32_16x16x32_bf16 v[84:87], v[108:111], a[220:223], v[84:87]
    s_add_u32 m0, s21, 98304
    s_nop 0
    buffer_load_dwordx4 v187, s[44:47], s20 offen offset:1024 sc1 lds
    v_mfma_f32_16x16x32_bf16 v[80:83], v[108:111], a[212:215], v[80:83]
    v_mfma_f32_16x16x32_bf16 v[80:83], v[104:107], a[208:211], v[80:83]
    ds_read_b128 v[104:107], v132 offset:2048
    s_waitcnt lgkmcnt(5)
    v_mfma_f32_16x16x32_bf16 v[80:83], v[112:115], a[224:227], v[80:83]
    s_add_u32 m0, s21, 106496
    s_add_u32 s20, s20, 8192
    buffer_load_dwordx4 v187, s[44:47], s20 offen offset:0 sc1 lds
    ds_read_b128 v[108:111], v132 offset:3072
    v_mfma_f32_16x16x32_bf16 v[80:83], v[116:119], a[228:231], v[80:83]
    v_mfma_f32_16x16x32_bf16 v[84:87], v[116:119], a[236:239], v[84:87]
    v_mfma_f32_16x16x32_bf16 v[84:87], v[112:115], a[232:235], v[84:87]
    s_add_u32 m0, s21, 106496
    s_nop 0
    buffer_load_dwordx4 v187, s[44:47], s20 offen offset:1024 sc1 lds
    s_waitcnt lgkmcnt(4)
    v_mfma_f32_16x16x32_bf16 v[84:87], v[120:123], a[248:251], v[84:87]
    ds_read_b128 v[112:115], v132 offset:4096
    ds_read_b128 v[116:119], v132 offset:5120
    v_mfma_f32_16x16x32_bf16 v[84:87], v[124:127], a[252:255], v[84:87]
    v_mfma_f32_16x16x32_bf16 v[80:83], v[124:127], a[244:247], v[80:83]
    s_add_u32 m0, s21, 114688
    s_add_u32 s20, s20, 8192
    buffer_load_dwordx4 v187, s[44:47], s20 offen offset:0 sc1 lds
    v_mfma_f32_16x16x32_bf16 v[80:83], v[120:123], a[240:243], v[80:83]
    ds_read_b128 v[120:123], v132 offset:6144
    ds_read_b128 v[124:127], v132 offset:7168
    s_waitcnt lgkmcnt(6)
    v_mfma_f32_16x16x32_bf16 v[88:91], v[96:99], a[0:3], v[88:91]
    v_mfma_f32_16x16x32_bf16 v[88:91], v[100:103], a[4:7], v[88:91]
    s_add_u32 m0, s21, 114688
    s_nop 0
    buffer_load_dwordx4 v187, s[44:47], s20 offen offset:1024 sc1 lds
    v_mfma_f32_16x16x32_bf16 v[92:95], v[100:103], a[12:15], v[92:95]
    v_mfma_f32_16x16x32_bf16 v[92:95], v[96:99], a[8:11], v[92:95]
    ds_read_b128 v[96:99], v132 offset:8192
    s_waitcnt lgkmcnt(5)
    v_mfma_f32_16x16x32_bf16 v[92:95], v[104:107], a[24:27], v[92:95]
    s_add_u32 m0, s21, 122880
    s_add_u32 s20, s20, 8192
    buffer_load_dwordx4 v187, s[44:47], s20 offen offset:0 sc1 lds
    ds_read_b128 v[100:103], v132 offset:9216
    v_mfma_f32_16x16x32_bf16 v[92:95], v[108:111], a[28:31], v[92:95]
    v_mul_f32 v242, v84, v150
    v_mfma_f32_16x16x32_bf16 v[88:91], v[108:111], a[20:23], v[88:91]
    v_mul_f32 v243, v85, v150
    v_mfma_f32_16x16x32_bf16 v[88:91], v[104:107], a[16:19], v[88:91]
    v_mul_f32 v244, v86, v150
    s_add_u32 m0, s21, 122880
    s_nop 0
    buffer_load_dwordx4 v187, s[44:47], s20 offen offset:1024 sc1 lds
    s_waitcnt lgkmcnt(4)
    v_mfma_f32_16x16x32_bf16 v[88:91], v[112:115], a[32:35], v[88:91]
    v_mul_f32 v245, v87, v150
    ds_read_b128 v[104:107], v132 offset:10240
    ds_read_b128 v[108:111], v132 offset:11264
    v_mfma_f32_16x16x32_bf16 v[88:91], v[116:119], a[36:39], v[88:91]
    v_exp_f32_e64 v242, v242 clamp
    v_mfma_f32_16x16x32_bf16 v[92:95], v[116:119], a[44:47], v[92:95]
    v_exp_f32_e64 v243, v243 clamp
    s_add_u32 m0, s21, 131072
    s_add_u32 s20, s20, 8192
    buffer_load_dwordx4 v187, s[44:47], s20 offen offset:0 sc1 lds
    v_mfma_f32_16x16x32_bf16 v[92:95], v[112:115], a[40:43], v[92:95]
    v_exp_f32_e64 v244, v244 clamp
    s_waitcnt lgkmcnt(4)
    v_mfma_f32_16x16x32_bf16 v[92:95], v[120:123], a[56:59], v[92:95]
    v_exp_f32_e64 v245, v245 clamp
    ds_read_b128 v[112:115], v132 offset:12288
    ds_read_b128 v[116:119], v132 offset:13312
    v_mfma_f32_16x16x32_bf16 v[92:95], v[124:127], a[60:63], v[92:95]
    v_fma_f32 v84, v84, v154, 1.0
    s_add_u32 m0, s21, 131072
    s_nop 0
    buffer_load_dwordx4 v187, s[44:47], s20 offen offset:1024 sc1 lds
    v_mfma_f32_16x16x32_bf16 v[88:91], v[124:127], a[52:55], v[88:91]
    v_fma_f32 v85, v85, v154, 1.0
    v_mfma_f32_16x16x32_bf16 v[88:91], v[120:123], a[48:51], v[88:91]
    v_fma_f32 v86, v86, v154, 1.0
    s_waitcnt lgkmcnt(4)
    v_mfma_f32_16x16x32_bf16 v[88:91], v[96:99], a[64:67], v[88:91]
    v_fma_f32 v87, v87, v154, 1.0
    s_add_u32 m0, s21, 139264
    s_add_u32 s20, s20, 8192
    buffer_load_dwordx4 v187, s[44:47], s20 offen offset:0 sc1 lds
    ds_read_b128 v[120:123], v132 offset:14336
    ds_read_b128 v[124:127], v132 offset:15360
    v_mfma_f32_16x16x32_bf16 v[88:91], v[100:103], a[68:71], v[88:91]
    v_max_f32 v84, v84, v242
    v_mfma_f32_16x16x32_bf16 v[92:95], v[100:103], a[76:79], v[92:95]
    v_max_f32 v85, v85, v243
    s_waitcnt vmcnt(12)
    s_barrier
    v_mfma_f32_16x16x32_bf16 v[92:95], v[96:99], a[72:75], v[92:95]
    v_max_f32 v86, v86, v244
    s_add_u32 m0, s21, 139264
    s_nop 0
    buffer_load_dwordx4 v187, s[44:47], s20 offen offset:1024 sc1 lds
    s_waitcnt lgkmcnt(4)
    v_mfma_f32_16x16x32_bf16 v[92:95], v[104:107], a[88:91], v[92:95]
    v_max_f32 v87, v87, v245
    ds_read_b128 v[96:99], v132 offset:16384
    ds_read_b128 v[100:103], v132 offset:17408
    v_mfma_f32_16x16x32_bf16 v[92:95], v[108:111], a[92:95], v[92:95]
    v_add_f32 v84, s52, v84
    v_mfma_f32_16x16x32_bf16 v[88:91], v[108:111], a[84:87], v[88:91]
    v_add_f32 v85, s52, v85
    s_add_u32 m0, s21, 147456
    s_add_u32 s20, s20, 8192
    buffer_load_dwordx4 v187, s[44:47], s20 offen offset:0 sc1 lds
    v_mfma_f32_16x16x32_bf16 v[88:91], v[104:107], a[80:83], v[88:91]
    v_add_f32 v86, s52, v86
    s_waitcnt lgkmcnt(4)
    v_mfma_f32_16x16x32_bf16 v[88:91], v[112:115], a[96:99], v[88:91]
    v_add_f32 v87, s52, v87
    ds_read_b128 v[104:107], v132 offset:18432
    ds_read_b128 v[108:111], v132 offset:19456
    v_mfma_f32_16x16x32_bf16 v[88:91], v[116:119], a[100:103], v[88:91]
    v_cvt_pk_bf16_f32 v84, v84, v85
    s_add_u32 m0, s21, 147456
    s_nop 0
    buffer_load_dwordx4 v187, s[44:47], s20 offen offset:1024 sc1 lds
    v_mfma_f32_16x16x32_bf16 v[92:95], v[116:119], a[108:111], v[92:95]
    v_cvt_pk_bf16_f32 v85, v86, v87
    v_mfma_f32_16x16x32_bf16 v[92:95], v[112:115], a[104:107], v[92:95]
    v_mul_f32 v238, v80, v142
    s_waitcnt lgkmcnt(4)
    v_mfma_f32_16x16x32_bf16 v[92:95], v[120:123], a[120:123], v[92:95]
    v_mul_f32 v239, v81, v142
    buffer_load_dword v136, v134, s[44:47], s59 offen sc1
    s_add_u32 m0, s21, 0
    s_add_u32 s20, s20, 8192
    buffer_load_dwordx4 v187, s[44:47], s20 offen offset:0 sc1 lds
    ds_read_b128 v[112:115], v132 offset:20480
    ds_read_b128 v[116:119], v132 offset:21504
    v_mfma_f32_16x16x32_bf16 v[92:95], v[124:127], a[124:127], v[92:95]
    v_mul_f32 v240, v82, v142
    v_mfma_f32_16x16x32_bf16 v[88:91], v[124:127], a[116:119], v[88:91]
    v_mul_f32 v241, v83, v142
    v_mfma_f32_16x16x32_bf16 v[88:91], v[120:123], a[112:115], v[88:91]
    v_exp_f32_e64 v238, v238 clamp
    s_add_u32 m0, s21, 0
    s_nop 0
    buffer_load_dwordx4 v187, s[44:47], s20 offen offset:1024 sc1 lds
    ds_read_b128 v[120:123], v132 offset:22528
    ds_read_b128 v[124:127], v132 offset:23552
    s_waitcnt lgkmcnt(6)
    v_mfma_f32_16x16x32_bf16 v[88:91], v[96:99], a[128:131], v[88:91]
    v_exp_f32_e64 v239, v239 clamp
    v_mfma_f32_16x16x32_bf16 v[88:91], v[100:103], a[132:135], v[88:91]
    v_exp_f32_e64 v240, v240 clamp
    v_mfma_f32_16x16x32_bf16 v[92:95], v[100:103], a[140:143], v[92:95]
    v_exp_f32_e64 v241, v241 clamp
    s_add_u32 m0, s21, 8192
    s_add_u32 s20, s20, 8192
    buffer_load_dwordx4 v187, s[44:47], s20 offen offset:0 sc1 lds
    v_mfma_f32_16x16x32_bf16 v[92:95], v[96:99], a[136:139], v[92:95]
    v_fma_f32 v80, v80, v146, 1.0
    s_waitcnt lgkmcnt(4)
    v_mfma_f32_16x16x32_bf16 v[92:95], v[104:107], a[152:155], v[92:95]
    v_fma_f32 v81, v81, v146, 1.0
    ds_read_b128 v[96:99], v132 offset:24576
    ds_read_b128 v[100:103], v132 offset:25600
    v_mfma_f32_16x16x32_bf16 v[92:95], v[108:111], a[156:159], v[92:95]
    v_fma_f32 v82, v82, v146, 1.0
    s_add_u32 m0, s21, 8192
    s_nop 0
    buffer_load_dwordx4 v187, s[44:47], s20 offen offset:1024 sc1 lds
    v_mfma_f32_16x16x32_bf16 v[88:91], v[108:111], a[148:151], v[88:91]
    v_fma_f32 v83, v83, v146, 1.0
    v_mfma_f32_16x16x32_bf16 v[88:91], v[104:107], a[144:147], v[88:91]
    v_max_f32 v80, v80, v238
    s_waitcnt lgkmcnt(4)
    v_mfma_f32_16x16x32_bf16 v[88:91], v[112:115], a[160:163], v[88:91]
    v_max_f32 v81, v81, v239
    s_add_u32 m0, s21, 16384
    s_add_u32 s20, s20, 8192
    buffer_load_dwordx4 v187, s[44:47], s20 offen offset:0 sc1 lds
    ds_read_b128 v[104:107], v132 offset:26624
    ds_read_b128 v[108:111], v132 offset:27648
    v_mfma_f32_16x16x32_bf16 v[88:91], v[116:119], a[164:167], v[88:91]
    v_max_f32 v82, v82, v240
    v_mfma_f32_16x16x32_bf16 v[92:95], v[116:119], a[172:175], v[92:95]
    v_max_f32 v83, v83, v241
    v_mfma_f32_16x16x32_bf16 v[92:95], v[112:115], a[168:171], v[92:95]
    v_add_f32 v80, s52, v80
    s_add_u32 m0, s21, 16384
    s_nop 0
    buffer_load_dwordx4 v187, s[44:47], s20 offen offset:1024 sc1 lds
    s_waitcnt lgkmcnt(4)
    v_mfma_f32_16x16x32_bf16 v[92:95], v[120:123], a[184:187], v[92:95]
    v_add_f32 v81, s52, v81
    ds_read_b128 v[112:115], v132 offset:28672
    ds_read_b128 v[116:119], v132 offset:29696
    v_mfma_f32_16x16x32_bf16 v[92:95], v[124:127], a[188:191], v[92:95]
    v_add_f32 v82, s52, v82
    v_mfma_f32_16x16x32_bf16 v[88:91], v[124:127], a[180:183], v[88:91]
    v_add_f32 v83, s52, v83
    v_mfma_f32_16x16x32_bf16 v[88:91], v[120:123], a[176:179], v[88:91]
    v_cvt_pk_bf16_f32 v80, v80, v81
    s_waitcnt lgkmcnt(4)
    v_mfma_f32_16x16x32_bf16 v[88:91], v[96:99], a[192:195], v[88:91]
    v_cvt_pk_bf16_f32 v81, v82, v83
    ds_read_b128 v[120:123], v132 offset:30720
    ds_read_b128 v[124:127], v132 offset:31744
    v_mfma_f32_16x16x32_bf16 v[88:91], v[100:103], a[196:199], v[88:91]
    v_mfma_f32_16x16x32_bf16 v[92:95], v[100:103], a[204:207], v[92:95]
    v_mfma_f32_16x16x32_bf16 v[92:95], v[96:99], a[200:203], v[92:95]
    s_waitcnt lgkmcnt(4)
    v_mfma_f32_16x16x32_bf16 v[92:95], v[104:107], a[216:219], v[92:95]
    v_mfma_f32_16x16x32_bf16 v[92:95], v[108:111], a[220:223], v[92:95]
    v_mfma_f32_16x16x32_bf16 v[88:91], v[108:111], a[212:215], v[88:91]
    v_mfma_f32_16x16x32_bf16 v[88:91], v[104:107], a[208:211], v[88:91]
    s_waitcnt lgkmcnt(2)
    v_mfma_f32_16x16x32_bf16 v[88:91], v[112:115], a[224:227], v[88:91]
    v_mfma_f32_16x16x32_bf16 v[88:91], v[116:119], a[228:231], v[88:91]
    v_mfma_f32_16x16x32_bf16 v[92:95], v[116:119], a[236:239], v[92:95]
    v_mfma_f32_16x16x32_bf16 v[92:95], v[112:115], a[232:235], v[92:95]
    s_waitcnt lgkmcnt(0)
    v_mfma_f32_16x16x32_bf16 v[92:95], v[120:123], a[248:251], v[92:95]
    v_mfma_f32_16x16x32_bf16 v[92:95], v[124:127], a[252:255], v[92:95]
    v_mfma_f32_16x16x32_bf16 v[88:91], v[124:127], a[244:247], v[88:91]
    v_mfma_f32_16x16x32_bf16 v[88:91], v[120:123], a[240:243], v[88:91]
    s_waitcnt vmcnt(0)
    v_readfirstlane_b32 s16, v136
    s_cmp_ge_u32 s16, 16
    s_cbranch_scc1 PEa11
    v_mov_b32 v134, 0
    s_mov_b32 s17, 0
Pa11:
    buffer_load_dword v136, v134, s[44:47], s59 offen sc1
    s_waitcnt vmcnt(0)
    v_readfirstlane_b32 s16, v136
    s_cmp_ge_u32 s16, 16
    s_cbranch_scc1 PEa11
    s_sleep 1
    s_add_u32 s17, s17, 1
    s_cmp_lt_u32 s17, 0x40000
    s_cbranch_scc1 Pa11
PEa11:
    buffer_load_dwordx4 v[190:193], v128, s[44:47], s40 offen sc1
    buffer_load_dwordx4 v[194:197], v128, s[44:47], s40 offen offset:1024 sc1
    buffer_load_dwordx4 v[198:201], v135, s[44:47], s58 offen offset:0 sc1
    buffer_load_dwordx4 v[202:205], v135, s[44:47], s58 offen offset:64 sc1
    buffer_load_dwordx4 v[206:209], v135, s[44:47], s58 offen offset:128 sc1
    buffer_load_dwordx4 v[210:213], v135, s[44:47], s58 offen offset:192 sc1
    v_mul_f32 v242, v92, v150
    v_mul_f32 v243, v93, v150
    v_mul_f32 v244, v94, v150
    v_mul_f32 v245, v95, v150
    v_exp_f32_e64 v242, v242 clamp
    v_exp_f32_e64 v243, v243 clamp
    v_exp_f32_e64 v244, v244 clamp
    v_exp_f32_e64 v245, v245 clamp
    v_fma_f32 v92, v92, v154, 1.0
    v_fma_f32 v93, v93, v154, 1.0
    v_fma_f32 v94, v94, v154, 1.0
    v_fma_f32 v95, v95, v154, 1.0
    v_max_f32 v92, v92, v242
    v_max_f32 v93, v93, v243
    v_max_f32 v94, v94, v244
    v_max_f32 v95, v95, v245
    v_add_f32 v92, s52, v92
    v_add_f32 v93, s52, v93
    v_add_f32 v94, s52, v94
    v_add_f32 v95, s52, v95
    v_cvt_pk_bf16_f32 v86, v92, v93
    v_cvt_pk_bf16_f32 v87, v94, v95
    v_mul_f32 v238, v88, v142
    v_mul_f32 v239, v89, v142
    v_mul_f32 v240, v90, v142
    v_mul_f32 v241, v91, v142
    v_exp_f32_e64 v238, v238 clamp
    v_exp_f32_e64 v239, v239 clamp
    v_exp_f32_e64 v240, v240 clamp
    v_exp_f32_e64 v241, v241 clamp
    v_fma_f32 v88, v88, v146, 1.0
    v_fma_f32 v89, v89, v146, 1.0
    v_fma_f32 v90, v90, v146, 1.0
    v_fma_f32 v91, v91, v146, 1.0
    v_max_f32 v88, v88, v238
    v_max_f32 v89, v89, v239
    v_max_f32 v90, v90, v240
    v_max_f32 v91, v91, v241
    v_add_f32 v88, s52, v88
    v_add_f32 v89, s52, v89
    v_add_f32 v90, s52, v90
    v_add_f32 v91, s52, v91
    v_cvt_pk_bf16_f32 v82, v88, v89
    v_cvt_pk_bf16_f32 v83, v90, v91
    s_waitcnt vmcnt(4)
    v_cvt_pk_bf16_f32 v190, v190, v191
    v_cvt_pk_bf16_f32 v191, v192, v193
    v_cvt_pk_bf16_f32 v192, v194, v195
    v_cvt_pk_bf16_f32 v193, v196, v197
    ds_write_b128 v139, v[190:193]
    s_waitcnt vmcnt(0)
    v_cvt_pk_bf16_f32 v198, v198, v199
    v_cvt_pk_bf16_f32 v199, v200, v201
    v_cvt_pk_bf16_f32 v200, v202, v203
    v_cvt_pk_bf16_f32 v201, v204, v205
    v_cvt_pk_bf16_f32 v206, v206, v207
    v_cvt_pk_bf16_f32 v207, v208, v209
    v_cvt_pk_bf16_f32 v208, v210, v211
    v_cvt_pk_bf16_f32 v209, v212, v213
    s_waitcnt lgkmcnt(0)
    s_barrier
    ds_read_b128 v[214:217], v186 offset:0
    ds_read_b128 v[218:221], v186 offset:1024
    ds_read_b128 v[222:225], v186 offset:2048
    ds_read_b128 v[226:229], v186 offset:3072
    v_mfma_f32_16x16x32_bf16 v[24:27], v[198:201], v[64:67], v[250:253]
    v_mfma_f32_16x16x32_bf16 v[36:39], v[198:201], v[68:71], v[250:253]
    v_mfma_f32_16x16x32_bf16 v[48:51], v[206:209], v[80:83], v[250:253]
    v_mfma_f32_16x16x32_bf16 v[60:63], v[206:209], v[84:87], v[250:253]
    s_waitcnt lgkmcnt(3)
    v_mfma_f32_16x16x32_bf16 v[16:19], v[214:217], v[64:67], 0
    v_mfma_f32_16x16x32_bf16 v[28:31], v[214:217], v[68:71], 0
    s_waitcnt lgkmcnt(2)
    v_mfma_f32_16x16x32_bf16 v[20:23], v[218:221], v[64:67], 0
    v_mfma_f32_16x16x32_bf16 v[32:35], v[218:221], v[68:71], 0
    s_waitcnt lgkmcnt(1)
    v_mfma_f32_16x16x32_bf16 v[40:43], v[222:225], v[80:83], 0
    v_mfma_f32_16x16x32_bf16 v[52:55], v[222:225], v[84:87], 0
    s_waitcnt lgkmcnt(0)
    v_mfma_f32_16x16x32_bf16 v[44:47], v[226:229], v[80:83], 0
    v_mfma_f32_16x16x32_bf16 v[56:59], v[226:229], v[84:87], 0
    v_rcp_f32 v24, v24
    v_rcp_f32 v36, v36
    v_rcp_f32 v48, v48
    v_rcp_f32 v60, v60
    v_pk_mul_f32 v[16:17], v[16:17], v[24:25] op_sel_hi:[1,0]
    v_pk_mul_f32 v[18:19], v[18:19], v[24:25] op_sel_hi:[1,0]
    v_pk_mul_f32 v[20:21], v[20:21], v[24:25] op_sel_hi:[1,0]
    v_pk_mul_f32 v[22:23], v[22:23], v[24:25] op_sel_hi:[1,0]
    v_cvt_pk_bf16_f32 v0, v16, v17
    v_cvt_pk_bf16_f32 v1, v18, v19
    v_cvt_pk_bf16_f32 v2, v20, v21
    v_cvt_pk_bf16_f32 v3, v22, v23
    buffer_store_dwordx4 v[0:3], v128, s[44:47], s60 offen offset:0 sc1
    v_pk_mul_f32 v[28:29], v[28:29], v[36:37] op_sel_hi:[1,0]
    v_pk_mul_f32 v[30:31], v[30:31], v[36:37] op_sel_hi:[1,0]
    v_pk_mul_f32 v[32:33], v[32:33], v[36:37] op_sel_hi:[1,0]
    v_pk_mul_f32 v[34:35], v[34:35], v[36:37] op_sel_hi:[1,0]
    v_cvt_pk_bf16_f32 v4, v28, v29
    v_cvt_pk_bf16_f32 v5, v30, v31
    v_cvt_pk_bf16_f32 v6, v32, v33
    v_cvt_pk_bf16_f32 v7, v34, v35
    buffer_store_dwordx4 v[4:7], v128, s[44:47], s61 offen offset:0 sc1
    v_pk_mul_f32 v[40:41], v[40:41], v[48:49] op_sel_hi:[1,0]
    v_pk_mul_f32 v[42:43], v[42:43], v[48:49] op_sel_hi:[1,0]
    v_pk_mul_f32 v[44:45], v[44:45], v[48:49] op_sel_hi:[1,0]
    v_pk_mul_f32 v[46:47], v[46:47], v[48:49] op_sel_hi:[1,0]
    v_cvt_pk_bf16_f32 v8, v40, v41
    v_cvt_pk_bf16_f32 v9, v42, v43
    v_cvt_pk_bf16_f32 v10, v44, v45
    v_cvt_pk_bf16_f32 v11, v46, v47
    buffer_store_dwordx4 v[8:11], v128, s[44:47], s60 offen offset:1024 sc1
    v_pk_mul_f32 v[52:53], v[52:53], v[60:61] op_sel_hi:[1,0]
    v_pk_mul_f32 v[54:55], v[54:55], v[60:61] op_sel_hi:[1,0]
    v_pk_mul_f32 v[56:57], v[56:57], v[60:61] op_sel_hi:[1,0]
    v_pk_mul_f32 v[58:59], v[58:59], v[60:61] op_sel_hi:[1,0]
    v_cvt_pk_bf16_f32 v12, v52, v53
    v_cvt_pk_bf16_f32 v13, v54, v55
    v_cvt_pk_bf16_f32 v14, v56, v57
    v_cvt_pk_bf16_f32 v15, v58, v59
    buffer_store_dwordx4 v[12:15], v128, s[44:47], s61 offen offset:1024 sc1
    v_and_b32 v158, 31, v133
    v_and_b32 v164, 15, v133
    v_lshrrev_b32 v165, 4, v133
    v_lshlrev_b32 v159, 4, v164
    v_lshl_add_u32 v159, v165, 2, v159
    v_mov_b32 v162, 0x3f803f80
    s_lshl_b32 s54, s42, 15
    s_lshl_b32 s55, s38, 11
    s_add_u32 s48, s54, s55
    s_add_u32 s49, s48, 32768
    s_lshl_b32 s54, s42, 11
    s_lshl_b32 s55, s38, 8
    s_add_u32 s52, s54, s55
    s_add_u32 s52, s52, 53739520
    s_add_u32 s53, s54, 0
    s_waitcnt vmcnt(0)
    s_barrier
    buffer_atomic_add v185, v184, s[44:47], s19 offen sc1
    s_add_u32 m0, s21, 24576
    s_add_u32 s20, s20, 8192
    buffer_load_dwordx4 v187, s[44:47], s20 offen offset:0 sc1 lds
    s_add_u32 m0, s21, 24576
    s_nop 0
    buffer_load_dwordx4 v187, s[44:47], s20 offen offset:1024 sc1 lds
    s_add_u32 m0, s21, 32768
    s_add_u32 s20, s20, 8192
    buffer_load_dwordx4 v187, s[44:47], s20 offen offset:0 sc1 lds
    s_add_u32 m0, s21, 32768
    s_nop 0
    buffer_load_dwordx4 v187, s[44:47], s20 offen offset:1024 sc1 lds
    s_add_u32 m0, s21, 40960
    s_add_u32 s20, s20, 8192
    buffer_load_dwordx4 v187, s[44:47], s20 offen offset:0 sc1 lds
    s_add_u32 m0, s21, 40960
    s_nop 0
    buffer_load_dwordx4 v187, s[44:47], s20 offen offset:1024 sc1 lds
    s_add_u32 m0, s21, 49152
    s_add_u32 s20, s20, 8192
    buffer_load_dwordx4 v187, s[44:47], s20 offen offset:0 sc1 lds
    s_add_u32 m0, s21, 49152
    s_nop 0
    buffer_load_dwordx4 v187, s[44:47], s20 offen offset:1024 sc1 lds
    s_add_u32 m0, s21, 57344
    s_add_u32 s20, s20, 8192
    buffer_load_dwordx4 v187, s[44:47], s20 offen offset:0 sc1 lds
    s_add_u32 m0, s21, 57344
    s_nop 0
    buffer_load_dwordx4 v187, s[44:47], s20 offen offset:1024 sc1 lds
    s_add_u32 m0, s21, 65536
    s_add_u32 s20, s20, 8192
    buffer_load_dwordx4 v187, s[44:47], s20 offen offset:0 sc1 lds
    s_add_u32 m0, s21, 65536
    s_nop 0
    buffer_load_dwordx4 v187, s[44:47], s20 offen offset:1024 sc1 lds
    buffer_load_dwordx4 v[190:193], v128, s[44:47], s48 offen offset:0 sc1
    buffer_load_dwordx4 v[194:197], v128, s[44:47], s48 offen offset:1024 sc1
    buffer_load_dwordx4 v[198:201], v128, s[44:47], s49 offen offset:0 sc1
    buffer_load_dwordx4 v[202:205], v128, s[44:47], s49 offen offset:1024 sc1
    ds_read_b128 v[32:35], v188 offset:32768
    ds_read_b128 v[36:39], v188 offset:33792
    ds_read_b128 v[40:43], v188 offset:34816
    ds_read_b128 v[44:47], v188 offset:35840
    ds_read_b128 v[48:51], v188 offset:36864
    ds_read_b128 v[52:55], v188 offset:37888
    ds_read_b128 v[56:59], v188 offset:38912
    ds_read_b128 v[60:63], v188 offset:39936
    s_cmp_lg_u32 s34, 0
    s_cbranch_scc1 PEa12
    v_mov_b32 v134, 0
    s_mov_b32 s17, 0
Pa12:
    buffer_load_dword v136, v134, s[44:47], s22 offen sc1
    s_waitcnt vmcnt(0)
    v_readfirstlane_b32 s16, v136
    s_cmp_ge_u32 s16, 16
    s_cbranch_scc1 PEa12
    s_sleep 4
    s_add_u32 s17, s17, 1
    s_cmp_lt_u32 s17, 0x40000
    s_cbranch_scc1 Pa12
PEa12:
    s_waitcnt vmcnt(0)
    s_barrier
    buffer_load_dwordx4 a[0:3], v128, s[44:47], s23 offen offset:0 sc1
    buffer_load_dwordx4 a[4:7], v128, s[44:47], s23 offen offset:1024 sc1
    buffer_load_dwordx4 a[8:11], v129, s[44:47], s23 offen offset:0 sc1
    buffer_load_dwordx4 a[12:15], v129, s[44:47], s23 offen offset:1024 sc1
    s_add_u32 s23, s23, 2048
    buffer_load_dwordx4 a[16:19], v128, s[44:47], s23 offen offset:0 sc1
    buffer_load_dwordx4 a[20:23], v128, s[44:47], s23 offen offset:1024 sc1
    buffer_load_dwordx4 a[24:27], v129, s[44:47], s23 offen offset:0 sc1
    buffer_load_dwordx4 a[28:31], v129, s[44:47], s23 offen offset:1024 sc1
    s_add_u32 s23, s23, 2048
    buffer_load_dwordx4 a[32:35], v128, s[44:47], s23 offen offset:0 sc1
    buffer_load_dwordx4 a[36:39], v128, s[44:47], s23 offen offset:1024 sc1
    buffer_load_dwordx4 a[40:43], v129, s[44:47], s23 offen offset:0 sc1
    buffer_load_dwordx4 a[44:47], v129, s[44:47], s23 offen offset:1024 sc1
    v_lshlrev_b32 v0, 16, v190
    v_and_b32 v1, 0xffff0000, v190
    v_lshlrev_b32 v2, 16, v191
    v_and_b32 v3, 0xffff0000, v191
    v_lshlrev_b32 v4, 16, v198
    v_and_b32 v5, 0xffff0000, v198
    v_lshlrev_b32 v6, 16, v199
    v_and_b32 v7, 0xffff0000, v199
    v_lshlrev_b32 v8, 16, v192
    v_and_b32 v9, 0xffff0000, v192
    v_lshlrev_b32 v10, 16, v193
    v_and_b32 v11, 0xffff0000, v193
    v_lshlrev_b32 v12, 16, v200
    v_and_b32 v13, 0xffff0000, v200
    v_lshlrev_b32 v14, 16, v201
    v_and_b32 v15, 0xffff0000, v201
    v_lshlrev_b32 v16, 16, v194
    v_and_b32 v17, 0xffff0000, v194
    v_lshlrev_b32 v18, 16, v195
    v_and_b32 v19, 0xffff0000, v195
    v_lshlrev_b32 v20, 16, v202
    v_and_b32 v21, 0xffff0000, v202
    v_lshlrev_b32 v22, 16, v203
    v_and_b32 v23, 0xffff0000, v203
    v_lshlrev_b32 v24, 16, v196
    v_and_b32 v25, 0xffff0000, v196
    v_lshlrev_b32 v26, 16, v197
    v_and_b32 v27, 0xffff0000, v197
    v_lshlrev_b32 v28, 16, v204
    v_and_b32 v29, 0xffff0000, v204
    v_lshlrev_b32 v30, 16, v205
    v_and_b32 v31, 0xffff0000, v205
    s_waitcnt lgkmcnt(0)
    s_waitcnt vmcnt(10)
    v_mfma_f32_16x16x32_bf16 v[0:3], v[32:35], a[0:3], v[0:3]
    ds_read_b128 v[64:67], v188 offset:40960
    v_mfma_f32_16x16x32_bf16 v[0:3], v[36:39], a[4:7], v[0:3]
    s_add_u32 s23, s23, 2048
    buffer_load_dwordx4 a[48:51], v128, s[44:47], s23 offen offset:0 sc1
    s_waitcnt vmcnt(9)
    v_mfma_f32_16x16x32_bf16 v[4:7], v[36:39], a[12:15], v[4:7]
    ds_read_b128 v[68:71], v188 offset:41984
    v_mfma_f32_16x16x32_bf16 v[4:7], v[32:35], a[8:11], v[4:7]
    v_mfma_f32_16x16x32_bf16 v[12:15], v[40:43], a[8:11], v[12:15]
    buffer_load_dwordx4 a[52:55], v128, s[44:47], s23 offen offset:1024 sc1
    v_mfma_f32_16x16x32_bf16 v[12:15], v[44:47], a[12:15], v[12:15]
    ds_read_b128 v[72:75], v188 offset:43008
    v_mfma_f32_16x16x32_bf16 v[8:11], v[44:47], a[4:7], v[8:11]
    buffer_load_dwordx4 a[56:59], v129, s[44:47], s23 offen offset:0 sc1
    v_mfma_f32_16x16x32_bf16 v[8:11], v[40:43], a[0:3], v[8:11]
    v_mfma_f32_16x16x32_bf16 v[16:19], v[48:51], a[0:3], v[16:19]
    ds_read_b128 v[76:79], v188 offset:44032
    v_mfma_f32_16x16x32_bf16 v[16:19], v[52:55], a[4:7], v[16:19]
    buffer_load_dwordx4 a[60:63], v129, s[44:47], s23 offen offset:1024 sc1
    v_mfma_f32_16x16x32_bf16 v[20:23], v[52:55], a[12:15], v[20:23]
    ds_read_b128 v[80:83], v188 offset:45056
    v_mfma_f32_16x16x32_bf16 v[20:23], v[48:51], a[8:11], v[20:23]
    v_mfma_f32_16x16x32_bf16 v[28:31], v[56:59], a[8:11], v[28:31]
    ds_read_b128 v[84:87], v188 offset:46080
    v_mfma_f32_16x16x32_bf16 v[28:31], v[60:63], a[12:15], v[28:31]
    ds_read_b128 v[88:91], v188 offset:47104
    v_mfma_f32_16x16x32_bf16 v[24:27], v[60:63], a[4:7], v[24:27]
    ds_read_b128 v[92:95], v188 offset:48128
    v_mfma_f32_16x16x32_bf16 v[24:27], v[56:59], a[0:3], v[24:27]
    s_waitcnt vmcnt(10) lgkmcnt(6)
    v_mfma_f32_16x16x32_bf16 v[0:3], v[64:67], a[16:19], v[0:3]
    ds_read_b128 v[32:35], v188 offset:49152
    v_mfma_f32_16x16x32_bf16 v[0:3], v[68:71], a[20:23], v[0:3]
    s_add_u32 s23, s23, 2048
    buffer_load_dwordx4 a[64:67], v128, s[44:47], s23 offen offset:0 sc1
    s_waitcnt vmcnt(9)
    v_mfma_f32_16x16x32_bf16 v[4:7], v[68:71], a[28:31], v[4:7]
    ds_read_b128 v[36:39], v188 offset:50176
    v_mfma_f32_16x16x32_bf16 v[4:7], v[64:67], a[24:27], v[4:7]
    s_waitcnt lgkmcnt(6)
    v_mfma_f32_16x16x32_bf16 v[12:15], v[72:75], a[24:27], v[12:15]
    buffer_load_dwordx4 a[68:71], v128, s[44:47], s23 offen offset:1024 sc1
    v_mfma_f32_16x16x32_bf16 v[12:15], v[76:79], a[28:31], v[12:15]
    ds_read_b128 v[40:43], v188 offset:51200
    v_mfma_f32_16x16x32_bf16 v[8:11], v[76:79], a[20:23], v[8:11]
    buffer_load_dwordx4 a[72:75], v129, s[44:47], s23 offen offset:0 sc1
    v_mfma_f32_16x16x32_bf16 v[8:11], v[72:75], a[16:19], v[8:11]
    s_waitcnt lgkmcnt(5)
    v_mfma_f32_16x16x32_bf16 v[16:19], v[80:83], a[16:19], v[16:19]
    ds_read_b128 v[44:47], v188 offset:52224
    v_mfma_f32_16x16x32_bf16 v[16:19], v[84:87], a[20:23], v[16:19]
    buffer_load_dwordx4 a[76:79], v129, s[44:47], s23 offen offset:1024 sc1
    v_mfma_f32_16x16x32_bf16 v[20:23], v[84:87], a[28:31], v[20:23]
    ds_read_b128 v[48:51], v188 offset:53248
    v_mfma_f32_16x16x32_bf16 v[20:23], v[80:83], a[24:27], v[20:23]
    s_waitcnt lgkmcnt(5)
    v_mfma_f32_16x16x32_bf16 v[28:31], v[88:91], a[24:27], v[28:31]
    ds_read_b128 v[52:55], v188 offset:54272
    v_mfma_f32_16x16x32_bf16 v[28:31], v[92:95], a[28:31], v[28:31]
    ds_read_b128 v[56:59], v188 offset:55296
    v_mfma_f32_16x16x32_bf16 v[24:27], v[92:95], a[20:23], v[24:27]
    ds_read_b128 v[60:63], v188 offset:56320
    v_mfma_f32_16x16x32_bf16 v[24:27], v[88:91], a[16:19], v[24:27]
    s_waitcnt vmcnt(10) lgkmcnt(6)
    v_mfma_f32_16x16x32_bf16 v[0:3], v[32:35], a[32:35], v[0:3]
    ds_read_b128 v[64:67], v188 offset:57344
    v_mfma_f32_16x16x32_bf16 v[0:3], v[36:39], a[36:39], v[0:3]
    s_add_u32 s23, s23, 2048
    buffer_load_dwordx4 a[80:83], v128, s[44:47], s23 offen offset:0 sc1
    s_waitcnt vmcnt(9)
    v_mfma_f32_16x16x32_bf16 v[4:7], v[36:39], a[44:47], v[4:7]
    ds_read_b128 v[68:71], v188 offset:58368
    v_mfma_f32_16x16x32_bf16 v[4:7], v[32:35], a[40:43], v[4:7]
    s_waitcnt lgkmcnt(6)
    v_mfma_f32_16x16x32_bf16 v[12:15], v[40:43], a[40:43], v[12:15]
    buffer_load_dwordx4 a[84:87], v128, s[44:47], s23 offen offset:1024 sc1
    v_mfma_f32_16x16x32_bf16 v[12:15], v[44:47], a[44:47], v[12:15]
    ds_read_b128 v[72:75], v188 offset:59392
    v_mfma_f32_16x16x32_bf16 v[8:11], v[44:47], a[36:39], v[8:11]
    buffer_load_dwordx4 a[88:91], v129, s[44:47], s23 offen offset:0 sc1
    v_mfma_f32_16x16x32_bf16 v[8:11], v[40:43], a[32:35], v[8:11]
    s_waitcnt lgkmcnt(5)
    v_mfma_f32_16x16x32_bf16 v[16:19], v[48:51], a[32:35], v[16:19]
    ds_read_b128 v[76:79], v188 offset:60416
    v_mfma_f32_16x16x32_bf16 v[16:19], v[52:55], a[36:39], v[16:19]
    buffer_load_dwordx4 a[92:95], v129, s[44:47], s23 offen offset:1024 sc1
    v_mfma_f32_16x16x32_bf16 v[20:23], v[52:55], a[44:47], v[20:23]
    ds_read_b128 v[80:83], v188 offset:61440
    v_mfma_f32_16x16x32_bf16 v[20:23], v[48:51], a[40:43], v[20:23]
    s_waitcnt lgkmcnt(5)
    v_mfma_f32_16x16x32_bf16 v[28:31], v[56:59], a[40:43], v[28:31]
    ds_read_b128 v[84:87], v188 offset:62464
    v_mfma_f32_16x16x32_bf16 v[28:31], v[60:63], a[44:47], v[28:31]
    ds_read_b128 v[88:91], v188 offset:63488
    v_mfma_f32_16x16x32_bf16 v[24:27], v[60:63], a[36:39], v[24:27]
    ds_read_b128 v[92:95], v188 offset:64512
    v_mfma_f32_16x16x32_bf16 v[24:27], v[56:59], a[32:35], v[24:27]
    s_waitcnt vmcnt(10) lgkmcnt(6)
    v_mfma_f32_16x16x32_bf16 v[0:3], v[64:67], a[48:51], v[0:3]
    ds_read_b128 v[32:35], v189 offset:0
    v_mfma_f32_16x16x32_bf16 v[0:3], v[68:71], a[52:55], v[0:3]
    s_add_u32 s23, s23, 2048
    buffer_load_dwordx4 a[96:99], v128, s[44:47], s23 offen offset:0 sc1
    s_waitcnt vmcnt(9)
    v_mfma_f32_16x16x32_bf16 v[4:7], v[68:71], a[60:63], v[4:7]
    ds_read_b128 v[36:39], v189 offset:1024
    v_mfma_f32_16x16x32_bf16 v[4:7], v[64:67], a[56:59], v[4:7]
    s_waitcnt lgkmcnt(6)
    v_mfma_f32_16x16x32_bf16 v[12:15], v[72:75], a[56:59], v[12:15]
    buffer_load_dwordx4 a[100:103], v128, s[44:47], s23 offen offset:1024 sc1
    v_mfma_f32_16x16x32_bf16 v[12:15], v[76:79], a[60:63], v[12:15]
    ds_read_b128 v[40:43], v189 offset:2048
    v_mfma_f32_16x16x32_bf16 v[8:11], v[76:79], a[52:55], v[8:11]
    buffer_load_dwordx4 a[104:107], v129, s[44:47], s23 offen offset:0 sc1
    v_mfma_f32_16x16x32_bf16 v[8:11], v[72:75], a[48:51], v[8:11]
    s_waitcnt lgkmcnt(5)
    v_mfma_f32_16x16x32_bf16 v[16:19], v[80:83], a[48:51], v[16:19]
    ds_read_b128 v[44:47], v189 offset:3072
    v_mfma_f32_16x16x32_bf16 v[16:19], v[84:87], a[52:55], v[16:19]
    buffer_load_dwordx4 a[108:111], v129, s[44:47], s23 offen offset:1024 sc1
    v_mfma_f32_16x16x32_bf16 v[20:23], v[84:87], a[60:63], v[20:23]
    ds_read_b128 v[48:51], v189 offset:4096
    v_mfma_f32_16x16x32_bf16 v[20:23], v[80:83], a[56:59], v[20:23]
    s_waitcnt lgkmcnt(5)
    v_mfma_f32_16x16x32_bf16 v[28:31], v[88:91], a[56:59], v[28:31]
    ds_read_b128 v[52:55], v189 offset:5120
    v_mfma_f32_16x16x32_bf16 v[28:31], v[92:95], a[60:63], v[28:31]
    ds_read_b128 v[56:59], v189 offset:6144
    v_mfma_f32_16x16x32_bf16 v[24:27], v[92:95], a[52:55], v[24:27]
    ds_read_b128 v[60:63], v189 offset:7168
    v_mfma_f32_16x16x32_bf16 v[24:27], v[88:91], a[48:51], v[24:27]
    s_waitcnt vmcnt(10) lgkmcnt(6)
    v_mfma_f32_16x16x32_bf16 v[0:3], v[32:35], a[64:67], v[0:3]
    ds_read_b128 v[64:67], v189 offset:8192
    v_mfma_f32_16x16x32_bf16 v[0:3], v[36:39], a[68:71], v[0:3]
    s_add_u32 s23, s23, 2048
    buffer_load_dwordx4 a[112:115], v128, s[44:47], s23 offen offset:0 sc1
    s_waitcnt vmcnt(9)
    v_mfma_f32_16x16x32_bf16 v[4:7], v[36:39], a[76:79], v[4:7]
    ds_read_b128 v[68:71], v189 offset:9216
    v_mfma_f32_16x16x32_bf16 v[4:7], v[32:35], a[72:75], v[4:7]
    s_waitcnt lgkmcnt(6)
    v_mfma_f32_16x16x32_bf16 v[12:15], v[40:43], a[72:75], v[12:15]
    buffer_load_dwordx4 a[116:119], v128, s[44:47], s23 offen offset:1024 sc1
    v_mfma_f32_16x16x32_bf16 v[12:15], v[44:47], a[76:79], v[12:15]
    ds_read_b128 v[72:75], v189 offset:10240
    v_mfma_f32_16x16x32_bf16 v[8:11], v[44:47], a[68:71], v[8:11]
    buffer_load_dwordx4 a[120:123], v129, s[44:47], s23 offen offset:0 sc1
    v_mfma_f32_16x16x32_bf16 v[8:11], v[40:43], a[64:67], v[8:11]
    s_waitcnt lgkmcnt(5)
    v_mfma_f32_16x16x32_bf16 v[16:19], v[48:51], a[64:67], v[16:19]
    ds_read_b128 v[76:79], v189 offset:11264
    v_mfma_f32_16x16x32_bf16 v[16:19], v[52:55], a[68:71], v[16:19]
    buffer_load_dwordx4 a[124:127], v129, s[44:47], s23 offen offset:1024 sc1
    v_mfma_f32_16x16x32_bf16 v[20:23], v[52:55], a[76:79], v[20:23]
    ds_read_b128 v[80:83], v189 offset:12288
    v_mfma_f32_16x16x32_bf16 v[20:23], v[48:51], a[72:75], v[20:23]
    s_waitcnt lgkmcnt(5)
    v_mfma_f32_16x16x32_bf16 v[28:31], v[56:59], a[72:75], v[28:31]
    ds_read_b128 v[84:87], v189 offset:13312
    v_mfma_f32_16x16x32_bf16 v[28:31], v[60:63], a[76:79], v[28:31]
    ds_read_b128 v[88:91], v189 offset:14336
    v_mfma_f32_16x16x32_bf16 v[24:27], v[60:63], a[68:71], v[24:27]
    ds_read_b128 v[92:95], v189 offset:15360
    v_mfma_f32_16x16x32_bf16 v[24:27], v[56:59], a[64:67], v[24:27]
    s_waitcnt vmcnt(10) lgkmcnt(6)
    v_mfma_f32_16x16x32_bf16 v[0:3], v[64:67], a[80:83], v[0:3]
    ds_read_b128 v[32:35], v189 offset:16384
    v_mfma_f32_16x16x32_bf16 v[0:3], v[68:71], a[84:87], v[0:3]
    s_add_u32 s23, s23, 2048
    buffer_load_dwordx4 a[128:131], v128, s[44:47], s23 offen offset:0 sc1
    s_waitcnt vmcnt(9)
    v_mfma_f32_16x16x32_bf16 v[4:7], v[68:71], a[92:95], v[4:7]
    ds_read_b128 v[36:39], v189 offset:17408
    v_mfma_f32_16x16x32_bf16 v[4:7], v[64:67], a[88:91], v[4:7]
    s_waitcnt lgkmcnt(6)
    v_mfma_f32_16x16x32_bf16 v[12:15], v[72:75], a[88:91], v[12:15]
    buffer_load_dwordx4 a[132:135], v128, s[44:47], s23 offen offset:1024 sc1
    v_mfma_f32_16x16x32_bf16 v[12:15], v[76:79], a[92:95], v[12:15]
    ds_read_b128 v[40:43], v189 offset:18432
    v_mfma_f32_16x16x32_bf16 v[8:11], v[76:79], a[84:87], v[8:11]
    buffer_load_dwordx4 a[136:139], v129, s[44:47], s23 offen offset:0 sc1
    v_mfma_f32_16x16x32_bf16 v[8:11], v[72:75], a[80:83], v[8:11]
    s_waitcnt lgkmcnt(5)
    v_mfma_f32_16x16x32_bf16 v[16:19], v[80:83], a[80:83], v[16:19]
    ds_read_b128 v[44:47], v189 offset:19456
    v_mfma_f32_16x16x32_bf16 v[16:19], v[84:87], a[84:87], v[16:19]
    buffer_load_dwordx4 a[140:143], v129, s[44:47], s23 offen offset:1024 sc1
    v_mfma_f32_16x16x32_bf16 v[20:23], v[84:87], a[92:95], v[20:23]
    ds_read_b128 v[48:51], v189 offset:20480
    v_mfma_f32_16x16x32_bf16 v[20:23], v[80:83], a[88:91], v[20:23]
    s_waitcnt lgkmcnt(5)
    v_mfma_f32_16x16x32_bf16 v[28:31], v[88:91], a[88:91], v[28:31]
    ds_read_b128 v[52:55], v189 offset:21504
    v_mfma_f32_16x16x32_bf16 v[28:31], v[92:95], a[92:95], v[28:31]
    ds_read_b128 v[56:59], v189 offset:22528
    v_mfma_f32_16x16x32_bf16 v[24:27], v[92:95], a[84:87], v[24:27]
    ds_read_b128 v[60:63], v189 offset:23552
    v_mfma_f32_16x16x32_bf16 v[24:27], v[88:91], a[80:83], v[24:27]
    s_waitcnt vmcnt(10) lgkmcnt(6)
    v_mfma_f32_16x16x32_bf16 v[0:3], v[32:35], a[96:99], v[0:3]
    ds_read_b128 v[64:67], v128 offset:0
    v_mfma_f32_16x16x32_bf16 v[0:3], v[36:39], a[100:103], v[0:3]
    s_add_u32 s23, s23, 2048
    buffer_load_dwordx4 a[144:147], v128, s[44:47], s23 offen offset:0 sc1
    s_waitcnt vmcnt(9)
    v_mfma_f32_16x16x32_bf16 v[4:7], v[36:39], a[108:111], v[4:7]
    ds_read_b128 v[68:71], v128 offset:1024
    v_mfma_f32_16x16x32_bf16 v[4:7], v[32:35], a[104:107], v[4:7]
    s_waitcnt lgkmcnt(6)
    v_mfma_f32_16x16x32_bf16 v[12:15], v[40:43], a[104:107], v[12:15]
    buffer_load_dwordx4 a[148:151], v128, s[44:47], s23 offen offset:1024 sc1
    v_mfma_f32_16x16x32_bf16 v[12:15], v[44:47], a[108:111], v[12:15]
    ds_read_b128 v[72:75], v128 offset:2048
    v_mfma_f32_16x16x32_bf16 v[8:11], v[44:47], a[100:103], v[8:11]
    buffer_load_dwordx4 a[152:155], v129, s[44:47], s23 offen offset:0 sc1
    v_mfma_f32_16x16x32_bf16 v[8:11], v[40:43], a[96:99], v[8:11]
    s_waitcnt lgkmcnt(5)
    v_mfma_f32_16x16x32_bf16 v[16:19], v[48:51], a[96:99], v[16:19]
    ds_read_b128 v[76:79], v128 offset:3072
    v_mfma_f32_16x16x32_bf16 v[16:19], v[52:55], a[100:103], v[16:19]
    buffer_load_dwordx4 a[156:159], v129, s[44:47], s23 offen offset:1024 sc1
    v_mfma_f32_16x16x32_bf16 v[20:23], v[52:55], a[108:111], v[20:23]
    ds_read_b128 v[80:83], v128 offset:4096
    v_mfma_f32_16x16x32_bf16 v[20:23], v[48:51], a[104:107], v[20:23]
    s_waitcnt lgkmcnt(5)
    v_mfma_f32_16x16x32_bf16 v[28:31], v[56:59], a[104:107], v[28:31]
    ds_read_b128 v[84:87], v128 offset:5120
    v_mfma_f32_16x16x32_bf16 v[28:31], v[60:63], a[108:111], v[28:31]
    ds_read_b128 v[88:91], v128 offset:6144
    v_mfma_f32_16x16x32_bf16 v[24:27], v[60:63], a[100:103], v[24:27]
    ds_read_b128 v[92:95], v128 offset:7168
    v_mfma_f32_16x16x32_bf16 v[24:27], v[56:59], a[96:99], v[24:27]
    s_waitcnt vmcnt(10) lgkmcnt(6)
    v_mfma_f32_16x16x32_bf16 v[0:3], v[64:67], a[112:115], v[0:3]
    ds_read_b128 v[32:35], v128 offset:8192
    v_mfma_f32_16x16x32_bf16 v[0:3], v[68:71], a[116:119], v[0:3]
    s_add_u32 s23, s23, 2048
    buffer_load_dwordx4 a[160:163], v128, s[44:47], s23 offen offset:0 sc1
    s_waitcnt vmcnt(9)
    v_mfma_f32_16x16x32_bf16 v[4:7], v[68:71], a[124:127], v[4:7]
    ds_read_b128 v[36:39], v128 offset:9216
    v_mfma_f32_16x16x32_bf16 v[4:7], v[64:67], a[120:123], v[4:7]
    s_waitcnt lgkmcnt(6)
    v_mfma_f32_16x16x32_bf16 v[12:15], v[72:75], a[120:123], v[12:15]
    buffer_load_dwordx4 a[164:167], v128, s[44:47], s23 offen offset:1024 sc1
    v_mfma_f32_16x16x32_bf16 v[12:15], v[76:79], a[124:127], v[12:15]
    ds_read_b128 v[40:43], v128 offset:10240
    v_mfma_f32_16x16x32_bf16 v[8:11], v[76:79], a[116:119], v[8:11]
    buffer_load_dwordx4 a[168:171], v129, s[44:47], s23 offen offset:0 sc1
    v_mfma_f32_16x16x32_bf16 v[8:11], v[72:75], a[112:115], v[8:11]
    s_waitcnt lgkmcnt(5)
    v_mfma_f32_16x16x32_bf16 v[16:19], v[80:83], a[112:115], v[16:19]
    ds_read_b128 v[44:47], v128 offset:11264
    v_mfma_f32_16x16x32_bf16 v[16:19], v[84:87], a[116:119], v[16:19]
    buffer_load_dwordx4 a[172:175], v129, s[44:47], s23 offen offset:1024 sc1
    v_mfma_f32_16x16x32_bf16 v[20:23], v[84:87], a[124:127], v[20:23]
    ds_read_b128 v[48:51], v128 offset:12288
    v_mfma_f32_16x16x32_bf16 v[20:23], v[80:83], a[120:123], v[20:23]
    s_waitcnt lgkmcnt(5)
    v_mfma_f32_16x16x32_bf16 v[28:31], v[88:91], a[120:123], v[28:31]
    ds_read_b128 v[52:55], v128 offset:13312
    v_mfma_f32_16x16x32_bf16 v[28:31], v[92:95], a[124:127], v[28:31]
    ds_read_b128 v[56:59], v128 offset:14336
    v_mfma_f32_16x16x32_bf16 v[24:27], v[92:95], a[116:119], v[24:27]
    ds_read_b128 v[60:63], v128 offset:15360
    v_mfma_f32_16x16x32_bf16 v[24:27], v[88:91], a[112:115], v[24:27]
    s_waitcnt vmcnt(10) lgkmcnt(6)
    v_mfma_f32_16x16x32_bf16 v[0:3], v[32:35], a[128:131], v[0:3]
    ds_read_b128 v[64:67], v128 offset:16384
    v_mfma_f32_16x16x32_bf16 v[0:3], v[36:39], a[132:135], v[0:3]
    s_add_u32 s23, s23, 2048
    buffer_load_dwordx4 a[176:179], v128, s[44:47], s23 offen offset:0 sc1
    s_waitcnt vmcnt(9)
    v_mfma_f32_16x16x32_bf16 v[4:7], v[36:39], a[140:143], v[4:7]
    ds_read_b128 v[68:71], v128 offset:17408
    v_mfma_f32_16x16x32_bf16 v[4:7], v[32:35], a[136:139], v[4:7]
    s_waitcnt lgkmcnt(6)
    v_mfma_f32_16x16x32_bf16 v[12:15], v[40:43], a[136:139], v[12:15]
    buffer_load_dwordx4 a[180:183], v128, s[44:47], s23 offen offset:1024 sc1
    v_mfma_f32_16x16x32_bf16 v[12:15], v[44:47], a[140:143], v[12:15]
    ds_read_b128 v[72:75], v128 offset:18432
    v_mfma_f32_16x16x32_bf16 v[8:11], v[44:47], a[132:135], v[8:11]
    buffer_load_dwordx4 a[184:187], v129, s[44:47], s23 offen offset:0 sc1
    v_mfma_f32_16x16x32_bf16 v[8:11], v[40:43], a[128:131], v[8:11]
    s_waitcnt lgkmcnt(5)
    v_mfma_f32_16x16x32_bf16 v[16:19], v[48:51], a[128:131], v[16:19]
    ds_read_b128 v[76:79], v128 offset:19456
    v_mfma_f32_16x16x32_bf16 v[16:19], v[52:55], a[132:135], v[16:19]
    buffer_load_dwordx4 a[188:191], v129, s[44:47], s23 offen offset:1024 sc1
    v_mfma_f32_16x16x32_bf16 v[20:23], v[52:55], a[140:143], v[20:23]
    ds_read_b128 v[80:83], v128 offset:20480
    v_mfma_f32_16x16x32_bf16 v[20:23], v[48:51], a[136:139], v[20:23]
    s_waitcnt lgkmcnt(5)
    v_mfma_f32_16x16x32_bf16 v[28:31], v[56:59], a[136:139], v[28:31]
    ds_read_b128 v[84:87], v128 offset:21504
    v_mfma_f32_16x16x32_bf16 v[28:31], v[60:63], a[140:143], v[28:31]
    ds_read_b128 v[88:91], v128 offset:22528
    v_mfma_f32_16x16x32_bf16 v[24:27], v[60:63], a[132:135], v[24:27]
    ds_read_b128 v[92:95], v128 offset:23552
    v_mfma_f32_16x16x32_bf16 v[24:27], v[56:59], a[128:131], v[24:27]
    s_barrier
    s_waitcnt vmcnt(10) lgkmcnt(6)
    v_mfma_f32_16x16x32_bf16 v[0:3], v[64:67], a[144:147], v[0:3]
    ds_read_b128 v[32:35], v128 offset:24576
    v_mfma_f32_16x16x32_bf16 v[0:3], v[68:71], a[148:151], v[0:3]
    s_add_u32 s23, s23, 2048
    buffer_load_dwordx4 a[192:195], v128, s[44:47], s23 offen offset:0 sc1
    s_waitcnt vmcnt(9)
    v_mfma_f32_16x16x32_bf16 v[4:7], v[68:71], a[156:159], v[4:7]
    ds_read_b128 v[36:39], v128 offset:25600
    v_mfma_f32_16x16x32_bf16 v[4:7], v[64:67], a[152:155], v[4:7]
    s_waitcnt lgkmcnt(6)
    v_mfma_f32_16x16x32_bf16 v[12:15], v[72:75], a[152:155], v[12:15]
    buffer_load_dwordx4 a[196:199], v128, s[44:47], s23 offen offset:1024 sc1
    v_mfma_f32_16x16x32_bf16 v[12:15], v[76:79], a[156:159], v[12:15]
    ds_read_b128 v[40:43], v128 offset:26624
    v_mfma_f32_16x16x32_bf16 v[8:11], v[76:79], a[148:151], v[8:11]
    buffer_load_dwordx4 a[200:203], v129, s[44:47], s23 offen offset:0 sc1
    v_mfma_f32_16x16x32_bf16 v[8:11], v[72:75], a[144:147], v[8:11]
    s_waitcnt lgkmcnt(5)
    v_mfma_f32_16x16x32_bf16 v[16:19], v[80:83], a[144:147], v[16:19]
    ds_read_b128 v[44:47], v128 offset:27648
    v_mfma_f32_16x16x32_bf16 v[16:19], v[84:87], a[148:151], v[16:19]
    buffer_load_dwordx4 a[204:207], v129, s[44:47], s23 offen offset:1024 sc1
    v_mfma_f32_16x16x32_bf16 v[20:23], v[84:87], a[156:159], v[20:23]
    ds_read_b128 v[48:51], v128 offset:28672
    v_mfma_f32_16x16x32_bf16 v[20:23], v[80:83], a[152:155], v[20:23]
    s_waitcnt lgkmcnt(5)
    v_mfma_f32_16x16x32_bf16 v[28:31], v[88:91], a[152:155], v[28:31]
    ds_read_b128 v[52:55], v128 offset:29696
    v_mfma_f32_16x16x32_bf16 v[28:31], v[92:95], a[156:159], v[28:31]
    ds_read_b128 v[56:59], v128 offset:30720
    v_mfma_f32_16x16x32_bf16 v[24:27], v[92:95], a[148:151], v[24:27]
    ds_read_b128 v[60:63], v128 offset:31744
    v_mfma_f32_16x16x32_bf16 v[24:27], v[88:91], a[144:147], v[24:27]
    s_waitcnt vmcnt(10) lgkmcnt(6)
    v_mfma_f32_16x16x32_bf16 v[0:3], v[32:35], a[160:163], v[0:3]
    ds_read_b128 v[64:67], v128 offset:32768
    v_mfma_f32_16x16x32_bf16 v[0:3], v[36:39], a[164:167], v[0:3]
    s_add_u32 s23, s23, 2048
    buffer_load_dwordx4 a[208:211], v128, s[44:47], s23 offen offset:0 sc1
    s_waitcnt vmcnt(9)
    v_mfma_f32_16x16x32_bf16 v[4:7], v[36:39], a[172:175], v[4:7]
    ds_read_b128 v[68:71], v128 offset:33792
    v_mfma_f32_16x16x32_bf16 v[4:7], v[32:35], a[168:171], v[4:7]
    s_waitcnt lgkmcnt(6)
    v_mfma_f32_16x16x32_bf16 v[12:15], v[40:43], a[168:171], v[12:15]
    buffer_load_dwordx4 a[212:215], v128, s[44:47], s23 offen offset:1024 sc1
    v_mfma_f32_16x16x32_bf16 v[12:15], v[44:47], a[172:175], v[12:15]
    ds_read_b128 v[72:75], v128 offset:34816
    v_mfma_f32_16x16x32_bf16 v[8:11], v[44:47], a[164:167], v[8:11]
    buffer_load_dwordx4 a[216:219], v129, s[44:47], s23 offen offset:0 sc1
    v_mfma_f32_16x16x32_bf16 v[8:11], v[40:43], a[160:163], v[8:11]
    s_waitcnt lgkmcnt(5)
    v_mfma_f32_16x16x32_bf16 v[16:19], v[48:51], a[160:163], v[16:19]
    ds_read_b128 v[76:79], v128 offset:35840
    v_mfma_f32_16x16x32_bf16 v[16:19], v[52:55], a[164:167], v[16:19]
    buffer_load_dwordx4 a[220:223], v129, s[44:47], s23 offen offset:1024 sc1
    v_mfma_f32_16x16x32_bf16 v[20:23], v[52:55], a[172:175], v[20:23]
    ds_read_b128 v[80:83], v128 offset:36864
    v_mfma_f32_16x16x32_bf16 v[20:23], v[48:51], a[168:171], v[20:23]
    s_waitcnt lgkmcnt(5)
    v_mfma_f32_16x16x32_bf16 v[28:31], v[56:59], a[168:171], v[28:31]
    ds_read_b128 v[84:87], v128 offset:37888
    v_mfma_f32_16x16x32_bf16 v[28:31], v[60:63], a[172:175], v[28:31]
    ds_read_b128 v[88:91], v128 offset:38912
    v_mfma_f32_16x16x32_bf16 v[24:27], v[60:63], a[164:167], v[24:27]
    ds_read_b128 v[92:95], v128 offset:39936
    v_mfma_f32_16x16x32_bf16 v[24:27], v[56:59], a[160:163], v[24:27]
    s_waitcnt vmcnt(10) lgkmcnt(6)
    v_mfma_f32_16x16x32_bf16 v[0:3], v[64:67], a[176:179], v[0:3]
    ds_read_b128 v[32:35], v128 offset:40960
    v_mfma_f32_16x16x32_bf16 v[0:3], v[68:71], a[180:183], v[0:3]
    s_add_u32 s23, s23, 2048
    buffer_load_dwordx4 a[224:227], v128, s[44:47], s23 offen offset:0 sc1
    s_waitcnt vmcnt(9)
    v_mfma_f32_16x16x32_bf16 v[4:7], v[68:71], a[188:191], v[4:7]
    ds_read_b128 v[36:39], v128 offset:41984
    v_mfma_f32_16x16x32_bf16 v[4:7], v[64:67], a[184:187], v[4:7]
    s_waitcnt lgkmcnt(6)
    v_mfma_f32_16x16x32_bf16 v[12:15], v[72:75], a[184:187], v[12:15]
    buffer_load_dwordx4 a[228:231], v128, s[44:47], s23 offen offset:1024 sc1
    v_mfma_f32_16x16x32_bf16 v[12:15], v[76:79], a[188:191], v[12:15]
    ds_read_b128 v[40:43], v128 offset:43008
    v_mfma_f32_16x16x32_bf16 v[8:11], v[76:79], a[180:183], v[8:11]
    buffer_load_dwordx4 a[232:235], v129, s[44:47], s23 offen offset:0 sc1
    v_mfma_f32_16x16x32_bf16 v[8:11], v[72:75], a[176:179], v[8:11]
    s_waitcnt lgkmcnt(5)
    v_mfma_f32_16x16x32_bf16 v[16:19], v[80:83], a[176:179], v[16:19]
    ds_read_b128 v[44:47], v128 offset:44032
    v_mfma_f32_16x16x32_bf16 v[16:19], v[84:87], a[180:183], v[16:19]
    buffer_load_dwordx4 a[236:239], v129, s[44:47], s23 offen offset:1024 sc1
    v_mfma_f32_16x16x32_bf16 v[20:23], v[84:87], a[188:191], v[20:23]
    ds_read_b128 v[48:51], v128 offset:45056
    v_mfma_f32_16x16x32_bf16 v[20:23], v[80:83], a[184:187], v[20:23]
    s_waitcnt lgkmcnt(5)
    v_mfma_f32_16x16x32_bf16 v[28:31], v[88:91], a[184:187], v[28:31]
    ds_read_b128 v[52:55], v128 offset:46080
    v_mfma_f32_16x16x32_bf16 v[28:31], v[92:95], a[188:191], v[28:31]
    ds_read_b128 v[56:59], v128 offset:47104
    v_mfma_f32_16x16x32_bf16 v[24:27], v[92:95], a[180:183], v[24:27]
    ds_read_b128 v[60:63], v128 offset:48128
    v_mfma_f32_16x16x32_bf16 v[24:27], v[88:91], a[176:179], v[24:27]
    s_waitcnt vmcnt(10) lgkmcnt(6)
    v_mfma_f32_16x16x32_bf16 v[0:3], v[32:35], a[192:195], v[0:3]
    ds_read_b128 v[64:67], v128 offset:49152
    v_mfma_f32_16x16x32_bf16 v[0:3], v[36:39], a[196:199], v[0:3]
    s_add_u32 s23, s23, 2048
    buffer_load_dwordx4 a[240:243], v128, s[44:47], s23 offen offset:0 sc1
    s_waitcnt vmcnt(9)
    v_mfma_f32_16x16x32_bf16 v[4:7], v[36:39], a[204:207], v[4:7]
    ds_read_b128 v[68:71], v128 offset:50176
    v_mfma_f32_16x16x32_bf16 v[4:7], v[32:35], a[200:203], v[4:7]
    s_waitcnt lgkmcnt(6)
    v_mfma_f32_16x16x32_bf16 v[12:15], v[40:43], a[200:203], v[12:15]
    buffer_load_dwordx4 a[244:247], v128, s[44:47], s23 offen offset:1024 sc1
    v_mfma_f32_16x16x32_bf16 v[12:15], v[44:47], a[204:207], v[12:15]
    ds_read_b128 v[72:75], v128 offset:51200
    v_mfma_f32_16x16x32_bf16 v[8:11], v[44:47], a[196:199], v[8:11]
    buffer_load_dwordx4 a[248:251], v129, s[44:47], s23 offen offset:0 sc1
    v_mfma_f32_16x16x32_bf16 v[8:11], v[40:43], a[192:195], v[8:11]
    s_waitcnt lgkmcnt(5)
    v_mfma_f32_16x16x32_bf16 v[16:19], v[48:51], a[192:195], v[16:19]
    ds_read_b128 v[76:79], v128 offset:52224
    v_mfma_f32_16x16x32_bf16 v[16:19], v[52:55], a[196:199], v[16:19]
    buffer_load_dwordx4 a[252:255], v129, s[44:47], s23 offen offset:1024 sc1
    v_mfma_f32_16x16x32_bf16 v[20:23], v[52:55], a[204:207], v[20:23]
    ds_read_b128 v[80:83], v128 offset:53248
    v_mfma_f32_16x16x32_bf16 v[20:23], v[48:51], a[200:203], v[20:23]
    s_waitcnt lgkmcnt(5)
    v_mfma_f32_16x16x32_bf16 v[28:31], v[56:59], a[200:203], v[28:31]
    ds_read_b128 v[84:87], v128 offset:54272
    v_mfma_f32_16x16x32_bf16 v[28:31], v[60:63], a[204:207], v[28:31]
    ds_read_b128 v[88:91], v128 offset:55296
    v_mfma_f32_16x16x32_bf16 v[24:27], v[60:63], a[196:199], v[24:27]
    ds_read_b128 v[92:95], v128 offset:56320
    v_mfma_f32_16x16x32_bf16 v[24:27], v[56:59], a[192:195], v[24:27]
    s_waitcnt vmcnt(10) lgkmcnt(6)
    v_mfma_f32_16x16x32_bf16 v[0:3], v[64:67], a[208:211], v[0:3]
    ds_read_b128 v[32:35], v128 offset:57344
    v_mfma_f32_16x16x32_bf16 v[0:3], v[68:71], a[212:215], v[0:3]
    s_waitcnt vmcnt(8)
    v_mfma_f32_16x16x32_bf16 v[4:7], v[68:71], a[220:223], v[4:7]
    ds_read_b128 v[36:39], v128 offset:58368
    v_mfma_f32_16x16x32_bf16 v[4:7], v[64:67], a[216:219], v[4:7]
    s_waitcnt lgkmcnt(6)
    v_mfma_f32_16x16x32_bf16 v[12:15], v[72:75], a[216:219], v[12:15]
    ds_read_b128 v[40:43], v128 offset:59392
    v_mfma_f32_16x16x32_bf16 v[12:15], v[76:79], a[220:223], v[12:15]
    v_mfma_f32_16x16x32_bf16 v[8:11], v[76:79], a[212:215], v[8:11]
    ds_read_b128 v[44:47], v128 offset:60416
    v_mfma_f32_16x16x32_bf16 v[8:11], v[72:75], a[208:211], v[8:11]
    s_waitcnt lgkmcnt(6)
    v_mfma_f32_16x16x32_bf16 v[16:19], v[80:83], a[208:211], v[16:19]
    ds_read_b128 v[48:51], v128 offset:61440
    v_mfma_f32_16x16x32_bf16 v[16:19], v[84:87], a[212:215], v[16:19]
    v_mfma_f32_16x16x32_bf16 v[20:23], v[84:87], a[220:223], v[20:23]
    ds_read_b128 v[52:55], v128 offset:62464
    v_mfma_f32_16x16x32_bf16 v[20:23], v[80:83], a[216:219], v[20:23]
    s_waitcnt lgkmcnt(6)
    v_mfma_f32_16x16x32_bf16 v[28:31], v[88:91], a[216:219], v[28:31]
    ds_read_b128 v[56:59], v128 offset:63488
    v_mfma_f32_16x16x32_bf16 v[28:31], v[92:95], a[220:223], v[28:31]
    v_mfma_f32_16x16x32_bf16 v[24:27], v[92:95], a[212:215], v[24:27]
    ds_read_b128 v[60:63], v128 offset:64512
    v_mfma_f32_16x16x32_bf16 v[24:27], v[88:91], a[208:211], v[24:27]
    s_lshr_b32 s12, s2, 3
    s_and_b32 s12, s12, 31
    s_lshl_b32 s12, s12, 10
    v_and_b32 v164, 7, v133
    v_lshlrev_b32 v164, 7, v164
    v_add_u32 v164, s12, v164
    s_getpc_b64 s[10:11]
    s_add_u32 s10, s10, PH_u1@rel32@lo+4
    s_addc_u32 s11, s11, PH_u1@rel32@hi+12
    v_min_u32 v165, END_PH_u1-PH_u1-4, v164
    global_load_dword v165, v165, s[10:11]
    s_waitcnt vmcnt(7) lgkmcnt(6)
    v_mfma_f32_16x16x32_bf16 v[0:3], v[32:35], a[224:227], v[0:3]
    ds_read_b128 v[64:67], v188 offset:0
    v_mfma_f32_16x16x32_bf16 v[0:3], v[36:39], a[228:231], v[0:3]
    s_waitcnt vmcnt(5)
    v_mfma_f32_16x16x32_bf16 v[4:7], v[36:39], a[236:239], v[4:7]
    ds_read_b128 v[68:71], v188 offset:1024
    v_mfma_f32_16x16x32_bf16 v[4:7], v[32:35], a[232:235], v[4:7]
    s_waitcnt lgkmcnt(6)
    v_mfma_f32_16x16x32_bf16 v[12:15], v[40:43], a[232:235], v[12:15]
    ds_read_b128 v[72:75], v188 offset:2048
    v_mfma_f32_16x16x32_bf16 v[12:15], v[44:47], a[236:239], v[12:15]
    v_mfma_f32_16x16x32_bf16 v[8:11], v[44:47], a[228:231], v[8:11]
    ds_read_b128 v[76:79], v188 offset:3072
    v_mfma_f32_16x16x32_bf16 v[8:11], v[40:43], a[224:227], v[8:11]
    s_waitcnt lgkmcnt(6)
    v_mfma_f32_16x16x32_bf16 v[16:19], v[48:51], a[224:227], v[16:19]
    ds_read_b128 v[80:83], v188 offset:4096
    v_mfma_f32_16x16x32_bf16 v[16:19], v[52:55], a[228:231], v[16:19]
    v_mfma_f32_16x16x32_bf16 v[20:23], v[52:55], a[236:239], v[20:23]
    ds_read_b128 v[84:87], v188 offset:5120
    v_mfma_f32_16x16x32_bf16 v[20:23], v[48:51], a[232:235], v[20:23]
    s_waitcnt lgkmcnt(6)
    v_mfma_f32_16x16x32_bf16 v[28:31], v[56:59], a[232:235], v[28:31]
    ds_read_b128 v[88:91], v188 offset:6144
    v_mfma_f32_16x16x32_bf16 v[28:31], v[60:63], a[236:239], v[28:31]
    v_mfma_f32_16x16x32_bf16 v[24:27], v[60:63], a[228:231], v[24:27]
    ds_read_b128 v[92:95], v188 offset:7168
    v_mfma_f32_16x16x32_bf16 v[24:27], v[56:59], a[224:227], v[24:27]
    s_waitcnt vmcnt(3) lgkmcnt(6)
    v_mfma_f32_16x16x32_bf16 v[0:3], v[64:67], a[240:243], v[0:3]
    v_mfma_f32_16x16x32_bf16 v[0:3], v[68:71], a[244:247], v[0:3]
    s_waitcnt vmcnt(1)
    v_mfma_f32_16x16x32_bf16 v[4:7], v[68:71], a[252:255], v[4:7]
    v_mfma_f32_16x16x32_bf16 v[4:7], v[64:67], a[248:251], v[4:7]
    s_waitcnt lgkmcnt(4)
    v_mfma_f32_16x16x32_bf16 v[12:15], v[72:75], a[248:251], v[12:15]
    v_mfma_f32_16x16x32_bf16 v[12:15], v[76:79], a[252:255], v[12:15]
    v_mfma_f32_16x16x32_bf16 v[8:11], v[76:79], a[244:247], v[8:11]
    v_mfma_f32_16x16x32_bf16 v[8:11], v[72:75], a[240:243], v[8:11]
    s_waitcnt lgkmcnt(2)
    v_mfma_f32_16x16x32_bf16 v[16:19], v[80:83], a[240:243], v[16:19]
    v_mfma_f32_16x16x32_bf16 v[16:19], v[84:87], a[244:247], v[16:19]
    v_mfma_f32_16x16x32_bf16 v[20:23], v[84:87], a[252:255], v[20:23]
    v_mfma_f32_16x16x32_bf16 v[20:23], v[80:83], a[248:251], v[20:23]
    s_waitcnt lgkmcnt(0)
    v_mfma_f32_16x16x32_bf16 v[28:31], v[88:91], a[248:251], v[28:31]
    v_mfma_f32_16x16x32_bf16 v[28:31], v[92:95], a[252:255], v[28:31]
    v_mfma_f32_16x16x32_bf16 v[24:27], v[92:95], a[244:247], v[24:27]
    v_mfma_f32_16x16x32_bf16 v[24:27], v[88:91], a[240:243], v[24:27]
    s_nop 7
    v_mov_b32 v214, 0
    v_mov_b32 v215, 0
    v_cvt_pk_bf16_f32 v190, v0, v1
    v_cvt_pk_bf16_f32 v191, v2, v3
    v_cvt_pk_bf16_f32 v192, v8, v9
    v_cvt_pk_bf16_f32 v193, v10, v11
    buffer_store_dwordx4 v[190:193], v128, s[44:47], s48 offen offset:0 sc1
    v_dot2_f32_bf16 v214, v190, v162, v214
    v_dot2_f32_bf16 v214, v191, v162, v214
    v_dot2_f32_bf16 v214, v192, v162, v214
    v_dot2_f32_bf16 v214, v193, v162, v214
    v_dot2_f32_bf16 v215, v190, v190, v215
    v_dot2_f32_bf16 v215, v191, v191, v215
    v_dot2_f32_bf16 v215, v192, v192, v215
    v_dot2_f32_bf16 v215, v193, v193, v215
    v_cvt_pk_bf16_f32 v194, v16, v17
    v_cvt_pk_bf16_f32 v195, v18, v19
    v_cvt_pk_bf16_f32 v196, v24, v25
    v_cvt_pk_bf16_f32 v197, v26, v27
    buffer_store_dwordx4 v[194:197], v128, s[44:47], s48 offen offset:1024 sc1
    v_dot2_f32_bf16 v214, v194, v162, v214
    v_dot2_f32_bf16 v214, v195, v162, v214
    v_dot2_f32_bf16 v214, v196, v162, v214
    v_dot2_f32_bf16 v214, v197, v162, v214
    v_dot2_f32_bf16 v215, v194, v194, v215
    v_dot2_f32_bf16 v215, v195, v195, v215
    v_dot2_f32_bf16 v215, v196, v196, v215
    v_dot2_f32_bf16 v215, v197, v197, v215
    v_mov_b32 v216, 0
    v_mov_b32 v217, 0
    v_cvt_pk_bf16_f32 v198, v4, v5
    v_cvt_pk_bf16_f32 v199, v6, v7
    v_cvt_pk_bf16_f32 v200, v12, v13
    v_cvt_pk_bf16_f32 v201, v14, v15
    buffer_store_dwordx4 v[198:201], v128, s[44:47], s49 offen offset:0 sc1
    v_dot2_f32_bf16 v216, v198, v162, v216
    v_dot2_f32_bf16 v216, v199, v162, v216
    v_dot2_f32_bf16 v216, v200, v162, v216
    v_dot2_f32_bf16 v216, v201, v162, v216
    v_dot2_f32_bf16 v217, v198, v198, v217
    v_dot2_f32_bf16 v217, v199, v199, v217
    v_dot2_f32_bf16 v217, v200, v200, v217
    v_dot2_f32_bf16 v217, v201, v201, v217
    v_cvt_pk_bf16_f32 v202, v20, v21
    v_cvt_pk_bf16_f32 v203, v22, v23
    v_cvt_pk_bf16_f32 v204, v28, v29
    v_cvt_pk_bf16_f32 v205, v30, v31
    buffer_store_dwordx4 v[202:205], v128, s[44:47], s49 offen offset:1024 sc1
    v_dot2_f32_bf16 v216, v202, v162, v216
    v_dot2_f32_bf16 v216, v203, v162, v216
    v_dot2_f32_bf16 v216, v204, v162, v216
    v_dot2_f32_bf16 v216, v205, v162, v216
    v_dot2_f32_bf16 v217, v202, v202, v217
    v_dot2_f32_bf16 v217, v203, v203, v217
    v_dot2_f32_bf16 v217, v204, v204, v217
    v_dot2_f32_bf16 v217, v205, v205, v217
    s_nop 2
    v_mov_b32 v206, v214
    v_mov_b32 v207, v215
    v_mov_b32 v208, v216
    v_mov_b32 v209, v217
    s_nop 1
    s_nop 1
    s_nop 1
    s_nop 1
    v_permlane32_swap_b32 v214, v206
    v_permlane32_swap_b32 v215, v207
    v_permlane32_swap_b32 v216, v208
    v_permlane32_swap_b32 v217, v209
    v_add_f32 v214, v214, v206
    v_add_f32 v215, v215, v207
    v_add_f32 v216, v216, v208
    v_add_f32 v217, v217, v209
    v_mov_b32 v206, v214
    v_mov_b32 v207, v215
    v_mov_b32 v208, v216
    v_mov_b32 v209, v217
    s_nop 1
    s_nop 1
    s_nop 1
    s_nop 1
    v_permlane16_swap_b32 v214, v206
    v_permlane16_swap_b32 v215, v207
    v_permlane16_swap_b32 v216, v208
    v_permlane16_swap_b32 v217, v209
    v_add_f32 v214, v214, v206
    v_add_f32 v215, v215, v207
    v_add_f32 v216, v216, v208
    v_add_f32 v217, v217, v209
    v_cmp_gt_u32 vcc, 16, v158
    s_nop 1
    v_cndmask_b32 v206, v215, v214, vcc
    v_cndmask_b32 v207, v217, v216, vcc
    v_cmp_gt_u32 vcc, 512, v128
    s_nop 1
    v_cndmask_b32 v206, v207, v206, vcc
    buffer_store_dword v206, v159, s[44:47], s52 offen sc1
    s_lshr_b32 s19, s37, 1
    s_lshl_b32 s19, s19, 7
    s_add_u32 s19, s19, 54353920
    v_min_u32 v134, 1, v133
    v_lshlrev_b32 v134, 26, v134
    v_mov_b32 v135, 1
    s_cmp_eq_u32 s34, 0
    s_cselect_b32 s18, s19, 0x7ff00000
    s_waitcnt vmcnt(0)
    s_barrier
    buffer_atomic_add v135, v134, s[44:47], s18 offen sc1
END_PH_a1:
PH_u1:
    v_mbcnt_lo_u32_b32 v232, -1, 0
    v_mbcnt_hi_u32_b32 v232, -1, v232
    s_and_b32 s35, s2, 7
    s_lshr_b32 s36, s2, 3
    s_lshr_b32 s37, s35, 2
    s_lshl_b32 s37, s37, 2
    s_lshr_b32 s38, s36, 3
    s_add_u32 s37, s37, s38
    s_and_b32 s38, s35, 3
    s_lshl_b32 s38, s38, 3
    s_and_b32 s39, s36, 7
    s_add_u32 s38, s38, s39
    s_and_b32 s53, s38, 1
    s_lshl_b32 s42, s37, 4
    s_lshl_b32 s43, s34, 2
    s_add_u32 s42, s42, s43
    v_lshrrev_b32 v233, 5, v232
    s_lshl_b32 s40, s34, 1
    s_add_u32 s40, s40, s53
    v_add_u32 v233, s40, v233
    v_subrev_u32 v235, 7, v233
    v_min_u32 v233, v233, v235
    v_lshlrev_b32 v233, 6, v233
    v_and_b32 v235, 15, v232
    v_lshl_add_u32 v233, v235, 2, v233
    v_bfe_u32 v234, v232, 4, 1
    v_mul_u32_u24 v234, 14336, v234
    v_add_u32 v237, v233, v234
    s_mul_i32 s49, s38, 448
    s_add_u32 s49, s49, 54394880
    v_lshrrev_b32 v234, 4, v232
    s_lshl_b32 s48, s42, 11
    s_add_u32 s48, s48, 53739520
    s_add_u32 s41, s48, 4096
    v_lshlrev_b32 v224, 4, v232
    v_add_u32 v225, 32768, v224
    v_add_u32 v226, 65536, v224
    v_add_u32 v227, 98304, v224
    s_mul_i32 s26, s34, 7168
    v_add_u32 v228, s26, v224
    v_add_u32 v229, 4096, v228
    s_lshl_b32 s25, s42, 15
    s_mul_i32 s24, s38, 458752
    s_add_u32 s24, s24, 31457280
    buffer_load_dword v128, v237, s[44:47], s49 offen sc1
    s_add_u32 s49, s49, 28672
    buffer_load_dword v129, v237, s[44:47], s49 offen sc1
    s_add_u32 s49, s49, 28672
    buffer_load_dword v130, v237, s[44:47], s49 offen sc1
    s_add_u32 s49, s49, 28672
    buffer_load_dword v131, v237, s[44:47], s49 offen sc1
    s_add_u32 s49, s49, 28672
    buffer_load_dword v132, v237, s[44:47], s49 offen sc1
    s_add_u32 s49, s49, 28672
    buffer_load_dword v133, v237, s[44:47], s49 offen sc1
    s_add_u32 s49, s49, 28672
    buffer_load_dword v134, v237, s[44:47], s49 offen sc1
    s_add_u32 s49, s49, 28672
    buffer_load_dword v135, v237, s[44:47], s49 offen sc1
    s_add_u32 s49, s49, 28672
    buffer_load_dword v136, v237, s[44:47], s49 offen sc1
    s_add_u32 s49, s49, 28672
    buffer_load_dword v137, v237, s[44:47], s49 offen sc1
    s_add_u32 s49, s49, 28672
    buffer_load_dword v138, v237, s[44:47], s49 offen sc1
    s_add_u32 s49, s49, 28672
    buffer_load_dword v139, v237, s[44:47], s49 offen sc1
    s_add_u32 s49, s49, 28672
    buffer_load_dword v140, v237, s[44:47], s49 offen sc1
    s_add_u32 s49, s49, 28672
    buffer_load_dword v141, v237, s[44:47], s49 offen sc1
    s_add_u32 s49, s49, 28672
    buffer_load_dword v142, v237, s[44:47], s49 offen sc1
    s_add_u32 s49, s49, 28672
    buffer_load_dword v143, v237, s[44:47], s49 offen sc1
    s_add_u32 m0, s26, 0
    s_nop 0
    buffer_load_dwordx4 v228, s[44:47], s24 offen offset:0 sc1 lds
    buffer_load_dwordx4 v228, s[44:47], s24 offen offset:1024 sc1 lds
    buffer_load_dwordx4 v228, s[44:47], s24 offen offset:2048 sc1 lds
    buffer_load_dwordx4 v228, s[44:47], s24 offen offset:3072 sc1 lds
    s_add_u32 m0, s26, 4096
    s_nop 0
    buffer_load_dwordx4 v229, s[44:47], s24 offen offset:0 sc1 lds
    buffer_load_dwordx4 v229, s[44:47], s24 offen offset:1024 sc1 lds
    buffer_load_dwordx4 v229, s[44:47], s24 offen offset:2048 sc1 lds
    s_add_u32 m0, s26, 28672
    s_add_u32 s24, s24, 28672
    buffer_load_dwordx4 v228, s[44:47], s24 offen offset:0 sc1 lds
    buffer_load_dwordx4 v228, s[44:47], s24 offen offset:1024 sc1 lds
    buffer_load_dwordx4 v228, s[44:47], s24 offen offset:2048 sc1 lds
    buffer_load_dwordx4 v228, s[44:47], s24 offen offset:3072 sc1 lds
    s_add_u32 m0, s26, 32768
    s_nop 0
    buffer_load_dwordx4 v229, s[44:47], s24 offen offset:0 sc1 lds
    buffer_load_dwordx4 v229, s[44:47], s24 offen offset:1024 sc1 lds
    buffer_load_dwordx4 v229, s[44:47], s24 offen offset:2048 sc1 lds
    s_add_u32 m0, s26, 57344
    s_add_u32 s24, s24, 28672
    buffer_load_dwordx4 v228, s[44:47], s24 offen offset:0 sc1 lds
    buffer_load_dwordx4 v228, s[44:47], s24 offen offset:1024 sc1 lds
    buffer_load_dwordx4 v228, s[44:47], s24 offen offset:2048 sc1 lds
    buffer_load_dwordx4 v228, s[44:47], s24 offen offset:3072 sc1 lds
    s_add_u32 m0, s26, 61440
    s_nop 0
    buffer_load_dwordx4 v229, s[44:47], s24 offen offset:0 sc1 lds
    buffer_load_dwordx4 v229, s[44:47], s24 offen offset:1024 sc1 lds
    buffer_load_dwordx4 v229, s[44:47], s24 offen offset:2048 sc1 lds
    s_lshl_b32 s40, s34, 8
    s_add_u32 s40, s40, 114688
    v_lshl_add_u32 v238, v232, 2, s40
    v_lshlrev_b32 v237, 4, v234
    v_add_u32 v237, 114688, v237
    v_mov_b32 v230, v224
    v_add_u32 v231, 57344, v224
    s_mul_i32 s50, s42, 114688
    s_add_u32 s50, s50, 8388608
    s_mul_i32 s55, s38, 7
    s_add_u32 s51, s55, s53
    s_lshr_b32 s51, s51, 1
    s_lshl_b32 s51, s51, 10
    s_add_u32 s51, s51, s50
    s_lshr_b32 s52, s55, 1
    s_lshl_b32 s52, s52, 10
    s_add_u32 s52, s52, s50
    s_cmp_eq_u32 s53, 0
    s_cselect_b32 s55, 3072, 8
    s_add_u32 s52, s52, s55
    s_add_u32 s56, s51, 114688
    s_add_u32 s57, s52, 114688
    s_add_u32 s58, s51, 229376
    s_add_u32 s59, s52, 229376
    s_add_u32 s60, s51, 344064
    s_add_u32 s61, s52, 344064
    s_waitcnt vmcnt(21)
    v_add_f32 v128, v128, v136
    v_add_f32 v129, v129, v137
    v_add_f32 v130, v130, v138
    v_add_f32 v131, v131, v139
    v_add_f32 v132, v132, v140
    v_add_f32 v133, v133, v141
    v_add_f32 v134, v134, v142
    v_add_f32 v135, v135, v143
    v_add_f32 v128, v128, v132
    v_add_f32 v129, v129, v133
    v_add_f32 v130, v130, v134
    v_add_f32 v131, v131, v135
    v_add_f32 v128, v128, v130
    v_add_f32 v129, v129, v131
    v_add_f32 v128, v128, v129
    ds_write_b32 v238, v128
    s_waitcnt lgkmcnt(0)
    s_barrier
    ds_read_b128 v[0:3], v237 offset:0
    ds_read_b128 v[16:19], v237 offset:64
    ds_read_b128 v[32:35], v237 offset:128
    ds_read_b128 v[48:51], v237 offset:192
    ds_read_b128 v[64:67], v237 offset:256
    ds_read_b128 v[80:83], v237 offset:320
    ds_read_b128 v[96:99], v237 offset:384
    ds_read_b128 v[112:115], v237 offset:448
    ds_read_b128 v[128:131], v237 offset:512
    ds_read_b128 v[144:147], v237 offset:576
    ds_read_b128 v[160:163], v237 offset:640
    ds_read_b128 v[176:179], v237 offset:704
    ds_read_b128 v[192:195], v237 offset:768
    ds_read_b128 v[208:211], v237 offset:832
    s_lshl_b32 s19, s37, 7
    s_add_u32 s19, s19, 54353920
    s_cmp_lg_u32 s34, 0
    s_cbranch_scc1 PEu1g
    v_mov_b32 v233, 0
    s_mov_b32 s17, 0
Pu1g:
    buffer_load_dword v235, v233, s[44:47], s19 offen sc1
    s_waitcnt vmcnt(0)
    v_readfirstlane_b32 s16, v235
    s_cmp_ge_u32 s16, 32
    s_cbranch_scc1 PEu1g
    s_sleep 4
    s_add_u32 s17, s17, 1
    s_cmp_lt_u32 s17, 0x40000
    s_cbranch_scc1 Pu1g
PEu1g:
    s_waitcnt vmcnt(0)
    s_barrier
    buffer_load_dwordx4 v[4:7], v224, s[44:47], s48 offen offset:0 sc1
    buffer_load_dwordx4 v[20:23], v224, s[44:47], s48 offen offset:1024 sc1
    buffer_load_dwordx4 v[36:39], v224, s[44:47], s48 offen offset:2048 sc1
    buffer_load_dwordx4 v[52:55], v224, s[44:47], s48 offen offset:3072 sc1
    buffer_load_dwordx4 v[68:71], v224, s[44:47], s41 offen offset:0 sc1
    buffer_load_dwordx4 v[84:87], v224, s[44:47], s41 offen offset:1024 sc1
    buffer_load_dwordx4 v[100:103], v224, s[44:47], s41 offen offset:2048 sc1
    buffer_load_dwordx4 v[116:119], v224, s[44:47], s41 offen offset:3072 sc1
    buffer_load_dwordx4 a[0:3], v224, s[44:47], s25 offen offset:0 sc1
    buffer_load_dwordx4 a[4:7], v224, s[44:47], s25 offen offset:1024 sc1
    buffer_load_dwordx4 a[8:11], v225, s[44:47], s25 offen offset:0 sc1
    buffer_load_dwordx4 a[12:15], v225, s[44:47], s25 offen offset:1024 sc1
    buffer_load_dwordx4 a[16:19], v226, s[44:47], s25 offen offset:0 sc1
    buffer_load_dwordx4 a[20:23], v226, s[44:47], s25 offen offset:1024 sc1
    buffer_load_dwordx4 a[24:27], v227, s[44:47], s25 offen offset:0 sc1
    buffer_load_dwordx4 a[28:31], v227, s[44:47], s25 offen offset:1024 sc1
    s_waitcnt vmcnt(8)
    v_add_f32 v240, v4, v20
    v_add_f32 v244, v6, v22
    v_add_f32 v248, v68, v84
    v_add_f32 v252, v70, v86
    v_add_f32 v241, v36, v52
    v_add_f32 v245, v38, v54
    v_add_f32 v249, v100, v116
    v_add_f32 v253, v102, v118
    v_add_f32 v240, v240, v241
    v_add_f32 v244, v244, v245
    v_add_f32 v248, v248, v249
    v_add_f32 v252, v252, v253
    v_mov_b32 v241, v240
    v_mov_b32 v245, v244
    v_mov_b32 v249, v248
    v_mov_b32 v253, v252
    v_permlane32_swap_b32 v240, v241
    v_permlane32_swap_b32 v244, v245
    v_permlane32_swap_b32 v248, v249
    v_permlane32_swap_b32 v252, v253
    v_add_f32 v240, v240, v241
    v_add_f32 v244, v244, v245
    v_add_f32 v248, v248, v249
    v_add_f32 v252, v252, v253
    v_mov_b32 v241, v240
    v_mov_b32 v245, v244
    v_mov_b32 v249, v248
    v_mov_b32 v253, v252
    v_permlane16_swap_b32 v240, v241
    v_permlane16_swap_b32 v244, v245
    v_permlane16_swap_b32 v248, v249
    v_permlane16_swap_b32 v252, v253
    v_add_f32 v240, v240, v241
    v_add_f32 v244, v244, v245
    v_add_f32 v248, v248, v249
    v_add_f32 v252, v252, v253
    v_mul_f32 v240, 0xba800000, v240
    v_mul_f32 v244, 0xba800000, v244
    v_mul_f32 v248, 0xba800000, v248
    v_mul_f32 v252, 0xba800000, v252
    v_cvt_pk_bf16_f32 v240, v240, v240
    v_cvt_pk_bf16_f32 v244, v244, v244
    v_cvt_pk_bf16_f32 v248, v248, v248
    v_cvt_pk_bf16_f32 v252, v252, v252
    v_and_b32 v240, 0xffff0000, v240
    v_and_b32 v244, 0xffff0000, v244
    v_and_b32 v248, 0xffff0000, v248
    v_and_b32 v252, 0xffff0000, v252
    s_waitcnt lgkmcnt(0)
    v_pk_mul_f32 v[12:13], v[0:1], v[252:253] op_sel_hi:[1,0]
    v_pk_mul_f32 v[14:15], v[2:3], v[252:253] op_sel_hi:[1,0]
    v_pk_mul_f32 v[8:9], v[0:1], v[248:249] op_sel_hi:[1,0]
    v_pk_mul_f32 v[10:11], v[2:3], v[248:249] op_sel_hi:[1,0]
    v_pk_mul_f32 v[4:5], v[0:1], v[244:245] op_sel_hi:[1,0]
    v_pk_mul_f32 v[6:7], v[2:3], v[244:245] op_sel_hi:[1,0]
    v_pk_mul_f32 v[0:1], v[0:1], v[240:241] op_sel_hi:[1,0]
    v_pk_mul_f32 v[2:3], v[2:3], v[240:241] op_sel_hi:[1,0]
    v_pk_mul_f32 v[28:29], v[16:17], v[252:253] op_sel_hi:[1,0]
    v_pk_mul_f32 v[30:31], v[18:19], v[252:253] op_sel_hi:[1,0]
    v_pk_mul_f32 v[24:25], v[16:17], v[248:249] op_sel_hi:[1,0]
    v_pk_mul_f32 v[26:27], v[18:19], v[248:249] op_sel_hi:[1,0]
    v_pk_mul_f32 v[20:21], v[16:17], v[244:245] op_sel_hi:[1,0]
    v_pk_mul_f32 v[22:23], v[18:19], v[244:245] op_sel_hi:[1,0]
    v_pk_mul_f32 v[16:17], v[16:17], v[240:241] op_sel_hi:[1,0]
    v_pk_mul_f32 v[18:19], v[18:19], v[240:241] op_sel_hi:[1,0]
    v_pk_mul_f32 v[44:45], v[32:33], v[252:253] op_sel_hi:[1,0]
    v_pk_mul_f32 v[46:47], v[34:35], v[252:253] op_sel_hi:[1,0]
    v_pk_mul_f32 v[40:41], v[32:33], v[248:249] op_sel_hi:[1,0]
    v_pk_mul_f32 v[42:43], v[34:35], v[248:249] op_sel_hi:[1,0]
    v_pk_mul_f32 v[36:37], v[32:33], v[244:245] op_sel_hi:[1,0]
    v_pk_mul_f32 v[38:39], v[34:35], v[244:245] op_sel_hi:[1,0]
    v_pk_mul_f32 v[32:33], v[32:33], v[240:241] op_sel_hi:[1,0]
    v_pk_mul_f32 v[34:35], v[34:35], v[240:241] op_sel_hi:[1,0]
    v_pk_mul_f32 v[60:61], v[48:49], v[252:253] op_sel_hi:[1,0]
    v_pk_mul_f32 v[62:63], v[50:51], v[252:253] op_sel_hi:[1,0]
    v_pk_mul_f32 v[56:57], v[48:49], v[248:249] op_sel_hi:[1,0]
    v_pk_mul_f32 v[58:59], v[50:51], v[248:249] op_sel_hi:[1,0]
    v_pk_mul_f32 v[52:53], v[48:49], v[244:245] op_sel_hi:[1,0]
    v_pk_mul_f32 v[54:55], v[50:51], v[244:245] op_sel_hi:[1,0]
    v_pk_mul_f32 v[48:49], v[48:49], v[240:241] op_sel_hi:[1,0]
    v_pk_mul_f32 v[50:51], v[50:51], v[240:241] op_sel_hi:[1,0]
    v_pk_mul_f32 v[76:77], v[64:65], v[252:253] op_sel_hi:[1,0]
    v_pk_mul_f32 v[78:79], v[66:67], v[252:253] op_sel_hi:[1,0]
    v_pk_mul_f32 v[72:73], v[64:65], v[248:249] op_sel_hi:[1,0]
    v_pk_mul_f32 v[74:75], v[66:67], v[248:249] op_sel_hi:[1,0]
    v_pk_mul_f32 v[68:69], v[64:65], v[244:245] op_sel_hi:[1,0]
    v_pk_mul_f32 v[70:71], v[66:67], v[244:245] op_sel_hi:[1,0]
    v_pk_mul_f32 v[64:65], v[64:65], v[240:241] op_sel_hi:[1,0]
    v_pk_mul_f32 v[66:67], v[66:67], v[240:241] op_sel_hi:[1,0]
    v_pk_mul_f32 v[92:93], v[80:81], v[252:253] op_sel_hi:[1,0]
    v_pk_mul_f32 v[94:95], v[82:83], v[252:253] op_sel_hi:[1,0]
    v_pk_mul_f32 v[88:89], v[80:81], v[248:249] op_sel_hi:[1,0]
    v_pk_mul_f32 v[90:91], v[82:83], v[248:249] op_sel_hi:[1,0]
    v_pk_mul_f32 v[84:85], v[80:81], v[244:245] op_sel_hi:[1,0]
    v_pk_mul_f32 v[86:87], v[82:83], v[244:245] op_sel_hi:[1,0]
    v_pk_mul_f32 v[80:81], v[80:81], v[240:241] op_sel_hi:[1,0]
    v_pk_mul_f32 v[82:83], v[82:83], v[240:241] op_sel_hi:[1,0]
    v_pk_mul_f32 v[108:109], v[96:97], v[252:253] op_sel_hi:[1,0]
    v_pk_mul_f32 v[110:111], v[98:99], v[252:253] op_sel_hi:[1,0]
    v_pk_mul_f32 v[104:105], v[96:97], v[248:249] op_sel_hi:[1,0]
    v_pk_mul_f32 v[106:107], v[98:99], v[248:249] op_sel_hi:[1,0]
    v_pk_mul_f32 v[100:101], v[96:97], v[244:245] op_sel_hi:[1,0]
    v_pk_mul_f32 v[102:103], v[98:99], v[244:245] op_sel_hi:[1,0]
    v_pk_mul_f32 v[96:97], v[96:97], v[240:241] op_sel_hi:[1,0]
    v_pk_mul_f32 v[98:99], v[98:99], v[240:241] op_sel_hi:[1,0]
    v_pk_mul_f32 v[124:125], v[112:113], v[252:253] op_sel_hi:[1,0]
    v_pk_mul_f32 v[126:127], v[114:115], v[252:253] op_sel_hi:[1,0]
    v_pk_mul_f32 v[120:121], v[112:113], v[248:249] op_sel_hi:[1,0]
    v_pk_mul_f32 v[122:123], v[114:115], v[248:249] op_sel_hi:[1,0]
    v_pk_mul_f32 v[116:117], v[112:113], v[244:245] op_sel_hi:[1,0]
    v_pk_mul_f32 v[118:119], v[114:115], v[244:245] op_sel_hi:[1,0]
    v_pk_mul_f32 v[112:113], v[112:113], v[240:241] op_sel_hi:[1,0]
    v_pk_mul_f32 v[114:115], v[114:115], v[240:241] op_sel_hi:[1,0]
    v_pk_mul_f32 v[140:141], v[128:129], v[252:253] op_sel_hi:[1,0]
    v_pk_mul_f32 v[142:143], v[130:131], v[252:253] op_sel_hi:[1,0]
    v_pk_mul_f32 v[136:137], v[128:129], v[248:249] op_sel_hi:[1,0]
    v_pk_mul_f32 v[138:139], v[130:131], v[248:249] op_sel_hi:[1,0]
    v_pk_mul_f32 v[132:133], v[128:129], v[244:245] op_sel_hi:[1,0]
    v_pk_mul_f32 v[134:135], v[130:131], v[244:245] op_sel_hi:[1,0]
    v_pk_mul_f32 v[128:129], v[128:129], v[240:241] op_sel_hi:[1,0]
    v_pk_mul_f32 v[130:131], v[130:131], v[240:241] op_sel_hi:[1,0]
    v_pk_mul_f32 v[156:157], v[144:145], v[252:253] op_sel_hi:[1,0]
    v_pk_mul_f32 v[158:159], v[146:147], v[252:253] op_sel_hi:[1,0]
    v_pk_mul_f32 v[152:153], v[144:145], v[248:249] op_sel_hi:[1,0]
    v_pk_mul_f32 v[154:155], v[146:147], v[248:249] op_sel_hi:[1,0]
    v_pk_mul_f32 v[148:149], v[144:145], v[244:245] op_sel_hi:[1,0]
    v_pk_mul_f32 v[150:151], v[146:147], v[244:245] op_sel_hi:[1,0]
    v_pk_mul_f32 v[144:145], v[144:145], v[240:241] op_sel_hi:[1,0]
    v_pk_mul_f32 v[146:147], v[146:147], v[240:241] op_sel_hi:[1,0]
    v_pk_mul_f32 v[172:173], v[160:161], v[252:253] op_sel_hi:[1,0]
    v_pk_mul_f32 v[174:175], v[162:163], v[252:253] op_sel_hi:[1,0]
    v_pk_mul_f32 v[168:169], v[160:161], v[248:249] op_sel_hi:[1,0]
    v_pk_mul_f32 v[170:171], v[162:163], v[248:249] op_sel_hi:[1,0]
    v_pk_mul_f32 v[164:165], v[160:161], v[244:245] op_sel_hi:[1,0]
    v_pk_mul_f32 v[166:167], v[162:163], v[244:245] op_sel_hi:[1,0]
    v_pk_mul_f32 v[160:161], v[160:161], v[240:241] op_sel_hi:[1,0]
    v_pk_mul_f32 v[162:163], v[162:163], v[240:241] op_sel_hi:[1,0]
    v_pk_mul_f32 v[188:189], v[176:177], v[252:253] op_sel_hi:[1,0]
    v_pk_mul_f32 v[190:191], v[178:179], v[252:253] op_sel_hi:[1,0]
    v_pk_mul_f32 v[184:185], v[176:177], v[248:249] op_sel_hi:[1,0]
    v_pk_mul_f32 v[186:187], v[178:179], v[248:249] op_sel_hi:[1,0]
    v_pk_mul_f32 v[180:181], v[176:177], v[244:245] op_sel_hi:[1,0]
    v_pk_mul_f32 v[182:183], v[178:179], v[244:245] op_sel_hi:[1,0]
    v_pk_mul_f32 v[176:177], v[176:177], v[240:241] op_sel_hi:[1,0]
    v_pk_mul_f32 v[178:179], v[178:179], v[240:241] op_sel_hi:[1,0]
    v_pk_mul_f32 v[204:205], v[192:193], v[252:253] op_sel_hi:[1,0]
    v_pk_mul_f32 v[206:207], v[194:195], v[252:253] op_sel_hi:[1,0]
    v_pk_mul_f32 v[200:201], v[192:193], v[248:249] op_sel_hi:[1,0]
    v_pk_mul_f32 v[202:203], v[194:195], v[248:249] op_sel_hi:[1,0]
    v_pk_mul_f32 v[196:197], v[192:193], v[244:245] op_sel_hi:[1,0]
    v_pk_mul_f32 v[198:199], v[194:195], v[244:245] op_sel_hi:[1,0]
    v_pk_mul_f32 v[192:193], v[192:193], v[240:241] op_sel_hi:[1,0]
    v_pk_mul_f32 v[194:195], v[194:195], v[240:241] op_sel_hi:[1,0]
    v_pk_mul_f32 v[220:221], v[208:209], v[252:253] op_sel_hi:[1,0]
    v_pk_mul_f32 v[222:223], v[210:211], v[252:253] op_sel_hi:[1,0]
    v_pk_mul_f32 v[216:217], v[208:209], v[248:249] op_sel_hi:[1,0]
    v_pk_mul_f32 v[218:219], v[210:211], v[248:249] op_sel_hi:[1,0]
    v_pk_mul_f32 v[212:213], v[208:209], v[244:245] op_sel_hi:[1,0]
    v_pk_mul_f32 v[214:215], v[210:211], v[244:245] op_sel_hi:[1,0]
    v_pk_mul_f32 v[208:209], v[208:209], v[240:241] op_sel_hi:[1,0]
    v_pk_mul_f32 v[210:211], v[210:211], v[240:241] op_sel_hi:[1,0]
    s_waitcnt vmcnt(22)
    s_barrier
    ds_read_b128 a[128:131], v230 offset:0
    ds_read_b128 a[132:135], v230 offset:1024
    ds_read_b128 a[136:139], v230 offset:2048
    ds_read_b128 a[140:143], v230 offset:3072
    ds_read_b128 a[144:147], v230 offset:4096
    ds_read_b128 a[148:151], v230 offset:5120
    ds_read_b128 a[152:155], v230 offset:6144
    ds_read_b128 a[156:159], v230 offset:7168
    s_waitcnt vmcnt(6) lgkmcnt(6)
    v_mfma_f32_16x16x32_bf16 v[0:3], a[128:131], a[0:3], v[0:3]
    s_add_u32 s25, s25, 2048
    buffer_load_dwordx4 a[32:35], v224, s[44:47], s25 offen offset:0 sc1
    v_mfma_f32_16x16x32_bf16 v[0:3], a[132:135], a[4:7], v[0:3]
    s_waitcnt vmcnt(5)
    v_mfma_f32_16x16x32_bf16 v[4:7], a[132:135], a[12:15], v[4:7]
    v_mfma_f32_16x16x32_bf16 v[4:7], a[128:131], a[8:11], v[4:7]
    s_waitcnt vmcnt(3)
    v_mfma_f32_16x16x32_bf16 v[8:11], a[128:131], a[16:19], v[8:11]
    buffer_load_dwordx4 a[36:39], v224, s[44:47], s25 offen offset:1024 sc1
    v_mfma_f32_16x16x32_bf16 v[8:11], a[132:135], a[20:23], v[8:11]
    s_waitcnt vmcnt(2)
    v_mfma_f32_16x16x32_bf16 v[12:15], a[132:135], a[28:31], v[12:15]
    v_mfma_f32_16x16x32_bf16 v[12:15], a[128:131], a[24:27], v[12:15]
    ds_read_b128 a[128:131], v230 offset:8192
    s_waitcnt lgkmcnt(5)
    v_mfma_f32_16x16x32_bf16 v[28:31], a[136:139], a[24:27], v[28:31]
    buffer_load_dwordx4 a[40:43], v225, s[44:47], s25 offen offset:0 sc1
    v_mfma_f32_16x16x32_bf16 v[28:31], a[140:143], a[28:31], v[28:31]
    ds_read_b128 a[132:135], v230 offset:9216
    v_mfma_f32_16x16x32_bf16 v[24:27], a[140:143], a[20:23], v[24:27]
    v_mfma_f32_16x16x32_bf16 v[24:27], a[136:139], a[16:19], v[24:27]
    v_mfma_f32_16x16x32_bf16 v[20:23], a[136:139], a[8:11], v[20:23]
    buffer_load_dwordx4 a[44:47], v225, s[44:47], s25 offen offset:1024 sc1
    v_mfma_f32_16x16x32_bf16 v[20:23], a[140:143], a[12:15], v[20:23]
    v_mfma_f32_16x16x32_bf16 v[16:19], a[140:143], a[4:7], v[16:19]
    v_mfma_f32_16x16x32_bf16 v[16:19], a[136:139], a[0:3], v[16:19]
    ds_read_b128 a[136:139], v230 offset:10240
    s_waitcnt lgkmcnt(5)
    v_mfma_f32_16x16x32_bf16 v[32:35], a[144:147], a[0:3], v[32:35]
    buffer_load_dwordx4 a[48:51], v226, s[44:47], s25 offen offset:0 sc1
    v_mfma_f32_16x16x32_bf16 v[32:35], a[148:151], a[4:7], v[32:35]
    ds_read_b128 a[140:143], v230 offset:11264
    v_mfma_f32_16x16x32_bf16 v[36:39], a[148:151], a[12:15], v[36:39]
    v_mfma_f32_16x16x32_bf16 v[36:39], a[144:147], a[8:11], v[36:39]
    v_mfma_f32_16x16x32_bf16 v[40:43], a[144:147], a[16:19], v[40:43]
    buffer_load_dwordx4 a[52:55], v226, s[44:47], s25 offen offset:1024 sc1
    v_mfma_f32_16x16x32_bf16 v[40:43], a[148:151], a[20:23], v[40:43]
    v_mfma_f32_16x16x32_bf16 v[44:47], a[148:151], a[28:31], v[44:47]
    v_mfma_f32_16x16x32_bf16 v[44:47], a[144:147], a[24:27], v[44:47]
    ds_read_b128 a[144:147], v230 offset:12288
    s_waitcnt lgkmcnt(5)
    v_mfma_f32_16x16x32_bf16 v[60:63], a[152:155], a[24:27], v[60:63]
    buffer_load_dwordx4 a[56:59], v227, s[44:47], s25 offen offset:0 sc1
    v_mfma_f32_16x16x32_bf16 v[60:63], a[156:159], a[28:31], v[60:63]
    ds_read_b128 a[148:151], v230 offset:13312
    v_mfma_f32_16x16x32_bf16 v[56:59], a[156:159], a[20:23], v[56:59]
    v_mfma_f32_16x16x32_bf16 v[56:59], a[152:155], a[16:19], v[56:59]
    v_mfma_f32_16x16x32_bf16 v[52:55], a[152:155], a[8:11], v[52:55]
    buffer_load_dwordx4 a[60:63], v227, s[44:47], s25 offen offset:1024 sc1
    v_mfma_f32_16x16x32_bf16 v[52:55], a[156:159], a[12:15], v[52:55]
    v_mfma_f32_16x16x32_bf16 v[48:51], a[156:159], a[4:7], v[48:51]
    v_mfma_f32_16x16x32_bf16 v[48:51], a[152:155], a[0:3], v[48:51]
    ds_read_b128 a[152:155], v230 offset:14336
    s_waitcnt lgkmcnt(5)
    v_mfma_f32_16x16x32_bf16 v[64:67], a[128:131], a[0:3], v[64:67]
    s_add_u32 s25, s25, 2048
    buffer_load_dwordx4 a[64:67], v224, s[44:47], s25 offen offset:0 sc1
    v_mfma_f32_16x16x32_bf16 v[64:67], a[132:135], a[4:7], v[64:67]
    ds_read_b128 a[156:159], v230 offset:15360
    v_mfma_f32_16x16x32_bf16 v[68:71], a[132:135], a[12:15], v[68:71]
    v_mfma_f32_16x16x32_bf16 v[68:71], a[128:131], a[8:11], v[68:71]
    v_mfma_f32_16x16x32_bf16 v[72:75], a[128:131], a[16:19], v[72:75]
    buffer_load_dwordx4 a[68:71], v224, s[44:47], s25 offen offset:1024 sc1
    v_mfma_f32_16x16x32_bf16 v[72:75], a[132:135], a[20:23], v[72:75]
    v_mfma_f32_16x16x32_bf16 v[76:79], a[132:135], a[28:31], v[76:79]
    v_mfma_f32_16x16x32_bf16 v[76:79], a[128:131], a[24:27], v[76:79]
    ds_read_b128 a[128:131], v230 offset:16384
    s_waitcnt lgkmcnt(5)
    v_mfma_f32_16x16x32_bf16 v[92:95], a[136:139], a[24:27], v[92:95]
    buffer_load_dwordx4 a[72:75], v225, s[44:47], s25 offen offset:0 sc1
    v_mfma_f32_16x16x32_bf16 v[92:95], a[140:143], a[28:31], v[92:95]
    ds_read_b128 a[132:135], v230 offset:17408
    v_mfma_f32_16x16x32_bf16 v[88:91], a[140:143], a[20:23], v[88:91]
    v_mfma_f32_16x16x32_bf16 v[88:91], a[136:139], a[16:19], v[88:91]
    v_mfma_f32_16x16x32_bf16 v[84:87], a[136:139], a[8:11], v[84:87]
    buffer_load_dwordx4 a[76:79], v225, s[44:47], s25 offen offset:1024 sc1
    v_mfma_f32_16x16x32_bf16 v[84:87], a[140:143], a[12:15], v[84:87]
    v_mfma_f32_16x16x32_bf16 v[80:83], a[140:143], a[4:7], v[80:83]
    v_mfma_f32_16x16x32_bf16 v[80:83], a[136:139], a[0:3], v[80:83]
    ds_read_b128 a[136:139], v230 offset:18432
    s_waitcnt lgkmcnt(5)
    v_mfma_f32_16x16x32_bf16 v[96:99], a[144:147], a[0:3], v[96:99]
    buffer_load_dwordx4 a[80:83], v226, s[44:47], s25 offen offset:0 sc1
    v_mfma_f32_16x16x32_bf16 v[96:99], a[148:151], a[4:7], v[96:99]
    ds_read_b128 a[140:143], v230 offset:19456
    v_mfma_f32_16x16x32_bf16 v[100:103], a[148:151], a[12:15], v[100:103]
    v_mfma_f32_16x16x32_bf16 v[100:103], a[144:147], a[8:11], v[100:103]
    v_mfma_f32_16x16x32_bf16 v[104:107], a[144:147], a[16:19], v[104:107]
    buffer_load_dwordx4 a[84:87], v226, s[44:47], s25 offen offset:1024 sc1
    v_mfma_f32_16x16x32_bf16 v[104:107], a[148:151], a[20:23], v[104:107]
    v_mfma_f32_16x16x32_bf16 v[108:111], a[148:151], a[28:31], v[108:111]
    v_mfma_f32_16x16x32_bf16 v[108:111], a[144:147], a[24:27], v[108:111]
    ds_read_b128 a[144:147], v230 offset:20480
    s_waitcnt lgkmcnt(5)
    v_mfma_f32_16x16x32_bf16 v[124:127], a[152:155], a[24:27], v[124:127]
    buffer_load_dwordx4 a[88:91], v227, s[44:47], s25 offen offset:0 sc1
    v_mfma_f32_16x16x32_bf16 v[124:127], a[156:159], a[28:31], v[124:127]
    ds_read_b128 a[148:151], v230 offset:21504
    v_mfma_f32_16x16x32_bf16 v[120:123], a[156:159], a[20:23], v[120:123]
    v_mfma_f32_16x16x32_bf16 v[120:123], a[152:155], a[16:19], v[120:123]
    v_mfma_f32_16x16x32_bf16 v[116:119], a[152:155], a[8:11], v[116:119]
    buffer_load_dwordx4 a[92:95], v227, s[44:47], s25 offen offset:1024 sc1
    v_mfma_f32_16x16x32_bf16 v[116:119], a[156:159], a[12:15], v[116:119]
    v_mfma_f32_16x16x32_bf16 v[112:115], a[156:159], a[4:7], v[112:115]
    v_mfma_f32_16x16x32_bf16 v[112:115], a[152:155], a[0:3], v[112:115]
    ds_read_b128 a[152:155], v230 offset:22528
    s_waitcnt lgkmcnt(5)
    v_mfma_f32_16x16x32_bf16 v[128:131], a[128:131], a[0:3], v[128:131]
    s_add_u32 s25, s25, 2048
    buffer_load_dwordx4 a[96:99], v224, s[44:47], s25 offen offset:0 sc1
    v_mfma_f32_16x16x32_bf16 v[128:131], a[132:135], a[4:7], v[128:131]
    ds_read_b128 a[156:159], v230 offset:23552
    v_mfma_f32_16x16x32_bf16 v[132:135], a[132:135], a[12:15], v[132:135]
    v_mfma_f32_16x16x32_bf16 v[132:135], a[128:131], a[8:11], v[132:135]
    v_mfma_f32_16x16x32_bf16 v[136:139], a[128:131], a[16:19], v[136:139]
    buffer_load_dwordx4 a[100:103], v224, s[44:47], s25 offen offset:1024 sc1
    v_mfma_f32_16x16x32_bf16 v[136:139], a[132:135], a[20:23], v[136:139]
    v_mfma_f32_16x16x32_bf16 v[140:143], a[132:135], a[28:31], v[140:143]
    v_mfma_f32_16x16x32_bf16 v[140:143], a[128:131], a[24:27], v[140:143]
    ds_read_b128 a[128:131], v230 offset:24576
    s_waitcnt lgkmcnt(5)
    v_mfma_f32_16x16x32_bf16 v[156:159], a[136:139], a[24:27], v[156:159]
    buffer_load_dwordx4 a[104:107], v225, s[44:47], s25 offen offset:0 sc1
    v_mfma_f32_16x16x32_bf16 v[156:159], a[140:143], a[28:31], v[156:159]
    ds_read_b128 a[132:135], v230 offset:25600
    v_mfma_f32_16x16x32_bf16 v[152:155], a[140:143], a[20:23], v[152:155]
    v_mfma_f32_16x16x32_bf16 v[152:155], a[136:139], a[16:19], v[152:155]
    v_mfma_f32_16x16x32_bf16 v[148:151], a[136:139], a[8:11], v[148:151]
    buffer_load_dwordx4 a[108:111], v225, s[44:47], s25 offen offset:1024 sc1
    v_mfma_f32_16x16x32_bf16 v[148:151], a[140:143], a[12:15], v[148:151]
    v_mfma_f32_16x16x32_bf16 v[144:147], a[140:143], a[4:7], v[144:147]
    v_mfma_f32_16x16x32_bf16 v[144:147], a[136:139], a[0:3], v[144:147]
    ds_read_b128 a[136:139], v230 offset:26624
    s_waitcnt lgkmcnt(5)
    v_mfma_f32_16x16x32_bf16 v[160:163], a[144:147], a[0:3], v[160:163]
    buffer_load_dwordx4 a[112:115], v226, s[44:47], s25 offen offset:0 sc1
    v_mfma_f32_16x16x32_bf16 v[160:163], a[148:151], a[4:7], v[160:163]
    ds_read_b128 a[140:143], v230 offset:27648
    v_mfma_f32_16x16x32_bf16 v[164:167], a[148:151], a[12:15], v[164:167]
    v_mfma_f32_16x16x32_bf16 v[164:167], a[144:147], a[8:11], v[164:167]
    v_mfma_f32_16x16x32_bf16 v[168:171], a[144:147], a[16:19], v[168:171]
    buffer_load_dwordx4 a[116:119], v226, s[44:47], s25 offen offset:1024 sc1
    v_mfma_f32_16x16x32_bf16 v[168:171], a[148:151], a[20:23], v[168:171]
    v_mfma_f32_16x16x32_bf16 v[172:175], a[148:151], a[28:31], v[172:175]
    s_barrier
    v_mfma_f32_16x16x32_bf16 v[172:175], a[144:147], a[24:27], v[172:175]
    ds_read_b128 a[144:147], v230 offset:28672
    s_waitcnt lgkmcnt(5)
    v_mfma_f32_16x16x32_bf16 v[188:191], a[152:155], a[24:27], v[188:191]
    s_add_u32 m0, s26, 86016
    s_add_u32 s24, s24, 28672
    buffer_load_dwordx4 v228, s[44:47], s24 offen offset:0 sc1 lds
    v_mfma_f32_16x16x32_bf16 v[188:191], a[156:159], a[28:31], v[188:191]
    ds_read_b128 a[148:151], v230 offset:29696
    v_mfma_f32_16x16x32_bf16 v[184:187], a[156:159], a[20:23], v[184:187]
    v_mfma_f32_16x16x32_bf16 v[184:187], a[152:155], a[16:19], v[184:187]
    v_mfma_f32_16x16x32_bf16 v[180:183], a[152:155], a[8:11], v[180:183]
    buffer_load_dwordx4 a[120:123], v227, s[44:47], s25 offen offset:0 sc1
    v_mfma_f32_16x16x32_bf16 v[180:183], a[156:159], a[12:15], v[180:183]
    v_mfma_f32_16x16x32_bf16 v[176:179], a[156:159], a[4:7], v[176:179]
    v_mfma_f32_16x16x32_bf16 v[176:179], a[152:155], a[0:3], v[176:179]
    ds_read_b128 a[152:155], v230 offset:30720
    s_waitcnt lgkmcnt(5)
    v_mfma_f32_16x16x32_bf16 v[192:195], a[128:131], a[0:3], v[192:195]
    ds_read_b128 a[156:159], v230 offset:31744
    v_mfma_f32_16x16x32_bf16 v[192:195], a[132:135], a[4:7], v[192:195]
    v_mfma_f32_16x16x32_bf16 v[196:199], a[132:135], a[12:15], v[196:199]
    v_mfma_f32_16x16x32_bf16 v[196:199], a[128:131], a[8:11], v[196:199]
    v_mfma_f32_16x16x32_bf16 v[200:203], a[128:131], a[16:19], v[200:203]
    v_mfma_f32_16x16x32_bf16 v[200:203], a[132:135], a[20:23], v[200:203]
    v_mfma_f32_16x16x32_bf16 v[204:207], a[132:135], a[28:31], v[204:207]
    buffer_load_dwordx4 v228, s[44:47], s24 offen offset:1024 sc1 lds
    v_mfma_f32_16x16x32_bf16 v[204:207], a[128:131], a[24:27], v[204:207]
    ds_read_b128 a[128:131], v230 offset:32768
    s_waitcnt lgkmcnt(5)
    v_mfma_f32_16x16x32_bf16 v[220:223], a[136:139], a[24:27], v[220:223]
    ds_read_b128 a[132:135], v230 offset:33792
    v_mfma_f32_16x16x32_bf16 v[220:223], a[140:143], a[28:31], v[220:223]
    v_mfma_f32_16x16x32_bf16 v[216:219], a[140:143], a[20:23], v[216:219]
    buffer_load_dwordx4 a[124:127], v227, s[44:47], s25 offen offset:1024 sc1
    v_mfma_f32_16x16x32_bf16 v[216:219], a[136:139], a[16:19], v[216:219]
    v_mfma_f32_16x16x32_bf16 v[212:215], a[136:139], a[8:11], v[212:215]
    v_mfma_f32_16x16x32_bf16 v[212:215], a[140:143], a[12:15], v[212:215]
    v_mfma_f32_16x16x32_bf16 v[208:211], a[140:143], a[4:7], v[208:211]
    v_mfma_f32_16x16x32_bf16 v[208:211], a[136:139], a[0:3], v[208:211]
    ds_read_b128 a[136:139], v230 offset:34816
    ds_read_b128 a[140:143], v230 offset:35840
    s_waitcnt vmcnt(24) lgkmcnt(6)
    v_mfma_f32_16x16x32_bf16 v[0:3], a[144:147], a[32:35], v[0:3]
    v_mfma_f32_16x16x32_bf16 v[0:3], a[148:151], a[36:39], v[0:3]
    s_waitcnt vmcnt(22)
    v_mfma_f32_16x16x32_bf16 v[4:7], a[148:151], a[44:47], v[4:7]
    v_mfma_f32_16x16x32_bf16 v[4:7], a[144:147], a[40:43], v[4:7]
    s_waitcnt vmcnt(20)
    v_mfma_f32_16x16x32_bf16 v[8:11], a[144:147], a[48:51], v[8:11]
    buffer_load_dwordx4 v228, s[44:47], s24 offen offset:2048 sc1 lds
    v_mfma_f32_16x16x32_bf16 v[8:11], a[148:151], a[52:55], v[8:11]
    s_waitcnt vmcnt(19)
    v_mfma_f32_16x16x32_bf16 v[12:15], a[148:151], a[60:63], v[12:15]
    v_mfma_f32_16x16x32_bf16 v[12:15], a[144:147], a[56:59], v[12:15]
    ds_read_b128 a[144:147], v230 offset:36864
    s_waitcnt lgkmcnt(5)
    v_mfma_f32_16x16x32_bf16 v[28:31], a[152:155], a[56:59], v[28:31]
    s_add_u32 s25, s25, 2048
    buffer_load_dwordx4 a[0:3], v224, s[44:47], s25 offen offset:0 sc1
    v_mfma_f32_16x16x32_bf16 v[28:31], a[156:159], a[60:63], v[28:31]
    ds_read_b128 a[148:151], v230 offset:37888
    v_mfma_f32_16x16x32_bf16 v[24:27], a[156:159], a[52:55], v[24:27]
    v_mfma_f32_16x16x32_bf16 v[24:27], a[152:155], a[48:51], v[24:27]
    v_mfma_f32_16x16x32_bf16 v[20:23], a[152:155], a[40:43], v[20:23]
    v_mfma_f32_16x16x32_bf16 v[20:23], a[156:159], a[44:47], v[20:23]
    v_mfma_f32_16x16x32_bf16 v[16:19], a[156:159], a[36:39], v[16:19]
    v_mfma_f32_16x16x32_bf16 v[16:19], a[152:155], a[32:35], v[16:19]
    ds_read_b128 a[152:155], v230 offset:38912
    s_waitcnt lgkmcnt(5)
    v_mfma_f32_16x16x32_bf16 v[32:35], a[128:131], a[32:35], v[32:35]
    ds_read_b128 a[156:159], v230 offset:39936
    v_mfma_f32_16x16x32_bf16 v[32:35], a[132:135], a[36:39], v[32:35]
    v_mfma_f32_16x16x32_bf16 v[36:39], a[132:135], a[44:47], v[36:39]
    buffer_load_dwordx4 v228, s[44:47], s24 offen offset:3072 sc1 lds
    v_mfma_f32_16x16x32_bf16 v[36:39], a[128:131], a[40:43], v[36:39]
    v_mfma_f32_16x16x32_bf16 v[40:43], a[128:131], a[48:51], v[40:43]
    v_mfma_f32_16x16x32_bf16 v[40:43], a[132:135], a[52:55], v[40:43]
    v_mfma_f32_16x16x32_bf16 v[44:47], a[132:135], a[60:63], v[44:47]
    buffer_load_dwordx4 a[4:7], v224, s[44:47], s25 offen offset:1024 sc1
    v_mfma_f32_16x16x32_bf16 v[44:47], a[128:131], a[56:59], v[44:47]
    ds_read_b128 a[128:131], v230 offset:40960
    s_waitcnt lgkmcnt(5)
    v_mfma_f32_16x16x32_bf16 v[60:63], a[136:139], a[56:59], v[60:63]
    ds_read_b128 a[132:135], v230 offset:41984
    v_mfma_f32_16x16x32_bf16 v[60:63], a[140:143], a[60:63], v[60:63]
    v_mfma_f32_16x16x32_bf16 v[56:59], a[140:143], a[52:55], v[56:59]
    v_mfma_f32_16x16x32_bf16 v[56:59], a[136:139], a[48:51], v[56:59]
    v_mfma_f32_16x16x32_bf16 v[52:55], a[136:139], a[40:43], v[52:55]
    v_mfma_f32_16x16x32_bf16 v[52:55], a[140:143], a[44:47], v[52:55]
    v_mfma_f32_16x16x32_bf16 v[48:51], a[140:143], a[36:39], v[48:51]
    v_mfma_f32_16x16x32_bf16 v[48:51], a[136:139], a[32:35], v[48:51]
    ds_read_b128 a[136:139], v230 offset:43008
    s_waitcnt lgkmcnt(5)
    v_mfma_f32_16x16x32_bf16 v[64:67], a[144:147], a[32:35], v[64:67]
    ds_read_b128 a[140:143], v230 offset:44032
    v_mfma_f32_16x16x32_bf16 v[64:67], a[148:151], a[36:39], v[64:67]
    s_add_u32 m0, s26, 90112
    s_nop 0
    buffer_load_dwordx4 v229, s[44:47], s24 offen offset:0 sc1 lds
    v_mfma_f32_16x16x32_bf16 v[68:71], a[148:151], a[44:47], v[68:71]
    v_mfma_f32_16x16x32_bf16 v[68:71], a[144:147], a[40:43], v[68:71]
    v_mfma_f32_16x16x32_bf16 v[72:75], a[144:147], a[48:51], v[72:75]
    v_mfma_f32_16x16x32_bf16 v[72:75], a[148:151], a[52:55], v[72:75]
    buffer_load_dwordx4 a[8:11], v225, s[44:47], s25 offen offset:0 sc1
    v_mfma_f32_16x16x32_bf16 v[76:79], a[148:151], a[60:63], v[76:79]
    v_mfma_f32_16x16x32_bf16 v[76:79], a[144:147], a[56:59], v[76:79]
    ds_read_b128 a[144:147], v230 offset:45056
    s_waitcnt lgkmcnt(5)
    v_mfma_f32_16x16x32_bf16 v[92:95], a[152:155], a[56:59], v[92:95]
    ds_read_b128 a[148:151], v230 offset:46080
    v_mfma_f32_16x16x32_bf16 v[92:95], a[156:159], a[60:63], v[92:95]
    v_mfma_f32_16x16x32_bf16 v[88:91], a[156:159], a[52:55], v[88:91]
    v_mfma_f32_16x16x32_bf16 v[88:91], a[152:155], a[48:51], v[88:91]
    v_mfma_f32_16x16x32_bf16 v[84:87], a[152:155], a[40:43], v[84:87]
    v_mfma_f32_16x16x32_bf16 v[84:87], a[156:159], a[44:47], v[84:87]
    v_mfma_f32_16x16x32_bf16 v[80:83], a[156:159], a[36:39], v[80:83]
    v_mfma_f32_16x16x32_bf16 v[80:83], a[152:155], a[32:35], v[80:83]
    ds_read_b128 a[152:155], v230 offset:47104
    s_waitcnt lgkmcnt(5)
    v_mfma_f32_16x16x32_bf16 v[96:99], a[128:131], a[32:35], v[96:99]
    buffer_load_dwordx4 v229, s[44:47], s24 offen offset:1024 sc1 lds
    v_mfma_f32_16x16x32_bf16 v[96:99], a[132:135], a[36:39], v[96:99]
    ds_read_b128 a[156:159], v230 offset:48128
    v_mfma_f32_16x16x32_bf16 v[100:103], a[132:135], a[44:47], v[100:103]
    v_mfma_f32_16x16x32_bf16 v[100:103], a[128:131], a[40:43], v[100:103]
    v_mfma_f32_16x16x32_bf16 v[104:107], a[128:131], a[48:51], v[104:107]
    buffer_load_dwordx4 a[12:15], v225, s[44:47], s25 offen offset:1024 sc1
    v_mfma_f32_16x16x32_bf16 v[104:107], a[132:135], a[52:55], v[104:107]
    v_mfma_f32_16x16x32_bf16 v[108:111], a[132:135], a[60:63], v[108:111]
    v_mfma_f32_16x16x32_bf16 v[108:111], a[128:131], a[56:59], v[108:111]
    ds_read_b128 a[128:131], v230 offset:49152
    s_waitcnt lgkmcnt(5)
    v_mfma_f32_16x16x32_bf16 v[124:127], a[136:139], a[56:59], v[124:127]
    ds_read_b128 a[132:135], v230 offset:50176
    v_mfma_f32_16x16x32_bf16 v[124:127], a[140:143], a[60:63], v[124:127]
    v_mfma_f32_16x16x32_bf16 v[120:123], a[140:143], a[52:55], v[120:123]
    v_mfma_f32_16x16x32_bf16 v[120:123], a[136:139], a[48:51], v[120:123]
    v_mfma_f32_16x16x32_bf16 v[116:119], a[136:139], a[40:43], v[116:119]
    v_mfma_f32_16x16x32_bf16 v[116:119], a[140:143], a[44:47], v[116:119]
    buffer_load_dwordx4 v229, s[44:47], s24 offen offset:2048 sc1 lds
    v_mfma_f32_16x16x32_bf16 v[112:115], a[140:143], a[36:39], v[112:115]
    v_mfma_f32_16x16x32_bf16 v[112:115], a[136:139], a[32:35], v[112:115]
    ds_read_b128 a[136:139], v230 offset:51200
    s_waitcnt lgkmcnt(5)
    v_mfma_f32_16x16x32_bf16 v[128:131], a[144:147], a[32:35], v[128:131]
    ds_read_b128 a[140:143], v230 offset:52224
    v_mfma_f32_16x16x32_bf16 v[128:131], a[148:151], a[36:39], v[128:131]
    buffer_load_dwordx4 a[16:19], v226, s[44:47], s25 offen offset:0 sc1
    v_mfma_f32_16x16x32_bf16 v[132:135], a[148:151], a[44:47], v[132:135]
    v_mfma_f32_16x16x32_bf16 v[132:135], a[144:147], a[40:43], v[132:135]
    v_mfma_f32_16x16x32_bf16 v[136:139], a[144:147], a[48:51], v[136:139]
    v_mfma_f32_16x16x32_bf16 v[136:139], a[148:151], a[52:55], v[136:139]
    v_mfma_f32_16x16x32_bf16 v[140:143], a[148:151], a[60:63], v[140:143]
    v_mfma_f32_16x16x32_bf16 v[140:143], a[144:147], a[56:59], v[140:143]
    ds_read_b128 a[144:147], v230 offset:53248
    s_waitcnt lgkmcnt(5)
    v_mfma_f32_16x16x32_bf16 v[156:159], a[152:155], a[56:59], v[156:159]
    ds_read_b128 a[148:151], v230 offset:54272
    v_mfma_f32_16x16x32_bf16 v[156:159], a[156:159], a[60:63], v[156:159]
    v_mfma_f32_16x16x32_bf16 v[152:155], a[156:159], a[52:55], v[152:155]
    v_mfma_f32_16x16x32_bf16 v[152:155], a[152:155], a[48:51], v[152:155]
    v_mfma_f32_16x16x32_bf16 v[148:151], a[152:155], a[40:43], v[148:151]
    v_mfma_f32_16x16x32_bf16 v[148:151], a[156:159], a[44:47], v[148:151]
    buffer_load_dwordx4 a[20:23], v226, s[44:47], s25 offen offset:1024 sc1
    v_mfma_f32_16x16x32_bf16 v[144:147], a[156:159], a[36:39], v[144:147]
    v_mfma_f32_16x16x32_bf16 v[144:147], a[152:155], a[32:35], v[144:147]
    ds_read_b128 a[152:155], v230 offset:55296
    s_waitcnt lgkmcnt(5)
    v_mfma_f32_16x16x32_bf16 v[160:163], a[128:131], a[32:35], v[160:163]
    ds_read_b128 a[156:159], v230 offset:56320
    v_mfma_f32_16x16x32_bf16 v[160:163], a[132:135], a[36:39], v[160:163]
    v_mfma_f32_16x16x32_bf16 v[164:167], a[132:135], a[44:47], v[164:167]
    v_mfma_f32_16x16x32_bf16 v[164:167], a[128:131], a[40:43], v[164:167]
    v_mfma_f32_16x16x32_bf16 v[168:171], a[128:131], a[48:51], v[168:171]
    v_mfma_f32_16x16x32_bf16 v[168:171], a[132:135], a[52:55], v[168:171]
    v_mfma_f32_16x16x32_bf16 v[172:175], a[132:135], a[60:63], v[172:175]
    s_barrier
    v_mfma_f32_16x16x32_bf16 v[172:175], a[128:131], a[56:59], v[172:175]
    ds_read_b128 a[128:131], v231 offset:0
    s_waitcnt lgkmcnt(5)
    v_mfma_f32_16x16x32_bf16 v[188:191], a[136:139], a[56:59], v[188:191]
    s_add_u32 m0, s26, 0
    s_add_u32 s24, s24, 28672
    buffer_load_dwordx4 v228, s[44:47], s24 offen offset:0 sc1 lds
    v_mfma_f32_16x16x32_bf16 v[188:191], a[140:143], a[60:63], v[188:191]
    ds_read_b128 a[132:135], v231 offset:1024
    v_mfma_f32_16x16x32_bf16 v[184:187], a[140:143], a[52:55], v[184:187]
    v_mfma_f32_16x16x32_bf16 v[184:187], a[136:139], a[48:51], v[184:187]
    v_mfma_f32_16x16x32_bf16 v[180:183], a[136:139], a[40:43], v[180:183]
    buffer_load_dwordx4 a[24:27], v227, s[44:47], s25 offen offset:0 sc1
    v_mfma_f32_16x16x32_bf16 v[180:183], a[140:143], a[44:47], v[180:183]
    v_mfma_f32_16x16x32_bf16 v[176:179], a[140:143], a[36:39], v[176:179]
    v_mfma_f32_16x16x32_bf16 v[176:179], a[136:139], a[32:35], v[176:179]
    ds_read_b128 a[136:139], v231 offset:2048
    s_waitcnt lgkmcnt(5)
    v_mfma_f32_16x16x32_bf16 v[192:195], a[144:147], a[32:35], v[192:195]
    ds_read_b128 a[140:143], v231 offset:3072
    v_mfma_f32_16x16x32_bf16 v[192:195], a[148:151], a[36:39], v[192:195]
    v_mfma_f32_16x16x32_bf16 v[196:199], a[148:151], a[44:47], v[196:199]
    v_mfma_f32_16x16x32_bf16 v[196:199], a[144:147], a[40:43], v[196:199]
    v_mfma_f32_16x16x32_bf16 v[200:203], a[144:147], a[48:51], v[200:203]
    v_mfma_f32_16x16x32_bf16 v[200:203], a[148:151], a[52:55], v[200:203]
    v_mfma_f32_16x16x32_bf16 v[204:207], a[148:151], a[60:63], v[204:207]
    buffer_load_dwordx4 v228, s[44:47], s24 offen offset:1024 sc1 lds
    v_mfma_f32_16x16x32_bf16 v[204:207], a[144:147], a[56:59], v[204:207]
    ds_read_b128 a[144:147], v231 offset:4096
    s_waitcnt lgkmcnt(5)
    v_mfma_f32_16x16x32_bf16 v[220:223], a[152:155], a[56:59], v[220:223]
    ds_read_b128 a[148:151], v231 offset:5120
    v_mfma_f32_16x16x32_bf16 v[220:223], a[156:159], a[60:63], v[220:223]
    v_mfma_f32_16x16x32_bf16 v[216:219], a[156:159], a[52:55], v[216:219]
    buffer_load_dwordx4 a[28:31], v227, s[44:47], s25 offen offset:1024 sc1
    v_mfma_f32_16x16x32_bf16 v[216:219], a[152:155], a[48:51], v[216:219]
    v_mfma_f32_16x16x32_bf16 v[212:215], a[152:155], a[40:43], v[212:215]
    v_mfma_f32_16x16x32_bf16 v[212:215], a[156:159], a[44:47], v[212:215]
    v_mfma_f32_16x16x32_bf16 v[208:211], a[156:159], a[36:39], v[208:211]
    v_mfma_f32_16x16x32_bf16 v[208:211], a[152:155], a[32:35], v[208:211]
    ds_read_b128 a[152:155], v231 offset:6144
    ds_read_b128 a[156:159], v231 offset:7168
    s_waitcnt vmcnt(25) lgkmcnt(6)
    v_mfma_f32_16x16x32_bf16 v[0:3], a[128:131], a[64:67], v[0:3]
    v_mfma_f32_16x16x32_bf16 v[0:3], a[132:135], a[68:71], v[0:3]
    v_mfma_f32_16x16x32_bf16 v[4:7], a[132:135], a[76:79], v[4:7]
    v_mfma_f32_16x16x32_bf16 v[4:7], a[128:131], a[72:75], v[4:7]
    v_mfma_f32_16x16x32_bf16 v[8:11], a[128:131], a[80:83], v[8:11]
    buffer_load_dwordx4 v228, s[44:47], s24 offen offset:2048 sc1 lds
    v_mfma_f32_16x16x32_bf16 v[8:11], a[132:135], a[84:87], v[8:11]
    v_mfma_f32_16x16x32_bf16 v[12:15], a[132:135], a[92:95], v[12:15]
    v_mfma_f32_16x16x32_bf16 v[12:15], a[128:131], a[88:91], v[12:15]
    ds_read_b128 a[128:131], v231 offset:8192
    s_waitcnt lgkmcnt(5)
    v_mfma_f32_16x16x32_bf16 v[28:31], a[136:139], a[88:91], v[28:31]
    s_add_u32 s25, s25, 2048
    buffer_load_dwordx4 a[32:35], v224, s[44:47], s25 offen offset:0 sc1
    v_mfma_f32_16x16x32_bf16 v[28:31], a[140:143], a[92:95], v[28:31]
    ds_read_b128 a[132:135], v231 offset:9216
    v_mfma_f32_16x16x32_bf16 v[24:27], a[140:143], a[84:87], v[24:27]
    v_mfma_f32_16x16x32_bf16 v[24:27], a[136:139], a[80:83], v[24:27]
    v_mfma_f32_16x16x32_bf16 v[20:23], a[136:139], a[72:75], v[20:23]
    v_mfma_f32_16x16x32_bf16 v[20:23], a[140:143], a[76:79], v[20:23]
    v_mfma_f32_16x16x32_bf16 v[16:19], a[140:143], a[68:71], v[16:19]
    v_mfma_f32_16x16x32_bf16 v[16:19], a[136:139], a[64:67], v[16:19]
    ds_read_b128 a[136:139], v231 offset:10240
    s_waitcnt lgkmcnt(5)
    v_mfma_f32_16x16x32_bf16 v[32:35], a[144:147], a[64:67], v[32:35]
    ds_read_b128 a[140:143], v231 offset:11264
    v_mfma_f32_16x16x32_bf16 v[32:35], a[148:151], a[68:71], v[32:35]
    v_mfma_f32_16x16x32_bf16 v[36:39], a[148:151], a[76:79], v[36:39]
    buffer_load_dwordx4 v228, s[44:47], s24 offen offset:3072 sc1 lds
    v_mfma_f32_16x16x32_bf16 v[36:39], a[144:147], a[72:75], v[36:39]
    v_mfma_f32_16x16x32_bf16 v[40:43], a[144:147], a[80:83], v[40:43]
    v_mfma_f32_16x16x32_bf16 v[40:43], a[148:151], a[84:87], v[40:43]
    v_mfma_f32_16x16x32_bf16 v[44:47], a[148:151], a[92:95], v[44:47]
    buffer_load_dwordx4 a[36:39], v224, s[44:47], s25 offen offset:1024 sc1
    v_mfma_f32_16x16x32_bf16 v[44:47], a[144:147], a[88:91], v[44:47]
    ds_read_b128 a[144:147], v231 offset:12288
    s_waitcnt lgkmcnt(5)
    v_mfma_f32_16x16x32_bf16 v[60:63], a[152:155], a[88:91], v[60:63]
    ds_read_b128 a[148:151], v231 offset:13312
    v_mfma_f32_16x16x32_bf16 v[60:63], a[156:159], a[92:95], v[60:63]
    v_mfma_f32_16x16x32_bf16 v[56:59], a[156:159], a[84:87], v[56:59]
    v_mfma_f32_16x16x32_bf16 v[56:59], a[152:155], a[80:83], v[56:59]
    v_mfma_f32_16x16x32_bf16 v[52:55], a[152:155], a[72:75], v[52:55]
    v_mfma_f32_16x16x32_bf16 v[52:55], a[156:159], a[76:79], v[52:55]
    v_mfma_f32_16x16x32_bf16 v[48:51], a[156:159], a[68:71], v[48:51]
    v_mfma_f32_16x16x32_bf16 v[48:51], a[152:155], a[64:67], v[48:51]
    ds_read_b128 a[152:155], v231 offset:14336
    s_waitcnt lgkmcnt(5)
    v_mfma_f32_16x16x32_bf16 v[64:67], a[128:131], a[64:67], v[64:67]
    ds_read_b128 a[156:159], v231 offset:15360
    v_mfma_f32_16x16x32_bf16 v[64:67], a[132:135], a[68:71], v[64:67]
    s_add_u32 m0, s26, 4096
    s_nop 0
    buffer_load_dwordx4 v229, s[44:47], s24 offen offset:0 sc1 lds
    v_mfma_f32_16x16x32_bf16 v[68:71], a[132:135], a[76:79], v[68:71]
    v_mfma_f32_16x16x32_bf16 v[68:71], a[128:131], a[72:75], v[68:71]
    v_mfma_f32_16x16x32_bf16 v[72:75], a[128:131], a[80:83], v[72:75]
    v_mfma_f32_16x16x32_bf16 v[72:75], a[132:135], a[84:87], v[72:75]
    buffer_load_dwordx4 a[40:43], v225, s[44:47], s25 offen offset:0 sc1
    v_mfma_f32_16x16x32_bf16 v[76:79], a[132:135], a[92:95], v[76:79]
    v_mfma_f32_16x16x32_bf16 v[76:79], a[128:131], a[88:91], v[76:79]
    ds_read_b128 a[128:131], v231 offset:16384
    s_waitcnt lgkmcnt(5)
    v_mfma_f32_16x16x32_bf16 v[92:95], a[136:139], a[88:91], v[92:95]
    ds_read_b128 a[132:135], v231 offset:17408
    v_mfma_f32_16x16x32_bf16 v[92:95], a[140:143], a[92:95], v[92:95]
    v_mfma_f32_16x16x32_bf16 v[88:91], a[140:143], a[84:87], v[88:91]
    v_mfma_f32_16x16x32_bf16 v[88:91], a[136:139], a[80:83], v[88:91]
    v_mfma_f32_16x16x32_bf16 v[84:87], a[136:139], a[72:75], v[84:87]
    v_mfma_f32_16x16x32_bf16 v[84:87], a[140:143], a[76:79], v[84:87]
    v_mfma_f32_16x16x32_bf16 v[80:83], a[140:143], a[68:71], v[80:83]
    v_mfma_f32_16x16x32_bf16 v[80:83], a[136:139], a[64:67], v[80:83]
    ds_read_b128 a[136:139], v231 offset:18432
    s_waitcnt lgkmcnt(5)
    v_mfma_f32_16x16x32_bf16 v[96:99], a[144:147], a[64:67], v[96:99]
    buffer_load_dwordx4 v229, s[44:47], s24 offen offset:1024 sc1 lds
    v_mfma_f32_16x16x32_bf16 v[96:99], a[148:151], a[68:71], v[96:99]
    ds_read_b128 a[140:143], v231 offset:19456
    v_mfma_f32_16x16x32_bf16 v[100:103], a[148:151], a[76:79], v[100:103]
    v_mfma_f32_16x16x32_bf16 v[100:103], a[144:147], a[72:75], v[100:103]
    v_mfma_f32_16x16x32_bf16 v[104:107], a[144:147], a[80:83], v[104:107]
    buffer_load_dwordx4 a[44:47], v225, s[44:47], s25 offen offset:1024 sc1
    v_mfma_f32_16x16x32_bf16 v[104:107], a[148:151], a[84:87], v[104:107]
    v_mfma_f32_16x16x32_bf16 v[108:111], a[148:151], a[92:95], v[108:111]
    v_mfma_f32_16x16x32_bf16 v[108:111], a[144:147], a[88:91], v[108:111]
    ds_read_b128 a[144:147], v231 offset:20480
    s_waitcnt lgkmcnt(5)
    v_mfma_f32_16x16x32_bf16 v[124:127], a[152:155], a[88:91], v[124:127]
    ds_read_b128 a[148:151], v231 offset:21504
    v_mfma_f32_16x16x32_bf16 v[124:127], a[156:159], a[92:95], v[124:127]
    v_mfma_f32_16x16x32_bf16 v[120:123], a[156:159], a[84:87], v[120:123]
    v_mfma_f32_16x16x32_bf16 v[120:123], a[152:155], a[80:83], v[120:123]
    v_mfma_f32_16x16x32_bf16 v[116:119], a[152:155], a[72:75], v[116:119]
    v_mfma_f32_16x16x32_bf16 v[116:119], a[156:159], a[76:79], v[116:119]
    buffer_load_dwordx4 v229, s[44:47], s24 offen offset:2048 sc1 lds
    v_mfma_f32_16x16x32_bf16 v[112:115], a[156:159], a[68:71], v[112:115]
    v_mfma_f32_16x16x32_bf16 v[112:115], a[152:155], a[64:67], v[112:115]
    ds_read_b128 a[152:155], v231 offset:22528
    s_waitcnt lgkmcnt(5)
    v_mfma_f32_16x16x32_bf16 v[128:131], a[128:131], a[64:67], v[128:131]
    ds_read_b128 a[156:159], v231 offset:23552
    v_mfma_f32_16x16x32_bf16 v[128:131], a[132:135], a[68:71], v[128:131]
    buffer_load_dwordx4 a[48:51], v226, s[44:47], s25 offen offset:0 sc1
    v_mfma_f32_16x16x32_bf16 v[132:135], a[132:135], a[76:79], v[132:135]
    v_mfma_f32_16x16x32_bf16 v[132:135], a[128:131], a[72:75], v[132:135]
    v_mfma_f32_16x16x32_bf16 v[136:139], a[128:131], a[80:83], v[136:139]
    v_mfma_f32_16x16x32_bf16 v[136:139], a[132:135], a[84:87], v[136:139]
    v_mfma_f32_16x16x32_bf16 v[140:143], a[132:135], a[92:95], v[140:143]
    v_mfma_f32_16x16x32_bf16 v[140:143], a[128:131], a[88:91], v[140:143]
    ds_read_b128 a[128:131], v231 offset:24576
    s_waitcnt lgkmcnt(5)
    v_mfma_f32_16x16x32_bf16 v[156:159], a[136:139], a[88:91], v[156:159]
    ds_read_b128 a[132:135], v231 offset:25600
    v_mfma_f32_16x16x32_bf16 v[156:159], a[140:143], a[92:95], v[156:159]
    v_mfma_f32_16x16x32_bf16 v[152:155], a[140:143], a[84:87], v[152:155]
    v_mfma_f32_16x16x32_bf16 v[152:155], a[136:139], a[80:83], v[152:155]
    v_mfma_f32_16x16x32_bf16 v[148:151], a[136:139], a[72:75], v[148:151]
    v_mfma_f32_16x16x32_bf16 v[148:151], a[140:143], a[76:79], v[148:151]
    buffer_load_dwordx4 a[52:55], v226, s[44:47], s25 offen offset:1024 sc1
    v_mfma_f32_16x16x32_bf16 v[144:147], a[140:143], a[68:71], v[144:147]
    v_mfma_f32_16x16x32_bf16 v[144:147], a[136:139], a[64:67], v[144:147]
    ds_read_b128 a[136:139], v231 offset:26624
    s_waitcnt lgkmcnt(5)
    v_mfma_f32_16x16x32_bf16 v[160:163], a[144:147], a[64:67], v[160:163]
    ds_read_b128 a[140:143], v231 offset:27648
    v_mfma_f32_16x16x32_bf16 v[160:163], a[148:151], a[68:71], v[160:163]
    v_mfma_f32_16x16x32_bf16 v[164:167], a[148:151], a[76:79], v[164:167]
    v_mfma_f32_16x16x32_bf16 v[164:167], a[144:147], a[72:75], v[164:167]
    v_mfma_f32_16x16x32_bf16 v[168:171], a[144:147], a[80:83], v[168:171]
    v_mfma_f32_16x16x32_bf16 v[168:171], a[148:151], a[84:87], v[168:171]
    v_mfma_f32_16x16x32_bf16 v[172:175], a[148:151], a[92:95], v[172:175]
    s_waitcnt vmcnt(17)
    s_barrier
    v_mfma_f32_16x16x32_bf16 v[172:175], a[144:147], a[88:91], v[172:175]
    ds_read_b128 a[144:147], v231 offset:28672
    s_waitcnt lgkmcnt(5)
    v_mfma_f32_16x16x32_bf16 v[188:191], a[152:155], a[88:91], v[188:191]
    s_add_u32 m0, s26, 28672
    s_add_u32 s24, s24, 28672
    buffer_load_dwordx4 v228, s[44:47], s24 offen offset:0 sc1 lds
    v_mfma_f32_16x16x32_bf16 v[188:191], a[156:159], a[92:95], v[188:191]
    ds_read_b128 a[148:151], v231 offset:29696
    v_mfma_f32_16x16x32_bf16 v[184:187], a[156:159], a[84:87], v[184:187]
    v_mfma_f32_16x16x32_bf16 v[184:187], a[152:155], a[80:83], v[184:187]
    v_mfma_f32_16x16x32_bf16 v[180:183], a[152:155], a[72:75], v[180:183]
    buffer_load_dwordx4 a[56:59], v227, s[44:47], s25 offen offset:0 sc1
    v_mfma_f32_16x16x32_bf16 v[180:183], a[156:159], a[76:79], v[180:183]
    v_mfma_f32_16x16x32_bf16 v[176:179], a[156:159], a[68:71], v[176:179]
    v_mfma_f32_16x16x32_bf16 v[176:179], a[152:155], a[64:67], v[176:179]
    ds_read_b128 a[152:155], v231 offset:30720
    s_waitcnt lgkmcnt(5)
    v_mfma_f32_16x16x32_bf16 v[192:195], a[128:131], a[64:67], v[192:195]
    ds_read_b128 a[156:159], v231 offset:31744
    v_mfma_f32_16x16x32_bf16 v[192:195], a[132:135], a[68:71], v[192:195]
    v_mfma_f32_16x16x32_bf16 v[196:199], a[132:135], a[76:79], v[196:199]
    v_mfma_f32_16x16x32_bf16 v[196:199], a[128:131], a[72:75], v[196:199]
    v_mfma_f32_16x16x32_bf16 v[200:203], a[128:131], a[80:83], v[200:203]
    v_mfma_f32_16x16x32_bf16 v[200:203], a[132:135], a[84:87], v[200:203]
    v_mfma_f32_16x16x32_bf16 v[204:207], a[132:135], a[92:95], v[204:207]
    buffer_load_dwordx4 v228, s[44:47], s24 offen offset:1024 sc1 lds
    v_mfma_f32_16x16x32_bf16 v[204:207], a[128:131], a[88:91], v[204:207]
    ds_read_b128 a[128:131], v231 offset:32768
    s_waitcnt lgkmcnt(5)
    v_mfma_f32_16x16x32_bf16 v[220:223], a[136:139], a[88:91], v[220:223]
    ds_read_b128 a[132:135], v231 offset:33792
    v_mfma_f32_16x16x32_bf16 v[220:223], a[140:143], a[92:95], v[220:223]
    v_mfma_f32_16x16x32_bf16 v[216:219], a[140:143], a[84:87], v[216:219]
    buffer_load_dwordx4 a[60:63], v227, s[44:47], s25 offen offset:1024 sc1
    v_mfma_f32_16x16x32_bf16 v[216:219], a[136:139], a[80:83], v[216:219]
    v_mfma_f32_16x16x32_bf16 v[212:215], a[136:139], a[72:75], v[212:215]
    v_mfma_f32_16x16x32_bf16 v[212:215], a[140:143], a[76:79], v[212:215]
    v_mfma_f32_16x16x32_bf16 v[208:211], a[140:143], a[68:71], v[208:211]
    v_mfma_f32_16x16x32_bf16 v[208:211], a[136:139], a[64:67], v[208:211]
    ds_read_b128 a[136:139], v231 offset:34816
    ds_read_b128 a[140:143], v231 offset:35840
    s_waitcnt lgkmcnt(6)
    v_mfma_f32_16x16x32_bf16 v[0:3], a[144:147], a[96:99], v[0:3]
    v_mfma_f32_16x16x32_bf16 v[0:3], a[148:151], a[100:103], v[0:3]
    v_mfma_f32_16x16x32_bf16 v[4:7], a[148:151], a[108:111], v[4:7]
    v_mfma_f32_16x16x32_bf16 v[4:7], a[144:147], a[104:107], v[4:7]
    v_mfma_f32_16x16x32_bf16 v[8:11], a[144:147], a[112:115], v[8:11]
    buffer_load_dwordx4 v228, s[44:47], s24 offen offset:2048 sc1 lds
    v_mfma_f32_16x16x32_bf16 v[8:11], a[148:151], a[116:119], v[8:11]
    v_mfma_f32_16x16x32_bf16 v[12:15], a[148:151], a[124:127], v[12:15]
    v_mfma_f32_16x16x32_bf16 v[12:15], a[144:147], a[120:123], v[12:15]
    ds_read_b128 a[144:147], v231 offset:36864
    s_waitcnt lgkmcnt(5)
    v_mfma_f32_16x16x32_bf16 v[28:31], a[152:155], a[120:123], v[28:31]
    s_add_u32 s25, s25, 2048
    buffer_load_dwordx4 a[64:67], v224, s[44:47], s25 offen offset:0 sc1
    v_mfma_f32_16x16x32_bf16 v[28:31], a[156:159], a[124:127], v[28:31]
    ds_read_b128 a[148:151], v231 offset:37888
    v_mfma_f32_16x16x32_bf16 v[24:27], a[156:159], a[116:119], v[24:27]
    v_mfma_f32_16x16x32_bf16 v[24:27], a[152:155], a[112:115], v[24:27]
    v_mfma_f32_16x16x32_bf16 v[20:23], a[152:155], a[104:107], v[20:23]
    v_mfma_f32_16x16x32_bf16 v[20:23], a[156:159], a[108:111], v[20:23]
    v_mfma_f32_16x16x32_bf16 v[16:19], a[156:159], a[100:103], v[16:19]
    v_mfma_f32_16x16x32_bf16 v[16:19], a[152:155], a[96:99], v[16:19]
    ds_read_b128 a[152:155], v231 offset:38912
    s_waitcnt lgkmcnt(5)
    v_mfma_f32_16x16x32_bf16 v[32:35], a[128:131], a[96:99], v[32:35]
    ds_read_b128 a[156:159], v231 offset:39936
    v_mfma_f32_16x16x32_bf16 v[32:35], a[132:135], a[100:103], v[32:35]
    v_mfma_f32_16x16x32_bf16 v[36:39], a[132:135], a[108:111], v[36:39]
    buffer_load_dwordx4 v228, s[44:47], s24 offen offset:3072 sc1 lds
    v_mfma_f32_16x16x32_bf16 v[36:39], a[128:131], a[104:107], v[36:39]
    v_mfma_f32_16x16x32_bf16 v[40:43], a[128:131], a[112:115], v[40:43]
    v_mfma_f32_16x16x32_bf16 v[40:43], a[132:135], a[116:119], v[40:43]
    v_mfma_f32_16x16x32_bf16 v[44:47], a[132:135], a[124:127], v[44:47]
    buffer_load_dwordx4 a[68:71], v224, s[44:47], s25 offen offset:1024 sc1
    v_mfma_f32_16x16x32_bf16 v[44:47], a[128:131], a[120:123], v[44:47]
    ds_read_b128 a[128:131], v231 offset:40960
    s_waitcnt lgkmcnt(5)
    v_mfma_f32_16x16x32_bf16 v[60:63], a[136:139], a[120:123], v[60:63]
    ds_read_b128 a[132:135], v231 offset:41984
    v_mfma_f32_16x16x32_bf16 v[60:63], a[140:143], a[124:127], v[60:63]
    v_mfma_f32_16x16x32_bf16 v[56:59], a[140:143], a[116:119], v[56:59]
    v_mfma_f32_16x16x32_bf16 v[56:59], a[136:139], a[112:115], v[56:59]
    v_mfma_f32_16x16x32_bf16 v[52:55], a[136:139], a[104:107], v[52:55]
    v_mfma_f32_16x16x32_bf16 v[52:55], a[140:143], a[108:111], v[52:55]
    v_mfma_f32_16x16x32_bf16 v[48:51], a[140:143], a[100:103], v[48:51]
    v_mfma_f32_16x16x32_bf16 v[48:51], a[136:139], a[96:99], v[48:51]
    ds_read_b128 a[136:139], v231 offset:43008
    s_waitcnt lgkmcnt(5)
    v_mfma_f32_16x16x32_bf16 v[64:67], a[144:147], a[96:99], v[64:67]
    ds_read_b128 a[140:143], v231 offset:44032
    v_mfma_f32_16x16x32_bf16 v[64:67], a[148:151], a[100:103], v[64:67]
    s_add_u32 m0, s26, 32768
    s_nop 0
    buffer_load_dwordx4 v229, s[44:47], s24 offen offset:0 sc1 lds
    v_mfma_f32_16x16x32_bf16 v[68:71], a[148:151], a[108:111], v[68:71]
    v_mfma_f32_16x16x32_bf16 v[68:71], a[144:147], a[104:107], v[68:71]
    v_mfma_f32_16x16x32_bf16 v[72:75], a[144:147], a[112:115], v[72:75]
    v_mfma_f32_16x16x32_bf16 v[72:75], a[148:151], a[116:119], v[72:75]
    buffer_load_dwordx4 a[72:75], v225, s[44:47], s25 offen offset:0 sc1
    v_mfma_f32_16x16x32_bf16 v[76:79], a[148:151], a[124:127], v[76:79]
    v_mfma_f32_16x16x32_bf16 v[76:79], a[144:147], a[120:123], v[76:79]
    ds_read_b128 a[144:147], v231 offset:45056
    s_waitcnt lgkmcnt(5)
    v_mfma_f32_16x16x32_bf16 v[92:95], a[152:155], a[120:123], v[92:95]
    ds_read_b128 a[148:151], v231 offset:46080
    v_mfma_f32_16x16x32_bf16 v[92:95], a[156:159], a[124:127], v[92:95]
    v_mfma_f32_16x16x32_bf16 v[88:91], a[156:159], a[116:119], v[88:91]
    v_mfma_f32_16x16x32_bf16 v[88:91], a[152:155], a[112:115], v[88:91]
    v_mfma_f32_16x16x32_bf16 v[84:87], a[152:155], a[104:107], v[84:87]
    v_mfma_f32_16x16x32_bf16 v[84:87], a[156:159], a[108:111], v[84:87]
    v_mfma_f32_16x16x32_bf16 v[80:83], a[156:159], a[100:103], v[80:83]
    v_mfma_f32_16x16x32_bf16 v[80:83], a[152:155], a[96:99], v[80:83]
    ds_read_b128 a[152:155], v231 offset:47104
    s_waitcnt lgkmcnt(5)
    v_mfma_f32_16x16x32_bf16 v[96:99], a[128:131], a[96:99], v[96:99]
    buffer_load_dwordx4 v229, s[44:47], s24 offen offset:1024 sc1 lds
    v_mfma_f32_16x16x32_bf16 v[96:99], a[132:135], a[100:103], v[96:99]
    ds_read_b128 a[156:159], v231 offset:48128
    v_mfma_f32_16x16x32_bf16 v[100:103], a[132:135], a[108:111], v[100:103]
    v_mfma_f32_16x16x32_bf16 v[100:103], a[128:131], a[104:107], v[100:103]
    v_mfma_f32_16x16x32_bf16 v[104:107], a[128:131], a[112:115], v[104:107]
    buffer_load_dwordx4 a[76:79], v225, s[44:47], s25 offen offset:1024 sc1
    v_mfma_f32_16x16x32_bf16 v[104:107], a[132:135], a[116:119], v[104:107]
    v_mfma_f32_16x16x32_bf16 v[108:111], a[132:135], a[124:127], v[108:111]
    v_mfma_f32_16x16x32_bf16 v[108:111], a[128:131], a[120:123], v[108:111]
    ds_read_b128 a[128:131], v231 offset:49152
    s_waitcnt lgkmcnt(5)
    v_mfma_f32_16x16x32_bf16 v[124:127], a[136:139], a[120:123], v[124:127]
    ds_read_b128 a[132:135], v231 offset:50176
    v_mfma_f32_16x16x32_bf16 v[124:127], a[140:143], a[124:127], v[124:127]
    v_mfma_f32_16x16x32_bf16 v[120:123], a[140:143], a[116:119], v[120:123]
    v_mfma_f32_16x16x32_bf16 v[120:123], a[136:139], a[112:115], v[120:123]
    v_mfma_f32_16x16x32_bf16 v[116:119], a[136:139], a[104:107], v[116:119]
    v_mfma_f32_16x16x32_bf16 v[116:119], a[140:143], a[108:111], v[116:119]
    buffer_load_dwordx4 v229, s[44:47], s24 offen offset:2048 sc1 lds
    v_mfma_f32_16x16x32_bf16 v[112:115], a[140:143], a[100:103], v[112:115]
    v_mfma_f32_16x16x32_bf16 v[112:115], a[136:139], a[96:99], v[112:115]
    ds_read_b128 a[136:139], v231 offset:51200
    s_waitcnt lgkmcnt(5)
    v_mfma_f32_16x16x32_bf16 v[128:131], a[144:147], a[96:99], v[128:131]
    ds_read_b128 a[140:143], v231 offset:52224
    v_mfma_f32_16x16x32_bf16 v[128:131], a[148:151], a[100:103], v[128:131]
    buffer_load_dwordx4 a[80:83], v226, s[44:47], s25 offen offset:0 sc1
    v_mfma_f32_16x16x32_bf16 v[132:135], a[148:151], a[108:111], v[132:135]
    v_mfma_f32_16x16x32_bf16 v[132:135], a[144:147], a[104:107], v[132:135]
    v_mfma_f32_16x16x32_bf16 v[136:139], a[144:147], a[112:115], v[136:139]
    v_mfma_f32_16x16x32_bf16 v[136:139], a[148:151], a[116:119], v[136:139]
    v_mfma_f32_16x16x32_bf16 v[140:143], a[148:151], a[124:127], v[140:143]
    v_mfma_f32_16x16x32_bf16 v[140:143], a[144:147], a[120:123], v[140:143]
    ds_read_b128 a[144:147], v231 offset:53248
    s_waitcnt lgkmcnt(5)
    v_mfma_f32_16x16x32_bf16 v[156:159], a[152:155], a[120:123], v[156:159]
    ds_read_b128 a[148:151], v231 offset:54272
    v_mfma_f32_16x16x32_bf16 v[156:159], a[156:159], a[124:127], v[156:159]
    v_mfma_f32_16x16x32_bf16 v[152:155], a[156:159], a[116:119], v[152:155]
    v_mfma_f32_16x16x32_bf16 v[152:155], a[152:155], a[112:115], v[152:155]
    v_mfma_f32_16x16x32_bf16 v[148:151], a[152:155], a[104:107], v[148:151]
    v_mfma_f32_16x16x32_bf16 v[148:151], a[156:159], a[108:111], v[148:151]
    buffer_load_dwordx4 a[84:87], v226, s[44:47], s25 offen offset:1024 sc1
    v_mfma_f32_16x16x32_bf16 v[144:147], a[156:159], a[100:103], v[144:147]
    v_mfma_f32_16x16x32_bf16 v[144:147], a[152:155], a[96:99], v[144:147]
    ds_read_b128 a[152:155], v231 offset:55296
    s_waitcnt lgkmcnt(5)
    v_mfma_f32_16x16x32_bf16 v[160:163], a[128:131], a[96:99], v[160:163]
    ds_read_b128 a[156:159], v231 offset:56320
    v_mfma_f32_16x16x32_bf16 v[160:163], a[132:135], a[100:103], v[160:163]
    v_mfma_f32_16x16x32_bf16 v[164:167], a[132:135], a[108:111], v[164:167]
    v_mfma_f32_16x16x32_bf16 v[164:167], a[128:131], a[104:107], v[164:167]
    v_mfma_f32_16x16x32_bf16 v[168:171], a[128:131], a[112:115], v[168:171]
    v_mfma_f32_16x16x32_bf16 v[168:171], a[132:135], a[116:119], v[168:171]
    v_mfma_f32_16x16x32_bf16 v[172:175], a[132:135], a[124:127], v[172:175]
    s_waitcnt vmcnt(17)
    s_barrier
    v_mfma_f32_16x16x32_bf16 v[172:175], a[128:131], a[120:123], v[172:175]
    ds_read_b128 a[128:131], v230 offset:0
    s_waitcnt lgkmcnt(5)
    v_mfma_f32_16x16x32_bf16 v[188:191], a[136:139], a[120:123], v[188:191]
    s_add_u32 m0, s26, 57344
    s_add_u32 s24, s24, 28672
    buffer_load_dwordx4 v228, s[44:47], s24 offen offset:0 sc1 lds
    v_mfma_f32_16x16x32_bf16 v[188:191], a[140:143], a[124:127], v[188:191]
    ds_read_b128 a[132:135], v230 offset:1024
    v_mfma_f32_16x16x32_bf16 v[184:187], a[140:143], a[116:119], v[184:187]
    v_mfma_f32_16x16x32_bf16 v[184:187], a[136:139], a[112:115], v[184:187]
    v_mfma_f32_16x16x32_bf16 v[180:183], a[136:139], a[104:107], v[180:183]
    buffer_load_dwordx4 a[88:91], v227, s[44:47], s25 offen offset:0 sc1
    v_mfma_f32_16x16x32_bf16 v[180:183], a[140:143], a[108:111], v[180:183]
    v_mfma_f32_16x16x32_bf16 v[176:179], a[140:143], a[100:103], v[176:179]
    v_mfma_f32_16x16x32_bf16 v[176:179], a[136:139], a[96:99], v[176:179]
    ds_read_b128 a[136:139], v230 offset:2048
    s_waitcnt lgkmcnt(5)
    v_mfma_f32_16x16x32_bf16 v[192:195], a[144:147], a[96:99], v[192:195]
    ds_read_b128 a[140:143], v230 offset:3072
    v_mfma_f32_16x16x32_bf16 v[192:195], a[148:151], a[100:103], v[192:195]
    v_mfma_f32_16x16x32_bf16 v[196:199], a[148:151], a[108:111], v[196:199]
    v_mfma_f32_16x16x32_bf16 v[196:199], a[144:147], a[104:107], v[196:199]
    v_mfma_f32_16x16x32_bf16 v[200:203], a[144:147], a[112:115], v[200:203]
    v_mfma_f32_16x16x32_bf16 v[200:203], a[148:151], a[116:119], v[200:203]
    v_mfma_f32_16x16x32_bf16 v[204:207], a[148:151], a[124:127], v[204:207]
    buffer_load_dwordx4 v228, s[44:47], s24 offen offset:1024 sc1 lds
    v_mfma_f32_16x16x32_bf16 v[204:207], a[144:147], a[120:123], v[204:207]
    ds_read_b128 a[144:147], v230 offset:4096
    s_waitcnt lgkmcnt(5)
    v_mfma_f32_16x16x32_bf16 v[220:223], a[152:155], a[120:123], v[220:223]
    ds_read_b128 a[148:151], v230 offset:5120
    v_mfma_f32_16x16x32_bf16 v[220:223], a[156:159], a[124:127], v[220:223]
    v_mfma_f32_16x16x32_bf16 v[216:219], a[156:159], a[116:119], v[216:219]
    buffer_load_dwordx4 a[92:95], v227, s[44:47], s25 offen offset:1024 sc1
    v_mfma_f32_16x16x32_bf16 v[216:219], a[152:155], a[112:115], v[216:219]
    v_mfma_f32_16x16x32_bf16 v[212:215], a[152:155], a[104:107], v[212:215]
    v_mfma_f32_16x16x32_bf16 v[212:215], a[156:159], a[108:111], v[212:215]
    v_mfma_f32_16x16x32_bf16 v[208:211], a[156:159], a[100:103], v[208:211]
    v_mfma_f32_16x16x32_bf16 v[208:211], a[152:155], a[96:99], v[208:211]
    ds_read_b128 a[152:155], v230 offset:6144
    ds_read_b128 a[156:159], v230 offset:7168
    s_mov_b32 s27, 2
L_u1:
    s_waitcnt vmcnt(30) lgkmcnt(6)
    v_mfma_f32_16x16x32_bf16 v[0:3], a[128:131], a[0:3], v[0:3]
    v_mfma_f32_16x16x32_bf16 v[0:3], a[132:135], a[4:7], v[0:3]
    v_mfma_f32_16x16x32_bf16 v[4:7], a[132:135], a[12:15], v[4:7]
    v_mfma_f32_16x16x32_bf16 v[4:7], a[128:131], a[8:11], v[4:7]
    v_mfma_f32_16x16x32_bf16 v[8:11], a[128:131], a[16:19], v[8:11]
    buffer_load_dwordx4 v228, s[44:47], s24 offen offset:2048 sc1 lds
    v_mfma_f32_16x16x32_bf16 v[8:11], a[132:135], a[20:23], v[8:11]
    v_mfma_f32_16x16x32_bf16 v[12:15], a[132:135], a[28:31], v[12:15]
    v_mfma_f32_16x16x32_bf16 v[12:15], a[128:131], a[24:27], v[12:15]
    ds_read_b128 a[128:131], v230 offset:8192
    s_waitcnt lgkmcnt(5)
    v_mfma_f32_16x16x32_bf16 v[28:31], a[136:139], a[24:27], v[28:31]
    s_add_u32 s25, s25, 2048
    buffer_load_dwordx4 a[96:99], v224, s[44:47], s25 offen offset:0 sc1
    v_mfma_f32_16x16x32_bf16 v[28:31], a[140:143], a[28:31], v[28:31]
    ds_read_b128 a[132:135], v230 offset:9216
    v_mfma_f32_16x16x32_bf16 v[24:27], a[140:143], a[20:23], v[24:27]
    v_mfma_f32_16x16x32_bf16 v[24:27], a[136:139], a[16:19], v[24:27]
    v_mfma_f32_16x16x32_bf16 v[20:23], a[136:139], a[8:11], v[20:23]
    v_mfma_f32_16x16x32_bf16 v[20:23], a[140:143], a[12:15], v[20:23]
    v_mfma_f32_16x16x32_bf16 v[16:19], a[140:143], a[4:7], v[16:19]
    v_mfma_f32_16x16x32_bf16 v[16:19], a[136:139], a[0:3], v[16:19]
    ds_read_b128 a[136:139], v230 offset:10240
    s_waitcnt lgkmcnt(5)
    v_mfma_f32_16x16x32_bf16 v[32:35], a[144:147], a[0:3], v[32:35]
    ds_read_b128 a[140:143], v230 offset:11264
    v_mfma_f32_16x16x32_bf16 v[32:35], a[148:151], a[4:7], v[32:35]
    v_mfma_f32_16x16x32_bf16 v[36:39], a[148:151], a[12:15], v[36:39]
    buffer_load_dwordx4 v228, s[44:47], s24 offen offset:3072 sc1 lds
    v_mfma_f32_16x16x32_bf16 v[36:39], a[144:147], a[8:11], v[36:39]
    v_mfma_f32_16x16x32_bf16 v[40:43], a[144:147], a[16:19], v[40:43]
    v_mfma_f32_16x16x32_bf16 v[40:43], a[148:151], a[20:23], v[40:43]
    buffer_load_dwordx4 a[100:103], v224, s[44:47], s25 offen offset:1024 sc1
    v_mfma_f32_16x16x32_bf16 v[44:47], a[148:151], a[28:31], v[44:47]
    v_mfma_f32_16x16x32_bf16 v[44:47], a[144:147], a[24:27], v[44:47]
    ds_read_b128 a[144:147], v230 offset:12288
    s_waitcnt lgkmcnt(5)
    v_mfma_f32_16x16x32_bf16 v[60:63], a[152:155], a[24:27], v[60:63]
    ds_read_b128 a[148:151], v230 offset:13312
    v_mfma_f32_16x16x32_bf16 v[60:63], a[156:159], a[28:31], v[60:63]
    v_mfma_f32_16x16x32_bf16 v[56:59], a[156:159], a[20:23], v[56:59]
    v_mfma_f32_16x16x32_bf16 v[56:59], a[152:155], a[16:19], v[56:59]
    v_mfma_f32_16x16x32_bf16 v[52:55], a[152:155], a[8:11], v[52:55]
    v_mfma_f32_16x16x32_bf16 v[52:55], a[156:159], a[12:15], v[52:55]
    v_mfma_f32_16x16x32_bf16 v[48:51], a[156:159], a[4:7], v[48:51]
    v_mfma_f32_16x16x32_bf16 v[48:51], a[152:155], a[0:3], v[48:51]
    ds_read_b128 a[152:155], v230 offset:14336
    s_waitcnt lgkmcnt(5)
    v_mfma_f32_16x16x32_bf16 v[64:67], a[128:131], a[0:3], v[64:67]
    ds_read_b128 a[156:159], v230 offset:15360
    v_mfma_f32_16x16x32_bf16 v[64:67], a[132:135], a[4:7], v[64:67]
    s_add_u32 m0, s26, 61440
    s_nop 0
    buffer_load_dwordx4 v229, s[44:47], s24 offen offset:0 sc1 lds
    v_mfma_f32_16x16x32_bf16 v[68:71], a[132:135], a[12:15], v[68:71]
    v_mfma_f32_16x16x32_bf16 v[68:71], a[128:131], a[8:11], v[68:71]
    buffer_load_dwordx4 a[104:107], v225, s[44:47], s25 offen offset:0 sc1
    v_mfma_f32_16x16x32_bf16 v[72:75], a[128:131], a[16:19], v[72:75]
    v_mfma_f32_16x16x32_bf16 v[72:75], a[132:135], a[20:23], v[72:75]
    v_mfma_f32_16x16x32_bf16 v[76:79], a[132:135], a[28:31], v[76:79]
    v_mfma_f32_16x16x32_bf16 v[76:79], a[128:131], a[24:27], v[76:79]
    ds_read_b128 a[128:131], v230 offset:16384
    s_waitcnt lgkmcnt(5)
    v_mfma_f32_16x16x32_bf16 v[92:95], a[136:139], a[24:27], v[92:95]
    ds_read_b128 a[132:135], v230 offset:17408
    v_mfma_f32_16x16x32_bf16 v[92:95], a[140:143], a[28:31], v[92:95]
    v_mfma_f32_16x16x32_bf16 v[88:91], a[140:143], a[20:23], v[88:91]
    v_mfma_f32_16x16x32_bf16 v[88:91], a[136:139], a[16:19], v[88:91]
    v_mfma_f32_16x16x32_bf16 v[84:87], a[136:139], a[8:11], v[84:87]
    v_mfma_f32_16x16x32_bf16 v[84:87], a[140:143], a[12:15], v[84:87]
    v_mfma_f32_16x16x32_bf16 v[80:83], a[140:143], a[4:7], v[80:83]
    v_mfma_f32_16x16x32_bf16 v[80:83], a[136:139], a[0:3], v[80:83]
    ds_read_b128 a[136:139], v230 offset:18432
    s_waitcnt lgkmcnt(5)
    v_mfma_f32_16x16x32_bf16 v[96:99], a[144:147], a[0:3], v[96:99]
    buffer_load_dwordx4 v229, s[44:47], s24 offen offset:1024 sc1 lds
    v_mfma_f32_16x16x32_bf16 v[96:99], a[148:151], a[4:7], v[96:99]
    buffer_load_dwordx4 a[108:111], v225, s[44:47], s25 offen offset:1024 sc1
    v_mfma_f32_16x16x32_bf16 v[100:103], a[148:151], a[12:15], v[100:103]
    ds_read_b128 a[140:143], v230 offset:19456
    v_mfma_f32_16x16x32_bf16 v[100:103], a[144:147], a[8:11], v[100:103]
    v_mfma_f32_16x16x32_bf16 v[104:107], a[144:147], a[16:19], v[104:107]
    v_mfma_f32_16x16x32_bf16 v[104:107], a[148:151], a[20:23], v[104:107]
    v_mfma_f32_16x16x32_bf16 v[108:111], a[148:151], a[28:31], v[108:111]
    v_mfma_f32_16x16x32_bf16 v[108:111], a[144:147], a[24:27], v[108:111]
    ds_read_b128 a[144:147], v230 offset:20480
    s_waitcnt lgkmcnt(5)
    v_mfma_f32_16x16x32_bf16 v[124:127], a[152:155], a[24:27], v[124:127]
    ds_read_b128 a[148:151], v230 offset:21504
    v_mfma_f32_16x16x32_bf16 v[124:127], a[156:159], a[28:31], v[124:127]
    v_mfma_f32_16x16x32_bf16 v[120:123], a[156:159], a[20:23], v[120:123]
    v_mfma_f32_16x16x32_bf16 v[120:123], a[152:155], a[16:19], v[120:123]
    v_mfma_f32_16x16x32_bf16 v[116:119], a[152:155], a[8:11], v[116:119]
    v_mfma_f32_16x16x32_bf16 v[116:119], a[156:159], a[12:15], v[116:119]
    buffer_load_dwordx4 v229, s[44:47], s24 offen offset:2048 sc1 lds
    v_mfma_f32_16x16x32_bf16 v[112:115], a[156:159], a[4:7], v[112:115]
    v_mfma_f32_16x16x32_bf16 v[112:115], a[152:155], a[0:3], v[112:115]
    ds_read_b128 a[152:155], v230 offset:22528
    s_waitcnt lgkmcnt(5)
    v_mfma_f32_16x16x32_bf16 v[128:131], a[128:131], a[0:3], v[128:131]
    buffer_load_dwordx4 a[112:115], v226, s[44:47], s25 offen offset:0 sc1
    v_mfma_f32_16x16x32_bf16 v[128:131], a[132:135], a[4:7], v[128:131]
    ds_read_b128 a[156:159], v230 offset:23552
    v_mfma_f32_16x16x32_bf16 v[132:135], a[132:135], a[12:15], v[132:135]
    v_mfma_f32_16x16x32_bf16 v[132:135], a[128:131], a[8:11], v[132:135]
    v_mfma_f32_16x16x32_bf16 v[136:139], a[128:131], a[16:19], v[136:139]
    v_mfma_f32_16x16x32_bf16 v[136:139], a[132:135], a[20:23], v[136:139]
    v_mfma_f32_16x16x32_bf16 v[140:143], a[132:135], a[28:31], v[140:143]
    v_mfma_f32_16x16x32_bf16 v[140:143], a[128:131], a[24:27], v[140:143]
    ds_read_b128 a[128:131], v230 offset:24576
    s_waitcnt lgkmcnt(5)
    v_mfma_f32_16x16x32_bf16 v[156:159], a[136:139], a[24:27], v[156:159]
    ds_read_b128 a[132:135], v230 offset:25600
    v_mfma_f32_16x16x32_bf16 v[156:159], a[140:143], a[28:31], v[156:159]
    v_mfma_f32_16x16x32_bf16 v[152:155], a[140:143], a[20:23], v[152:155]
    v_mfma_f32_16x16x32_bf16 v[152:155], a[136:139], a[16:19], v[152:155]
    v_mfma_f32_16x16x32_bf16 v[148:151], a[136:139], a[8:11], v[148:151]
    v_mfma_f32_16x16x32_bf16 v[148:151], a[140:143], a[12:15], v[148:151]
    buffer_load_dwordx4 a[116:119], v226, s[44:47], s25 offen offset:1024 sc1
    v_mfma_f32_16x16x32_bf16 v[144:147], a[140:143], a[4:7], v[144:147]
    v_mfma_f32_16x16x32_bf16 v[144:147], a[136:139], a[0:3], v[144:147]
    ds_read_b128 a[136:139], v230 offset:26624
    s_waitcnt lgkmcnt(5)
    v_mfma_f32_16x16x32_bf16 v[160:163], a[144:147], a[0:3], v[160:163]
    ds_read_b128 a[140:143], v230 offset:27648
    v_mfma_f32_16x16x32_bf16 v[160:163], a[148:151], a[4:7], v[160:163]
    v_mfma_f32_16x16x32_bf16 v[164:167], a[148:151], a[12:15], v[164:167]
    v_mfma_f32_16x16x32_bf16 v[164:167], a[144:147], a[8:11], v[164:167]
    v_mfma_f32_16x16x32_bf16 v[168:171], a[144:147], a[16:19], v[168:171]
    v_mfma_f32_16x16x32_bf16 v[168:171], a[148:151], a[20:23], v[168:171]
    v_mfma_f32_16x16x32_bf16 v[172:175], a[148:151], a[28:31], v[172:175]
    s_waitcnt vmcnt(17)
    s_barrier
    v_mfma_f32_16x16x32_bf16 v[172:175], a[144:147], a[24:27], v[172:175]
    ds_read_b128 a[144:147], v230 offset:28672
    s_waitcnt lgkmcnt(5)
    v_mfma_f32_16x16x32_bf16 v[188:191], a[152:155], a[24:27], v[188:191]
    s_add_u32 m0, s26, 86016
    s_add_u32 s24, s24, 28672
    buffer_load_dwordx4 v228, s[44:47], s24 offen offset:0 sc1 lds
    v_mfma_f32_16x16x32_bf16 v[188:191], a[156:159], a[28:31], v[188:191]
    ds_read_b128 a[148:151], v230 offset:29696
    v_mfma_f32_16x16x32_bf16 v[184:187], a[156:159], a[20:23], v[184:187]
    v_mfma_f32_16x16x32_bf16 v[184:187], a[152:155], a[16:19], v[184:187]
    buffer_load_dwordx4 a[120:123], v227, s[44:47], s25 offen offset:0 sc1
    v_mfma_f32_16x16x32_bf16 v[180:183], a[152:155], a[8:11], v[180:183]
    v_mfma_f32_16x16x32_bf16 v[180:183], a[156:159], a[12:15], v[180:183]
    v_mfma_f32_16x16x32_bf16 v[176:179], a[156:159], a[4:7], v[176:179]
    v_mfma_f32_16x16x32_bf16 v[176:179], a[152:155], a[0:3], v[176:179]
    ds_read_b128 a[152:155], v230 offset:30720
    s_waitcnt lgkmcnt(5)
    v_mfma_f32_16x16x32_bf16 v[192:195], a[128:131], a[0:3], v[192:195]
    ds_read_b128 a[156:159], v230 offset:31744
    v_mfma_f32_16x16x32_bf16 v[192:195], a[132:135], a[4:7], v[192:195]
    v_mfma_f32_16x16x32_bf16 v[196:199], a[132:135], a[12:15], v[196:199]
    v_mfma_f32_16x16x32_bf16 v[196:199], a[128:131], a[8:11], v[196:199]
    v_mfma_f32_16x16x32_bf16 v[200:203], a[128:131], a[16:19], v[200:203]
    v_mfma_f32_16x16x32_bf16 v[200:203], a[132:135], a[20:23], v[200:203]
    v_mfma_f32_16x16x32_bf16 v[204:207], a[132:135], a[28:31], v[204:207]
    buffer_load_dwordx4 v228, s[44:47], s24 offen offset:1024 sc1 lds
    v_mfma_f32_16x16x32_bf16 v[204:207], a[128:131], a[24:27], v[204:207]
    ds_read_b128 a[128:131], v230 offset:32768
    s_waitcnt lgkmcnt(5)
    v_mfma_f32_16x16x32_bf16 v[220:223], a[136:139], a[24:27], v[220:223]
    ds_read_b128 a[132:135], v230 offset:33792
    v_mfma_f32_16x16x32_bf16 v[220:223], a[140:143], a[28:31], v[220:223]
    buffer_load_dwordx4 a[124:127], v227, s[44:47], s25 offen offset:1024 sc1
    v_mfma_f32_16x16x32_bf16 v[216:219], a[140:143], a[20:23], v[216:219]
    v_mfma_f32_16x16x32_bf16 v[216:219], a[136:139], a[16:19], v[216:219]
    v_mfma_f32_16x16x32_bf16 v[212:215], a[136:139], a[8:11], v[212:215]
    v_mfma_f32_16x16x32_bf16 v[212:215], a[140:143], a[12:15], v[212:215]
    v_mfma_f32_16x16x32_bf16 v[208:211], a[140:143], a[4:7], v[208:211]
    v_mfma_f32_16x16x32_bf16 v[208:211], a[136:139], a[0:3], v[208:211]
    ds_read_b128 a[136:139], v230 offset:34816
    ds_read_b128 a[140:143], v230 offset:35840
    s_waitcnt lgkmcnt(6)
    v_mfma_f32_16x16x32_bf16 v[0:3], a[144:147], a[32:35], v[0:3]
    v_mfma_f32_16x16x32_bf16 v[0:3], a[148:151], a[36:39], v[0:3]
    v_mfma_f32_16x16x32_bf16 v[4:7], a[148:151], a[44:47], v[4:7]
    v_mfma_f32_16x16x32_bf16 v[4:7], a[144:147], a[40:43], v[4:7]
    v_mfma_f32_16x16x32_bf16 v[8:11], a[144:147], a[48:51], v[8:11]
    buffer_load_dwordx4 v228, s[44:47], s24 offen offset:2048 sc1 lds
    v_mfma_f32_16x16x32_bf16 v[8:11], a[148:151], a[52:55], v[8:11]
    v_mfma_f32_16x16x32_bf16 v[12:15], a[148:151], a[60:63], v[12:15]
    v_mfma_f32_16x16x32_bf16 v[12:15], a[144:147], a[56:59], v[12:15]
    ds_read_b128 a[144:147], v230 offset:36864
    s_waitcnt lgkmcnt(5)
    v_mfma_f32_16x16x32_bf16 v[28:31], a[152:155], a[56:59], v[28:31]
    s_add_u32 s25, s25, 2048
    buffer_load_dwordx4 a[0:3], v224, s[44:47], s25 offen offset:0 sc1
    v_mfma_f32_16x16x32_bf16 v[28:31], a[156:159], a[60:63], v[28:31]
    ds_read_b128 a[148:151], v230 offset:37888
    v_mfma_f32_16x16x32_bf16 v[24:27], a[156:159], a[52:55], v[24:27]
    v_mfma_f32_16x16x32_bf16 v[24:27], a[152:155], a[48:51], v[24:27]
    v_mfma_f32_16x16x32_bf16 v[20:23], a[152:155], a[40:43], v[20:23]
    v_mfma_f32_16x16x32_bf16 v[20:23], a[156:159], a[44:47], v[20:23]
    v_mfma_f32_16x16x32_bf16 v[16:19], a[156:159], a[36:39], v[16:19]
    v_mfma_f32_16x16x32_bf16 v[16:19], a[152:155], a[32:35], v[16:19]
    ds_read_b128 a[152:155], v230 offset:38912
    s_waitcnt lgkmcnt(5)
    v_mfma_f32_16x16x32_bf16 v[32:35], a[128:131], a[32:35], v[32:35]
    ds_read_b128 a[156:159], v230 offset:39936
    v_mfma_f32_16x16x32_bf16 v[32:35], a[132:135], a[36:39], v[32:35]
    v_mfma_f32_16x16x32_bf16 v[36:39], a[132:135], a[44:47], v[36:39]
    buffer_load_dwordx4 v228, s[44:47], s24 offen offset:3072 sc1 lds
    v_mfma_f32_16x16x32_bf16 v[36:39], a[128:131], a[40:43], v[36:39]
    v_mfma_f32_16x16x32_bf16 v[40:43], a[128:131], a[48:51], v[40:43]
    v_mfma_f32_16x16x32_bf16 v[40:43], a[132:135], a[52:55], v[40:43]
    buffer_load_dwordx4 a[4:7], v224, s[44:47], s25 offen offset:1024 sc1
    v_mfma_f32_16x16x32_bf16 v[44:47], a[132:135], a[60:63], v[44:47]
    v_mfma_f32_16x16x32_bf16 v[44:47], a[128:131], a[56:59], v[44:47]
    ds_read_b128 a[128:131], v230 offset:40960
    s_waitcnt lgkmcnt(5)
    v_mfma_f32_16x16x32_bf16 v[60:63], a[136:139], a[56:59], v[60:63]
    ds_read_b128 a[132:135], v230 offset:41984
    v_mfma_f32_16x16x32_bf16 v[60:63], a[140:143], a[60:63], v[60:63]
    v_mfma_f32_16x16x32_bf16 v[56:59], a[140:143], a[52:55], v[56:59]
    v_mfma_f32_16x16x32_bf16 v[56:59], a[136:139], a[48:51], v[56:59]
    v_mfma_f32_16x16x32_bf16 v[52:55], a[136:139], a[40:43], v[52:55]
    v_mfma_f32_16x16x32_bf16 v[52:55], a[140:143], a[44:47], v[52:55]
    v_mfma_f32_16x16x32_bf16 v[48:51], a[140:143], a[36:39], v[48:51]
    v_mfma_f32_16x16x32_bf16 v[48:51], a[136:139], a[32:35], v[48:51]
    ds_read_b128 a[136:139], v230 offset:43008
    s_waitcnt lgkmcnt(5)
    v_mfma_f32_16x16x32_bf16 v[64:67], a[144:147], a[32:35], v[64:67]
    ds_read_b128 a[140:143], v230 offset:44032
    v_mfma_f32_16x16x32_bf16 v[64:67], a[148:151], a[36:39], v[64:67]
    s_add_u32 m0, s26, 90112
    s_nop 0
    buffer_load_dwordx4 v229, s[44:47], s24 offen offset:0 sc1 lds
    v_mfma_f32_16x16x32_bf16 v[68:71], a[148:151], a[44:47], v[68:71]
    v_mfma_f32_16x16x32_bf16 v[68:71], a[144:147], a[40:43], v[68:71]
    buffer_load_dwordx4 a[8:11], v225, s[44:47], s25 offen offset:0 sc1
    v_mfma_f32_16x16x32_bf16 v[72:75], a[144:147], a[48:51], v[72:75]
    v_mfma_f32_16x16x32_bf16 v[72:75], a[148:151], a[52:55], v[72:75]
    v_mfma_f32_16x16x32_bf16 v[76:79], a[148:151], a[60:63], v[76:79]
    v_mfma_f32_16x16x32_bf16 v[76:79], a[144:147], a[56:59], v[76:79]
    ds_read_b128 a[144:147], v230 offset:45056
    s_waitcnt lgkmcnt(5)
    v_mfma_f32_16x16x32_bf16 v[92:95], a[152:155], a[56:59], v[92:95]
    ds_read_b128 a[148:151], v230 offset:46080
    v_mfma_f32_16x16x32_bf16 v[92:95], a[156:159], a[60:63], v[92:95]
    v_mfma_f32_16x16x32_bf16 v[88:91], a[156:159], a[52:55], v[88:91]
    v_mfma_f32_16x16x32_bf16 v[88:91], a[152:155], a[48:51], v[88:91]
    v_mfma_f32_16x16x32_bf16 v[84:87], a[152:155], a[40:43], v[84:87]
    v_mfma_f32_16x16x32_bf16 v[84:87], a[156:159], a[44:47], v[84:87]
    v_mfma_f32_16x16x32_bf16 v[80:83], a[156:159], a[36:39], v[80:83]
    v_mfma_f32_16x16x32_bf16 v[80:83], a[152:155], a[32:35], v[80:83]
    ds_read_b128 a[152:155], v230 offset:47104
    s_waitcnt lgkmcnt(5)
    v_mfma_f32_16x16x32_bf16 v[96:99], a[128:131], a[32:35], v[96:99]
    buffer_load_dwordx4 v229, s[44:47], s24 offen offset:1024 sc1 lds
    v_mfma_f32_16x16x32_bf16 v[96:99], a[132:135], a[36:39], v[96:99]
    buffer_load_dwordx4 a[12:15], v225, s[44:47], s25 offen offset:1024 sc1
    v_mfma_f32_16x16x32_bf16 v[100:103], a[132:135], a[44:47], v[100:103]
    ds_read_b128 a[156:159], v230 offset:48128
    v_mfma_f32_16x16x32_bf16 v[100:103], a[128:131], a[40:43], v[100:103]
    v_mfma_f32_16x16x32_bf16 v[104:107], a[128:131], a[48:51], v[104:107]
    v_mfma_f32_16x16x32_bf16 v[104:107], a[132:135], a[52:55], v[104:107]
    v_mfma_f32_16x16x32_bf16 v[108:111], a[132:135], a[60:63], v[108:111]
    v_mfma_f32_16x16x32_bf16 v[108:111], a[128:131], a[56:59], v[108:111]
    ds_read_b128 a[128:131], v230 offset:49152
    s_waitcnt lgkmcnt(5)
    v_mfma_f32_16x16x32_bf16 v[124:127], a[136:139], a[56:59], v[124:127]
    ds_read_b128 a[132:135], v230 offset:50176
    v_mfma_f32_16x16x32_bf16 v[124:127], a[140:143], a[60:63], v[124:127]
    v_mfma_f32_16x16x32_bf16 v[120:123], a[140:143], a[52:55], v[120:123]
    v_mfma_f32_16x16x32_bf16 v[120:123], a[136:139], a[48:51], v[120:123]
    v_mfma_f32_16x16x32_bf16 v[116:119], a[136:139], a[40:43], v[116:119]
    v_mfma_f32_16x16x32_bf16 v[116:119], a[140:143], a[44:47], v[116:119]
    buffer_load_dwordx4 v229, s[44:47], s24 offen offset:2048 sc1 lds
    v_mfma_f32_16x16x32_bf16 v[112:115], a[140:143], a[36:39], v[112:115]
    v_mfma_f32_16x16x32_bf16 v[112:115], a[136:139], a[32:35], v[112:115]
    ds_read_b128 a[136:139], v230 offset:51200
    s_waitcnt lgkmcnt(5)
    v_mfma_f32_16x16x32_bf16 v[128:131], a[144:147], a[32:35], v[128:131]
    buffer_load_dwordx4 a[16:19], v226, s[44:47], s25 offen offset:0 sc1
    v_mfma_f32_16x16x32_bf16 v[128:131], a[148:151], a[36:39], v[128:131]
    ds_read_b128 a[140:143], v230 offset:52224
    v_mfma_f32_16x16x32_bf16 v[132:135], a[148:151], a[44:47], v[132:135]
    v_mfma_f32_16x16x32_bf16 v[132:135], a[144:147], a[40:43], v[132:135]
    v_mfma_f32_16x16x32_bf16 v[136:139], a[144:147], a[48:51], v[136:139]
    v_mfma_f32_16x16x32_bf16 v[136:139], a[148:151], a[52:55], v[136:139]
    v_mfma_f32_16x16x32_bf16 v[140:143], a[148:151], a[60:63], v[140:143]
    v_mfma_f32_16x16x32_bf16 v[140:143], a[144:147], a[56:59], v[140:143]
    ds_read_b128 a[144:147], v230 offset:53248
    s_waitcnt lgkmcnt(5)
    v_mfma_f32_16x16x32_bf16 v[156:159], a[152:155], a[56:59], v[156:159]
    ds_read_b128 a[148:151], v230 offset:54272
    v_mfma_f32_16x16x32_bf16 v[156:159], a[156:159], a[60:63], v[156:159]
    v_mfma_f32_16x16x32_bf16 v[152:155], a[156:159], a[52:55], v[152:155]
    v_mfma_f32_16x16x32_bf16 v[152:155], a[152:155], a[48:51], v[152:155]
    v_mfma_f32_16x16x32_bf16 v[148:151], a[152:155], a[40:43], v[148:151]
    v_mfma_f32_16x16x32_bf16 v[148:151], a[156:159], a[44:47], v[148:151]
    buffer_load_dwordx4 a[20:23], v226, s[44:47], s25 offen offset:1024 sc1
    v_mfma_f32_16x16x32_bf16 v[144:147], a[156:159], a[36:39], v[144:147]
    v_mfma_f32_16x16x32_bf16 v[144:147], a[152:155], a[32:35], v[144:147]
    ds_read_b128 a[152:155], v230 offset:55296
    s_waitcnt lgkmcnt(5)
    v_mfma_f32_16x16x32_bf16 v[160:163], a[128:131], a[32:35], v[160:163]
    ds_read_b128 a[156:159], v230 offset:56320
    v_mfma_f32_16x16x32_bf16 v[160:163], a[132:135], a[36:39], v[160:163]
    v_mfma_f32_16x16x32_bf16 v[164:167], a[132:135], a[44:47], v[164:167]
    v_mfma_f32_16x16x32_bf16 v[164:167], a[128:131], a[40:43], v[164:167]
    v_mfma_f32_16x16x32_bf16 v[168:171], a[128:131], a[48:51], v[168:171]
    v_mfma_f32_16x16x32_bf16 v[168:171], a[132:135], a[52:55], v[168:171]
    v_mfma_f32_16x16x32_bf16 v[172:175], a[132:135], a[60:63], v[172:175]
    s_waitcnt vmcnt(17)
    s_barrier
    v_mfma_f32_16x16x32_bf16 v[172:175], a[128:131], a[56:59], v[172:175]
    ds_read_b128 a[128:131], v231 offset:0
    s_waitcnt lgkmcnt(5)
    v_mfma_f32_16x16x32_bf16 v[188:191], a[136:139], a[56:59], v[188:191]
    s_add_u32 m0, s26, 0
    s_add_u32 s24, s24, 28672
    buffer_load_dwordx4 v228, s[44:47], s24 offen offset:0 sc1 lds
    v_mfma_f32_16x16x32_bf16 v[188:191], a[140:143], a[60:63], v[188:191]
    ds_read_b128 a[132:135], v231 offset:1024
    v_mfma_f32_16x16x32_bf16 v[184:187], a[140:143], a[52:55], v[184:187]
    v_mfma_f32_16x16x32_bf16 v[184:187], a[136:139], a[48:51], v[184:187]
    buffer_load_dwordx4 a[24:27], v227, s[44:47], s25 offen offset:0 sc1
    v_mfma_f32_16x16x32_bf16 v[180:183], a[136:139], a[40:43], v[180:183]
    v_mfma_f32_16x16x32_bf16 v[180:183], a[140:143], a[44:47], v[180:183]
    v_mfma_f32_16x16x32_bf16 v[176:179], a[140:143], a[36:39], v[176:179]
    v_mfma_f32_16x16x32_bf16 v[176:179], a[136:139], a[32:35], v[176:179]
    ds_read_b128 a[136:139], v231 offset:2048
    s_waitcnt lgkmcnt(5)
    v_mfma_f32_16x16x32_bf16 v[192:195], a[144:147], a[32:35], v[192:195]
    ds_read_b128 a[140:143], v231 offset:3072
    v_mfma_f32_16x16x32_bf16 v[192:195], a[148:151], a[36:39], v[192:195]
    v_mfma_f32_16x16x32_bf16 v[196:199], a[148:151], a[44:47], v[196:199]
    v_mfma_f32_16x16x32_bf16 v[196:199], a[144:147], a[40:43], v[196:199]
    v_mfma_f32_16x16x32_bf16 v[200:203], a[144:147], a[48:51], v[200:203]
    v_mfma_f32_16x16x32_bf16 v[200:203], a[148:151], a[52:55], v[200:203]
    v_mfma_f32_16x16x32_bf16 v[204:207], a[148:151], a[60:63], v[204:207]
    buffer_load_dwordx4 v228, s[44:47], s24 offen offset:1024 sc1 lds
    v_mfma_f32_16x16x32_bf16 v[204:207], a[144:147], a[56:59], v[204:207]
    ds_read_b128 a[144:147], v231 offset:4096
    s_waitcnt lgkmcnt(5)
    v_mfma_f32_16x16x32_bf16 v[220:223], a[152:155], a[56:59], v[220:223]
    ds_read_b128 a[148:151], v231 offset:5120
    v_mfma_f32_16x16x32_bf16 v[220:223], a[156:159], a[60:63], v[220:223]
    buffer_load_dwordx4 a[28:31], v227, s[44:47], s25 offen offset:1024 sc1
    v_mfma_f32_16x16x32_bf16 v[216:219], a[156:159], a[52:55], v[216:219]
    v_mfma_f32_16x16x32_bf16 v[216:219], a[152:155], a[48:51], v[216:219]
    v_mfma_f32_16x16x32_bf16 v[212:215], a[152:155], a[40:43], v[212:215]
    v_mfma_f32_16x16x32_bf16 v[212:215], a[156:159], a[44:47], v[212:215]
    v_mfma_f32_16x16x32_bf16 v[208:211], a[156:159], a[36:39], v[208:211]
    v_mfma_f32_16x16x32_bf16 v[208:211], a[152:155], a[32:35], v[208:211]
    ds_read_b128 a[152:155], v231 offset:6144
    ds_read_b128 a[156:159], v231 offset:7168
    s_waitcnt lgkmcnt(6)
    v_mfma_f32_16x16x32_bf16 v[0:3], a[128:131], a[64:67], v[0:3]
    v_mfma_f32_16x16x32_bf16 v[0:3], a[132:135], a[68:71], v[0:3]
    v_mfma_f32_16x16x32_bf16 v[4:7], a[132:135], a[76:79], v[4:7]
    v_mfma_f32_16x16x32_bf16 v[4:7], a[128:131], a[72:75], v[4:7]
    v_mfma_f32_16x16x32_bf16 v[8:11], a[128:131], a[80:83], v[8:11]
    buffer_load_dwordx4 v228, s[44:47], s24 offen offset:2048 sc1 lds
    v_mfma_f32_16x16x32_bf16 v[8:11], a[132:135], a[84:87], v[8:11]
    v_mfma_f32_16x16x32_bf16 v[12:15], a[132:135], a[92:95], v[12:15]
    v_mfma_f32_16x16x32_bf16 v[12:15], a[128:131], a[88:91], v[12:15]
    ds_read_b128 a[128:131], v231 offset:8192
    s_waitcnt lgkmcnt(5)
    v_mfma_f32_16x16x32_bf16 v[28:31], a[136:139], a[88:91], v[28:31]
    s_add_u32 s25, s25, 2048
    buffer_load_dwordx4 a[32:35], v224, s[44:47], s25 offen offset:0 sc1
    v_mfma_f32_16x16x32_bf16 v[28:31], a[140:143], a[92:95], v[28:31]
    ds_read_b128 a[132:135], v231 offset:9216
    v_mfma_f32_16x16x32_bf16 v[24:27], a[140:143], a[84:87], v[24:27]
    v_mfma_f32_16x16x32_bf16 v[24:27], a[136:139], a[80:83], v[24:27]
    v_mfma_f32_16x16x32_bf16 v[20:23], a[136:139], a[72:75], v[20:23]
    v_mfma_f32_16x16x32_bf16 v[20:23], a[140:143], a[76:79], v[20:23]
    v_mfma_f32_16x16x32_bf16 v[16:19], a[140:143], a[68:71], v[16:19]
    v_mfma_f32_16x16x32_bf16 v[16:19], a[136:139], a[64:67], v[16:19]
    ds_read_b128 a[136:139], v231 offset:10240
    s_waitcnt lgkmcnt(5)
    v_mfma_f32_16x16x32_bf16 v[32:35], a[144:147], a[64:67], v[32:35]
    ds_read_b128 a[140:143], v231 offset:11264
    v_mfma_f32_16x16x32_bf16 v[32:35], a[148:151], a[68:71], v[32:35]
    v_mfma_f32_16x16x32_bf16 v[36:39], a[148:151], a[76:79], v[36:39]
    buffer_load_dwordx4 v228, s[44:47], s24 offen offset:3072 sc1 lds
    v_mfma_f32_16x16x32_bf16 v[36:39], a[144:147], a[72:75], v[36:39]
    v_mfma_f32_16x16x32_bf16 v[40:43], a[144:147], a[80:83], v[40:43]
    v_mfma_f32_16x16x32_bf16 v[40:43], a[148:151], a[84:87], v[40:43]
    buffer_load_dwordx4 a[36:39], v224, s[44:47], s25 offen offset:1024 sc1
    v_mfma_f32_16x16x32_bf16 v[44:47], a[148:151], a[92:95], v[44:47]
    v_mfma_f32_16x16x32_bf16 v[44:47], a[144:147], a[88:91], v[44:47]
    ds_read_b128 a[144:147], v231 offset:12288
    s_waitcnt lgkmcnt(5)
    v_mfma_f32_16x16x32_bf16 v[60:63], a[152:155], a[88:91], v[60:63]
    ds_read_b128 a[148:151], v231 offset:13312
    v_mfma_f32_16x16x32_bf16 v[60:63], a[156:159], a[92:95], v[60:63]
    v_mfma_f32_16x16x32_bf16 v[56:59], a[156:159], a[84:87], v[56:59]
    v_mfma_f32_16x16x32_bf16 v[56:59], a[152:155], a[80:83], v[56:59]
    v_mfma_f32_16x16x32_bf16 v[52:55], a[152:155], a[72:75], v[52:55]
    v_mfma_f32_16x16x32_bf16 v[52:55], a[156:159], a[76:79], v[52:55]
    v_mfma_f32_16x16x32_bf16 v[48:51], a[156:159], a[68:71], v[48:51]
    v_mfma_f32_16x16x32_bf16 v[48:51], a[152:155], a[64:67], v[48:51]
    ds_read_b128 a[152:155], v231 offset:14336
    s_waitcnt lgkmcnt(5)
    v_mfma_f32_16x16x32_bf16 v[64:67], a[128:131], a[64:67], v[64:67]
    ds_read_b128 a[156:159], v231 offset:15360
    v_mfma_f32_16x16x32_bf16 v[64:67], a[132:135], a[68:71], v[64:67]
    s_add_u32 m0, s26, 4096
    s_nop 0
    buffer_load_dwordx4 v229, s[44:47], s24 offen offset:0 sc1 lds
    v_mfma_f32_16x16x32_bf16 v[68:71], a[132:135], a[76:79], v[68:71]
    v_mfma_f32_16x16x32_bf16 v[68:71], a[128:131], a[72:75], v[68:71]
    buffer_load_dwordx4 a[40:43], v225, s[44:47], s25 offen offset:0 sc1
    v_mfma_f32_16x16x32_bf16 v[72:75], a[128:131], a[80:83], v[72:75]
    v_mfma_f32_16x16x32_bf16 v[72:75], a[132:135], a[84:87], v[72:75]
    v_mfma_f32_16x16x32_bf16 v[76:79], a[132:135], a[92:95], v[76:79]
    v_mfma_f32_16x16x32_bf16 v[76:79], a[128:131], a[88:91], v[76:79]
    ds_read_b128 a[128:131], v231 offset:16384
    s_waitcnt lgkmcnt(5)
    v_mfma_f32_16x16x32_bf16 v[92:95], a[136:139], a[88:91], v[92:95]
    ds_read_b128 a[132:135], v231 offset:17408
    v_mfma_f32_16x16x32_bf16 v[92:95], a[140:143], a[92:95], v[92:95]
    v_mfma_f32_16x16x32_bf16 v[88:91], a[140:143], a[84:87], v[88:91]
    v_mfma_f32_16x16x32_bf16 v[88:91], a[136:139], a[80:83], v[88:91]
    v_mfma_f32_16x16x32_bf16 v[84:87], a[136:139], a[72:75], v[84:87]
    v_mfma_f32_16x16x32_bf16 v[84:87], a[140:143], a[76:79], v[84:87]
    v_mfma_f32_16x16x32_bf16 v[80:83], a[140:143], a[68:71], v[80:83]
    v_mfma_f32_16x16x32_bf16 v[80:83], a[136:139], a[64:67], v[80:83]
    ds_read_b128 a[136:139], v231 offset:18432
    s_waitcnt lgkmcnt(5)
    v_mfma_f32_16x16x32_bf16 v[96:99], a[144:147], a[64:67], v[96:99]
    buffer_load_dwordx4 v229, s[44:47], s24 offen offset:1024 sc1 lds
    v_mfma_f32_16x16x32_bf16 v[96:99], a[148:151], a[68:71], v[96:99]
    buffer_load_dwordx4 a[44:47], v225, s[44:47], s25 offen offset:1024 sc1
    v_mfma_f32_16x16x32_bf16 v[100:103], a[148:151], a[76:79], v[100:103]
    ds_read_b128 a[140:143], v231 offset:19456
    v_mfma_f32_16x16x32_bf16 v[100:103], a[144:147], a[72:75], v[100:103]
    v_mfma_f32_16x16x32_bf16 v[104:107], a[144:147], a[80:83], v[104:107]
    v_mfma_f32_16x16x32_bf16 v[104:107], a[148:151], a[84:87], v[104:107]
    v_mfma_f32_16x16x32_bf16 v[108:111], a[148:151], a[92:95], v[108:111]
    v_mfma_f32_16x16x32_bf16 v[108:111], a[144:147], a[88:91], v[108:111]
    ds_read_b128 a[144:147], v231 offset:20480
    s_waitcnt lgkmcnt(5)
    v_mfma_f32_16x16x32_bf16 v[124:127], a[152:155], a[88:91], v[124:127]
    ds_read_b128 a[148:151], v231 offset:21504
    v_mfma_f32_16x16x32_bf16 v[124:127], a[156:159], a[92:95], v[124:127]
    v_mfma_f32_16x16x32_bf16 v[120:123], a[156:159], a[84:87], v[120:123]
    v_mfma_f32_16x16x32_bf16 v[120:123], a[152:155], a[80:83], v[120:123]
    v_mfma_f32_16x16x32_bf16 v[116:119], a[152:155], a[72:75], v[116:119]
    v_mfma_f32_16x16x32_bf16 v[116:119], a[156:159], a[76:79], v[116:119]
    buffer_load_dwordx4 v229, s[44:47], s24 offen offset:2048 sc1 lds
    v_mfma_f32_16x16x32_bf16 v[112:115], a[156:159], a[68:71], v[112:115]
    v_mfma_f32_16x16x32_bf16 v[112:115], a[152:155], a[64:67], v[112:115]
    ds_read_b128 a[152:155], v231 offset:22528
    s_waitcnt lgkmcnt(5)
    v_mfma_f32_16x16x32_bf16 v[128:131], a[128:131], a[64:67], v[128:131]
    buffer_load_dwordx4 a[48:51], v226, s[44:47], s25 offen offset:0 sc1
    v_mfma_f32_16x16x32_bf16 v[128:131], a[132:135], a[68:71], v[128:131]
    ds_read_b128 a[156:159], v231 offset:23552
    v_mfma_f32_16x16x32_bf16 v[132:135], a[132:135], a[76:79], v[132:135]
    v_mfma_f32_16x16x32_bf16 v[132:135], a[128:131], a[72:75], v[132:135]
    v_mfma_f32_16x16x32_bf16 v[136:139], a[128:131], a[80:83], v[136:139]
    v_mfma_f32_16x16x32_bf16 v[136:139], a[132:135], a[84:87], v[136:139]
    v_mfma_f32_16x16x32_bf16 v[140:143], a[132:135], a[92:95], v[140:143]
    v_mfma_f32_16x16x32_bf16 v[140:143], a[128:131], a[88:91], v[140:143]
    ds_read_b128 a[128:131], v231 offset:24576
    s_waitcnt lgkmcnt(5)
    v_mfma_f32_16x16x32_bf16 v[156:159], a[136:139], a[88:91], v[156:159]
    ds_read_b128 a[132:135], v231 offset:25600
    v_mfma_f32_16x16x32_bf16 v[156:159], a[140:143], a[92:95], v[156:159]
    v_mfma_f32_16x16x32_bf16 v[152:155], a[140:143], a[84:87], v[152:155]
    v_mfma_f32_16x16x32_bf16 v[152:155], a[136:139], a[80:83], v[152:155]
    v_mfma_f32_16x16x32_bf16 v[148:151], a[136:139], a[72:75], v[148:151]
    v_mfma_f32_16x16x32_bf16 v[148:151], a[140:143], a[76:79], v[148:151]
    buffer_load_dwordx4 a[52:55], v226, s[44:47], s25 offen offset:1024 sc1
    v_mfma_f32_16x16x32_bf16 v[144:147], a[140:143], a[68:71], v[144:147]
    v_mfma_f32_16x16x32_bf16 v[144:147], a[136:139], a[64:67], v[144:147]
    ds_read_b128 a[136:139], v231 offset:26624
    s_waitcnt lgkmcnt(5)
    v_mfma_f32_16x16x32_bf16 v[160:163], a[144:147], a[64:67], v[160:163]
    ds_read_b128 a[140:143], v231 offset:27648
    v_mfma_f32_16x16x32_bf16 v[160:163], a[148:151], a[68:71], v[160:163]
    v_mfma_f32_16x16x32_bf16 v[164:167], a[148:151], a[76:79], v[164:167]
    v_mfma_f32_16x16x32_bf16 v[164:167], a[144:147], a[72:75], v[164:167]
    v_mfma_f32_16x16x32_bf16 v[168:171], a[144:147], a[80:83], v[168:171]
    v_mfma_f32_16x16x32_bf16 v[168:171], a[148:151], a[84:87], v[168:171]
    v_mfma_f32_16x16x32_bf16 v[172:175], a[148:151], a[92:95], v[172:175]
    s_waitcnt vmcnt(17)
    s_barrier
    v_mfma_f32_16x16x32_bf16 v[172:175], a[144:147], a[88:91], v[172:175]
    ds_read_b128 a[144:147], v231 offset:28672
    s_waitcnt lgkmcnt(5)
    v_mfma_f32_16x16x32_bf16 v[188:191], a[152:155], a[88:91], v[188:191]
    s_add_u32 m0, s26, 28672
    s_add_u32 s24, s24, 28672
    buffer_load_dwordx4 v228, s[44:47], s24 offen offset:0 sc1 lds
    v_mfma_f32_16x16x32_bf16 v[188:191], a[156:159], a[92:95], v[188:191]
    ds_read_b128 a[148:151], v231 offset:29696
    v_mfma_f32_16x16x32_bf16 v[184:187], a[156:159], a[84:87], v[184:187]
    v_mfma_f32_16x16x32_bf16 v[184:187], a[152:155], a[80:83], v[184:187]
    buffer_load_dwordx4 a[56:59], v227, s[44:47], s25 offen offset:0 sc1
    v_mfma_f32_16x16x32_bf16 v[180:183], a[152:155], a[72:75], v[180:183]
    v_mfma_f32_16x16x32_bf16 v[180:183], a[156:159], a[76:79], v[180:183]
    v_mfma_f32_16x16x32_bf16 v[176:179], a[156:159], a[68:71], v[176:179]
    v_mfma_f32_16x16x32_bf16 v[176:179], a[152:155], a[64:67], v[176:179]
    ds_read_b128 a[152:155], v231 offset:30720
    s_waitcnt lgkmcnt(5)
    v_mfma_f32_16x16x32_bf16 v[192:195], a[128:131], a[64:67], v[192:195]
    ds_read_b128 a[156:159], v231 offset:31744
    v_mfma_f32_16x16x32_bf16 v[192:195], a[132:135], a[68:71], v[192:195]
    v_mfma_f32_16x16x32_bf16 v[196:199], a[132:135], a[76:79], v[196:199]
    v_mfma_f32_16x16x32_bf16 v[196:199], a[128:131], a[72:75], v[196:199]
    v_mfma_f32_16x16x32_bf16 v[200:203], a[128:131], a[80:83], v[200:203]
    v_mfma_f32_16x16x32_bf16 v[200:203], a[132:135], a[84:87], v[200:203]
    v_mfma_f32_16x16x32_bf16 v[204:207], a[132:135], a[92:95], v[204:207]
    buffer_load_dwordx4 v228, s[44:47], s24 offen offset:1024 sc1 lds
    v_mfma_f32_16x16x32_bf16 v[204:207], a[128:131], a[88:91], v[204:207]
    ds_read_b128 a[128:131], v231 offset:32768
    s_waitcnt lgkmcnt(5)
    v_mfma_f32_16x16x32_bf16 v[220:223], a[136:139], a[88:91], v[220:223]
    ds_read_b128 a[132:135], v231 offset:33792
    v_mfma_f32_16x16x32_bf16 v[220:223], a[140:143], a[92:95], v[220:223]
    buffer_load_dwordx4 a[60:63], v227, s[44:47], s25 offen offset:1024 sc1
    v_mfma_f32_16x16x32_bf16 v[216:219], a[140:143], a[84:87], v[216:219]
    v_mfma_f32_16x16x32_bf16 v[216:219], a[136:139], a[80:83], v[216:219]
    v_mfma_f32_16x16x32_bf16 v[212:215], a[136:139], a[72:75], v[212:215]
    v_mfma_f32_16x16x32_bf16 v[212:215], a[140:143], a[76:79], v[212:215]
    v_mfma_f32_16x16x32_bf16 v[208:211], a[140:143], a[68:71], v[208:211]
    v_mfma_f32_16x16x32_bf16 v[208:211], a[136:139], a[64:67], v[208:211]
    ds_read_b128 a[136:139], v231 offset:34816
    ds_read_b128 a[140:143], v231 offset:35840
    s_waitcnt lgkmcnt(6)
    v_mfma_f32_16x16x32_bf16 v[0:3], a[144:147], a[96:99], v[0:3]
    v_mfma_f32_16x16x32_bf16 v[0:3], a[148:151], a[100:103], v[0:3]
    v_mfma_f32_16x16x32_bf16 v[4:7], a[148:151], a[108:111], v[4:7]
    v_mfma_f32_16x16x32_bf16 v[4:7], a[144:147], a[104:107], v[4:7]
    v_mfma_f32_16x16x32_bf16 v[8:11], a[144:147], a[112:115], v[8:11]
    buffer_load_dwordx4 v228, s[44:47], s24 offen offset:2048 sc1 lds
    v_mfma_f32_16x16x32_bf16 v[8:11], a[148:151], a[116:119], v[8:11]
    v_mfma_f32_16x16x32_bf16 v[12:15], a[148:151], a[124:127], v[12:15]
    v_mfma_f32_16x16x32_bf16 v[12:15], a[144:147], a[120:123], v[12:15]
    ds_read_b128 a[144:147], v231 offset:36864
    s_waitcnt lgkmcnt(5)
    v_mfma_f32_16x16x32_bf16 v[28:31], a[152:155], a[120:123], v[28:31]
    s_add_u32 s25, s25, 2048
    buffer_load_dwordx4 a[64:67], v224, s[44:47], s25 offen offset:0 sc1
    v_mfma_f32_16x16x32_bf16 v[28:31], a[156:159], a[124:127], v[28:31]
    ds_read_b128 a[148:151], v231 offset:37888
    v_mfma_f32_16x16x32_bf16 v[24:27], a[156:159], a[116:119], v[24:27]
    v_mfma_f32_16x16x32_bf16 v[24:27], a[152:155], a[112:115], v[24:27]
    v_mfma_f32_16x16x32_bf16 v[20:23], a[152:155], a[104:107], v[20:23]
    v_mfma_f32_16x16x32_bf16 v[20:23], a[156:159], a[108:111], v[20:23]
    v_mfma_f32_16x16x32_bf16 v[16:19], a[156:159], a[100:103], v[16:19]
    v_mfma_f32_16x16x32_bf16 v[16:19], a[152:155], a[96:99], v[16:19]
    ds_read_b128 a[152:155], v231 offset:38912
    s_waitcnt lgkmcnt(5)
    v_mfma_f32_16x16x32_bf16 v[32:35], a[128:131], a[96:99], v[32:35]
    ds_read_b128 a[156:159], v231 offset:39936
    v_mfma_f32_16x16x32_bf16 v[32:35], a[132:135], a[100:103], v[32:35]
    v_mfma_f32_16x16x32_bf16 v[36:39], a[132:135], a[108:111], v[36:39]
    buffer_load_dwordx4 v228, s[44:47], s24 offen offset:3072 sc1 lds
    v_mfma_f32_16x16x32_bf16 v[36:39], a[128:131], a[104:107], v[36:39]
    v_mfma_f32_16x16x32_bf16 v[40:43], a[128:131], a[112:115], v[40:43]
    v_mfma_f32_16x16x32_bf16 v[40:43], a[132:135], a[116:119], v[40:43]
    buffer_load_dwordx4 a[68:71], v224, s[44:47], s25 offen offset:1024 sc1
    v_mfma_f32_16x16x32_bf16 v[44:47], a[132:135], a[124:127], v[44:47]
    v_mfma_f32_16x16x32_bf16 v[44:47], a[128:131], a[120:123], v[44:47]
    ds_read_b128 a[128:131], v231 offset:40960
    s_waitcnt lgkmcnt(5)
    v_mfma_f32_16x16x32_bf16 v[60:63], a[136:139], a[120:123], v[60:63]
    ds_read_b128 a[132:135], v231 offset:41984
    v_mfma_f32_16x16x32_bf16 v[60:63], a[140:143], a[124:127], v[60:63]
    v_mfma_f32_16x16x32_bf16 v[56:59], a[140:143], a[116:119], v[56:59]
    v_mfma_f32_16x16x32_bf16 v[56:59], a[136:139], a[112:115], v[56:59]
    v_mfma_f32_16x16x32_bf16 v[52:55], a[136:139], a[104:107], v[52:55]
    v_mfma_f32_16x16x32_bf16 v[52:55], a[140:143], a[108:111], v[52:55]
    v_mfma_f32_16x16x32_bf16 v[48:51], a[140:143], a[100:103], v[48:51]
    v_mfma_f32_16x16x32_bf16 v[48:51], a[136:139], a[96:99], v[48:51]
    ds_read_b128 a[136:139], v231 offset:43008
    s_waitcnt lgkmcnt(5)
    v_mfma_f32_16x16x32_bf16 v[64:67], a[144:147], a[96:99], v[64:67]
    ds_read_b128 a[140:143], v231 offset:44032
    v_mfma_f32_16x16x32_bf16 v[64:67], a[148:151], a[100:103], v[64:67]
    s_add_u32 m0, s26, 32768
    s_nop 0
    buffer_load_dwordx4 v229, s[44:47], s24 offen offset:0 sc1 lds
    v_mfma_f32_16x16x32_bf16 v[68:71], a[148:151], a[108:111], v[68:71]
    v_mfma_f32_16x16x32_bf16 v[68:71], a[144:147], a[104:107], v[68:71]
    buffer_load_dwordx4 a[72:75], v225, s[44:47], s25 offen offset:0 sc1
    v_mfma_f32_16x16x32_bf16 v[72:75], a[144:147], a[112:115], v[72:75]
    v_mfma_f32_16x16x32_bf16 v[72:75], a[148:151], a[116:119], v[72:75]
    v_mfma_f32_16x16x32_bf16 v[76:79], a[148:151], a[124:127], v[76:79]
    v_mfma_f32_16x16x32_bf16 v[76:79], a[144:147], a[120:123], v[76:79]
    ds_read_b128 a[144:147], v231 offset:45056
    s_waitcnt lgkmcnt(5)
    v_mfma_f32_16x16x32_bf16 v[92:95], a[152:155], a[120:123], v[92:95]
    ds_read_b128 a[148:151], v231 offset:46080
    v_mfma_f32_16x16x32_bf16 v[92:95], a[156:159], a[124:127], v[92:95]
    v_mfma_f32_16x16x32_bf16 v[88:91], a[156:159], a[116:119], v[88:91]
    v_mfma_f32_16x16x32_bf16 v[88:91], a[152:155], a[112:115], v[88:91]
    v_mfma_f32_16x16x32_bf16 v[84:87], a[152:155], a[104:107], v[84:87]
    v_mfma_f32_16x16x32_bf16 v[84:87], a[156:159], a[108:111], v[84:87]
    v_mfma_f32_16x16x32_bf16 v[80:83], a[156:159], a[100:103], v[80:83]
    v_mfma_f32_16x16x32_bf16 v[80:83], a[152:155], a[96:99], v[80:83]
    ds_read_b128 a[152:155], v231 offset:47104
    s_waitcnt lgkmcnt(5)
    v_mfma_f32_16x16x32_bf16 v[96:99], a[128:131], a[96:99], v[96:99]
    buffer_load_dwordx4 v229, s[44:47], s24 offen offset:1024 sc1 lds
    v_mfma_f32_16x16x32_bf16 v[96:99], a[132:135], a[100:103], v[96:99]
    buffer_load_dwordx4 a[76:79], v225, s[44:47], s25 offen offset:1024 sc1
    v_mfma_f32_16x16x32_bf16 v[100:103], a[132:135], a[108:111], v[100:103]
    ds_read_b128 a[156:159], v231 offset:48128
    v_mfma_f32_16x16x32_bf16 v[100:103], a[128:131], a[104:107], v[100:103]
    v_mfma_f32_16x16x32_bf16 v[104:107], a[128:131], a[112:115], v[104:107]
    v_mfma_f32_16x16x32_bf16 v[104:107], a[132:135], a[116:119], v[104:107]
    v_mfma_f32_16x16x32_bf16 v[108:111], a[132:135], a[124:127], v[108:111]
    v_mfma_f32_16x16x32_bf16 v[108:111], a[128:131], a[120:123], v[108:111]
    ds_read_b128 a[128:131], v231 offset:49152
    s_waitcnt lgkmcnt(5)
    v_mfma_f32_16x16x32_bf16 v[124:127], a[136:139], a[120:123], v[124:127]
    ds_read_b128 a[132:135], v231 offset:50176
    v_mfma_f32_16x16x32_bf16 v[124:127], a[140:143], a[124:127], v[124:127]
    v_mfma_f32_16x16x32_bf16 v[120:123], a[140:143], a[116:119], v[120:123]
    v_mfma_f32_16x16x32_bf16 v[120:123], a[136:139], a[112:115], v[120:123]
    v_mfma_f32_16x16x32_bf16 v[116:119], a[136:139], a[104:107], v[116:119]
    v_mfma_f32_16x16x32_bf16 v[116:119], a[140:143], a[108:111], v[116:119]
    buffer_load_dwordx4 v229, s[44:47], s24 offen offset:2048 sc1 lds
    v_mfma_f32_16x16x32_bf16 v[112:115], a[140:143], a[100:103], v[112:115]
    v_mfma_f32_16x16x32_bf16 v[112:115], a[136:139], a[96:99], v[112:115]
    ds_read_b128 a[136:139], v231 offset:51200
    s_waitcnt lgkmcnt(5)
    v_mfma_f32_16x16x32_bf16 v[128:131], a[144:147], a[96:99], v[128:131]
    buffer_load_dwordx4 a[80:83], v226, s[44:47], s25 offen offset:0 sc1
    v_mfma_f32_16x16x32_bf16 v[128:131], a[148:151], a[100:103], v[128:131]
    ds_read_b128 a[140:143], v231 offset:52224
    v_mfma_f32_16x16x32_bf16 v[132:135], a[148:151], a[108:111], v[132:135]
    v_mfma_f32_16x16x32_bf16 v[132:135], a[144:147], a[104:107], v[132:135]
    v_mfma_f32_16x16x32_bf16 v[136:139], a[144:147], a[112:115], v[136:139]
    v_mfma_f32_16x16x32_bf16 v[136:139], a[148:151], a[116:119], v[136:139]
    v_mfma_f32_16x16x32_bf16 v[140:143], a[148:151], a[124:127], v[140:143]
    v_mfma_f32_16x16x32_bf16 v[140:143], a[144:147], a[120:123], v[140:143]
    ds_read_b128 a[144:147], v231 offset:53248
    s_waitcnt lgkmcnt(5)
    v_mfma_f32_16x16x32_bf16 v[156:159], a[152:155], a[120:123], v[156:159]
    ds_read_b128 a[148:151], v231 offset:54272
    v_mfma_f32_16x16x32_bf16 v[156:159], a[156:159], a[124:127], v[156:159]
    v_mfma_f32_16x16x32_bf16 v[152:155], a[156:159], a[116:119], v[152:155]
    v_mfma_f32_16x16x32_bf16 v[152:155], a[152:155], a[112:115], v[152:155]
    v_mfma_f32_16x16x32_bf16 v[148:151], a[152:155], a[104:107], v[148:151]
    v_mfma_f32_16x16x32_bf16 v[148:151], a[156:159], a[108:111], v[148:151]
    buffer_load_dwordx4 a[84:87], v226, s[44:47], s25 offen offset:1024 sc1
    v_mfma_f32_16x16x32_bf16 v[144:147], a[156:159], a[100:103], v[144:147]
    v_mfma_f32_16x16x32_bf16 v[144:147], a[152:155], a[96:99], v[144:147]
    ds_read_b128 a[152:155], v231 offset:55296
    s_waitcnt lgkmcnt(5)
    v_mfma_f32_16x16x32_bf16 v[160:163], a[128:131], a[96:99], v[160:163]
    ds_read_b128 a[156:159], v231 offset:56320
    v_mfma_f32_16x16x32_bf16 v[160:163], a[132:135], a[100:103], v[160:163]
    v_mfma_f32_16x16x32_bf16 v[164:167], a[132:135], a[108:111], v[164:167]
    v_mfma_f32_16x16x32_bf16 v[164:167], a[128:131], a[104:107], v[164:167]
    v_mfma_f32_16x16x32_bf16 v[168:171], a[128:131], a[112:115], v[168:171]
    v_mfma_f32_16x16x32_bf16 v[168:171], a[132:135], a[116:119], v[168:171]
    v_mfma_f32_16x16x32_bf16 v[172:175], a[132:135], a[124:127], v[172:175]
    s_waitcnt vmcnt(17)
    s_barrier
    v_mfma_f32_16x16x32_bf16 v[172:175], a[128:131], a[120:123], v[172:175]
    ds_read_b128 a[128:131], v230 offset:0
    s_waitcnt lgkmcnt(5)
    v_mfma_f32_16x16x32_bf16 v[188:191], a[136:139], a[120:123], v[188:191]
    s_add_u32 m0, s26, 57344
    s_add_u32 s24, s24, 28672
    buffer_load_dwordx4 v228, s[44:47], s24 offen offset:0 sc1 lds
    v_mfma_f32_16x16x32_bf16 v[188:191], a[140:143], a[124:127], v[188:191]
    ds_read_b128 a[132:135], v230 offset:1024
    v_mfma_f32_16x16x32_bf16 v[184:187], a[140:143], a[116:119], v[184:187]
    v_mfma_f32_16x16x32_bf16 v[184:187], a[136:139], a[112:115], v[184:187]
    buffer_load_dwordx4 a[88:91], v227, s[44:47], s25 offen offset:0 sc1
    v_mfma_f32_16x16x32_bf16 v[180:183], a[136:139], a[104:107], v[180:183]
    v_mfma_f32_16x16x32_bf16 v[180:183], a[140:143], a[108:111], v[180:183]
    v_mfma_f32_16x16x32_bf16 v[176:179], a[140:143], a[100:103], v[176:179]
    v_mfma_f32_16x16x32_bf16 v[176:179], a[136:139], a[96:99], v[176:179]
    ds_read_b128 a[136:139], v230 offset:2048
    s_waitcnt lgkmcnt(5)
    v_mfma_f32_16x16x32_bf16 v[192:195], a[144:147], a[96:99], v[192:195]
    ds_read_b128 a[140:143], v230 offset:3072
    v_mfma_f32_16x16x32_bf16 v[192:195], a[148:151], a[100:103], v[192:195]
    v_mfma_f32_16x16x32_bf16 v[196:199], a[148:151], a[108:111], v[196:199]
    v_mfma_f32_16x16x32_bf16 v[196:199], a[144:147], a[104:107], v[196:199]
    v_mfma_f32_16x16x32_bf16 v[200:203], a[144:147], a[112:115], v[200:203]
    v_mfma_f32_16x16x32_bf16 v[200:203], a[148:151], a[116:119], v[200:203]
    v_mfma_f32_16x16x32_bf16 v[204:207], a[148:151], a[124:127], v[204:207]
    buffer_load_dwordx4 v228, s[44:47], s24 offen offset:1024 sc1 lds
    v_mfma_f32_16x16x32_bf16 v[204:207], a[144:147], a[120:123], v[204:207]
    ds_read_b128 a[144:147], v230 offset:4096
    s_waitcnt lgkmcnt(5)
    v_mfma_f32_16x16x32_bf16 v[220:223], a[152:155], a[120:123], v[220:223]
    ds_read_b128 a[148:151], v230 offset:5120
    v_mfma_f32_16x16x32_bf16 v[220:223], a[156:159], a[124:127], v[220:223]
    buffer_load_dwordx4 a[92:95], v227, s[44:47], s25 offen offset:1024 sc1
    v_mfma_f32_16x16x32_bf16 v[216:219], a[156:159], a[116:119], v[216:219]
    v_mfma_f32_16x16x32_bf16 v[216:219], a[152:155], a[112:115], v[216:219]
    v_mfma_f32_16x16x32_bf16 v[212:215], a[152:155], a[104:107], v[212:215]
    v_mfma_f32_16x16x32_bf16 v[212:215], a[156:159], a[108:111], v[212:215]
    v_mfma_f32_16x16x32_bf16 v[208:211], a[156:159], a[100:103], v[208:211]
    v_mfma_f32_16x16x32_bf16 v[208:211], a[152:155], a[96:99], v[208:211]
    ds_read_b128 a[152:155], v230 offset:6144
    ds_read_b128 a[156:159], v230 offset:7168
    s_sub_u32 s27, s27, 1
    s_cmp_lg_u32 s27, 0
    s_cbranch_scc1 L_u1
    s_waitcnt lgkmcnt(6)
    v_mfma_f32_16x16x32_bf16 v[0:3], a[128:131], a[0:3], v[0:3]
    v_mfma_f32_16x16x32_bf16 v[0:3], a[132:135], a[4:7], v[0:3]
    v_mfma_f32_16x16x32_bf16 v[4:7], a[132:135], a[12:15], v[4:7]
    v_mfma_f32_16x16x32_bf16 v[4:7], a[128:131], a[8:11], v[4:7]
    v_mfma_f32_16x16x32_bf16 v[8:11], a[128:131], a[16:19], v[8:11]
    buffer_load_dwordx4 v228, s[44:47], s24 offen offset:2048 sc1 lds
    v_mfma_f32_16x16x32_bf16 v[8:11], a[132:135], a[20:23], v[8:11]
    v_mfma_f32_16x16x32_bf16 v[12:15], a[132:135], a[28:31], v[12:15]
    v_mfma_f32_16x16x32_bf16 v[12:15], a[128:131], a[24:27], v[12:15]
    ds_read_b128 a[128:131], v230 offset:8192
    s_waitcnt lgkmcnt(5)
    v_mfma_f32_16x16x32_bf16 v[28:31], a[136:139], a[24:27], v[28:31]
    s_add_u32 s25, s25, 2048
    buffer_load_dwordx4 a[96:99], v224, s[44:47], s25 offen offset:0 sc1
    v_mfma_f32_16x16x32_bf16 v[28:31], a[140:143], a[28:31], v[28:31]
    ds_read_b128 a[132:135], v230 offset:9216
    v_mfma_f32_16x16x32_bf16 v[24:27], a[140:143], a[20:23], v[24:27]
    v_mfma_f32_16x16x32_bf16 v[24:27], a[136:139], a[16:19], v[24:27]
    v_mfma_f32_16x16x32_bf16 v[20:23], a[136:139], a[8:11], v[20:23]
    v_mfma_f32_16x16x32_bf16 v[20:23], a[140:143], a[12:15], v[20:23]
    v_mfma_f32_16x16x32_bf16 v[16:19], a[140:143], a[4:7], v[16:19]
    v_mfma_f32_16x16x32_bf16 v[16:19], a[136:139], a[0:3], v[16:19]
    ds_read_b128 a[136:139], v230 offset:10240
    s_waitcnt lgkmcnt(5)
    v_mfma_f32_16x16x32_bf16 v[32:35], a[144:147], a[0:3], v[32:35]
    ds_read_b128 a[140:143], v230 offset:11264
    v_mfma_f32_16x16x32_bf16 v[32:35], a[148:151], a[4:7], v[32:35]
    v_mfma_f32_16x16x32_bf16 v[36:39], a[148:151], a[12:15], v[36:39]
    buffer_load_dwordx4 v228, s[44:47], s24 offen offset:3072 sc1 lds
    v_mfma_f32_16x16x32_bf16 v[36:39], a[144:147], a[8:11], v[36:39]
    v_mfma_f32_16x16x32_bf16 v[40:43], a[144:147], a[16:19], v[40:43]
    v_mfma_f32_16x16x32_bf16 v[40:43], a[148:151], a[20:23], v[40:43]
    buffer_load_dwordx4 a[100:103], v224, s[44:47], s25 offen offset:1024 sc1
    v_mfma_f32_16x16x32_bf16 v[44:47], a[148:151], a[28:31], v[44:47]
    v_mfma_f32_16x16x32_bf16 v[44:47], a[144:147], a[24:27], v[44:47]
    ds_read_b128 a[144:147], v230 offset:12288
    s_waitcnt lgkmcnt(5)
    v_mfma_f32_16x16x32_bf16 v[60:63], a[152:155], a[24:27], v[60:63]
    ds_read_b128 a[148:151], v230 offset:13312
    v_mfma_f32_16x16x32_bf16 v[60:63], a[156:159], a[28:31], v[60:63]
    v_mfma_f32_16x16x32_bf16 v[56:59], a[156:159], a[20:23], v[56:59]
    v_mfma_f32_16x16x32_bf16 v[56:59], a[152:155], a[16:19], v[56:59]
    v_mfma_f32_16x16x32_bf16 v[52:55], a[152:155], a[8:11], v[52:55]
    v_mfma_f32_16x16x32_bf16 v[52:55], a[156:159], a[12:15], v[52:55]
    v_mfma_f32_16x16x32_bf16 v[48:51], a[156:159], a[4:7], v[48:51]
    v_mfma_f32_16x16x32_bf16 v[48:51], a[152:155], a[0:3], v[48:51]
    ds_read_b128 a[152:155], v230 offset:14336
    s_waitcnt lgkmcnt(5)
    v_mfma_f32_16x16x32_bf16 v[64:67], a[128:131], a[0:3], v[64:67]
    ds_read_b128 a[156:159], v230 offset:15360
    v_mfma_f32_16x16x32_bf16 v[64:67], a[132:135], a[4:7], v[64:67]
    s_add_u32 m0, s26, 61440
    s_nop 0
    buffer_load_dwordx4 v229, s[44:47], s24 offen offset:0 sc1 lds
    v_mfma_f32_16x16x32_bf16 v[68:71], a[132:135], a[12:15], v[68:71]
    v_mfma_f32_16x16x32_bf16 v[68:71], a[128:131], a[8:11], v[68:71]
    buffer_load_dwordx4 a[104:107], v225, s[44:47], s25 offen offset:0 sc1
    v_mfma_f32_16x16x32_bf16 v[72:75], a[128:131], a[16:19], v[72:75]
    v_mfma_f32_16x16x32_bf16 v[72:75], a[132:135], a[20:23], v[72:75]
    v_mfma_f32_16x16x32_bf16 v[76:79], a[132:135], a[28:31], v[76:79]
    v_mfma_f32_16x16x32_bf16 v[76:79], a[128:131], a[24:27], v[76:79]
    ds_read_b128 a[128:131], v230 offset:16384
    s_waitcnt lgkmcnt(5)
    v_mfma_f32_16x16x32_bf16 v[92:95], a[136:139], a[24:27], v[92:95]
    ds_read_b128 a[132:135], v230 offset:17408
    v_mfma_f32_16x16x32_bf16 v[92:95], a[140:143], a[28:31], v[92:95]
    v_mfma_f32_16x16x32_bf16 v[88:91], a[140:143], a[20:23], v[88:91]
    v_mfma_f32_16x16x32_bf16 v[88:91], a[136:139], a[16:19], v[88:91]
    v_mfma_f32_16x16x32_bf16 v[84:87], a[136:139], a[8:11], v[84:87]
    v_mfma_f32_16x16x32_bf16 v[84:87], a[140:143], a[12:15], v[84:87]
    v_mfma_f32_16x16x32_bf16 v[80:83], a[140:143], a[4:7], v[80:83]
    v_mfma_f32_16x16x32_bf16 v[80:83], a[136:139], a[0:3], v[80:83]
    ds_read_b128 a[136:139], v230 offset:18432
    s_waitcnt lgkmcnt(5)
    v_mfma_f32_16x16x32_bf16 v[96:99], a[144:147], a[0:3], v[96:99]
    buffer_load_dwordx4 v229, s[44:47], s24 offen offset:1024 sc1 lds
    v_mfma_f32_16x16x32_bf16 v[96:99], a[148:151], a[4:7], v[96:99]
    buffer_load_dwordx4 a[108:111], v225, s[44:47], s25 offen offset:1024 sc1
    v_mfma_f32_16x16x32_bf16 v[100:103], a[148:151], a[12:15], v[100:103]
    ds_read_b128 a[140:143], v230 offset:19456
    v_mfma_f32_16x16x32_bf16 v[100:103], a[144:147], a[8:11], v[100:103]
    v_mfma_f32_16x16x32_bf16 v[104:107], a[144:147], a[16:19], v[104:107]
    v_mfma_f32_16x16x32_bf16 v[104:107], a[148:151], a[20:23], v[104:107]
    v_mfma_f32_16x16x32_bf16 v[108:111], a[148:151], a[28:31], v[108:111]
    v_mfma_f32_16x16x32_bf16 v[108:111], a[144:147], a[24:27], v[108:111]
    ds_read_b128 a[144:147], v230 offset:20480
    s_waitcnt lgkmcnt(5)
    v_mfma_f32_16x16x32_bf16 v[124:127], a[152:155], a[24:27], v[124:127]
    ds_read_b128 a[148:151], v230 offset:21504
    v_mfma_f32_16x16x32_bf16 v[124:127], a[156:159], a[28:31], v[124:127]
    v_mfma_f32_16x16x32_bf16 v[120:123], a[156:159], a[20:23], v[120:123]
    v_mfma_f32_16x16x32_bf16 v[120:123], a[152:155], a[16:19], v[120:123]
    v_mfma_f32_16x16x32_bf16 v[116:119], a[152:155], a[8:11], v[116:119]
    v_mfma_f32_16x16x32_bf16 v[116:119], a[156:159], a[12:15], v[116:119]
    buffer_load_dwordx4 v229, s[44:47], s24 offen offset:2048 sc1 lds
    v_mfma_f32_16x16x32_bf16 v[112:115], a[156:159], a[4:7], v[112:115]
    v_mfma_f32_16x16x32_bf16 v[112:115], a[152:155], a[0:3], v[112:115]
    ds_read_b128 a[152:155], v230 offset:22528
    s_waitcnt lgkmcnt(5)
    v_mfma_f32_16x16x32_bf16 v[128:131], a[128:131], a[0:3], v[128:131]
    buffer_load_dwordx4 a[112:115], v226, s[44:47], s25 offen offset:0 sc1
    v_mfma_f32_16x16x32_bf16 v[128:131], a[132:135], a[4:7], v[128:131]
    ds_read_b128 a[156:159], v230 offset:23552
    v_mfma_f32_16x16x32_bf16 v[132:135], a[132:135], a[12:15], v[132:135]
    v_mfma_f32_16x16x32_bf16 v[132:135], a[128:131], a[8:11], v[132:135]
    v_mfma_f32_16x16x32_bf16 v[136:139], a[128:131], a[16:19], v[136:139]
    v_mfma_f32_16x16x32_bf16 v[136:139], a[132:135], a[20:23], v[136:139]
    v_mfma_f32_16x16x32_bf16 v[140:143], a[132:135], a[28:31], v[140:143]
    v_mfma_f32_16x16x32_bf16 v[140:143], a[128:131], a[24:27], v[140:143]
    ds_read_b128 a[128:131], v230 offset:24576
    s_waitcnt lgkmcnt(5)
    v_mfma_f32_16x16x32_bf16 v[156:159], a[136:139], a[24:27], v[156:159]
    ds_read_b128 a[132:135], v230 offset:25600
    v_mfma_f32_16x16x32_bf16 v[156:159], a[140:143], a[28:31], v[156:159]
    v_mfma_f32_16x16x32_bf16 v[152:155], a[140:143], a[20:23], v[152:155]
    v_mfma_f32_16x16x32_bf16 v[152:155], a[136:139], a[16:19], v[152:155]
    v_mfma_f32_16x16x32_bf16 v[148:151], a[136:139], a[8:11], v[148:151]
    v_mfma_f32_16x16x32_bf16 v[148:151], a[140:143], a[12:15], v[148:151]
    buffer_load_dwordx4 a[116:119], v226, s[44:47], s25 offen offset:1024 sc1
    v_mfma_f32_16x16x32_bf16 v[144:147], a[140:143], a[4:7], v[144:147]
    v_mfma_f32_16x16x32_bf16 v[144:147], a[136:139], a[0:3], v[144:147]
    ds_read_b128 a[136:139], v230 offset:26624
    s_waitcnt lgkmcnt(5)
    v_mfma_f32_16x16x32_bf16 v[160:163], a[144:147], a[0:3], v[160:163]
    ds_read_b128 a[140:143], v230 offset:27648
    v_mfma_f32_16x16x32_bf16 v[160:163], a[148:151], a[4:7], v[160:163]
    v_mfma_f32_16x16x32_bf16 v[164:167], a[148:151], a[12:15], v[164:167]
    v_mfma_f32_16x16x32_bf16 v[164:167], a[144:147], a[8:11], v[164:167]
    v_mfma_f32_16x16x32_bf16 v[168:171], a[144:147], a[16:19], v[168:171]
    v_mfma_f32_16x16x32_bf16 v[168:171], a[148:151], a[20:23], v[168:171]
    v_mfma_f32_16x16x32_bf16 v[172:175], a[148:151], a[28:31], v[172:175]
    s_waitcnt vmcnt(17)
    s_barrier
    v_mfma_f32_16x16x32_bf16 v[172:175], a[144:147], a[24:27], v[172:175]
    ds_read_b128 a[144:147], v230 offset:28672
    s_waitcnt lgkmcnt(5)
    v_mfma_f32_16x16x32_bf16 v[188:191], a[152:155], a[24:27], v[188:191]
    s_add_u32 m0, s26, 86016
    s_add_u32 s24, s24, 28672
    buffer_load_dwordx4 v228, s[44:47], s24 offen offset:0 sc1 lds
    v_mfma_f32_16x16x32_bf16 v[188:191], a[156:159], a[28:31], v[188:191]
    ds_read_b128 a[148:151], v230 offset:29696
    v_mfma_f32_16x16x32_bf16 v[184:187], a[156:159], a[20:23], v[184:187]
    v_mfma_f32_16x16x32_bf16 v[184:187], a[152:155], a[16:19], v[184:187]
    buffer_load_dwordx4 a[120:123], v227, s[44:47], s25 offen offset:0 sc1
    v_mfma_f32_16x16x32_bf16 v[180:183], a[152:155], a[8:11], v[180:183]
    v_mfma_f32_16x16x32_bf16 v[180:183], a[156:159], a[12:15], v[180:183]
    v_mfma_f32_16x16x32_bf16 v[176:179], a[156:159], a[4:7], v[176:179]
    buffer_load_dwordx4 v228, s[44:47], s24 offen offset:1024 sc1 lds
    v_mfma_f32_16x16x32_bf16 v[176:179], a[152:155], a[0:3], v[176:179]
    ds_read_b128 a[152:155], v230 offset:30720
    s_waitcnt lgkmcnt(5)
    v_mfma_f32_16x16x32_bf16 v[192:195], a[128:131], a[0:3], v[192:195]
    ds_read_b128 a[156:159], v230 offset:31744
    v_mfma_f32_16x16x32_bf16 v[192:195], a[132:135], a[4:7], v[192:195]
    v_mfma_f32_16x16x32_bf16 v[196:199], a[132:135], a[12:15], v[196:199]
    v_mfma_f32_16x16x32_bf16 v[196:199], a[128:131], a[8:11], v[196:199]
    v_mfma_f32_16x16x32_bf16 v[200:203], a[128:131], a[16:19], v[200:203]
    buffer_load_dwordx4 v228, s[44:47], s24 offen offset:2048 sc1 lds
    v_mfma_f32_16x16x32_bf16 v[200:203], a[132:135], a[20:23], v[200:203]
    v_mfma_f32_16x16x32_bf16 v[204:207], a[132:135], a[28:31], v[204:207]
    v_mfma_f32_16x16x32_bf16 v[204:207], a[128:131], a[24:27], v[204:207]
    ds_read_b128 a[128:131], v230 offset:32768
    s_waitcnt lgkmcnt(5)
    v_mfma_f32_16x16x32_bf16 v[220:223], a[136:139], a[24:27], v[220:223]
    ds_read_b128 a[132:135], v230 offset:33792
    v_mfma_f32_16x16x32_bf16 v[220:223], a[140:143], a[28:31], v[220:223]
    buffer_load_dwordx4 a[124:127], v227, s[44:47], s25 offen offset:1024 sc1
    v_mfma_f32_16x16x32_bf16 v[216:219], a[140:143], a[20:23], v[216:219]
    buffer_load_dwordx4 v228, s[44:47], s24 offen offset:3072 sc1 lds
    v_mfma_f32_16x16x32_bf16 v[216:219], a[136:139], a[16:19], v[216:219]
    v_mfma_f32_16x16x32_bf16 v[212:215], a[136:139], a[8:11], v[212:215]
    v_mfma_f32_16x16x32_bf16 v[212:215], a[140:143], a[12:15], v[212:215]
    v_mfma_f32_16x16x32_bf16 v[208:211], a[140:143], a[4:7], v[208:211]
    v_mfma_f32_16x16x32_bf16 v[208:211], a[136:139], a[0:3], v[208:211]
    ds_read_b128 a[136:139], v230 offset:34816
    ds_read_b128 a[140:143], v230 offset:35840
    s_waitcnt lgkmcnt(6)
    v_mfma_f32_16x16x32_bf16 v[0:3], a[144:147], a[32:35], v[0:3]
    v_mfma_f32_16x16x32_bf16 v[0:3], a[148:151], a[36:39], v[0:3]
    s_add_u32 m0, s26, 90112
    s_nop 0
    buffer_load_dwordx4 v229, s[44:47], s24 offen offset:0 sc1 lds
    v_mfma_f32_16x16x32_bf16 v[4:7], a[148:151], a[44:47], v[4:7]
    v_mfma_f32_16x16x32_bf16 v[4:7], a[144:147], a[40:43], v[4:7]
    v_mfma_f32_16x16x32_bf16 v[8:11], a[144:147], a[48:51], v[8:11]
    v_mfma_f32_16x16x32_bf16 v[8:11], a[148:151], a[52:55], v[8:11]
    v_mfma_f32_16x16x32_bf16 v[12:15], a[148:151], a[60:63], v[12:15]
    v_mfma_f32_16x16x32_bf16 v[12:15], a[144:147], a[56:59], v[12:15]
    ds_read_b128 a[144:147], v230 offset:36864
    s_waitcnt lgkmcnt(5)
    v_mfma_f32_16x16x32_bf16 v[28:31], a[152:155], a[56:59], v[28:31]
    buffer_load_dwordx4 v229, s[44:47], s24 offen offset:1024 sc1 lds
    v_mfma_f32_16x16x32_bf16 v[28:31], a[156:159], a[60:63], v[28:31]
    ds_read_b128 a[148:151], v230 offset:37888
    v_mfma_f32_16x16x32_bf16 v[24:27], a[156:159], a[52:55], v[24:27]
    v_mfma_f32_16x16x32_bf16 v[24:27], a[152:155], a[48:51], v[24:27]
    v_mfma_f32_16x16x32_bf16 v[20:23], a[152:155], a[40:43], v[20:23]
    v_mfma_f32_16x16x32_bf16 v[20:23], a[156:159], a[44:47], v[20:23]
    buffer_load_dwordx4 v229, s[44:47], s24 offen offset:2048 sc1 lds
    v_mfma_f32_16x16x32_bf16 v[16:19], a[156:159], a[36:39], v[16:19]
    v_mfma_f32_16x16x32_bf16 v[16:19], a[152:155], a[32:35], v[16:19]
    ds_read_b128 a[152:155], v230 offset:38912
    s_waitcnt lgkmcnt(5)
    v_mfma_f32_16x16x32_bf16 v[32:35], a[128:131], a[32:35], v[32:35]
    ds_read_b128 a[156:159], v230 offset:39936
    v_mfma_f32_16x16x32_bf16 v[32:35], a[132:135], a[36:39], v[32:35]
    v_mfma_f32_16x16x32_bf16 v[36:39], a[132:135], a[44:47], v[36:39]
    v_mfma_f32_16x16x32_bf16 v[36:39], a[128:131], a[40:43], v[36:39]
    v_mfma_f32_16x16x32_bf16 v[40:43], a[128:131], a[48:51], v[40:43]
    v_mfma_f32_16x16x32_bf16 v[40:43], a[132:135], a[52:55], v[40:43]
    v_mfma_f32_16x16x32_bf16 v[44:47], a[132:135], a[60:63], v[44:47]
    v_mfma_f32_16x16x32_bf16 v[44:47], a[128:131], a[56:59], v[44:47]
    ds_read_b128 a[128:131], v230 offset:40960
    s_waitcnt lgkmcnt(5)
    v_mfma_f32_16x16x32_bf16 v[60:63], a[136:139], a[56:59], v[60:63]
    ds_read_b128 a[132:135], v230 offset:41984
    v_mfma_f32_16x16x32_bf16 v[60:63], a[140:143], a[60:63], v[60:63]
    v_mfma_f32_16x16x32_bf16 v[56:59], a[140:143], a[52:55], v[56:59]
    v_mfma_f32_16x16x32_bf16 v[56:59], a[136:139], a[48:51], v[56:59]
    v_mfma_f32_16x16x32_bf16 v[52:55], a[136:139], a[40:43], v[52:55]
    v_mfma_f32_16x16x32_bf16 v[52:55], a[140:143], a[44:47], v[52:55]
    v_mfma_f32_16x16x32_bf16 v[48:51], a[140:143], a[36:39], v[48:51]
    v_mfma_f32_16x16x32_bf16 v[48:51], a[136:139], a[32:35], v[48:51]
    ds_read_b128 a[136:139], v230 offset:43008
    s_waitcnt lgkmcnt(5)
    v_mfma_f32_16x16x32_bf16 v[64:67], a[144:147], a[32:35], v[64:67]
    ds_read_b128 a[140:143], v230 offset:44032
    v_mfma_f32_16x16x32_bf16 v[64:67], a[148:151], a[36:39], v[64:67]
    v_mfma_f32_16x16x32_bf16 v[68:71], a[148:151], a[44:47], v[68:71]
    v_mfma_f32_16x16x32_bf16 v[68:71], a[144:147], a[40:43], v[68:71]
    v_mfma_f32_16x16x32_bf16 v[72:75], a[144:147], a[48:51], v[72:75]
    v_mfma_f32_16x16x32_bf16 v[72:75], a[148:151], a[52:55], v[72:75]
    v_mfma_f32_16x16x32_bf16 v[76:79], a[148:151], a[60:63], v[76:79]
    v_mfma_f32_16x16x32_bf16 v[76:79], a[144:147], a[56:59], v[76:79]
    ds_read_b128 a[144:147], v230 offset:45056
    s_waitcnt lgkmcnt(5)
    v_mfma_f32_16x16x32_bf16 v[92:95], a[152:155], a[56:59], v[92:95]
    ds_read_b128 a[148:151], v230 offset:46080
    v_mfma_f32_16x16x32_bf16 v[92:95], a[156:159], a[60:63], v[92:95]
    v_mfma_f32_16x16x32_bf16 v[88:91], a[156:159], a[52:55], v[88:91]
    v_mfma_f32_16x16x32_bf16 v[88:91], a[152:155], a[48:51], v[88:91]
    v_mfma_f32_16x16x32_bf16 v[84:87], a[152:155], a[40:43], v[84:87]
    v_mfma_f32_16x16x32_bf16 v[84:87], a[156:159], a[44:47], v[84:87]
    v_mfma_f32_16x16x32_bf16 v[80:83], a[156:159], a[36:39], v[80:83]
    v_mfma_f32_16x16x32_bf16 v[80:83], a[152:155], a[32:35], v[80:83]
    ds_read_b128 a[152:155], v230 offset:47104
    s_waitcnt lgkmcnt(5)
    v_mfma_f32_16x16x32_bf16 v[96:99], a[128:131], a[32:35], v[96:99]
    ds_read_b128 a[156:159], v230 offset:48128
    v_mfma_f32_16x16x32_bf16 v[96:99], a[132:135], a[36:39], v[96:99]
    v_mfma_f32_16x16x32_bf16 v[100:103], a[132:135], a[44:47], v[100:103]
    v_mfma_f32_16x16x32_bf16 v[100:103], a[128:131], a[40:43], v[100:103]
    v_mfma_f32_16x16x32_bf16 v[104:107], a[128:131], a[48:51], v[104:107]
    v_mfma_f32_16x16x32_bf16 v[104:107], a[132:135], a[52:55], v[104:107]
    v_mfma_f32_16x16x32_bf16 v[108:111], a[132:135], a[60:63], v[108:111]
    v_mfma_f32_16x16x32_bf16 v[108:111], a[128:131], a[56:59], v[108:111]
    ds_read_b128 a[128:131], v230 offset:49152
    s_waitcnt lgkmcnt(5)
    v_mfma_f32_16x16x32_bf16 v[124:127], a[136:139], a[56:59], v[124:127]
    ds_read_b128 a[132:135], v230 offset:50176
    v_mfma_f32_16x16x32_bf16 v[124:127], a[140:143], a[60:63], v[124:127]
    v_mfma_f32_16x16x32_bf16 v[120:123], a[140:143], a[52:55], v[120:123]
    v_mfma_f32_16x16x32_bf16 v[120:123], a[136:139], a[48:51], v[120:123]
    v_mfma_f32_16x16x32_bf16 v[116:119], a[136:139], a[40:43], v[116:119]
    s_lshr_b32 s12, s2, 3
    v_mfma_f32_16x16x32_bf16 v[116:119], a[140:143], a[44:47], v[116:119]
    s_and_b32 s12, s12, 31
    v_mfma_f32_16x16x32_bf16 v[112:115], a[140:143], a[36:39], v[112:115]
    s_lshl_b32 s12, s12, 10
    v_mfma_f32_16x16x32_bf16 v[112:115], a[136:139], a[32:35], v[112:115]
    v_and_b32 v233, 7, v232
    s_waitcnt lgkmcnt(4)
    v_mfma_f32_16x16x32_bf16 v[128:131], a[144:147], a[32:35], v[128:131]
    v_lshlrev_b32 v233, 7, v233
    v_mfma_f32_16x16x32_bf16 v[128:131], a[148:151], a[36:39], v[128:131]
    v_add_u32 v233, s12, v233
    v_mfma_f32_16x16x32_bf16 v[132:135], a[148:151], a[44:47], v[132:135]
    s_getpc_b64 s[10:11]
    s_add_u32 s10, s10, PH_d1@rel32@lo+4
    s_addc_u32 s11, s11, PH_d1@rel32@hi+12
    v_min_u32 v234, END_PH_d1-PH_d1-4, v233
    global_load_dword v234, v234, s[10:11]
    v_mfma_f32_16x16x32_bf16 v[132:135], a[144:147], a[40:43], v[132:135]
    ds_read_b128 a[136:139], v230 offset:51200
    v_mfma_f32_16x16x32_bf16 v[136:139], a[144:147], a[48:51], v[136:139]
    ds_read_b128 a[140:143], v230 offset:52224
    v_mfma_f32_16x16x32_bf16 v[136:139], a[148:151], a[52:55], v[136:139]
    v_mfma_f32_16x16x32_bf16 v[140:143], a[148:151], a[60:63], v[140:143]
    v_mfma_f32_16x16x32_bf16 v[140:143], a[144:147], a[56:59], v[140:143]
    ds_read_b128 a[144:147], v230 offset:53248
    s_waitcnt lgkmcnt(5)
    v_mfma_f32_16x16x32_bf16 v[156:159], a[152:155], a[56:59], v[156:159]
    ds_read_b128 a[148:151], v230 offset:54272
    v_mfma_f32_16x16x32_bf16 v[156:159], a[156:159], a[60:63], v[156:159]
    v_mfma_f32_16x16x32_bf16 v[152:155], a[156:159], a[52:55], v[152:155]
    v_mfma_f32_16x16x32_bf16 v[152:155], a[152:155], a[48:51], v[152:155]
    v_mfma_f32_16x16x32_bf16 v[148:151], a[152:155], a[40:43], v[148:151]
    v_mfma_f32_16x16x32_bf16 v[148:151], a[156:159], a[44:47], v[148:151]
    v_mfma_f32_16x16x32_bf16 v[144:147], a[156:159], a[36:39], v[144:147]
    v_mfma_f32_16x16x32_bf16 v[144:147], a[152:155], a[32:35], v[144:147]
    ds_read_b128 a[152:155], v230 offset:55296
    s_waitcnt lgkmcnt(5)
    v_mfma_f32_16x16x32_bf16 v[160:163], a[128:131], a[32:35], v[160:163]
    ds_read_b128 a[156:159], v230 offset:56320
    v_mfma_f32_16x16x32_bf16 v[160:163], a[132:135], a[36:39], v[160:163]
    v_mfma_f32_16x16x32_bf16 v[164:167], a[132:135], a[44:47], v[164:167]
    v_mfma_f32_16x16x32_bf16 v[164:167], a[128:131], a[40:43], v[164:167]
    v_mfma_f32_16x16x32_bf16 v[168:171], a[128:131], a[48:51], v[168:171]
    v_mfma_f32_16x16x32_bf16 v[168:171], a[132:135], a[52:55], v[168:171]
    v_mfma_f32_16x16x32_bf16 v[172:175], a[132:135], a[60:63], v[172:175]
    s_waitcnt vmcnt(1)
    s_barrier
    v_mfma_f32_16x16x32_bf16 v[172:175], a[128:131], a[56:59], v[172:175]
    ds_read_b128 a[128:131], v231 offset:0
    s_waitcnt lgkmcnt(5)
    v_mfma_f32_16x16x32_bf16 v[188:191], a[136:139], a[56:59], v[188:191]
    ds_read_b128 a[132:135], v231 offset:1024
    v_mfma_f32_16x16x32_bf16 v[188:191], a[140:143], a[60:63], v[188:191]
    v_mfma_f32_16x16x32_bf16 v[184:187], a[140:143], a[52:55], v[184:187]
    v_mfma_f32_16x16x32_bf16 v[184:187], a[136:139], a[48:51], v[184:187]
    v_mfma_f32_16x16x32_bf16 v[180:183], a[136:139], a[40:43], v[180:183]
    v_mfma_f32_16x16x32_bf16 v[180:183], a[140:143], a[44:47], v[180:183]
    v_mfma_f32_16x16x32_bf16 v[176:179], a[140:143], a[36:39], v[176:179]
    v_mfma_f32_16x16x32_bf16 v[176:179], a[136:139], a[32:35], v[176:179]
    ds_read_b128 a[136:139], v231 offset:28672
    s_waitcnt lgkmcnt(5)
    v_mfma_f32_16x16x32_bf16 v[192:195], a[144:147], a[32:35], v[192:195]
    ds_read_b128 a[140:143], v231 offset:29696
    v_mfma_f32_16x16x32_bf16 v[192:195], a[148:151], a[36:39], v[192:195]
    v_mfma_f32_16x16x32_bf16 v[196:199], a[148:151], a[44:47], v[196:199]
    v_mfma_f32_16x16x32_bf16 v[196:199], a[144:147], a[40:43], v[196:199]
    v_mfma_f32_16x16x32_bf16 v[200:203], a[144:147], a[48:51], v[200:203]
    v_mfma_f32_16x16x32_bf16 v[200:203], a[148:151], a[52:55], v[200:203]
    v_mfma_f32_16x16x32_bf16 v[204:207], a[148:151], a[60:63], v[204:207]
    v_mfma_f32_16x16x32_bf16 v[204:207], a[144:147], a[56:59], v[204:207]
    ds_read_b128 a[144:147], v231 offset:2048
    s_waitcnt lgkmcnt(5)
    v_mfma_f32_16x16x32_bf16 v[220:223], a[152:155], a[56:59], v[220:223]
    ds_read_b128 a[148:151], v231 offset:3072
    v_mfma_f32_16x16x32_bf16 v[220:223], a[156:159], a[60:63], v[220:223]
    v_mfma_f32_16x16x32_bf16 v[216:219], a[156:159], a[52:55], v[216:219]
    v_mfma_f32_16x16x32_bf16 v[216:219], a[152:155], a[48:51], v[216:219]
    v_mfma_f32_16x16x32_bf16 v[212:215], a[152:155], a[40:43], v[212:215]
    v_mfma_f32_16x16x32_bf16 v[212:215], a[156:159], a[44:47], v[212:215]
    v_mfma_f32_16x16x32_bf16 v[208:211], a[156:159], a[36:39], v[208:211]
    v_mfma_f32_16x16x32_bf16 v[208:211], a[152:155], a[32:35], v[208:211]
    ds_read_b128 a[152:155], v231 offset:30720
    ds_read_b128 a[156:159], v231 offset:31744
    s_waitcnt lgkmcnt(6)
    v_mfma_f32_16x16x32_bf16 v[0:3], a[128:131], a[64:67], v[0:3]
    v_mfma_f32_16x16x32_bf16 v[0:3], a[132:135], a[68:71], v[0:3]
    v_mfma_f32_16x16x32_bf16 v[4:7], a[132:135], a[76:79], v[4:7]
    v_mfma_f32_16x16x32_bf16 v[4:7], a[128:131], a[72:75], v[4:7]
    v_mfma_f32_16x16x32_bf16 v[8:11], a[128:131], a[80:83], v[8:11]
    v_mfma_f32_16x16x32_bf16 v[8:11], a[132:135], a[84:87], v[8:11]
    v_mfma_f32_16x16x32_bf16 v[12:15], a[132:135], a[92:95], v[12:15]
    v_mfma_f32_16x16x32_bf16 v[12:15], a[128:131], a[88:91], v[12:15]
    ds_read_b128 a[128:131], v231 offset:4096
    s_waitcnt lgkmcnt(5)
    v_mfma_f32_16x16x32_bf16 v[12:15], a[136:139], a[120:123], v[12:15]
    ds_read_b128 a[132:135], v231 offset:5120
    v_mfma_f32_16x16x32_bf16 v[12:15], a[140:143], a[124:127], v[12:15]
    v_mfma_f32_16x16x32_bf16 v[8:11], a[140:143], a[116:119], v[8:11]
    v_mfma_f32_16x16x32_bf16 v[8:11], a[136:139], a[112:115], v[8:11]
    v_mfma_f32_16x16x32_bf16 v[4:7], a[136:139], a[104:107], v[4:7]
    v_mfma_f32_16x16x32_bf16 v[4:7], a[140:143], a[108:111], v[4:7]
    v_mfma_f32_16x16x32_bf16 v[0:3], a[140:143], a[100:103], v[0:3]
    v_mfma_f32_16x16x32_bf16 v[0:3], a[136:139], a[96:99], v[0:3]
    ds_read_b128 a[136:139], v231 offset:32768
    s_waitcnt lgkmcnt(5)
    v_mfma_f32_16x16x32_bf16 v[16:19], a[144:147], a[64:67], v[16:19]
    ds_read_b128 a[140:143], v231 offset:33792
    v_mfma_f32_16x16x32_bf16 v[16:19], a[148:151], a[68:71], v[16:19]
    v_mfma_f32_16x16x32_bf16 v[20:23], a[148:151], a[76:79], v[20:23]
    v_mfma_f32_16x16x32_bf16 v[20:23], a[144:147], a[72:75], v[20:23]
    v_mfma_f32_16x16x32_bf16 v[24:27], a[144:147], a[80:83], v[24:27]
    v_mfma_f32_16x16x32_bf16 v[24:27], a[148:151], a[84:87], v[24:27]
    v_mfma_f32_16x16x32_bf16 v[28:31], a[148:151], a[92:95], v[28:31]
    v_mfma_f32_16x16x32_bf16 v[28:31], a[144:147], a[88:91], v[28:31]
    ds_read_b128 a[144:147], v231 offset:6144
    s_waitcnt lgkmcnt(5)
    v_mfma_f32_16x16x32_bf16 v[28:31], a[152:155], a[120:123], v[28:31]
    ds_read_b128 a[148:151], v231 offset:7168
    v_mfma_f32_16x16x32_bf16 v[28:31], a[156:159], a[124:127], v[28:31]
    v_mfma_f32_16x16x32_bf16 v[24:27], a[156:159], a[116:119], v[24:27]
    v_mfma_f32_16x16x32_bf16 v[24:27], a[152:155], a[112:115], v[24:27]
    v_mfma_f32_16x16x32_bf16 v[20:23], a[152:155], a[104:107], v[20:23]
    v_mfma_f32_16x16x32_bf16 v[20:23], a[156:159], a[108:111], v[20:23]
    v_mfma_f32_16x16x32_bf16 v[16:19], a[156:159], a[100:103], v[16:19]
    v_mfma_f32_16x16x32_bf16 v[16:19], a[152:155], a[96:99], v[16:19]
    ds_read_b128 a[152:155], v231 offset:34816
    s_waitcnt lgkmcnt(5)
    v_mfma_f32_16x16x32_bf16 v[32:35], a[128:131], a[64:67], v[32:35]
    ds_read_b128 a[156:159], v231 offset:35840
    v_mfma_f32_16x16x32_bf16 v[32:35], a[132:135], a[68:71], v[32:35]
    v_mfma_f32_16x16x32_bf16 v[36:39], a[132:135], a[76:79], v[36:39]
    v_mfma_f32_16x16x32_bf16 v[36:39], a[128:131], a[72:75], v[36:39]
    v_mfma_f32_16x16x32_bf16 v[40:43], a[128:131], a[80:83], v[40:43]
    v_mfma_f32_16x16x32_bf16 v[40:43], a[132:135], a[84:87], v[40:43]
    v_mfma_f32_16x16x32_bf16 v[44:47], a[132:135], a[92:95], v[44:47]
    v_mfma_f32_16x16x32_bf16 v[44:47], a[128:131], a[88:91], v[44:47]
    ds_read_b128 a[128:131], v231 offset:8192
    s_waitcnt lgkmcnt(5)
    v_mfma_f32_16x16x32_bf16 v[44:47], a[136:139], a[120:123], v[44:47]
    ds_read_b128 a[132:135], v231 offset:9216
    v_mfma_f32_16x16x32_bf16 v[44:47], a[140:143], a[124:127], v[44:47]
    v_mfma_f32_16x16x32_bf16 v[40:43], a[140:143], a[116:119], v[40:43]
    v_mfma_f32_16x16x32_bf16 v[40:43], a[136:139], a[112:115], v[40:43]
    v_mfma_f32_16x16x32_bf16 v[36:39], a[136:139], a[104:107], v[36:39]
    v_mfma_f32_16x16x32_bf16 v[36:39], a[140:143], a[108:111], v[36:39]
    v_mfma_f32_16x16x32_bf16 v[32:35], a[140:143], a[100:103], v[32:35]
    v_mfma_f32_16x16x32_bf16 v[32:35], a[136:139], a[96:99], v[32:35]
    ds_read_b128 a[136:139], v231 offset:36864
    s_waitcnt lgkmcnt(5)
    v_mfma_f32_16x16x32_bf16 v[48:51], a[144:147], a[64:67], v[48:51]
    ds_read_b128 a[140:143], v231 offset:37888
    v_mfma_f32_16x16x32_bf16 v[48:51], a[148:151], a[68:71], v[48:51]
    v_mfma_f32_16x16x32_bf16 v[52:55], a[148:151], a[76:79], v[52:55]
    v_mfma_f32_16x16x32_bf16 v[52:55], a[144:147], a[72:75], v[52:55]
    v_mfma_f32_16x16x32_bf16 v[56:59], a[144:147], a[80:83], v[56:59]
    v_mfma_f32_16x16x32_bf16 v[56:59], a[148:151], a[84:87], v[56:59]
    v_mfma_f32_16x16x32_bf16 v[60:63], a[148:151], a[92:95], v[60:63]
    v_mfma_f32_16x16x32_bf16 v[60:63], a[144:147], a[88:91], v[60:63]
    ds_read_b128 a[144:147], v231 offset:10240
    s_waitcnt lgkmcnt(5)
    v_mfma_f32_16x16x32_bf16 v[60:63], a[152:155], a[120:123], v[60:63]
    ds_read_b128 a[148:151], v231 offset:11264
    v_mfma_f32_16x16x32_bf16 v[60:63], a[156:159], a[124:127], v[60:63]
    v_mfma_f32_16x16x32_bf16 v[56:59], a[156:159], a[116:119], v[56:59]
    v_mfma_f32_16x16x32_bf16 v[56:59], a[152:155], a[112:115], v[56:59]
    v_mfma_f32_16x16x32_bf16 v[52:55], a[152:155], a[104:107], v[52:55]
    v_mfma_f32_16x16x32_bf16 v[52:55], a[156:159], a[108:111], v[52:55]
    v_mfma_f32_16x16x32_bf16 v[48:51], a[156:159], a[100:103], v[48:51]
    v_mfma_f32_16x16x32_bf16 v[48:51], a[152:155], a[96:99], v[48:51]
    ds_read_b128 a[152:155], v231 offset:38912
    s_waitcnt lgkmcnt(5)
    v_mfma_f32_16x16x32_bf16 v[64:67], a[128:131], a[64:67], v[64:67]
    ds_read_b128 a[156:159], v231 offset:39936
    v_mfma_f32_16x16x32_bf16 v[64:67], a[132:135], a[68:71], v[64:67]
    v_mfma_f32_16x16x32_bf16 v[68:71], a[132:135], a[76:79], v[68:71]
    v_mul_f32 v28, v12, v28
    v_mfma_f32_16x16x32_bf16 v[68:71], a[128:131], a[72:75], v[68:71]
    v_mul_f32 v29, v13, v29
    v_mfma_f32_16x16x32_bf16 v[72:75], a[128:131], a[80:83], v[72:75]
    v_mul_f32 v30, v14, v30
    v_mfma_f32_16x16x32_bf16 v[72:75], a[132:135], a[84:87], v[72:75]
    v_mul_f32 v31, v15, v31
    v_mfma_f32_16x16x32_bf16 v[76:79], a[132:135], a[92:95], v[76:79]
    v_mul_f32 v60, v44, v60
    v_mfma_f32_16x16x32_bf16 v[76:79], a[128:131], a[88:91], v[76:79]
    v_mul_f32 v61, v45, v61
    s_waitcnt lgkmcnt(4)
    v_mfma_f32_16x16x32_bf16 v[76:79], a[136:139], a[120:123], v[76:79]
    v_mul_f32 v62, v46, v62
    v_mfma_f32_16x16x32_bf16 v[76:79], a[140:143], a[124:127], v[76:79]
    v_mul_f32 v63, v47, v63
    v_mfma_f32_16x16x32_bf16 v[72:75], a[140:143], a[116:119], v[72:75]
    v_cvt_pk_bf16_f32 v12, v28, v29
    v_mfma_f32_16x16x32_bf16 v[72:75], a[136:139], a[112:115], v[72:75]
    v_cvt_pk_bf16_f32 v13, v30, v31
    v_mfma_f32_16x16x32_bf16 v[68:71], a[136:139], a[104:107], v[68:71]
    v_cvt_pk_bf16_f32 v14, v60, v61
    ds_read_b128 a[128:131], v231 offset:12288
    ds_read_b128 a[132:135], v231 offset:13312
    v_mfma_f32_16x16x32_bf16 v[68:71], a[140:143], a[108:111], v[68:71]
    v_cvt_pk_bf16_f32 v15, v62, v63
    v_mfma_f32_16x16x32_bf16 v[64:67], a[140:143], a[100:103], v[64:67]
    buffer_store_dwordx4 v[12:15], v224, s[44:47], s60 offen offset:0 sc1
    v_mfma_f32_16x16x32_bf16 v[64:67], a[136:139], a[96:99], v[64:67]
    v_mul_f32 v24, v8, v24
    s_waitcnt lgkmcnt(4)
    v_mfma_f32_16x16x32_bf16 v[80:83], a[144:147], a[64:67], v[80:83]
    v_mul_f32 v25, v9, v25
    v_mfma_f32_16x16x32_bf16 v[80:83], a[148:151], a[68:71], v[80:83]
    v_mul_f32 v26, v10, v26
    v_mfma_f32_16x16x32_bf16 v[84:87], a[148:151], a[76:79], v[84:87]
    v_mul_f32 v27, v11, v27
    v_mfma_f32_16x16x32_bf16 v[84:87], a[144:147], a[72:75], v[84:87]
    v_mul_f32 v56, v40, v56
    v_mfma_f32_16x16x32_bf16 v[88:91], a[144:147], a[80:83], v[88:91]
    v_mul_f32 v57, v41, v57
    ds_read_b128 a[136:139], v231 offset:40960
    ds_read_b128 a[140:143], v231 offset:41984
    v_mfma_f32_16x16x32_bf16 v[88:91], a[148:151], a[84:87], v[88:91]
    v_mul_f32 v58, v42, v58
    v_mfma_f32_16x16x32_bf16 v[92:95], a[148:151], a[92:95], v[92:95]
    v_mul_f32 v59, v43, v59
    v_mfma_f32_16x16x32_bf16 v[92:95], a[144:147], a[88:91], v[92:95]
    v_cvt_pk_bf16_f32 v8, v24, v25
    s_waitcnt lgkmcnt(4)
    v_mfma_f32_16x16x32_bf16 v[92:95], a[152:155], a[120:123], v[92:95]
    v_cvt_pk_bf16_f32 v9, v26, v27
    v_mfma_f32_16x16x32_bf16 v[92:95], a[156:159], a[124:127], v[92:95]
    v_cvt_pk_bf16_f32 v10, v56, v57
    v_mfma_f32_16x16x32_bf16 v[88:91], a[156:159], a[116:119], v[88:91]
    v_cvt_pk_bf16_f32 v11, v58, v59
    v_mfma_f32_16x16x32_bf16 v[88:91], a[152:155], a[112:115], v[88:91]
    buffer_store_dwordx4 v[8:11], v224, s[44:47], s58 offen offset:0 sc1
    v_mfma_f32_16x16x32_bf16 v[84:87], a[152:155], a[104:107], v[84:87]
    v_mul_f32 v20, v4, v20
    ds_read_b128 a[144:147], v231 offset:14336
    ds_read_b128 a[148:151], v231 offset:15360
    v_mfma_f32_16x16x32_bf16 v[84:87], a[156:159], a[108:111], v[84:87]
    v_mul_f32 v21, v5, v21
    v_mfma_f32_16x16x32_bf16 v[80:83], a[156:159], a[100:103], v[80:83]
    v_mul_f32 v22, v6, v22
    v_mfma_f32_16x16x32_bf16 v[80:83], a[152:155], a[96:99], v[80:83]
    v_mul_f32 v23, v7, v23
    s_waitcnt lgkmcnt(4)
    v_mfma_f32_16x16x32_bf16 v[96:99], a[128:131], a[64:67], v[96:99]
    v_mul_f32 v52, v36, v52
    v_mfma_f32_16x16x32_bf16 v[96:99], a[132:135], a[68:71], v[96:99]
    v_mul_f32 v53, v37, v53
    v_mfma_f32_16x16x32_bf16 v[100:103], a[132:135], a[76:79], v[100:103]
    v_mul_f32 v54, v38, v54
    v_mfma_f32_16x16x32_bf16 v[100:103], a[128:131], a[72:75], v[100:103]
    v_mul_f32 v55, v39, v55
    v_mfma_f32_16x16x32_bf16 v[104:107], a[128:131], a[80:83], v[104:107]
    v_cvt_pk_bf16_f32 v4, v20, v21
    ds_read_b128 a[152:155], v231 offset:43008
    ds_read_b128 a[156:159], v231 offset:44032
    v_mfma_f32_16x16x32_bf16 v[104:107], a[132:135], a[84:87], v[104:107]
    v_cvt_pk_bf16_f32 v5, v22, v23
    v_mfma_f32_16x16x32_bf16 v[108:111], a[132:135], a[92:95], v[108:111]
    v_cvt_pk_bf16_f32 v6, v52, v53
    v_mfma_f32_16x16x32_bf16 v[108:111], a[128:131], a[88:91], v[108:111]
    v_cvt_pk_bf16_f32 v7, v54, v55
    s_waitcnt lgkmcnt(4)
    v_mfma_f32_16x16x32_bf16 v[108:111], a[136:139], a[120:123], v[108:111]
    buffer_store_dwordx4 v[4:7], v224, s[44:47], s56 offen offset:0 sc1
    v_mfma_f32_16x16x32_bf16 v[108:111], a[140:143], a[124:127], v[108:111]
    v_mul_f32 v16, v0, v16
    v_mfma_f32_16x16x32_bf16 v[104:107], a[140:143], a[116:119], v[104:107]
    v_mul_f32 v17, v1, v17
    v_mfma_f32_16x16x32_bf16 v[104:107], a[136:139], a[112:115], v[104:107]
    v_mul_f32 v18, v2, v18
    v_mfma_f32_16x16x32_bf16 v[100:103], a[136:139], a[104:107], v[100:103]
    v_mul_f32 v19, v3, v19
    ds_read_b128 a[128:131], v231 offset:16384
    ds_read_b128 a[132:135], v231 offset:17408
    v_mfma_f32_16x16x32_bf16 v[100:103], a[140:143], a[108:111], v[100:103]
    v_mul_f32 v48, v32, v48
    v_mfma_f32_16x16x32_bf16 v[96:99], a[140:143], a[100:103], v[96:99]
    v_mul_f32 v49, v33, v49
    v_mfma_f32_16x16x32_bf16 v[96:99], a[136:139], a[96:99], v[96:99]
    v_mul_f32 v50, v34, v50
    ds_read_b128 a[136:139], v231 offset:45056
    ds_read_b128 a[140:143], v231 offset:46080
    s_waitcnt lgkmcnt(6)
    v_mfma_f32_16x16x32_bf16 v[112:115], a[144:147], a[64:67], v[112:115]
    v_mul_f32 v51, v35, v51
    v_mfma_f32_16x16x32_bf16 v[112:115], a[148:151], a[68:71], v[112:115]
    v_cvt_pk_bf16_f32 v0, v16, v17
    v_mfma_f32_16x16x32_bf16 v[116:119], a[148:151], a[76:79], v[116:119]
    v_cvt_pk_bf16_f32 v1, v18, v19
    v_mfma_f32_16x16x32_bf16 v[116:119], a[144:147], a[72:75], v[116:119]
    v_cvt_pk_bf16_f32 v2, v48, v49
    v_mfma_f32_16x16x32_bf16 v[120:123], a[144:147], a[80:83], v[120:123]
    v_cvt_pk_bf16_f32 v3, v50, v51
    v_mfma_f32_16x16x32_bf16 v[120:123], a[148:151], a[84:87], v[120:123]
    buffer_store_dwordx4 v[0:3], v224, s[44:47], s51 offen offset:0 sc1
    v_mfma_f32_16x16x32_bf16 v[124:127], a[148:151], a[92:95], v[124:127]
    v_mfma_f32_16x16x32_bf16 v[124:127], a[144:147], a[88:91], v[124:127]
    ds_read_b128 a[144:147], v231 offset:18432
    s_waitcnt lgkmcnt(5)
    v_mfma_f32_16x16x32_bf16 v[124:127], a[152:155], a[120:123], v[124:127]
    ds_read_b128 a[148:151], v231 offset:19456
    v_mfma_f32_16x16x32_bf16 v[124:127], a[156:159], a[124:127], v[124:127]
    v_mfma_f32_16x16x32_bf16 v[120:123], a[156:159], a[116:119], v[120:123]
    v_mfma_f32_16x16x32_bf16 v[120:123], a[152:155], a[112:115], v[120:123]
    v_mfma_f32_16x16x32_bf16 v[116:119], a[152:155], a[104:107], v[116:119]
    v_mfma_f32_16x16x32_bf16 v[116:119], a[156:159], a[108:111], v[116:119]
    v_mfma_f32_16x16x32_bf16 v[112:115], a[156:159], a[100:103], v[112:115]
    v_mfma_f32_16x16x32_bf16 v[112:115], a[152:155], a[96:99], v[112:115]
    ds_read_b128 a[152:155], v231 offset:47104
    s_waitcnt lgkmcnt(5)
    v_mfma_f32_16x16x32_bf16 v[128:131], a[128:131], a[64:67], v[128:131]
    ds_read_b128 a[156:159], v231 offset:48128
    v_mfma_f32_16x16x32_bf16 v[128:131], a[132:135], a[68:71], v[128:131]
    v_mfma_f32_16x16x32_bf16 v[132:135], a[132:135], a[76:79], v[132:135]
    v_mul_f32 v92, v76, v92
    v_mfma_f32_16x16x32_bf16 v[132:135], a[128:131], a[72:75], v[132:135]
    v_mul_f32 v93, v77, v93
    v_mfma_f32_16x16x32_bf16 v[136:139], a[128:131], a[80:83], v[136:139]
    v_mul_f32 v94, v78, v94
    v_mfma_f32_16x16x32_bf16 v[136:139], a[132:135], a[84:87], v[136:139]
    v_mul_f32 v95, v79, v95
    v_mfma_f32_16x16x32_bf16 v[140:143], a[132:135], a[92:95], v[140:143]
    v_mul_f32 v124, v108, v124
    v_mfma_f32_16x16x32_bf16 v[140:143], a[128:131], a[88:91], v[140:143]
    v_mul_f32 v125, v109, v125
    s_waitcnt lgkmcnt(4)
    v_mfma_f32_16x16x32_bf16 v[140:143], a[136:139], a[120:123], v[140:143]
    v_mul_f32 v126, v110, v126
    v_mfma_f32_16x16x32_bf16 v[140:143], a[140:143], a[124:127], v[140:143]
    v_mul_f32 v127, v111, v127
    v_mfma_f32_16x16x32_bf16 v[136:139], a[140:143], a[116:119], v[136:139]
    v_cvt_pk_bf16_f32 v76, v92, v93
    v_mfma_f32_16x16x32_bf16 v[136:139], a[136:139], a[112:115], v[136:139]
    v_cvt_pk_bf16_f32 v77, v94, v95
    v_mfma_f32_16x16x32_bf16 v[132:135], a[136:139], a[104:107], v[132:135]
    v_cvt_pk_bf16_f32 v78, v124, v125
    ds_read_b128 a[128:131], v231 offset:20480
    ds_read_b128 a[132:135], v231 offset:21504
    v_mfma_f32_16x16x32_bf16 v[132:135], a[140:143], a[108:111], v[132:135]
    v_cvt_pk_bf16_f32 v79, v126, v127
    v_mfma_f32_16x16x32_bf16 v[128:131], a[140:143], a[100:103], v[128:131]
    buffer_store_dwordx4 v[76:79], v224, s[44:47], s60 offen offset:1024 sc1
    v_mfma_f32_16x16x32_bf16 v[128:131], a[136:139], a[96:99], v[128:131]
    v_mul_f32 v88, v72, v88
    s_waitcnt lgkmcnt(4)
    v_mfma_f32_16x16x32_bf16 v[144:147], a[144:147], a[64:67], v[144:147]
    v_mul_f32 v89, v73, v89
    v_mfma_f32_16x16x32_bf16 v[144:147], a[148:151], a[68:71], v[144:147]
    v_mul_f32 v90, v74, v90
    v_mfma_f32_16x16x32_bf16 v[148:151], a[148:151], a[76:79], v[148:151]
    v_mul_f32 v91, v75, v91
    v_mfma_f32_16x16x32_bf16 v[148:151], a[144:147], a[72:75], v[148:151]
    v_mul_f32 v120, v104, v120
    v_mfma_f32_16x16x32_bf16 v[152:155], a[144:147], a[80:83], v[152:155]
    v_mul_f32 v121, v105, v121
    ds_read_b128 a[136:139], v231 offset:49152
    ds_read_b128 a[140:143], v231 offset:50176
    v_mfma_f32_16x16x32_bf16 v[152:155], a[148:151], a[84:87], v[152:155]
    v_mul_f32 v122, v106, v122
    v_mfma_f32_16x16x32_bf16 v[156:159], a[148:151], a[92:95], v[156:159]
    v_mul_f32 v123, v107, v123
    v_mfma_f32_16x16x32_bf16 v[156:159], a[144:147], a[88:91], v[156:159]
    v_cvt_pk_bf16_f32 v72, v88, v89
    s_waitcnt lgkmcnt(4)
    v_mfma_f32_16x16x32_bf16 v[156:159], a[152:155], a[120:123], v[156:159]
    v_cvt_pk_bf16_f32 v73, v90, v91
    v_mfma_f32_16x16x32_bf16 v[156:159], a[156:159], a[124:127], v[156:159]
    v_cvt_pk_bf16_f32 v74, v120, v121
    v_mfma_f32_16x16x32_bf16 v[152:155], a[156:159], a[116:119], v[152:155]
    v_cvt_pk_bf16_f32 v75, v122, v123
    v_mfma_f32_16x16x32_bf16 v[152:155], a[152:155], a[112:115], v[152:155]
    buffer_store_dwordx4 v[72:75], v224, s[44:47], s58 offen offset:1024 sc1
    v_mfma_f32_16x16x32_bf16 v[148:151], a[152:155], a[104:107], v[148:151]
    v_mul_f32 v84, v68, v84
    ds_read_b128 a[144:147], v231 offset:22528
    ds_read_b128 a[148:151], v231 offset:23552
    v_mfma_f32_16x16x32_bf16 v[148:151], a[156:159], a[108:111], v[148:151]
    v_mul_f32 v85, v69, v85
    v_mfma_f32_16x16x32_bf16 v[144:147], a[156:159], a[100:103], v[144:147]
    v_mul_f32 v86, v70, v86
    v_mfma_f32_16x16x32_bf16 v[144:147], a[152:155], a[96:99], v[144:147]
    v_mul_f32 v87, v71, v87
    s_waitcnt lgkmcnt(4)
    v_mfma_f32_16x16x32_bf16 v[160:163], a[128:131], a[64:67], v[160:163]
    v_mul_f32 v116, v100, v116
    v_mfma_f32_16x16x32_bf16 v[160:163], a[132:135], a[68:71], v[160:163]
    v_mul_f32 v117, v101, v117
    v_mfma_f32_16x16x32_bf16 v[164:167], a[132:135], a[76:79], v[164:167]
    v_mul_f32 v118, v102, v118
    v_mfma_f32_16x16x32_bf16 v[164:167], a[128:131], a[72:75], v[164:167]
    v_mul_f32 v119, v103, v119
    v_mfma_f32_16x16x32_bf16 v[168:171], a[128:131], a[80:83], v[168:171]
    v_cvt_pk_bf16_f32 v68, v84, v85
    ds_read_b128 a[152:155], v231 offset:51200
    ds_read_b128 a[156:159], v231 offset:52224
    v_mfma_f32_16x16x32_bf16 v[168:171], a[132:135], a[84:87], v[168:171]
    v_cvt_pk_bf16_f32 v69, v86, v87
    v_mfma_f32_16x16x32_bf16 v[172:175], a[132:135], a[92:95], v[172:175]
    v_cvt_pk_bf16_f32 v70, v116, v117
    v_mfma_f32_16x16x32_bf16 v[172:175], a[128:131], a[88:91], v[172:175]
    v_cvt_pk_bf16_f32 v71, v118, v119
    s_waitcnt lgkmcnt(4)
    v_mfma_f32_16x16x32_bf16 v[172:175], a[136:139], a[120:123], v[172:175]
    buffer_store_dwordx4 v[68:71], v224, s[44:47], s56 offen offset:1024 sc1
    v_mfma_f32_16x16x32_bf16 v[172:175], a[140:143], a[124:127], v[172:175]
    v_mul_f32 v80, v64, v80
    v_mfma_f32_16x16x32_bf16 v[168:171], a[140:143], a[116:119], v[168:171]
    v_mul_f32 v81, v65, v81
    v_mfma_f32_16x16x32_bf16 v[168:171], a[136:139], a[112:115], v[168:171]
    v_mul_f32 v82, v66, v82
    v_mfma_f32_16x16x32_bf16 v[164:167], a[136:139], a[104:107], v[164:167]
    v_mul_f32 v83, v67, v83
    ds_read_b128 a[128:131], v231 offset:24576
    ds_read_b128 a[132:135], v231 offset:25600
    v_mfma_f32_16x16x32_bf16 v[164:167], a[140:143], a[108:111], v[164:167]
    v_mul_f32 v112, v96, v112
    v_mfma_f32_16x16x32_bf16 v[160:163], a[140:143], a[100:103], v[160:163]
    v_mul_f32 v113, v97, v113
    v_mfma_f32_16x16x32_bf16 v[160:163], a[136:139], a[96:99], v[160:163]
    v_mul_f32 v114, v98, v114
    s_waitcnt lgkmcnt(4)
    v_mfma_f32_16x16x32_bf16 v[176:179], a[144:147], a[64:67], v[176:179]
    v_mul_f32 v115, v99, v115
    v_mfma_f32_16x16x32_bf16 v[176:179], a[148:151], a[68:71], v[176:179]
    v_cvt_pk_bf16_f32 v64, v80, v81
    v_mfma_f32_16x16x32_bf16 v[180:183], a[148:151], a[76:79], v[180:183]
    v_cvt_pk_bf16_f32 v65, v82, v83
    v_mfma_f32_16x16x32_bf16 v[180:183], a[144:147], a[72:75], v[180:183]
    v_cvt_pk_bf16_f32 v66, v112, v113
    v_mfma_f32_16x16x32_bf16 v[184:187], a[144:147], a[80:83], v[184:187]
    v_cvt_pk_bf16_f32 v67, v114, v115
    ds_read_b128 a[136:139], v231 offset:53248
    ds_read_b128 a[140:143], v231 offset:54272
    v_mfma_f32_16x16x32_bf16 v[184:187], a[148:151], a[84:87], v[184:187]
    buffer_store_dwordx4 v[64:67], v224, s[44:47], s51 offen offset:1024 sc1
    v_mfma_f32_16x16x32_bf16 v[188:191], a[148:151], a[92:95], v[188:191]
    v_mfma_f32_16x16x32_bf16 v[188:191], a[144:147], a[88:91], v[188:191]
    ds_read_b128 a[144:147], v231 offset:26624
    s_waitcnt lgkmcnt(5)
    v_mfma_f32_16x16x32_bf16 v[188:191], a[152:155], a[120:123], v[188:191]
    ds_read_b128 a[148:151], v231 offset:27648
    v_mfma_f32_16x16x32_bf16 v[188:191], a[156:159], a[124:127], v[188:191]
    v_mfma_f32_16x16x32_bf16 v[184:187], a[156:159], a[116:119], v[184:187]
    v_mfma_f32_16x16x32_bf16 v[184:187], a[152:155], a[112:115], v[184:187]
    v_mfma_f32_16x16x32_bf16 v[180:183], a[152:155], a[104:107], v[180:183]
    v_mfma_f32_16x16x32_bf16 v[180:183], a[156:159], a[108:111], v[180:183]
    v_mfma_f32_16x16x32_bf16 v[176:179], a[156:159], a[100:103], v[176:179]
    v_mfma_f32_16x16x32_bf16 v[176:179], a[152:155], a[96:99], v[176:179]
    ds_read_b128 a[152:155], v231 offset:55296
    s_waitcnt lgkmcnt(5)
    v_mfma_f32_16x16x32_bf16 v[192:195], a[128:131], a[64:67], v[192:195]
    ds_read_b128 a[156:159], v231 offset:56320
    v_mfma_f32_16x16x32_bf16 v[192:195], a[132:135], a[68:71], v[192:195]
    v_mfma_f32_16x16x32_bf16 v[196:199], a[132:135], a[76:79], v[196:199]
    v_mul_f32 v156, v140, v156
    v_mul_f32 v157, v141, v157
    v_mfma_f32_16x16x32_bf16 v[196:199], a[128:131], a[72:75], v[196:199]
    v_mul_f32 v158, v142, v158
    v_mul_f32 v159, v143, v159
    v_mfma_f32_16x16x32_bf16 v[200:203], a[128:131], a[80:83], v[200:203]
    v_mul_f32 v188, v172, v188
    v_mul_f32 v189, v173, v189
    v_mfma_f32_16x16x32_bf16 v[200:203], a[132:135], a[84:87], v[200:203]
    v_mul_f32 v190, v174, v190
    v_mul_f32 v191, v175, v191
    v_mfma_f32_16x16x32_bf16 v[204:207], a[132:135], a[92:95], v[204:207]
    v_cvt_pk_bf16_f32 v140, v156, v157
    v_cvt_pk_bf16_f32 v141, v158, v159
    v_mfma_f32_16x16x32_bf16 v[204:207], a[128:131], a[88:91], v[204:207]
    v_cvt_pk_bf16_f32 v142, v188, v189
    v_cvt_pk_bf16_f32 v143, v190, v191
    s_waitcnt lgkmcnt(4)
    v_mfma_f32_16x16x32_bf16 v[204:207], a[136:139], a[120:123], v[204:207]
    buffer_store_dwordx4 v[140:143], v224, s[44:47], s60 offen offset:2048 sc1
    v_mfma_f32_16x16x32_bf16 v[204:207], a[140:143], a[124:127], v[204:207]
    v_mul_f32 v152, v136, v152
    v_mul_f32 v153, v137, v153
    v_mfma_f32_16x16x32_bf16 v[200:203], a[140:143], a[116:119], v[200:203]
    v_mul_f32 v154, v138, v154
    v_mul_f32 v155, v139, v155
    v_mfma_f32_16x16x32_bf16 v[200:203], a[136:139], a[112:115], v[200:203]
    v_mul_f32 v184, v168, v184
    v_mul_f32 v185, v169, v185
    v_mfma_f32_16x16x32_bf16 v[196:199], a[136:139], a[104:107], v[196:199]
    v_mul_f32 v186, v170, v186
    v_mul_f32 v187, v171, v187
    v_mfma_f32_16x16x32_bf16 v[196:199], a[140:143], a[108:111], v[196:199]
    v_cvt_pk_bf16_f32 v136, v152, v153
    v_cvt_pk_bf16_f32 v137, v154, v155
    v_mfma_f32_16x16x32_bf16 v[192:195], a[140:143], a[100:103], v[192:195]
    v_cvt_pk_bf16_f32 v138, v184, v185
    v_cvt_pk_bf16_f32 v139, v186, v187
    v_mfma_f32_16x16x32_bf16 v[192:195], a[136:139], a[96:99], v[192:195]
    buffer_store_dwordx4 v[136:139], v224, s[44:47], s58 offen offset:2048 sc1
    s_waitcnt lgkmcnt(2)
    v_mfma_f32_16x16x32_bf16 v[208:211], a[144:147], a[64:67], v[208:211]
    v_mul_f32 v148, v132, v148
    v_mul_f32 v149, v133, v149
    v_mfma_f32_16x16x32_bf16 v[208:211], a[148:151], a[68:71], v[208:211]
    v_mul_f32 v150, v134, v150
    v_mul_f32 v151, v135, v151
    v_mfma_f32_16x16x32_bf16 v[212:215], a[148:151], a[76:79], v[212:215]
    v_mul_f32 v180, v164, v180
    v_mul_f32 v181, v165, v181
    v_mfma_f32_16x16x32_bf16 v[212:215], a[144:147], a[72:75], v[212:215]
    v_mul_f32 v182, v166, v182
    v_mul_f32 v183, v167, v183
    v_mfma_f32_16x16x32_bf16 v[216:219], a[144:147], a[80:83], v[216:219]
    v_cvt_pk_bf16_f32 v132, v148, v149
    v_cvt_pk_bf16_f32 v133, v150, v151
    v_mfma_f32_16x16x32_bf16 v[216:219], a[148:151], a[84:87], v[216:219]
    v_cvt_pk_bf16_f32 v134, v180, v181
    v_cvt_pk_bf16_f32 v135, v182, v183
    v_mfma_f32_16x16x32_bf16 v[220:223], a[148:151], a[92:95], v[220:223]
    buffer_store_dwordx4 v[132:135], v224, s[44:47], s56 offen offset:2048 sc1
    v_mfma_f32_16x16x32_bf16 v[220:223], a[144:147], a[88:91], v[220:223]
    v_mul_f32 v144, v128, v144
    v_mul_f32 v145, v129, v145
    s_waitcnt lgkmcnt(0)
    v_mfma_f32_16x16x32_bf16 v[220:223], a[152:155], a[120:123], v[220:223]
    v_mul_f32 v146, v130, v146
    v_mul_f32 v147, v131, v147
    v_mfma_f32_16x16x32_bf16 v[220:223], a[156:159], a[124:127], v[220:223]
    v_mul_f32 v176, v160, v176
    v_mul_f32 v177, v161, v177
    v_mfma_f32_16x16x32_bf16 v[216:219], a[156:159], a[116:119], v[216:219]
    v_mul_f32 v178, v162, v178
    v_mul_f32 v179, v163, v179
    v_mfma_f32_16x16x32_bf16 v[216:219], a[152:155], a[112:115], v[216:219]
    v_cvt_pk_bf16_f32 v128, v144, v145
    v_cvt_pk_bf16_f32 v129, v146, v147
    v_mfma_f32_16x16x32_bf16 v[212:215], a[152:155], a[104:107], v[212:215]
    v_cvt_pk_bf16_f32 v130, v176, v177
    v_cvt_pk_bf16_f32 v131, v178, v179
    v_mfma_f32_16x16x32_bf16 v[212:215], a[156:159], a[108:111], v[212:215]
    buffer_store_dwordx4 v[128:131], v224, s[44:47], s51 offen offset:2048 sc1
    v_mfma_f32_16x16x32_bf16 v[208:211], a[156:159], a[100:103], v[208:211]
    v_mfma_f32_16x16x32_bf16 v[208:211], a[152:155], a[96:99], v[208:211]
    s_nop 7
    v_mul_f32 v220, v204, v220
    v_mul_f32 v221, v205, v221
    v_mul_f32 v222, v206, v222
    v_mul_f32 v223, v207, v223
    v_cvt_pk_bf16_f32 v204, v220, v221
    v_cvt_pk_bf16_f32 v205, v222, v223
    buffer_store_dwordx2 v[204:205], v224, s[44:47], s61 offen sc1
    v_mul_f32 v216, v200, v216
    v_mul_f32 v217, v201, v217
    v_mul_f32 v218, v202, v218
    v_mul_f32 v219, v203, v219
    v_cvt_pk_bf16_f32 v200, v216, v217
    v_cvt_pk_bf16_f32 v201, v218, v219
    buffer_store_dwordx2 v[200:201], v224, s[44:47], s59 offen sc1
    v_mul_f32 v212, v196, v212
    v_mul_f32 v213, v197, v213
    v_mul_f32 v214, v198, v214
    v_mul_f32 v215, v199, v215
    v_cvt_pk_bf16_f32 v196, v212, v213
    v_cvt_pk_bf16_f32 v197, v214, v215
    buffer_store_dwordx2 v[196:197], v224, s[44:47], s57 offen sc1
    v_mul_f32 v208, v192, v208
    v_mul_f32 v209, v193, v209
    v_mul_f32 v210, v194, v210
    v_mul_f32 v211, v195, v211
    v_cvt_pk_bf16_f32 v192, v208, v209
    v_cvt_pk_bf16_f32 v193, v210, v211
    buffer_store_dwordx2 v[192:193], v224, s[44:47], s52 offen sc1
    s_lshl_b32 s19, s37, 7
    s_add_u32 s19, s19, 54355968
    v_min_u32 v233, 1, v232
    v_lshlrev_b32 v233, 26, v233
    v_mov_b32 v234, 1
    s_cmp_eq_u32 s34, 0
    s_cselect_b32 s18, s19, 0x7ff00000
    s_waitcnt vmcnt(0)
    s_barrier
    buffer_atomic_add v234, v233, s[44:47], s18 offen sc1
END_PH_u1:
PH_d1:
    v_mbcnt_lo_u32_b32 v40, -1, 0
    v_mbcnt_hi_u32_b32 v40, -1, v40
    s_and_b32 s35, s2, 7
    s_lshr_b32 s36, s2, 3
    s_lshr_b32 s37, s35, 1
    s_lshl_b32 s37, s37, 2
    s_lshr_b32 s38, s36, 3
    s_add_u32 s37, s37, s38
    s_and_b32 s38, s35, 1
    s_lshl_b32 s38, s38, 3
    s_and_b32 s39, s36, 7
    s_add_u32 s38, s38, s39
    v_lshlrev_b32 v32, 4, v40
    v_add_u32 v33, 114688, v32
    s_mul_i32 s26, s34, 2048
    v_add_u32 v34, s26, v32
    s_lshl_b32 s42, s37, 3
    s_lshl_b32 s43, s34, 1
    s_add_u32 s42, s42, s43
    s_mul_i32 s25, s42, 114688
    s_add_u32 s25, s25, 8388608
    s_mul_i32 s24, s38, 458752
    s_add_u32 s24, s24, 46137344
    s_add_u32 m0, s26, 0
    s_nop 0
    buffer_load_dwordx4 v34, s[44:47], s24 offen offset:0 sc1 lds
    buffer_load_dwordx4 v34, s[44:47], s24 offen offset:1024 sc1 lds
    s_add_u32 m0, s26, 8192
    s_add_u32 s24, s24, 8192
    buffer_load_dwordx4 v34, s[44:47], s24 offen offset:0 sc1 lds
    buffer_load_dwordx4 v34, s[44:47], s24 offen offset:1024 sc1 lds
    s_add_u32 m0, s26, 16384
    s_add_u32 s24, s24, 8192
    buffer_load_dwordx4 v34, s[44:47], s24 offen offset:0 sc1 lds
    buffer_load_dwordx4 v34, s[44:47], s24 offen offset:1024 sc1 lds
    s_add_u32 m0, s26, 24576
    s_add_u32 s24, s24, 8192
    buffer_load_dwordx4 v34, s[44:47], s24 offen offset:0 sc1 lds
    buffer_load_dwordx4 v34, s[44:47], s24 offen offset:1024 sc1 lds
    s_add_u32 m0, s26, 32768
    s_add_u32 s24, s24, 8192
    buffer_load_dwordx4 v34, s[44:47], s24 offen offset:0 sc1 lds
    buffer_load_dwordx4 v34, s[44:47], s24 offen offset:1024 sc1 lds
    s_add_u32 m0, s26, 40960
    s_add_u32 s24, s24, 8192
    buffer_load_dwordx4 v34, s[44:47], s24 offen offset:0 sc1 lds
    buffer_load_dwordx4 v34, s[44:47], s24 offen offset:1024 sc1 lds
    s_add_u32 m0, s26, 49152
    s_add_u32 s24, s24, 8192
    buffer_load_dwordx4 v34, s[44:47], s24 offen offset:0 sc1 lds
    buffer_load_dwordx4 v34, s[44:47], s24 offen offset:1024 sc1 lds
    v_mov_b32 v36, v32
    s_mov_b32 s56, s30
    s_mov_b32 s57, s31
    s_mov_b32 s58, 4194304
    s_mov_b32 s59, 0x20000
    v_and_b32 v44, 31, v40
    v_and_b32 v41, 15, v40
    v_lshrrev_b32 v42, 4, v40
    v_lshlrev_b32 v45, 4, v41
    v_lshl_add_u32 v45, v42, 2, v45
    v_and_b32 v35, 1, v42
    v_lshlrev_b32 v47, 11, v41
    v_lshl_add_u32 v47, v35, 5, v47
    v_lshrrev_b32 v42, 1, v42
    v_lshl_add_u32 v47, v42, 4, v47
    v_mov_b32 v35, 0x3f803f80
    s_lshl_b32 s54, s42, 15
    s_lshl_b32 s55, s38, 11
    s_add_u32 s48, s54, s55
    s_add_u32 s49, s48, 32768
    s_lshl_b32 s55, s38, 7
    s_add_u32 s50, s54, s55
    s_add_u32 s51, s50, 32768
    s_lshl_b32 s54, s42, 11
    s_lshl_b32 s55, s38, 8
    s_add_u32 s52, s54, s55
    s_add_u32 s52, s52, 53477376
    s_add_u32 s53, s54, 53739520
    s_lshr_b32 s19, s37, 1
    s_lshl_b32 s19, s19, 7
    s_add_u32 s19, s19, 54355968
    s_cmp_lg_u32 s34, 0
    s_cbranch_scc1 PEd1g
    v_mov_b32 v41, 0
    s_mov_b32 s17, 0
Pd1g:
    buffer_load_dword v42, v41, s[44:47], s19 offen sc1
    s_waitcnt vmcnt(0)
    v_readfirstlane_b32 s16, v42
    s_cmp_ge_u32 s16, 32
    s_cbranch_scc1 PEd1g
    s_sleep 4
    s_add_u32 s17, s17, 1
    s_cmp_lt_u32 s17, 0x40000
    s_cbranch_scc1 Pd1g
PEd1g:
    s_waitcnt vmcnt(0)
    s_barrier
    buffer_load_dwordx4 a[0:3], v32, s[44:47], s25 offen offset:0 sc1
    buffer_load_dwordx4 a[4:7], v32, s[44:47], s25 offen offset:1024 sc1
    buffer_load_dwordx4 a[8:11], v33, s[44:47], s25 offen offset:0 sc1
    buffer_load_dwordx4 a[12:15], v33, s[44:47], s25 offen offset:1024 sc1
    s_add_u32 s25, s25, 2048
    buffer_load_dwordx4 a[16:19], v32, s[44:47], s25 offen offset:0 sc1
    buffer_load_dwordx4 a[20:23], v32, s[44:47], s25 offen offset:1024 sc1
    buffer_load_dwordx4 a[24:27], v33, s[44:47], s25 offen offset:0 sc1
    buffer_load_dwordx4 a[28:31], v33, s[44:47], s25 offen offset:1024 sc1
    s_waitcnt vmcnt(20)
    s_barrier
    ds_read_b128 a[64:67], v36 offset:0
    ds_read_b128 a[68:71], v36 offset:1024
    ds_read_b128 a[72:75], v36 offset:2048
    ds_read_b128 a[76:79], v36 offset:3072
    s_waitcnt vmcnt(6) lgkmcnt(2)
    v_mfma_f32_16x16x32_bf16 v[0:3], a[64:67], a[0:3], 0
    s_add_u32 s25, s25, 2048
    buffer_load_dwordx4 a[32:35], v32, s[44:47], s25 offen offset:0 sc1
    v_mfma_f32_16x16x32_bf16 v[0:3], a[68:71], a[4:7], v[0:3]
    buffer_load_dwordx4 a[36:39], v32, s[44:47], s25 offen offset:1024 sc1
    s_waitcnt vmcnt(6)
    v_mfma_f32_16x16x32_bf16 v[4:7], a[68:71], a[12:15], 0
    buffer_load_dwordx4 a[40:43], v33, s[44:47], s25 offen offset:0 sc1
    v_mfma_f32_16x16x32_bf16 v[4:7], a[64:67], a[8:11], v[4:7]
    buffer_load_dwordx4 a[44:47], v33, s[44:47], s25 offen offset:1024 sc1
    s_waitcnt lgkmcnt(0)
    v_mfma_f32_16x16x32_bf16 v[12:15], a[72:75], a[8:11], 0
    s_add_u32 s25, s25, 2048
    buffer_load_dwordx4 a[48:51], v32, s[44:47], s25 offen offset:0 sc1
    v_mfma_f32_16x16x32_bf16 v[12:15], a[76:79], a[12:15], v[12:15]
    ds_read_b128 a[64:67], v36 offset:4096
    ds_read_b128 a[68:71], v36 offset:5120
    v_mfma_f32_16x16x32_bf16 v[8:11], a[76:79], a[4:7], 0
    buffer_load_dwordx4 a[52:55], v32, s[44:47], s25 offen offset:1024 sc1
    v_mfma_f32_16x16x32_bf16 v[8:11], a[72:75], a[0:3], v[8:11]
    ds_read_b128 a[72:75], v36 offset:6144
    s_waitcnt lgkmcnt(1)
    v_mfma_f32_16x16x32_bf16 v[16:19], a[64:67], a[0:3], 0
    ds_read_b128 a[76:79], v36 offset:7168
    v_mfma_f32_16x16x32_bf16 v[16:19], a[68:71], a[4:7], v[16:19]
    v_mfma_f32_16x16x32_bf16 v[20:23], a[68:71], a[12:15], 0
    buffer_load_dwordx4 a[56:59], v33, s[44:47], s25 offen offset:0 sc1
    s_barrier
    v_mfma_f32_16x16x32_bf16 v[20:23], a[64:67], a[8:11], v[20:23]
    ds_read_b128 a[64:67], v36 offset:8192
    s_waitcnt lgkmcnt(1)
    v_mfma_f32_16x16x32_bf16 v[28:31], a[72:75], a[8:11], 0
    s_add_u32 m0, s26, 57344
    s_add_u32 s24, s24, 8192
    buffer_load_dwordx4 v34, s[44:47], s24 offen offset:0 sc1 lds
    v_mfma_f32_16x16x32_bf16 v[28:31], a[76:79], a[12:15], v[28:31]
    ds_read_b128 a[68:71], v36 offset:9216
    v_mfma_f32_16x16x32_bf16 v[24:27], a[76:79], a[4:7], 0
    buffer_load_dwordx4 a[60:63], v33, s[44:47], s25 offen offset:1024 sc1
    v_mfma_f32_16x16x32_bf16 v[24:27], a[72:75], a[0:3], v[24:27]
    ds_read_b128 a[72:75], v36 offset:10240
    ds_read_b128 a[76:79], v36 offset:11264
    s_waitcnt vmcnt(11) lgkmcnt(2)
    v_mfma_f32_16x16x32_bf16 v[0:3], a[64:67], a[16:19], v[0:3]
    v_mfma_f32_16x16x32_bf16 v[0:3], a[68:71], a[20:23], v[0:3]
    s_waitcnt vmcnt(9)
    v_mfma_f32_16x16x32_bf16 v[4:7], a[68:71], a[28:31], v[4:7]
    s_add_u32 s25, s25, 2048
    buffer_load_dwordx4 a[0:3], v32, s[44:47], s25 offen offset:0 sc1
    v_mfma_f32_16x16x32_bf16 v[4:7], a[64:67], a[24:27], v[4:7]
    buffer_load_dwordx4 v[48:51], v32, s[44:47], s53 offen offset:0 sc1
    buffer_load_dwordx4 v34, s[44:47], s24 offen offset:1024 sc1 lds
    s_waitcnt lgkmcnt(0)
    v_mfma_f32_16x16x32_bf16 v[12:15], a[72:75], a[24:27], v[12:15]
    ds_read_b128 a[64:67], v36 offset:12288
    v_mfma_f32_16x16x32_bf16 v[12:15], a[76:79], a[28:31], v[12:15]
    ds_read_b128 a[68:71], v36 offset:13312
    v_mfma_f32_16x16x32_bf16 v[8:11], a[76:79], a[20:23], v[8:11]
    buffer_load_dwordx4 v[64:67], v32, s[44:47], s48 offen offset:0 sc1
    buffer_load_dwordx4 a[4:7], v32, s[44:47], s25 offen offset:1024 sc1
    v_mfma_f32_16x16x32_bf16 v[8:11], a[72:75], a[16:19], v[8:11]
    ds_read_b128 a[72:75], v36 offset:14336
    s_waitcnt lgkmcnt(1)
    v_mfma_f32_16x16x32_bf16 v[16:19], a[64:67], a[16:19], v[16:19]
    ds_read_b128 a[76:79], v36 offset:15360
    v_mfma_f32_16x16x32_bf16 v[16:19], a[68:71], a[20:23], v[16:19]
    v_mfma_f32_16x16x32_bf16 v[20:23], a[68:71], a[28:31], v[20:23]
    buffer_load_dwordx4 a[8:11], v33, s[44:47], s25 offen offset:0 sc1
    s_barrier
    v_mfma_f32_16x16x32_bf16 v[20:23], a[64:67], a[24:27], v[20:23]
    buffer_load_dwordx4 v[52:55], v32, s[44:47], s53 offen offset:1024 sc1
    s_waitcnt lgkmcnt(0)
    v_mfma_f32_16x16x32_bf16 v[28:31], a[72:75], a[24:27], v[28:31]
    s_add_u32 m0, s26, 0
    s_add_u32 s24, s24, 8192
    buffer_load_dwordx4 v34, s[44:47], s24 offen offset:0 sc1 lds
    v_mfma_f32_16x16x32_bf16 v[28:31], a[76:79], a[28:31], v[28:31]
    ds_read_b128 a[64:67], v36 offset:16384
    ds_read_b128 a[68:71], v36 offset:17408
    v_mfma_f32_16x16x32_bf16 v[24:27], a[76:79], a[20:23], v[24:27]
    buffer_load_dwordx4 v[68:71], v32, s[44:47], s48 offen offset:1024 sc1
    buffer_load_dwordx4 a[12:15], v33, s[44:47], s25 offen offset:1024 sc1
    v_mfma_f32_16x16x32_bf16 v[24:27], a[72:75], a[16:19], v[24:27]
    ds_read_b128 a[72:75], v36 offset:18432
    ds_read_b128 a[76:79], v36 offset:19456
    s_waitcnt vmcnt(15) lgkmcnt(2)
    v_mfma_f32_16x16x32_bf16 v[0:3], a[64:67], a[32:35], v[0:3]
    v_mfma_f32_16x16x32_bf16 v[0:3], a[68:71], a[36:39], v[0:3]
    v_mfma_f32_16x16x32_bf16 v[4:7], a[68:71], a[44:47], v[4:7]
    s_add_u32 s25, s25, 2048
    buffer_load_dwordx4 a[16:19], v32, s[44:47], s25 offen offset:0 sc1
    v_mfma_f32_16x16x32_bf16 v[4:7], a[64:67], a[40:43], v[4:7]
    buffer_load_dwordx4 v[56:59], v32, s[44:47], s53 offen offset:2048 sc1
    buffer_load_dwordx4 v34, s[44:47], s24 offen offset:1024 sc1 lds
    s_waitcnt lgkmcnt(0)
    v_mfma_f32_16x16x32_bf16 v[12:15], a[72:75], a[40:43], v[12:15]
    ds_read_b128 a[64:67], v36 offset:20480
    v_mfma_f32_16x16x32_bf16 v[12:15], a[76:79], a[44:47], v[12:15]
    ds_read_b128 a[68:71], v36 offset:21504
    v_mfma_f32_16x16x32_bf16 v[8:11], a[76:79], a[36:39], v[8:11]
    buffer_load_dwordx4 v[72:75], v32, s[44:47], s49 offen offset:0 sc1
    buffer_load_dwordx4 a[20:23], v32, s[44:47], s25 offen offset:1024 sc1
    v_mfma_f32_16x16x32_bf16 v[8:11], a[72:75], a[32:35], v[8:11]
    ds_read_b128 a[72:75], v36 offset:22528
    s_waitcnt lgkmcnt(1)
    v_mfma_f32_16x16x32_bf16 v[16:19], a[64:67], a[32:35], v[16:19]
    ds_read_b128 a[76:79], v36 offset:23552
    v_mfma_f32_16x16x32_bf16 v[16:19], a[68:71], a[36:39], v[16:19]
    v_mfma_f32_16x16x32_bf16 v[20:23], a[68:71], a[44:47], v[20:23]
    buffer_load_dwordx4 a[24:27], v33, s[44:47], s25 offen offset:0 sc1
    s_barrier
    v_mfma_f32_16x16x32_bf16 v[20:23], a[64:67], a[40:43], v[20:23]
    buffer_load_dwordx4 v[60:63], v32, s[44:47], s53 offen offset:3072 sc1
    s_waitcnt lgkmcnt(0)
    v_mfma_f32_16x16x32_bf16 v[28:31], a[72:75], a[40:43], v[28:31]
    s_add_u32 m0, s26, 8192
    s_add_u32 s24, s24, 8192
    buffer_load_dwordx4 v34, s[44:47], s24 offen offset:0 sc1 lds
    v_mfma_f32_16x16x32_bf16 v[28:31], a[76:79], a[44:47], v[28:31]
    ds_read_b128 a[64:67], v36 offset:24576
    ds_read_b128 a[68:71], v36 offset:25600
    v_mfma_f32_16x16x32_bf16 v[24:27], a[76:79], a[36:39], v[24:27]
    buffer_load_dwordx4 v[76:79], v32, s[44:47], s49 offen offset:1024 sc1
    buffer_load_dwordx4 a[28:31], v33, s[44:47], s25 offen offset:1024 sc1
    v_mfma_f32_16x16x32_bf16 v[24:27], a[72:75], a[32:35], v[24:27]
    ds_read_b128 a[72:75], v36 offset:26624
    ds_read_b128 a[76:79], v36 offset:27648
    s_waitcnt vmcnt(20) lgkmcnt(2)
    v_mfma_f32_16x16x32_bf16 v[0:3], a[64:67], a[48:51], v[0:3]
    v_mfma_f32_16x16x32_bf16 v[0:3], a[68:71], a[52:55], v[0:3]
    v_mfma_f32_16x16x32_bf16 v[4:7], a[68:71], a[60:63], v[4:7]
    s_add_u32 s25, s25, 2048
    buffer_load_dwordx4 a[32:35], v32, s[44:47], s25 offen offset:0 sc1
    v_mfma_f32_16x16x32_bf16 v[4:7], a[64:67], a[56:59], v[4:7]
    buffer_load_dwordx4 v34, s[44:47], s24 offen offset:1024 sc1 lds
    s_waitcnt lgkmcnt(0)
    v_mfma_f32_16x16x32_bf16 v[12:15], a[72:75], a[56:59], v[12:15]
    ds_read_b128 a[64:67], v36 offset:28672
    v_mfma_f32_16x16x32_bf16 v[12:15], a[76:79], a[60:63], v[12:15]
    ds_read_b128 a[68:71], v36 offset:29696
    v_mfma_f32_16x16x32_bf16 v[8:11], a[76:79], a[52:55], v[8:11]
    buffer_load_dwordx4 a[36:39], v32, s[44:47], s25 offen offset:1024 sc1
    v_mfma_f32_16x16x32_bf16 v[8:11], a[72:75], a[48:51], v[8:11]
    ds_read_b128 a[72:75], v36 offset:30720
    s_waitcnt lgkmcnt(1)
    v_mfma_f32_16x16x32_bf16 v[16:19], a[64:67], a[48:51], v[16:19]
    ds_read_b128 a[76:79], v36 offset:31744
    v_mfma_f32_16x16x32_bf16 v[16:19], a[68:71], a[52:55], v[16:19]
    v_mfma_f32_16x16x32_bf16 v[20:23], a[68:71], a[60:63], v[20:23]
    buffer_load_dwordx4 a[40:43], v33, s[44:47], s25 offen offset:0 sc1
    s_barrier
    v_mfma_f32_16x16x32_bf16 v[20:23], a[64:67], a[56:59], v[20:23]
    ds_read_b128 a[64:67], v36 offset:32768
    s_waitcnt lgkmcnt(1)
    v_mfma_f32_16x16x32_bf16 v[28:31], a[72:75], a[56:59], v[28:31]
    s_add_u32 m0, s26, 16384
    s_add_u32 s24, s24, 8192
    buffer_load_dwordx4 v34, s[44:47], s24 offen offset:0 sc1 lds
    v_mfma_f32_16x16x32_bf16 v[28:31], a[76:79], a[60:63], v[28:31]
    ds_read_b128 a[68:71], v36 offset:33792
    v_mfma_f32_16x16x32_bf16 v[24:27], a[76:79], a[52:55], v[24:27]
    buffer_load_dwordx4 a[44:47], v33, s[44:47], s25 offen offset:1024 sc1
    v_mfma_f32_16x16x32_bf16 v[24:27], a[72:75], a[48:51], v[24:27]
    ds_read_b128 a[72:75], v36 offset:34816
    ds_read_b128 a[76:79], v36 offset:35840
    s_waitcnt vmcnt(16) lgkmcnt(2)
    v_mfma_f32_16x16x32_bf16 v[0:3], a[64:67], a[0:3], v[0:3]
    v_mfma_f32_16x16x32_bf16 v[0:3], a[68:71], a[4:7], v[0:3]
    v_mfma_f32_16x16x32_bf16 v[4:7], a[68:71], a[12:15], v[4:7]
    s_add_u32 s25, s25, 2048
    buffer_load_dwordx4 a[48:51], v32, s[44:47], s25 offen offset:0 sc1
    v_mfma_f32_16x16x32_bf16 v[4:7], a[64:67], a[8:11], v[4:7]
    buffer_load_dwordx4 v34, s[44:47], s24 offen offset:1024 sc1 lds
    s_waitcnt lgkmcnt(0)
    v_mfma_f32_16x16x32_bf16 v[12:15], a[72:75], a[8:11], v[12:15]
    ds_read_b128 a[64:67], v36 offset:36864
    v_mfma_f32_16x16x32_bf16 v[12:15], a[76:79], a[12:15], v[12:15]
    ds_read_b128 a[68:71], v36 offset:37888
    v_mfma_f32_16x16x32_bf16 v[8:11], a[76:79], a[4:7], v[8:11]
    buffer_load_dwordx4 a[52:55], v32, s[44:47], s25 offen offset:1024 sc1
    v_mfma_f32_16x16x32_bf16 v[8:11], a[72:75], a[0:3], v[8:11]
    ds_read_b128 a[72:75], v36 offset:38912
    s_waitcnt lgkmcnt(1)
    v_mfma_f32_16x16x32_bf16 v[16:19], a[64:67], a[0:3], v[16:19]
    s_waitcnt vmcnt(10)
    v_add_f32 v48, v48, v52
    v_add_f32 v49, v49, v53
    v_add_f32 v50, v50, v54
    v_mfma_f32_16x16x32_bf16 v[16:19], a[68:71], a[4:7], v[16:19]
    v_add_f32 v51, v51, v55
    v_add_f32 v56, v56, v60
    v_add_f32 v57, v57, v61
    ds_read_b128 a[76:79], v36 offset:39936
    v_mfma_f32_16x16x32_bf16 v[20:23], a[68:71], a[12:15], v[20:23]
    v_add_f32 v58, v58, v62
    v_add_f32 v59, v59, v63
    v_add_f32 v52, v49, v57
    buffer_load_dwordx4 a[56:59], v33, s[44:47], s25 offen offset:0 sc1
    s_barrier
    v_mfma_f32_16x16x32_bf16 v[20:23], a[64:67], a[8:11], v[20:23]
    v_add_f32 v60, v51, v59
    v_add_f32 v48, v48, v56
    v_add_f32 v56, v50, v58
    s_waitcnt lgkmcnt(0)
    v_mfma_f32_16x16x32_bf16 v[28:31], a[72:75], a[8:11], v[28:31]
    v_mov_b32 v49, v48
    v_mov_b32 v57, v56
    s_nop 1
    s_add_u32 m0, s26, 24576
    s_add_u32 s24, s24, 8192
    buffer_load_dwordx4 v34, s[44:47], s24 offen offset:0 sc1 lds
    v_mfma_f32_16x16x32_bf16 v[28:31], a[76:79], a[12:15], v[28:31]
    s_nop 1
    v_permlane32_swap_b32 v48, v49
    v_permlane32_swap_b32 v56, v57
    ds_read_b128 a[64:67], v36 offset:40960
    ds_read_b128 a[68:71], v36 offset:41984
    v_mfma_f32_16x16x32_bf16 v[24:27], a[76:79], a[4:7], v[24:27]
    v_add_f32 v48, v48, v49
    v_add_f32 v56, v56, v57
    v_mov_b32 v49, v48
    buffer_load_dwordx4 a[60:63], v33, s[44:47], s25 offen offset:1024 sc1
    v_mfma_f32_16x16x32_bf16 v[24:27], a[72:75], a[0:3], v[24:27]
    v_mov_b32 v57, v56
    s_nop 1
    s_nop 1
    ds_read_b128 a[72:75], v36 offset:43008
    ds_read_b128 a[76:79], v36 offset:44032
    s_waitcnt vmcnt(12) lgkmcnt(2)
    v_mfma_f32_16x16x32_bf16 v[0:3], a[64:67], a[16:19], v[0:3]
    v_permlane16_swap_b32 v48, v49
    v_permlane16_swap_b32 v56, v57
    v_add_f32 v48, v48, v49
    v_mfma_f32_16x16x32_bf16 v[0:3], a[68:71], a[20:23], v[0:3]
    v_add_f32 v56, v56, v57
    v_mul_f32 v48, 0xba800000, v48
    v_mul_f32 v56, 0xba800000, v56
    v_mfma_f32_16x16x32_bf16 v[4:7], a[68:71], a[28:31], v[4:7]
    v_mov_b32 v53, v52
    v_mov_b32 v61, v60
    s_nop 1
    s_add_u32 s25, s25, 2048
    buffer_load_dwordx4 a[0:3], v32, s[44:47], s25 offen offset:0 sc1
    v_mfma_f32_16x16x32_bf16 v[4:7], a[64:67], a[24:27], v[4:7]
    s_nop 1
    v_permlane32_swap_b32 v52, v53
    v_permlane32_swap_b32 v60, v61
    buffer_load_dwordx4 v34, s[44:47], s24 offen offset:1024 sc1 lds
    s_waitcnt lgkmcnt(0)
    v_mfma_f32_16x16x32_bf16 v[12:15], a[72:75], a[24:27], v[12:15]
    v_add_f32 v52, v52, v53
    v_add_f32 v60, v60, v61
    v_mov_b32 v53, v52
    v_mfma_f32_16x16x32_bf16 v[12:15], a[76:79], a[28:31], v[12:15]
    v_mov_b32 v61, v60
    s_nop 1
    s_nop 1
    ds_read_b128 a[64:67], v36 offset:45056
    ds_read_b128 a[68:71], v36 offset:46080
    v_mfma_f32_16x16x32_bf16 v[8:11], a[76:79], a[20:23], v[8:11]
    v_permlane16_swap_b32 v52, v53
    v_permlane16_swap_b32 v60, v61
    v_add_f32 v52, v52, v53
    buffer_load_dwordx4 a[4:7], v32, s[44:47], s25 offen offset:1024 sc1
    v_mfma_f32_16x16x32_bf16 v[8:11], a[72:75], a[16:19], v[8:11]
    v_add_f32 v60, v60, v61
    v_mul_f32 v52, 0x3a800000, v52
    v_mul_f32 v60, 0x3a800000, v60
    s_waitcnt lgkmcnt(0)
    v_mfma_f32_16x16x32_bf16 v[16:19], a[64:67], a[16:19], v[16:19]
    v_fma_f32 v52, -v48, v48, v52
    v_fma_f32 v60, -v56, v56, v60
    v_max_f32 v52, 0, v52
    v_mfma_f32_16x16x32_bf16 v[16:19], a[68:71], a[20:23], v[16:19]
    v_max_f32 v60, 0, v60
    v_cvt_pk_bf16_f32 v52, v52, v52
    v_cvt_pk_bf16_f32 v60, v60, v60
    ds_read_b128 a[72:75], v36 offset:47104
    ds_read_b128 a[76:79], v36 offset:48128
    v_mfma_f32_16x16x32_bf16 v[20:23], a[68:71], a[28:31], v[20:23]
    v_and_b32 v52, 0xffff0000, v52
    v_and_b32 v60, 0xffff0000, v60
    v_add_f32 v52, 0x3727c5ac, v52
    buffer_load_dwordx4 a[8:11], v33, s[44:47], s25 offen offset:0 sc1
    s_barrier
    v_mfma_f32_16x16x32_bf16 v[20:23], a[64:67], a[24:27], v[20:23]
    v_add_f32 v60, 0x3727c5ac, v60
    v_cvt_pk_bf16_f32 v52, v52, v52
    v_cvt_pk_bf16_f32 v60, v60, v60
    s_waitcnt lgkmcnt(0)
    v_mfma_f32_16x16x32_bf16 v[28:31], a[72:75], a[24:27], v[28:31]
    v_and_b32 v52, 0xffff0000, v52
    v_and_b32 v60, 0xffff0000, v60
    v_sqrt_f32 v52, v52
    s_add_u32 m0, s26, 32768
    s_add_u32 s24, s24, 8192
    buffer_load_dwordx4 v34, s[44:47], s24 offen offset:0 sc1 lds
    v_mfma_f32_16x16x32_bf16 v[28:31], a[76:79], a[28:31], v[28:31]
    v_sqrt_f32 v60, v60
    s_nop 0
    s_nop 0
    ds_read_b128 a[64:67], v36 offset:49152
    ds_read_b128 a[68:71], v36 offset:50176
    v_mfma_f32_16x16x32_bf16 v[24:27], a[76:79], a[20:23], v[24:27]
    v_cvt_pk_bf16_f32 v52, v52, v52
    v_cvt_pk_bf16_f32 v60, v60, v60
    v_and_b32 v52, 0xffff0000, v52
    buffer_load_dwordx4 a[12:15], v33, s[44:47], s25 offen offset:1024 sc1
    v_mfma_f32_16x16x32_bf16 v[24:27], a[72:75], a[16:19], v[24:27]
    v_and_b32 v60, 0xffff0000, v60
    v_mul_f32 v50, v52, v52
    v_mul_f32 v58, v60, v60
    ds_read_b128 a[72:75], v36 offset:51200
    ds_read_b128 a[76:79], v36 offset:52224
    s_waitcnt vmcnt(12) lgkmcnt(2)
    v_mfma_f32_16x16x32_bf16 v[0:3], a[64:67], a[32:35], v[0:3]
    v_rcp_f32 v52, v52
    v_rcp_f32 v60, v60
    s_nop 0
    v_mfma_f32_16x16x32_bf16 v[0:3], a[68:71], a[36:39], v[0:3]
    s_nop 0
    v_mul_f32 v52, v52, v52
    v_mul_f32 v60, v60, v60
    v_mfma_f32_16x16x32_bf16 v[4:7], a[68:71], a[44:47], v[4:7]
    s_add_u32 s25, s25, 2048
    buffer_load_dwordx4 a[16:19], v32, s[44:47], s25 offen offset:0 sc1
    v_mfma_f32_16x16x32_bf16 v[4:7], a[64:67], a[40:43], v[4:7]
    buffer_load_dwordx4 v34, s[44:47], s24 offen offset:1024 sc1 lds
    s_waitcnt lgkmcnt(0)
    v_mfma_f32_16x16x32_bf16 v[12:15], a[72:75], a[40:43], v[12:15]
    ds_read_b128 a[64:67], v36 offset:53248
    v_mfma_f32_16x16x32_bf16 v[12:15], a[76:79], a[44:47], v[12:15]
    ds_read_b128 a[68:71], v36 offset:54272
    v_mfma_f32_16x16x32_bf16 v[8:11], a[76:79], a[36:39], v[8:11]
    buffer_load_dwordx4 a[20:23], v32, s[44:47], s25 offen offset:1024 sc1
    v_mfma_f32_16x16x32_bf16 v[8:11], a[72:75], a[32:35], v[8:11]
    ds_read_b128 a[72:75], v36 offset:55296
    s_waitcnt lgkmcnt(1)
    v_mfma_f32_16x16x32_bf16 v[16:19], a[64:67], a[32:35], v[16:19]
    v_lshlrev_b32 v80, 16, v64
    v_and_b32 v81, 0xffff0000, v64
    v_lshlrev_b32 v82, 16, v65
    v_and_b32 v83, 0xffff0000, v65
    v_mfma_f32_16x16x32_bf16 v[16:19], a[68:71], a[36:39], v[16:19]
    v_fmac_f32 v0, v80, v50
    v_fmac_f32 v1, v81, v50
    v_fmac_f32 v2, v82, v50
    v_fmac_f32 v3, v83, v50
    ds_read_b128 a[76:79], v36 offset:56320
    v_mfma_f32_16x16x32_bf16 v[20:23], a[68:71], a[44:47], v[20:23]
    v_lshlrev_b32 v84, 16, v72
    v_and_b32 v85, 0xffff0000, v72
    v_lshlrev_b32 v86, 16, v73
    v_and_b32 v87, 0xffff0000, v73
    buffer_load_dwordx4 a[24:27], v33, s[44:47], s25 offen offset:0 sc1
    s_barrier
    v_mfma_f32_16x16x32_bf16 v[20:23], a[64:67], a[40:43], v[20:23]
    v_fmac_f32 v4, v84, v58
    v_fmac_f32 v5, v85, v58
    v_fmac_f32 v6, v86, v58
    v_fmac_f32 v7, v87, v58
    s_waitcnt lgkmcnt(0)
    v_mfma_f32_16x16x32_bf16 v[28:31], a[72:75], a[40:43], v[28:31]
    v_lshlrev_b32 v84, 16, v74
    v_and_b32 v85, 0xffff0000, v74
    v_lshlrev_b32 v86, 16, v75
    v_and_b32 v87, 0xffff0000, v75
    s_add_u32 m0, s26, 40960
    s_add_u32 s24, s24, 8192
    buffer_load_dwordx4 v34, s[44:47], s24 offen offset:0 sc1 lds
    v_mfma_f32_16x16x32_bf16 v[28:31], a[76:79], a[44:47], v[28:31]
    v_fmac_f32 v12, v84, v58
    v_fmac_f32 v13, v85, v58
    v_fmac_f32 v14, v86, v58
    v_fmac_f32 v15, v87, v58
    ds_read_b128 a[64:67], v36 offset:57344
    ds_read_b128 a[68:71], v36 offset:58368
    v_mfma_f32_16x16x32_bf16 v[24:27], a[76:79], a[36:39], v[24:27]
    v_lshlrev_b32 v80, 16, v66
    v_and_b32 v81, 0xffff0000, v66
    v_lshlrev_b32 v82, 16, v67
    v_and_b32 v83, 0xffff0000, v67
    buffer_load_dwordx4 a[28:31], v33, s[44:47], s25 offen offset:1024 sc1
    v_mfma_f32_16x16x32_bf16 v[24:27], a[72:75], a[32:35], v[24:27]
    v_fmac_f32 v8, v80, v50
    v_fmac_f32 v9, v81, v50
    v_fmac_f32 v10, v82, v50
    v_fmac_f32 v11, v83, v50
    ds_read_b128 a[72:75], v36 offset:59392
    ds_read_b128 a[76:79], v36 offset:60416
    s_waitcnt vmcnt(12) lgkmcnt(2)
    v_mfma_f32_16x16x32_bf16 v[0:3], a[64:67], a[48:51], v[0:3]
    v_lshlrev_b32 v80, 16, v68
    v_and_b32 v81, 0xffff0000, v68
    v_lshlrev_b32 v82, 16, v69
    v_and_b32 v83, 0xffff0000, v69
    v_mfma_f32_16x16x32_bf16 v[0:3], a[68:71], a[52:55], v[0:3]
    v_fmac_f32 v16, v80, v50
    v_fmac_f32 v17, v81, v50
    v_fmac_f32 v18, v82, v50
    v_fmac_f32 v19, v83, v50
    v_mfma_f32_16x16x32_bf16 v[4:7], a[68:71], a[60:63], v[4:7]
    v_lshlrev_b32 v84, 16, v76
    v_and_b32 v85, 0xffff0000, v76
    v_lshlrev_b32 v86, 16, v77
    v_and_b32 v87, 0xffff0000, v77
    s_add_u32 s25, s25, 2048
    buffer_load_dwordx4 a[32:35], v32, s[44:47], s25 offen offset:0 sc1
    v_mfma_f32_16x16x32_bf16 v[4:7], a[64:67], a[56:59], v[4:7]
    v_fmac_f32 v20, v84, v58
    v_fmac_f32 v21, v85, v58
    v_fmac_f32 v22, v86, v58
    v_fmac_f32 v23, v87, v58
    buffer_load_dwordx4 v34, s[44:47], s24 offen offset:1024 sc1 lds
    s_waitcnt lgkmcnt(0)
    v_mfma_f32_16x16x32_bf16 v[12:15], a[72:75], a[56:59], v[12:15]
    v_lshlrev_b32 v84, 16, v78
    v_and_b32 v85, 0xffff0000, v78
    v_lshlrev_b32 v86, 16, v79
    v_and_b32 v87, 0xffff0000, v79
    v_mfma_f32_16x16x32_bf16 v[12:15], a[76:79], a[60:63], v[12:15]
    v_fmac_f32 v28, v84, v58
    v_fmac_f32 v29, v85, v58
    v_fmac_f32 v30, v86, v58
    v_fmac_f32 v31, v87, v58
    ds_read_b128 a[64:67], v36 offset:61440
    ds_read_b128 a[68:71], v36 offset:62464
    v_mfma_f32_16x16x32_bf16 v[8:11], a[76:79], a[52:55], v[8:11]
    v_lshlrev_b32 v80, 16, v70
    v_and_b32 v81, 0xffff0000, v70
    v_lshlrev_b32 v82, 16, v71
    v_and_b32 v83, 0xffff0000, v71
    buffer_load_dwordx4 a[36:39], v32, s[44:47], s25 offen offset:1024 sc1
    v_mfma_f32_16x16x32_bf16 v[8:11], a[72:75], a[48:51], v[8:11]
    v_fmac_f32 v24, v80, v50
    v_fmac_f32 v25, v81, v50
    v_fmac_f32 v26, v82, v50
    v_fmac_f32 v27, v83, v50
    s_waitcnt lgkmcnt(0)
    v_mfma_f32_16x16x32_bf16 v[16:19], a[64:67], a[48:51], v[16:19]
    ds_read_b128 a[72:75], v36 offset:63488
    v_mfma_f32_16x16x32_bf16 v[16:19], a[68:71], a[52:55], v[16:19]
    ds_read_b128 a[76:79], v36 offset:64512
    v_mfma_f32_16x16x32_bf16 v[20:23], a[68:71], a[60:63], v[20:23]
    buffer_load_dwordx4 a[40:43], v33, s[44:47], s25 offen offset:0 sc1
    s_barrier
    v_mfma_f32_16x16x32_bf16 v[20:23], a[64:67], a[56:59], v[20:23]
    ds_read_b128 a[64:67], v36 offset:0
    s_waitcnt lgkmcnt(1)
    v_mfma_f32_16x16x32_bf16 v[28:31], a[72:75], a[56:59], v[28:31]
    s_add_u32 m0, s26, 49152
    s_add_u32 s24, s24, 8192
    buffer_load_dwordx4 v34, s[44:47], s24 offen offset:0 sc1 lds
    v_mfma_f32_16x16x32_bf16 v[28:31], a[76:79], a[60:63], v[28:31]
    ds_read_b128 a[68:71], v36 offset:1024
    v_mfma_f32_16x16x32_bf16 v[24:27], a[76:79], a[52:55], v[24:27]
    buffer_load_dwordx4 a[44:47], v33, s[44:47], s25 offen offset:1024 sc1
    v_mfma_f32_16x16x32_bf16 v[24:27], a[72:75], a[48:51], v[24:27]
    ds_read_b128 a[72:75], v36 offset:2048
    ds_read_b128 a[76:79], v36 offset:3072
    s_mov_b32 s27, 5
L_d1:
    s_waitcnt vmcnt(12) lgkmcnt(2)
    v_mfma_f32_16x16x32_bf16 v[0:3], a[64:67], a[0:3], v[0:3]
    v_mfma_f32_16x16x32_bf16 v[0:3], a[68:71], a[4:7], v[0:3]
    v_mfma_f32_16x16x32_bf16 v[4:7], a[68:71], a[12:15], v[4:7]
    s_add_u32 s25, s25, 2048
    buffer_load_dwordx4 a[48:51], v32, s[44:47], s25 offen offset:0 sc1
    v_mfma_f32_16x16x32_bf16 v[4:7], a[64:67], a[8:11], v[4:7]
    buffer_load_dwordx4 v34, s[44:47], s24 offen offset:1024 sc1 lds
    s_waitcnt lgkmcnt(0)
    v_mfma_f32_16x16x32_bf16 v[12:15], a[72:75], a[8:11], v[12:15]
    ds_read_b128 a[64:67], v36 offset:4096
    v_mfma_f32_16x16x32_bf16 v[12:15], a[76:79], a[12:15], v[12:15]
    ds_read_b128 a[68:71], v36 offset:5120
    v_mfma_f32_16x16x32_bf16 v[8:11], a[76:79], a[4:7], v[8:11]
    buffer_load_dwordx4 a[52:55], v32, s[44:47], s25 offen offset:1024 sc1
    v_mfma_f32_16x16x32_bf16 v[8:11], a[72:75], a[0:3], v[8:11]
    ds_read_b128 a[72:75], v36 offset:6144
    s_waitcnt lgkmcnt(1)
    v_mfma_f32_16x16x32_bf16 v[16:19], a[64:67], a[0:3], v[16:19]
    ds_read_b128 a[76:79], v36 offset:7168
    v_mfma_f32_16x16x32_bf16 v[16:19], a[68:71], a[4:7], v[16:19]
    v_mfma_f32_16x16x32_bf16 v[20:23], a[68:71], a[12:15], v[20:23]
    buffer_load_dwordx4 a[56:59], v33, s[44:47], s25 offen offset:0 sc1
    s_barrier
    v_mfma_f32_16x16x32_bf16 v[20:23], a[64:67], a[8:11], v[20:23]
    ds_read_b128 a[64:67], v36 offset:8192
    s_waitcnt lgkmcnt(1)
    v_mfma_f32_16x16x32_bf16 v[28:31], a[72:75], a[8:11], v[28:31]
    s_add_u32 m0, s26, 57344
    s_add_u32 s24, s24, 8192
    buffer_load_dwordx4 v34, s[44:47], s24 offen offset:0 sc1 lds
    v_mfma_f32_16x16x32_bf16 v[28:31], a[76:79], a[12:15], v[28:31]
    ds_read_b128 a[68:71], v36 offset:9216
    v_mfma_f32_16x16x32_bf16 v[24:27], a[76:79], a[4:7], v[24:27]
    buffer_load_dwordx4 a[60:63], v33, s[44:47], s25 offen offset:1024 sc1
    v_mfma_f32_16x16x32_bf16 v[24:27], a[72:75], a[0:3], v[24:27]
    ds_read_b128 a[72:75], v36 offset:10240
    ds_read_b128 a[76:79], v36 offset:11264
    s_waitcnt vmcnt(12) lgkmcnt(2)
    v_mfma_f32_16x16x32_bf16 v[0:3], a[64:67], a[16:19], v[0:3]
    v_mfma_f32_16x16x32_bf16 v[0:3], a[68:71], a[20:23], v[0:3]
    v_mfma_f32_16x16x32_bf16 v[4:7], a[68:71], a[28:31], v[4:7]
    s_add_u32 s25, s25, 2048
    buffer_load_dwordx4 a[0:3], v32, s[44:47], s25 offen offset:0 sc1
    v_mfma_f32_16x16x32_bf16 v[4:7], a[64:67], a[24:27], v[4:7]
    buffer_load_dwordx4 v34, s[44:47], s24 offen offset:1024 sc1 lds
    s_waitcnt lgkmcnt(0)
    v_mfma_f32_16x16x32_bf16 v[12:15], a[72:75], a[24:27], v[12:15]
    ds_read_b128 a[64:67], v36 offset:12288
    v_mfma_f32_16x16x32_bf16 v[12:15], a[76:79], a[28:31], v[12:15]
    ds_read_b128 a[68:71], v36 offset:13312
    v_mfma_f32_16x16x32_bf16 v[8:11], a[76:79], a[20:23], v[8:11]
    buffer_load_dwordx4 a[4:7], v32, s[44:47], s25 offen offset:1024 sc1
    v_mfma_f32_16x16x32_bf16 v[8:11], a[72:75], a[16:19], v[8:11]
    ds_read_b128 a[72:75], v36 offset:14336
    s_waitcnt lgkmcnt(1)
    v_mfma_f32_16x16x32_bf16 v[16:19], a[64:67], a[16:19], v[16:19]
    ds_read_b128 a[76:79], v36 offset:15360
    v_mfma_f32_16x16x32_bf16 v[16:19], a[68:71], a[20:23], v[16:19]
    v_mfma_f32_16x16x32_bf16 v[20:23], a[68:71], a[28:31], v[20:23]
    buffer_load_dwordx4 a[8:11], v33, s[44:47], s25 offen offset:0 sc1
    s_barrier
    v_mfma_f32_16x16x32_bf16 v[20:23], a[64:67], a[24:27], v[20:23]
    ds_read_b128 a[64:67], v36 offset:16384
    s_waitcnt lgkmcnt(1)
    v_mfma_f32_16x16x32_bf16 v[28:31], a[72:75], a[24:27], v[28:31]
    s_add_u32 m0, s26, 0
    s_add_u32 s24, s24, 8192
    buffer_load_dwordx4 v34, s[44:47], s24 offen offset:0 sc1 lds
    v_mfma_f32_16x16x32_bf16 v[28:31], a[76:79], a[28:31], v[28:31]
    ds_read_b128 a[68:71], v36 offset:17408
    v_mfma_f32_16x16x32_bf16 v[24:27], a[76:79], a[20:23], v[24:27]
    buffer_load_dwordx4 a[12:15], v33, s[44:47], s25 offen offset:1024 sc1
    v_mfma_f32_16x16x32_bf16 v[24:27], a[72:75], a[16:19], v[24:27]
    ds_read_b128 a[72:75], v36 offset:18432
    ds_read_b128 a[76:79], v36 offset:19456
    s_waitcnt vmcnt(12) lgkmcnt(2)
    v_mfma_f32_16x16x32_bf16 v[0:3], a[64:67], a[32:35], v[0:3]
    v_mfma_f32_16x16x32_bf16 v[0:3], a[68:71], a[36:39], v[0:3]
    v_mfma_f32_16x16x32_bf16 v[4:7], a[68:71], a[44:47], v[4:7]
    s_add_u32 s25, s25, 2048
    buffer_load_dwordx4 a[16:19], v32, s[44:47], s25 offen offset:0 sc1
    v_mfma_f32_16x16x32_bf16 v[4:7], a[64:67], a[40:43], v[4:7]
    buffer_load_dwordx4 v34, s[44:47], s24 offen offset:1024 sc1 lds
    s_waitcnt lgkmcnt(0)
    v_mfma_f32_16x16x32_bf16 v[12:15], a[72:75], a[40:43], v[12:15]
    ds_read_b128 a[64:67], v36 offset:20480
    v_mfma_f32_16x16x32_bf16 v[12:15], a[76:79], a[44:47], v[12:15]
    ds_read_b128 a[68:71], v36 offset:21504
    v_mfma_f32_16x16x32_bf16 v[8:11], a[76:79], a[36:39], v[8:11]
    buffer_load_dwordx4 a[20:23], v32, s[44:47], s25 offen offset:1024 sc1
    v_mfma_f32_16x16x32_bf16 v[8:11], a[72:75], a[32:35], v[8:11]
    ds_read_b128 a[72:75], v36 offset:22528
    s_waitcnt lgkmcnt(1)
    v_mfma_f32_16x16x32_bf16 v[16:19], a[64:67], a[32:35], v[16:19]
    ds_read_b128 a[76:79], v36 offset:23552
    v_mfma_f32_16x16x32_bf16 v[16:19], a[68:71], a[36:39], v[16:19]
    v_mfma_f32_16x16x32_bf16 v[20:23], a[68:71], a[44:47], v[20:23]
    buffer_load_dwordx4 a[24:27], v33, s[44:47], s25 offen offset:0 sc1
    s_barrier
    v_mfma_f32_16x16x32_bf16 v[20:23], a[64:67], a[40:43], v[20:23]
    ds_read_b128 a[64:67], v36 offset:24576
    s_waitcnt lgkmcnt(1)
    v_mfma_f32_16x16x32_bf16 v[28:31], a[72:75], a[40:43], v[28:31]
    s_add_u32 m0, s26, 8192
    s_add_u32 s24, s24, 8192
    buffer_load_dwordx4 v34, s[44:47], s24 offen offset:0 sc1 lds
    v_mfma_f32_16x16x32_bf16 v[28:31], a[76:79], a[44:47], v[28:31]
    ds_read_b128 a[68:71], v36 offset:25600
    v_mfma_f32_16x16x32_bf16 v[24:27], a[76:79], a[36:39], v[24:27]
    buffer_load_dwordx4 a[28:31], v33, s[44:47], s25 offen offset:1024 sc1
    v_mfma_f32_16x16x32_bf16 v[24:27], a[72:75], a[32:35], v[24:27]
    ds_read_b128 a[72:75], v36 offset:26624
    ds_read_b128 a[76:79], v36 offset:27648
    s_waitcnt vmcnt(12) lgkmcnt(2)
    v_mfma_f32_16x16x32_bf16 v[0:3], a[64:67], a[48:51], v[0:3]
    v_mfma_f32_16x16x32_bf16 v[0:3], a[68:71], a[52:55], v[0:3]
    v_mfma_f32_16x16x32_bf16 v[4:7], a[68:71], a[60:63], v[4:7]
    s_add_u32 s25, s25, 2048
    buffer_load_dwordx4 a[32:35], v32, s[44:47], s25 offen offset:0 sc1
    v_mfma_f32_16x16x32_bf16 v[4:7], a[64:67], a[56:59], v[4:7]
    buffer_load_dwordx4 v34, s[44:47], s24 offen offset:1024 sc1 lds
    s_waitcnt lgkmcnt(0)
    v_mfma_f32_16x16x32_bf16 v[12:15], a[72:75], a[56:59], v[12:15]
    ds_read_b128 a[64:67], v36 offset:28672
    v_mfma_f32_16x16x32_bf16 v[12:15], a[76:79], a[60:63], v[12:15]
    ds_read_b128 a[68:71], v36 offset:29696
    v_mfma_f32_16x16x32_bf16 v[8:11], a[76:79], a[52:55], v[8:11]
    buffer_load_dwordx4 a[36:39], v32, s[44:47], s25 offen offset:1024 sc1
    v_mfma_f32_16x16x32_bf16 v[8:11], a[72:75], a[48:51], v[8:11]
    ds_read_b128 a[72:75], v36 offset:30720
    s_waitcnt lgkmcnt(1)
    v_mfma_f32_16x16x32_bf16 v[16:19], a[64:67], a[48:51], v[16:19]
    ds_read_b128 a[76:79], v36 offset:31744
    v_mfma_f32_16x16x32_bf16 v[16:19], a[68:71], a[52:55], v[16:19]
    v_mfma_f32_16x16x32_bf16 v[20:23], a[68:71], a[60:63], v[20:23]
    buffer_load_dwordx4 a[40:43], v33, s[44:47], s25 offen offset:0 sc1
    s_barrier
    v_mfma_f32_16x16x32_bf16 v[20:23], a[64:67], a[56:59], v[20:23]
    ds_read_b128 a[64:67], v36 offset:32768
    s_waitcnt lgkmcnt(1)
    v_mfma_f32_16x16x32_bf16 v[28:31], a[72:75], a[56:59], v[28:31]
    s_add_u32 m0, s26, 16384
    s_add_u32 s24, s24, 8192
    buffer_load_dwordx4 v34, s[44:47], s24 offen offset:0 sc1 lds
    v_mfma_f32_16x16x32_bf16 v[28:31], a[76:79], a[60:63], v[28:31]
    ds_read_b128 a[68:71], v36 offset:33792
    v_mfma_f32_16x16x32_bf16 v[24:27], a[76:79], a[52:55], v[24:27]
    buffer_load_dwordx4 a[44:47], v33, s[44:47], s25 offen offset:1024 sc1
    v_mfma_f32_16x16x32_bf16 v[24:27], a[72:75], a[48:51], v[24:27]
    ds_read_b128 a[72:75], v36 offset:34816
    ds_read_b128 a[76:79], v36 offset:35840
    s_waitcnt vmcnt(12) lgkmcnt(2)
    v_mfma_f32_16x16x32_bf16 v[0:3], a[64:67], a[0:3], v[0:3]
    v_mfma_f32_16x16x32_bf16 v[0:3], a[68:71], a[4:7], v[0:3]
    v_mfma_f32_16x16x32_bf16 v[4:7], a[68:71], a[12:15], v[4:7]
    s_add_u32 s25, s25, 2048
    buffer_load_dwordx4 a[48:51], v32, s[44:47], s25 offen offset:0 sc1
    v_mfma_f32_16x16x32_bf16 v[4:7], a[64:67], a[8:11], v[4:7]
    buffer_load_dwordx4 v34, s[44:47], s24 offen offset:1024 sc1 lds
    s_waitcnt lgkmcnt(0)
    v_mfma_f32_16x16x32_bf16 v[12:15], a[72:75], a[8:11], v[12:15]
    ds_read_b128 a[64:67], v36 offset:36864
    v_mfma_f32_16x16x32_bf16 v[12:15], a[76:79], a[12:15], v[12:15]
    ds_read_b128 a[68:71], v36 offset:37888
    v_mfma_f32_16x16x32_bf16 v[8:11], a[76:79], a[4:7], v[8:11]
    buffer_load_dwordx4 a[52:55], v32, s[44:47], s25 offen offset:1024 sc1
    v_mfma_f32_16x16x32_bf16 v[8:11], a[72:75], a[0:3], v[8:11]
    ds_read_b128 a[72:75], v36 offset:38912
    s_waitcnt lgkmcnt(1)
    v_mfma_f32_16x16x32_bf16 v[16:19], a[64:67], a[0:3], v[16:19]
    ds_read_b128 a[76:79], v36 offset:39936
    v_mfma_f32_16x16x32_bf16 v[16:19], a[68:71], a[4:7], v[16:19]
    v_mfma_f32_16x16x32_bf16 v[20:23], a[68:71], a[12:15], v[20:23]
    buffer_load_dwordx4 a[56:59], v33, s[44:47], s25 offen offset:0 sc1
    s_barrier
    v_mfma_f32_16x16x32_bf16 v[20:23], a[64:67], a[8:11], v[20:23]
    ds_read_b128 a[64:67], v36 offset:40960
    s_waitcnt lgkmcnt(1)
    v_mfma_f32_16x16x32_bf16 v[28:31], a[72:75], a[8:11], v[28:31]
    s_add_u32 m0, s26, 24576
    s_add_u32 s24, s24, 8192
    buffer_load_dwordx4 v34, s[44:47], s24 offen offset:0 sc1 lds
    v_mfma_f32_16x16x32_bf16 v[28:31], a[76:79], a[12:15], v[28:31]
    ds_read_b128 a[68:71], v36 offset:41984
    v_mfma_f32_16x16x32_bf16 v[24:27], a[76:79], a[4:7], v[24:27]
    buffer_load_dwordx4 a[60:63], v33, s[44:47], s25 offen offset:1024 sc1
    v_mfma_f32_16x16x32_bf16 v[24:27], a[72:75], a[0:3], v[24:27]
    ds_read_b128 a[72:75], v36 offset:43008
    ds_read_b128 a[76:79], v36 offset:44032
    s_waitcnt vmcnt(12) lgkmcnt(2)
    v_mfma_f32_16x16x32_bf16 v[0:3], a[64:67], a[16:19], v[0:3]
    v_mfma_f32_16x16x32_bf16 v[0:3], a[68:71], a[20:23], v[0:3]
    v_mfma_f32_16x16x32_bf16 v[4:7], a[68:71], a[28:31], v[4:7]
    s_add_u32 s25, s25, 2048
    buffer_load_dwordx4 a[0:3], v32, s[44:47], s25 offen offset:0 sc1
    v_mfma_f32_16x16x32_bf16 v[4:7], a[64:67], a[24:27], v[4:7]
    buffer_load_dwordx4 v34, s[44:47], s24 offen offset:1024 sc1 lds
    s_waitcnt lgkmcnt(0)
    v_mfma_f32_16x16x32_bf16 v[12:15], a[72:75], a[24:27], v[12:15]
    ds_read_b128 a[64:67], v36 offset:45056
    v_mfma_f32_16x16x32_bf16 v[12:15], a[76:79], a[28:31], v[12:15]
    ds_read_b128 a[68:71], v36 offset:46080
    v_mfma_f32_16x16x32_bf16 v[8:11], a[76:79], a[20:23], v[8:11]
    buffer_load_dwordx4 a[4:7], v32, s[44:47], s25 offen offset:1024 sc1
    v_mfma_f32_16x16x32_bf16 v[8:11], a[72:75], a[16:19], v[8:11]
    ds_read_b128 a[72:75], v36 offset:47104
    s_waitcnt lgkmcnt(1)
    v_mfma_f32_16x16x32_bf16 v[16:19], a[64:67], a[16:19], v[16:19]
    ds_read_b128 a[76:79], v36 offset:48128
    v_mfma_f32_16x16x32_bf16 v[16:19], a[68:71], a[20:23], v[16:19]
    v_mfma_f32_16x16x32_bf16 v[20:23], a[68:71], a[28:31], v[20:23]
    buffer_load_dwordx4 a[8:11], v33, s[44:47], s25 offen offset:0 sc1
    s_barrier
    v_mfma_f32_16x16x32_bf16 v[20:23], a[64:67], a[24:27], v[20:23]
    ds_read_b128 a[64:67], v36 offset:49152
    s_waitcnt lgkmcnt(1)
    v_mfma_f32_16x16x32_bf16 v[28:31], a[72:75], a[24:27], v[28:31]
    s_add_u32 m0, s26, 32768
    s_add_u32 s24, s24, 8192
    buffer_load_dwordx4 v34, s[44:47], s24 offen offset:0 sc1 lds
    v_mfma_f32_16x16x32_bf16 v[28:31], a[76:79], a[28:31], v[28:31]
    ds_read_b128 a[68:71], v36 offset:50176
    v_mfma_f32_16x16x32_bf16 v[24:27], a[76:79], a[20:23], v[24:27]
    buffer_load_dwordx4 a[12:15], v33, s[44:47], s25 offen offset:1024 sc1
    v_mfma_f32_16x16x32_bf16 v[24:27], a[72:75], a[16:19], v[24:27]
    ds_read_b128 a[72:75], v36 offset:51200
    ds_read_b128 a[76:79], v36 offset:52224
    s_waitcnt vmcnt(12) lgkmcnt(2)
    v_mfma_f32_16x16x32_bf16 v[0:3], a[64:67], a[32:35], v[0:3]
    v_mfma_f32_16x16x32_bf16 v[0:3], a[68:71], a[36:39], v[0:3]
    v_mfma_f32_16x16x32_bf16 v[4:7], a[68:71], a[44:47], v[4:7]
    s_add_u32 s25, s25, 2048
    buffer_load_dwordx4 a[16:19], v32, s[44:47], s25 offen offset:0 sc1
    v_mfma_f32_16x16x32_bf16 v[4:7], a[64:67], a[40:43], v[4:7]
    buffer_load_dwordx4 v34, s[44:47], s24 offen offset:1024 sc1 lds
    s_waitcnt lgkmcnt(0)
    v_mfma_f32_16x16x32_bf16 v[12:15], a[72:75], a[40:43], v[12:15]
    ds_read_b128 a[64:67], v36 offset:53248
    v_mfma_f32_16x16x32_bf16 v[12:15], a[76:79], a[44:47], v[12:15]
    ds_read_b128 a[68:71], v36 offset:54272
    v_mfma_f32_16x16x32_bf16 v[8:11], a[76:79], a[36:39], v[8:11]
    buffer_load_dwordx4 a[20:23], v32, s[44:47], s25 offen offset:1024 sc1
    v_mfma_f32_16x16x32_bf16 v[8:11], a[72:75], a[32:35], v[8:11]
    ds_read_b128 a[72:75], v36 offset:55296
    s_waitcnt lgkmcnt(1)
    v_mfma_f32_16x16x32_bf16 v[16:19], a[64:67], a[32:35], v[16:19]
    ds_read_b128 a[76:79], v36 offset:56320
    v_mfma_f32_16x16x32_bf16 v[16:19], a[68:71], a[36:39], v[16:19]
    v_mfma_f32_16x16x32_bf16 v[20:23], a[68:71], a[44:47], v[20:23]
    buffer_load_dwordx4 a[24:27], v33, s[44:47], s25 offen offset:0 sc1
    s_barrier
    v_mfma_f32_16x16x32_bf16 v[20:23], a[64:67], a[40:43], v[20:23]
    ds_read_b128 a[64:67], v36 offset:57344
    s_waitcnt lgkmcnt(1)
    v_mfma_f32_16x16x32_bf16 v[28:31], a[72:75], a[40:43], v[28:31]
    s_add_u32 m0, s26, 40960
    s_add_u32 s24, s24, 8192
    buffer_load_dwordx4 v34, s[44:47], s24 offen offset:0 sc1 lds
    v_mfma_f32_16x16x32_bf16 v[28:31], a[76:79], a[44:47], v[28:31]
    ds_read_b128 a[68:71], v36 offset:58368
    v_mfma_f32_16x16x32_bf16 v[24:27], a[76:79], a[36:39], v[24:27]
    buffer_load_dwordx4 a[28:31], v33, s[44:47], s25 offen offset:1024 sc1
    v_mfma_f32_16x16x32_bf16 v[24:27], a[72:75], a[32:35], v[24:27]
    ds_read_b128 a[72:75], v36 offset:59392
    ds_read_b128 a[76:79], v36 offset:60416
    s_waitcnt vmcnt(12) lgkmcnt(2)
    v_mfma_f32_16x16x32_bf16 v[0:3], a[64:67], a[48:51], v[0:3]
    v_mfma_f32_16x16x32_bf16 v[0:3], a[68:71], a[52:55], v[0:3]
    v_mfma_f32_16x16x32_bf16 v[4:7], a[68:71], a[60:63], v[4:7]
    s_add_u32 s25, s25, 2048
    buffer_load_dwordx4 a[32:35], v32, s[44:47], s25 offen offset:0 sc1
    v_mfma_f32_16x16x32_bf16 v[4:7], a[64:67], a[56:59], v[4:7]
    buffer_load_dwordx4 v34, s[44:47], s24 offen offset:1024 sc1 lds
    s_waitcnt lgkmcnt(0)
    v_mfma_f32_16x16x32_bf16 v[12:15], a[72:75], a[56:59], v[12:15]
    ds_read_b128 a[64:67], v36 offset:61440
    v_mfma_f32_16x16x32_bf16 v[12:15], a[76:79], a[60:63], v[12:15]
    ds_read_b128 a[68:71], v36 offset:62464
    v_mfma_f32_16x16x32_bf16 v[8:11], a[76:79], a[52:55], v[8:11]
    buffer_load_dwordx4 a[36:39], v32, s[44:47], s25 offen offset:1024 sc1
    v_mfma_f32_16x16x32_bf16 v[8:11], a[72:75], a[48:51], v[8:11]
    ds_read_b128 a[72:75], v36 offset:63488
    s_waitcnt lgkmcnt(1)
    v_mfma_f32_16x16x32_bf16 v[16:19], a[64:67], a[48:51], v[16:19]
    ds_read_b128 a[76:79], v36 offset:64512
    v_mfma_f32_16x16x32_bf16 v[16:19], a[68:71], a[52:55], v[16:19]
    v_mfma_f32_16x16x32_bf16 v[20:23], a[68:71], a[60:63], v[20:23]
    buffer_load_dwordx4 a[40:43], v33, s[44:47], s25 offen offset:0 sc1
    s_barrier
    v_mfma_f32_16x16x32_bf16 v[20:23], a[64:67], a[56:59], v[20:23]
    ds_read_b128 a[64:67], v36 offset:0
    s_waitcnt lgkmcnt(1)
    v_mfma_f32_16x16x32_bf16 v[28:31], a[72:75], a[56:59], v[28:31]
    s_add_u32 m0, s26, 49152
    s_add_u32 s24, s24, 8192
    buffer_load_dwordx4 v34, s[44:47], s24 offen offset:0 sc1 lds
    v_mfma_f32_16x16x32_bf16 v[28:31], a[76:79], a[60:63], v[28:31]
    ds_read_b128 a[68:71], v36 offset:1024
    v_mfma_f32_16x16x32_bf16 v[24:27], a[76:79], a[52:55], v[24:27]
    buffer_load_dwordx4 a[44:47], v33, s[44:47], s25 offen offset:1024 sc1
    v_mfma_f32_16x16x32_bf16 v[24:27], a[72:75], a[48:51], v[24:27]
    ds_read_b128 a[72:75], v36 offset:2048
    ds_read_b128 a[76:79], v36 offset:3072
    s_sub_u32 s27, s27, 1
    s_cmp_lg_u32 s27, 0
    s_cbranch_scc1 L_d1
    s_waitcnt vmcnt(12) lgkmcnt(2)
    v_mfma_f32_16x16x32_bf16 v[0:3], a[64:67], a[0:3], v[0:3]
    v_mfma_f32_16x16x32_bf16 v[0:3], a[68:71], a[4:7], v[0:3]
    v_mfma_f32_16x16x32_bf16 v[4:7], a[68:71], a[12:15], v[4:7]
    s_add_u32 s25, s25, 2048
    buffer_load_dwordx4 a[48:51], v32, s[44:47], s25 offen offset:0 sc1
    v_mfma_f32_16x16x32_bf16 v[4:7], a[64:67], a[8:11], v[4:7]
    buffer_load_dwordx4 v34, s[44:47], s24 offen offset:1024 sc1 lds
    s_waitcnt lgkmcnt(0)
    v_mfma_f32_16x16x32_bf16 v[12:15], a[72:75], a[8:11], v[12:15]
    ds_read_b128 a[64:67], v36 offset:4096
    v_mfma_f32_16x16x32_bf16 v[12:15], a[76:79], a[12:15], v[12:15]
    ds_read_b128 a[68:71], v36 offset:5120
    v_mfma_f32_16x16x32_bf16 v[8:11], a[76:79], a[4:7], v[8:11]
    buffer_load_dwordx4 a[52:55], v32, s[44:47], s25 offen offset:1024 sc1
    v_mfma_f32_16x16x32_bf16 v[8:11], a[72:75], a[0:3], v[8:11]
    ds_read_b128 a[72:75], v36 offset:6144
    s_waitcnt lgkmcnt(1)
    v_mfma_f32_16x16x32_bf16 v[16:19], a[64:67], a[0:3], v[16:19]
    ds_read_b128 a[76:79], v36 offset:7168
    v_mfma_f32_16x16x32_bf16 v[16:19], a[68:71], a[4:7], v[16:19]
    v_mfma_f32_16x16x32_bf16 v[20:23], a[68:71], a[12:15], v[20:23]
    buffer_load_dwordx4 a[56:59], v33, s[44:47], s25 offen offset:0 sc1
    s_barrier
    v_mfma_f32_16x16x32_bf16 v[20:23], a[64:67], a[8:11], v[20:23]
    ds_read_b128 a[64:67], v36 offset:8192
    s_waitcnt lgkmcnt(1)
    v_mfma_f32_16x16x32_bf16 v[28:31], a[72:75], a[8:11], v[28:31]
    s_add_u32 m0, s26, 57344
    s_add_u32 s24, s24, 8192
    buffer_load_dwordx4 v34, s[44:47], s24 offen offset:0 sc1 lds
    v_mfma_f32_16x16x32_bf16 v[28:31], a[76:79], a[12:15], v[28:31]
    ds_read_b128 a[68:71], v36 offset:9216
    v_mfma_f32_16x16x32_bf16 v[24:27], a[76:79], a[4:7], v[24:27]
    buffer_load_dwordx4 a[60:63], v33, s[44:47], s25 offen offset:1024 sc1
    v_mfma_f32_16x16x32_bf16 v[24:27], a[72:75], a[0:3], v[24:27]
    ds_read_b128 a[72:75], v36 offset:10240
    ds_read_b128 a[76:79], v36 offset:11264
    s_waitcnt vmcnt(12) lgkmcnt(2)
    v_mfma_f32_16x16x32_bf16 v[0:3], a[64:67], a[16:19], v[0:3]
    v_mfma_f32_16x16x32_bf16 v[0:3], a[68:71], a[20:23], v[0:3]
    v_mfma_f32_16x16x32_bf16 v[4:7], a[68:71], a[28:31], v[4:7]
    s_add_u32 s25, s25, 2048
    buffer_load_dwordx4 a[0:3], v32, s[44:47], s25 offen offset:0 sc1
    v_mfma_f32_16x16x32_bf16 v[4:7], a[64:67], a[24:27], v[4:7]
    buffer_load_dwordx4 v34, s[44:47], s24 offen offset:1024 sc1 lds
    s_waitcnt lgkmcnt(0)
    v_mfma_f32_16x16x32_bf16 v[12:15], a[72:75], a[24:27], v[12:15]
    ds_read_b128 a[64:67], v36 offset:12288
    v_mfma_f32_16x16x32_bf16 v[12:15], a[76:79], a[28:31], v[12:15]
    ds_read_b128 a[68:71], v36 offset:13312
    v_mfma_f32_16x16x32_bf16 v[8:11], a[76:79], a[20:23], v[8:11]
    buffer_load_dwordx4 a[4:7], v32, s[44:47], s25 offen offset:1024 sc1
    v_mfma_f32_16x16x32_bf16 v[8:11], a[72:75], a[16:19], v[8:11]
    ds_read_b128 a[72:75], v36 offset:14336
    s_waitcnt lgkmcnt(1)
    v_mfma_f32_16x16x32_bf16 v[16:19], a[64:67], a[16:19], v[16:19]
    ds_read_b128 a[76:79], v36 offset:15360
    v_mfma_f32_16x16x32_bf16 v[16:19], a[68:71], a[20:23], v[16:19]
    v_mfma_f32_16x16x32_bf16 v[20:23], a[68:71], a[28:31], v[20:23]
    buffer_load_dwordx4 a[8:11], v33, s[44:47], s25 offen offset:0 sc1
    s_barrier
    v_mfma_f32_16x16x32_bf16 v[20:23], a[64:67], a[24:27], v[20:23]
    ds_read_b128 a[64:67], v36 offset:16384
    s_waitcnt lgkmcnt(1)
    v_mfma_f32_16x16x32_bf16 v[28:31], a[72:75], a[24:27], v[28:31]
    ds_read_b128 a[68:71], v36 offset:17408
    v_mfma_f32_16x16x32_bf16 v[28:31], a[76:79], a[28:31], v[28:31]
    v_mfma_f32_16x16x32_bf16 v[24:27], a[76:79], a[20:23], v[24:27]
    buffer_load_dwordx4 a[12:15], v33, s[44:47], s25 offen offset:1024 sc1
    v_mfma_f32_16x16x32_bf16 v[24:27], a[72:75], a[16:19], v[24:27]
    ds_read_b128 a[72:75], v36 offset:18432
    ds_read_b128 a[76:79], v36 offset:19456
    s_waitcnt vmcnt(11) lgkmcnt(2)
    v_mfma_f32_16x16x32_bf16 v[0:3], a[64:67], a[32:35], v[0:3]
    v_mfma_f32_16x16x32_bf16 v[0:3], a[68:71], a[36:39], v[0:3]
    v_mfma_f32_16x16x32_bf16 v[4:7], a[68:71], a[44:47], v[4:7]
    s_add_u32 s25, s25, 2048
    buffer_load_dwordx4 a[16:19], v32, s[44:47], s25 offen offset:0 sc1
    v_mfma_f32_16x16x32_bf16 v[4:7], a[64:67], a[40:43], v[4:7]
    ds_read_b128 a[64:67], v36 offset:20480
    s_waitcnt lgkmcnt(1)
    v_mfma_f32_16x16x32_bf16 v[12:15], a[72:75], a[40:43], v[12:15]
    ds_read_b128 a[68:71], v36 offset:21504
    v_mfma_f32_16x16x32_bf16 v[12:15], a[76:79], a[44:47], v[12:15]
    v_mfma_f32_16x16x32_bf16 v[8:11], a[76:79], a[36:39], v[8:11]
    buffer_load_dwordx4 a[20:23], v32, s[44:47], s25 offen offset:1024 sc1
    v_mfma_f32_16x16x32_bf16 v[8:11], a[72:75], a[32:35], v[8:11]
    ds_read_b128 a[72:75], v36 offset:22528
    s_waitcnt lgkmcnt(1)
    v_mfma_f32_16x16x32_bf16 v[16:19], a[64:67], a[32:35], v[16:19]
    ds_read_b128 a[76:79], v36 offset:23552
    v_mfma_f32_16x16x32_bf16 v[16:19], a[68:71], a[36:39], v[16:19]
    v_mfma_f32_16x16x32_bf16 v[20:23], a[68:71], a[44:47], v[20:23]
    buffer_load_dwordx4 a[24:27], v33, s[44:47], s25 offen offset:0 sc1
    s_barrier
    v_mfma_f32_16x16x32_bf16 v[20:23], a[64:67], a[40:43], v[20:23]
    ds_read_b128 a[64:67], v36 offset:24576
    s_waitcnt lgkmcnt(1)
    v_mfma_f32_16x16x32_bf16 v[28:31], a[72:75], a[40:43], v[28:31]
    ds_read_b128 a[68:71], v36 offset:25600
    v_mfma_f32_16x16x32_bf16 v[28:31], a[76:79], a[44:47], v[28:31]
    v_mfma_f32_16x16x32_bf16 v[24:27], a[76:79], a[36:39], v[24:27]
    buffer_load_dwordx4 a[28:31], v33, s[44:47], s25 offen offset:1024 sc1
    v_mfma_f32_16x16x32_bf16 v[24:27], a[72:75], a[32:35], v[24:27]
    ds_read_b128 a[72:75], v36 offset:26624
    ds_read_b128 a[76:79], v36 offset:27648
    s_waitcnt vmcnt(9) lgkmcnt(2)
    v_mfma_f32_16x16x32_bf16 v[0:3], a[64:67], a[48:51], v[0:3]
    v_mfma_f32_16x16x32_bf16 v[0:3], a[68:71], a[52:55], v[0:3]
    v_mfma_f32_16x16x32_bf16 v[4:7], a[68:71], a[60:63], v[4:7]
    s_add_u32 s25, s25, 2048
    buffer_load_dwordx4 a[32:35], v32, s[44:47], s25 offen offset:0 sc1
    v_mfma_f32_16x16x32_bf16 v[4:7], a[64:67], a[56:59], v[4:7]
    ds_read_b128 a[64:67], v36 offset:28672
    s_waitcnt lgkmcnt(1)
    v_mfma_f32_16x16x32_bf16 v[12:15], a[72:75], a[56:59], v[12:15]
    ds_read_b128 a[68:71], v36 offset:29696
    v_mfma_f32_16x16x32_bf16 v[12:15], a[76:79], a[60:63], v[12:15]
    v_mfma_f32_16x16x32_bf16 v[8:11], a[76:79], a[52:55], v[8:11]
    buffer_load_dwordx4 a[36:39], v32, s[44:47], s25 offen offset:1024 sc1
    v_mfma_f32_16x16x32_bf16 v[8:11], a[72:75], a[48:51], v[8:11]
    ds_read_b128 a[72:75], v36 offset:30720
    s_waitcnt lgkmcnt(1)
    v_mfma_f32_16x16x32_bf16 v[16:19], a[64:67], a[48:51], v[16:19]
    ds_read_b128 a[76:79], v36 offset:31744
    v_mfma_f32_16x16x32_bf16 v[16:19], a[68:71], a[52:55], v[16:19]
    v_mfma_f32_16x16x32_bf16 v[20:23], a[68:71], a[60:63], v[20:23]
    buffer_load_dwordx4 a[40:43], v33, s[44:47], s25 offen offset:0 sc1
    s_barrier
    v_mfma_f32_16x16x32_bf16 v[20:23], a[64:67], a[56:59], v[20:23]
    ds_read_b128 a[64:67], v36 offset:32768
    s_waitcnt lgkmcnt(1)
    v_mfma_f32_16x16x32_bf16 v[28:31], a[72:75], a[56:59], v[28:31]
    ds_read_b128 a[68:71], v36 offset:33792
    v_mfma_f32_16x16x32_bf16 v[28:31], a[76:79], a[60:63], v[28:31]
    v_mfma_f32_16x16x32_bf16 v[24:27], a[76:79], a[52:55], v[24:27]
    buffer_load_dwordx4 a[44:47], v33, s[44:47], s25 offen offset:1024 sc1
    v_mfma_f32_16x16x32_bf16 v[24:27], a[72:75], a[48:51], v[24:27]
    ds_read_b128 a[72:75], v36 offset:34816
    ds_read_b128 a[76:79], v36 offset:35840
    s_waitcnt vmcnt(8) lgkmcnt(2)
    v_mfma_f32_16x16x32_bf16 v[0:3], a[64:67], a[0:3], v[0:3]
    v_mfma_f32_16x16x32_bf16 v[0:3], a[68:71], a[4:7], v[0:3]
    v_mfma_f32_16x16x32_bf16 v[4:7], a[68:71], a[12:15], v[4:7]
    s_add_u32 s25, s25, 2048
    buffer_load_dwordx4 a[48:51], v32, s[44:47], s25 offen offset:0 sc1
    v_mfma_f32_16x16x32_bf16 v[4:7], a[64:67], a[8:11], v[4:7]
    ds_read_b128 a[64:67], v36 offset:36864
    s_waitcnt lgkmcnt(1)
    v_mfma_f32_16x16x32_bf16 v[12:15], a[72:75], a[8:11], v[12:15]
    ds_read_b128 a[68:71], v36 offset:37888
    v_mfma_f32_16x16x32_bf16 v[12:15], a[76:79], a[12:15], v[12:15]
    v_mfma_f32_16x16x32_bf16 v[8:11], a[76:79], a[4:7], v[8:11]
    buffer_load_dwordx4 a[52:55], v32, s[44:47], s25 offen offset:1024 sc1
    v_mfma_f32_16x16x32_bf16 v[8:11], a[72:75], a[0:3], v[8:11]
    ds_read_b128 a[72:75], v36 offset:38912
    s_waitcnt lgkmcnt(1)
    v_mfma_f32_16x16x32_bf16 v[16:19], a[64:67], a[0:3], v[16:19]
    ds_read_b128 a[76:79], v36 offset:39936
    v_mfma_f32_16x16x32_bf16 v[16:19], a[68:71], a[4:7], v[16:19]
    v_mfma_f32_16x16x32_bf16 v[20:23], a[68:71], a[12:15], v[20:23]
    buffer_load_dwordx4 a[56:59], v33, s[44:47], s25 offen offset:0 sc1
    s_barrier
    v_mfma_f32_16x16x32_bf16 v[20:23], a[64:67], a[8:11], v[20:23]
    ds_read_b128 a[64:67], v36 offset:40960
    s_waitcnt lgkmcnt(1)
    v_mfma_f32_16x16x32_bf16 v[28:31], a[72:75], a[8:11], v[28:31]
    ds_read_b128 a[68:71], v36 offset:41984
    v_mfma_f32_16x16x32_bf16 v[28:31], a[76:79], a[12:15], v[28:31]
    v_mfma_f32_16x16x32_bf16 v[24:27], a[76:79], a[4:7], v[24:27]
    buffer_load_dwordx4 a[60:63], v33, s[44:47], s25 offen offset:1024 sc1
    v_mfma_f32_16x16x32_bf16 v[24:27], a[72:75], a[0:3], v[24:27]
    ds_read_b128 a[72:75], v36 offset:43008
    ds_read_b128 a[76:79], v36 offset:44032
    s_waitcnt vmcnt(8) lgkmcnt(2)
    v_mfma_f32_16x16x32_bf16 v[0:3], a[64:67], a[16:19], v[0:3]
    v_mfma_f32_16x16x32_bf16 v[0:3], a[68:71], a[20:23], v[0:3]
    v_mfma_f32_16x16x32_bf16 v[4:7], a[68:71], a[28:31], v[4:7]
    v_mfma_f32_16x16x32_bf16 v[4:7], a[64:67], a[24:27], v[4:7]
    ds_read_b128 a[64:67], v36 offset:45056
    s_waitcnt lgkmcnt(1)
    v_mfma_f32_16x16x32_bf16 v[12:15], a[72:75], a[24:27], v[12:15]
    ds_read_b128 a[68:71], v36 offset:46080
    v_mfma_f32_16x16x32_bf16 v[12:15], a[76:79], a[28:31], v[12:15]
    v_mfma_f32_16x16x32_bf16 v[8:11], a[76:79], a[20:23], v[8:11]
    v_mfma_f32_16x16x32_bf16 v[8:11], a[72:75], a[16:19], v[8:11]
    ds_read_b128 a[72:75], v36 offset:47104
    s_waitcnt lgkmcnt(1)
    v_mfma_f32_16x16x32_bf16 v[16:19], a[64:67], a[16:19], v[16:19]
    ds_read_b128 a[76:79], v36 offset:48128
    v_mfma_f32_16x16x32_bf16 v[16:19], a[68:71], a[20:23], v[16:19]
    v_mfma_f32_16x16x32_bf16 v[20:23], a[68:71], a[28:31], v[20:23]
    s_barrier
    v_mfma_f32_16x16x32_bf16 v[20:23], a[64:67], a[24:27], v[20:23]
    ds_read_b128 a[64:67], v36 offset:49152
    s_waitcnt lgkmcnt(1)
    v_mfma_f32_16x16x32_bf16 v[28:31], a[72:75], a[24:27], v[28:31]
    ds_read_b128 a[68:71], v36 offset:50176
    v_mfma_f32_16x16x32_bf16 v[28:31], a[76:79], a[28:31], v[28:31]
    v_mfma_f32_16x16x32_bf16 v[24:27], a[76:79], a[20:23], v[24:27]
    v_mfma_f32_16x16x32_bf16 v[24:27], a[72:75], a[16:19], v[24:27]
    ds_read_b128 a[72:75], v36 offset:51200
    ds_read_b128 a[76:79], v36 offset:52224
    s_waitcnt vmcnt(4) lgkmcnt(2)
    v_mfma_f32_16x16x32_bf16 v[0:3], a[64:67], a[32:35], v[0:3]
    v_mfma_f32_16x16x32_bf16 v[0:3], a[68:71], a[36:39], v[0:3]
    v_mfma_f32_16x16x32_bf16 v[4:7], a[68:71], a[44:47], v[4:7]
    v_mfma_f32_16x16x32_bf16 v[4:7], a[64:67], a[40:43], v[4:7]
    ds_read_b128 a[64:67], v36 offset:53248
    s_waitcnt lgkmcnt(1)
    v_mfma_f32_16x16x32_bf16 v[12:15], a[72:75], a[40:43], v[12:15]
    ds_read_b128 a[68:71], v36 offset:54272
    v_mfma_f32_16x16x32_bf16 v[12:15], a[76:79], a[44:47], v[12:15]
    v_mfma_f32_16x16x32_bf16 v[8:11], a[76:79], a[36:39], v[8:11]
    v_mfma_f32_16x16x32_bf16 v[8:11], a[72:75], a[32:35], v[8:11]
    ds_read_b128 a[72:75], v36 offset:55296
    s_waitcnt lgkmcnt(1)
    v_mfma_f32_16x16x32_bf16 v[16:19], a[64:67], a[32:35], v[16:19]
    ds_read_b128 a[76:79], v36 offset:56320
    v_mfma_f32_16x16x32_bf16 v[16:19], a[68:71], a[36:39], v[16:19]
    v_mfma_f32_16x16x32_bf16 v[20:23], a[68:71], a[44:47], v[20:23]
    s_barrier
    v_mfma_f32_16x16x32_bf16 v[20:23], a[64:67], a[40:43], v[20:23]
    ds_read_b128 a[64:67], v36 offset:57344
    s_waitcnt lgkmcnt(1)
    v_mfma_f32_16x16x32_bf16 v[28:31], a[72:75], a[40:43], v[28:31]
    ds_read_b128 a[68:71], v36 offset:58368
    v_mfma_f32_16x16x32_bf16 v[28:31], a[76:79], a[44:47], v[28:31]
    v_mfma_f32_16x16x32_bf16 v[24:27], a[76:79], a[36:39], v[24:27]
    v_mfma_f32_16x16x32_bf16 v[24:27], a[72:75], a[32:35], v[24:27]
    ds_read_b128 a[72:75], v36 offset:59392
    ds_read_b128 a[76:79], v36 offset:60416
    s_waitcnt vmcnt(0) lgkmcnt(2)
    v_mfma_f32_16x16x32_bf16 v[0:3], a[64:67], a[48:51], v[0:3]
    v_mfma_f32_16x16x32_bf16 v[0:3], a[68:71], a[52:55], v[0:3]
    v_mfma_f32_16x16x32_bf16 v[4:7], a[68:71], a[60:63], v[4:7]
    v_mfma_f32_16x16x32_bf16 v[4:7], a[64:67], a[56:59], v[4:7]
    ds_read_b128 a[64:67], v36 offset:61440
    s_waitcnt lgkmcnt(1)
    v_mfma_f32_16x16x32_bf16 v[12:15], a[72:75], a[56:59], v[12:15]
    ds_read_b128 a[68:71], v36 offset:62464
    v_mfma_f32_16x16x32_bf16 v[12:15], a[76:79], a[60:63], v[12:15]
    v_mfma_f32_16x16x32_bf16 v[8:11], a[76:79], a[52:55], v[8:11]
    v_mfma_f32_16x16x32_bf16 v[8:11], a[72:75], a[48:51], v[8:11]
    ds_read_b128 a[72:75], v36 offset:63488
    s_waitcnt lgkmcnt(1)
    v_mfma_f32_16x16x32_bf16 v[16:19], a[64:67], a[48:51], v[16:19]
    ds_read_b128 a[76:79], v36 offset:64512
    v_mfma_f32_16x16x32_bf16 v[16:19], a[68:71], a[52:55], v[16:19]
    v_mfma_f32_16x16x32_bf16 v[20:23], a[68:71], a[60:63], v[20:23]
    v_mfma_f32_16x16x32_bf16 v[20:23], a[64:67], a[56:59], v[20:23]
    s_waitcnt lgkmcnt(0)
    v_mfma_f32_16x16x32_bf16 v[28:31], a[72:75], a[56:59], v[28:31]
    v_mfma_f32_16x16x32_bf16 v[28:31], a[76:79], a[60:63], v[28:31]
    v_mfma_f32_16x16x32_bf16 v[24:27], a[76:79], a[52:55], v[24:27]
    v_mfma_f32_16x16x32_bf16 v[24:27], a[72:75], a[48:51], v[24:27]
    s_nop 7
    v_mov_b32 v88, 0
    v_mov_b32 v89, 0
    v_mul_f32 v0, v0, v52
    v_mul_f32 v1, v1, v52
    v_mul_f32 v2, v2, v52
    v_mul_f32 v3, v3, v52
    v_mul_f32 v8, v8, v52
    v_mul_f32 v9, v9, v52
    v_mul_f32 v10, v10, v52
    v_mul_f32 v11, v11, v52
    v_cvt_pk_bf16_f32 v64, v0, v1
    v_cvt_pk_bf16_f32 v65, v2, v3
    v_cvt_pk_bf16_f32 v66, v8, v9
    v_cvt_pk_bf16_f32 v67, v10, v11
    s_nop 1
    v_permlane16_swap_b32 v64, v66
    v_permlane16_swap_b32 v65, v67
    buffer_store_dwordx4 v[64:67], v47, s[56:59], s50 offen offset:0
    v_mul_f32 v16, v16, v52
    v_mul_f32 v17, v17, v52
    v_mul_f32 v18, v18, v52
    v_mul_f32 v19, v19, v52
    v_mul_f32 v24, v24, v52
    v_mul_f32 v25, v25, v52
    v_mul_f32 v26, v26, v52
    v_mul_f32 v27, v27, v52
    v_cvt_pk_bf16_f32 v68, v16, v17
    v_cvt_pk_bf16_f32 v69, v18, v19
    v_cvt_pk_bf16_f32 v70, v24, v25
    v_cvt_pk_bf16_f32 v71, v26, v27
    s_nop 1
    v_permlane16_swap_b32 v68, v70
    v_permlane16_swap_b32 v69, v71
    buffer_store_dwordx4 v[68:71], v47, s[56:59], s50 offen offset:64
    v_mov_b32 v90, 0
    v_mov_b32 v91, 0
    v_mul_f32 v4, v4, v60
    v_mul_f32 v5, v5, v60
    v_mul_f32 v6, v6, v60
    v_mul_f32 v7, v7, v60
    v_mul_f32 v12, v12, v60
    v_mul_f32 v13, v13, v60
    v_mul_f32 v14, v14, v60
    v_mul_f32 v15, v15, v60
    v_cvt_pk_bf16_f32 v72, v4, v5
    v_cvt_pk_bf16_f32 v73, v6, v7
    v_cvt_pk_bf16_f32 v74, v12, v13
    v_cvt_pk_bf16_f32 v75, v14, v15
    s_nop 1
    v_permlane16_swap_b32 v72, v74
    v_permlane16_swap_b32 v73, v75
    buffer_store_dwordx4 v[72:75], v47, s[56:59], s51 offen offset:0
    v_mul_f32 v20, v20, v60
    v_mul_f32 v21, v21, v60
    v_mul_f32 v22, v22, v60
    v_mul_f32 v23, v23, v60
    v_mul_f32 v28, v28, v60
    v_mul_f32 v29, v29, v60
    v_mul_f32 v30, v30, v60
    v_mul_f32 v31, v31, v60
    v_cvt_pk_bf16_f32 v76, v20, v21
    v_cvt_pk_bf16_f32 v77, v22, v23
    v_cvt_pk_bf16_f32 v78, v28, v29
    v_cvt_pk_bf16_f32 v79, v30, v31
    s_nop 1
    v_permlane16_swap_b32 v76, v78
    v_permlane16_swap_b32 v77, v79
    buffer_store_dwordx4 v[76:79], v47, s[56:59], s51 offen offset:64
END_PH_d1:
    s_endpgm

END_interleave_layers__linear_attn_block__glu_gated_bilinear__prompt_kernel:
.section .rodata,"a"
.p2align 6
.amdhsa_kernel interleave_layers__linear_attn_block__glu_gated_bilinear__prompt_kernel
  .amdhsa_next_free_vgpr 512
  .amdhsa_next_free_sgpr 102
  .amdhsa_accum_offset 256
  .amdhsa_group_segment_fixed_size 0
  .amdhsa_kernarg_size 80
  .amdhsa_user_sgpr_count 2
  .amdhsa_user_sgpr_kernarg_segment_ptr 1
  .amdhsa_system_sgpr_workgroup_id_x 1

.end_amdhsa_kernel
```
